```python
import torch

def _softmax(x, axis=-1):
    return torch.softmax(x, dim=axis)
def _gelu(x):
    return torch.nn.functional.gelu(x, approximate="tanh")
def _silu(x):
    return torch.nn.functional.silu(x)
def _sigmoid(x):
    return torch.sigmoid(x)
def _layernorm(x, axis=-1, eps=1e-5):
    m = x.mean(dim=axis, keepdim=True)
    v = x.var(dim=axis, keepdim=True, unbiased=False)
    return (x - m) / torch.sqrt(v + eps)
def _scatter_add(tgt, idx, src, axis=0):
    return tgt.clone().index_add_(axis, idx, src)
def _segment_sum(src, seg, n):
    out = torch.zeros((n,) + src.shape[1:], dtype=src.dtype)
    return out.index_add_(0, seg, src)
def _pad(x, pw):
    flat = tuple(v for pair in reversed(pw) for v in pair)
    return torch.nn.functional.pad(x, flat)

kernel_name = 'parallel_sum__linear_attn_block__dense_activation_squared_relu__prompt'

def setup_inputs():

    _w = (lambda a: (lambda t: t.to(torch.bfloat16) if t.is_floating_point() else t)(torch.as_tensor(a)))
    def _A_setup():
        B, S, D = 1, 2048, 576
        return {
            "x": _w((lambda *s: torch.randn(*s, dtype=torch.bfloat16) * 0.05)(B, S, D)),
            "wqkv": _w((lambda *s: torch.randn(*s, dtype=torch.bfloat16) * 0.4)(D, 3 * D)),
            "wo": _w((lambda *s: torch.randn(*s, dtype=torch.bfloat16) * 0.4)(D, D)),
        }
    _A_in = _A_setup()

    def _B_setup():
        B, S, D, F = 1, 2048, 576, 4608
        return {
            "x": _w((lambda *s: torch.randn(*s, dtype=torch.bfloat16) * 0.05)(B, S, D)),
            "w1": _w((lambda *s: torch.randn(*s, dtype=torch.bfloat16) * 0.05)(D, F)),
            "b1": _w((lambda *s: torch.randn(*s, dtype=torch.bfloat16) * 0.2)(F)),
            "w2": _w((lambda *s: torch.randn(*s, dtype=torch.bfloat16) * 0.05)(F, D)),
            "b2": _w((lambda *s: torch.randn(*s, dtype=torch.bfloat16) * 1.6)(D)),
        }
    _B_in = _B_setup()

    return {
        "A_x": _A_in["x"],
        "A_wqkv": _A_in["wqkv"],
        "A_wo": _A_in["wo"],
        "B_x": _B_in["x"],
        "B_w1": _B_in["w1"],
        "B_b1": _B_in["b1"],
        "B_w2": _B_in["w2"],
        "B_b2": _B_in["b2"],
    }

def reference(A_x, A_wqkv, A_wo, B_x, B_w1, B_b1, B_w2, B_b2):
    def _A_ref(x, wqkv, wo):
        B, S, D = x.shape
        H = 32; Dh = D // H
        qkv = (lambda x, *d: x.permute(*d))((x @ wqkv).reshape(B, S, 3, H, Dh), 2, 0, 3, 1, 4)
        q, k, v = qkv[0], qkv[1], qkv[2]
        phi = lambda t: torch.where(t > 0, t + 1, torch.exp(t)) + 1e-6
        pq, pk = phi(q), phi(k)
        kv = torch.einsum("bhsd,bhse->bhde", pk, v)
        z = torch.einsum("bhsd->bhd", pk)
        num = torch.einsum("bhqd,bhde->bhqe", pq, kv)
        den = torch.einsum("bhqd,bhd->bhq", pq, z)[..., None] + 1e-6
        o = num / den
        return (lambda x, *d: x.permute(*d))(o, 0, 2, 1, 3).reshape(B, S, D) @ wo

    def _B_ref(x, w1, b1, w2, b2):
        h = torch.einsum("bsd,df->bsf", x, w1) + b1
        zero = torch.zeros_like(h)
        r = torch.where(h > zero, h, zero)
        h = r * r
        out = torch.einsum("bsf,fd->bsd", h, w2) + b2
        return out

    x = A_x
    xn = _layernorm(x, axis=-1)
    return x + _A_ref(xn, A_wqkv, A_wo) + _B_ref(xn, B_w1, B_b1, B_w2, B_b2)
```

```asm
; @launch grid=(256,1,1) block=(256,1,1) lds=163840
.amdgcn_target "amdgcn-amd-amdhsa--gfx950"
.text
.globl parallel_sum__linear_attn_block__dense_activation_squared_relu__prompt_kernel
.p2align 12
.p2align 8
.type parallel_sum__linear_attn_block__dense_activation_squared_relu__prompt_kernel,@function
parallel_sum__linear_attn_block__dense_activation_squared_relu__prompt_kernel:
    s_cmp_ge_u32 s2, 256
    s_cbranch_scc1 L_exit
    s_load_dwordx2 s[8:9], s[0:1], 0
    s_getpc_b64 s[96:97]
L_pcref:
    s_lshr_b32 s68, s2, 3
    s_mul_i32 s68, s68, 3584
    v_lshrrev_b32 v22, 6, v0
    v_and_b32 v1, 63, v0
    v_min_u32 v24, 6, v1
    v_mad_u32_u24 v24, v22, 7, v24
    v_lshlrev_b32 v24, 7, v24
    v_add_u32 v24, s68, v24
    v_min_u32 v24, L_exit-L_pcref, v24
    global_load_dword a208, v24, s[96:97]
    v_readfirstlane_b32 s62, v22
    s_lshr_b32 s70, s2, 3
    s_sub_u32 s71, s70, 8
    s_mul_i32 s64, s71, 43
    s_lshr_b32 s64, s64, 7
    s_mul_i32 s65, s64, 3
    s_sub_u32 s65, s71, s65
    s_cmp_lt_u32 s70, 8
    s_cselect_b32 s64, s70, s64
    s_cselect_b32 s65, 3, s65
    s_and_b32 s68, s2, 4
    s_lshl_b32 s68, s68, 1
    s_add_u32 s64, s64, s68
    v_lshrrev_b32 v22, 3, v1
    v_and_b32 v23, 6, v22
    v_and_b32 v24, 7, v1
    v_xor_b32 v23, v23, v24
    v_lshlrev_b32 v23, 4, v23
    v_mul_u32_u24 v16, 1152, v22
    v_add_u32 v16, v16, v23
    v_add_u32 v25, 8176, v16
    s_mul_i32 s67, s62, 37440
    s_lshl_b32 s81, s64, 2
    s_add_u32 s81, s81, s62
    s_mul_i32 s69, s81, 36864
    v_add_u32 v234, 16352, v16
    v_add_u32 v235, 24528, v16
    s_cmp_eq_u32 s65, 3
    s_cselect_b32 s78, 0, s65
    s_mul_i32 s75, s78, 384
    s_add_u32 s75, s75, s69
    s_cmp_eq_u32 s78, 2
    s_mov_b32 s68, 384
    s_cselect_b32 s70, -768, s68
    s_add_u32 s76, s75, s70
    s_cmp_eq_u32 s78, 1
    s_cselect_b32 s70, -768, s68
    s_add_u32 s77, s76, s70
    s_mov_b32 s10, 0x240000
    s_mov_b32 s11, 0x20000
    s_waitcnt lgkmcnt(0)
    s_and_b32 s9, s9, 0xffff
    s_load_dwordx16 s[40:55], s[0:1], 0
    s_load_dwordx4 s[56:59], s[0:1], 64
    s_load_dwordx2 s[60:61], s[0:1], 80
    s_add_u32 m0, s67, 0
    s_add_u32 s72, s75, 0
    buffer_load_dwordx4 v16, s[8:11], s72 offen offset:0 lds
    buffer_load_dwordx4 v25, s[8:11], s72 offen offset:1040 lds
    buffer_load_dwordx4 v234, s[8:11], s72 offen offset:2080 lds
    buffer_load_dwordx4 v235, s[8:11], s72 offen offset:3120 lds
    s_add_u32 m0, s67, 4160
    s_add_u32 s72, s75, 128
    buffer_load_dwordx4 v16, s[8:11], s72 offen offset:0 lds
    buffer_load_dwordx4 v25, s[8:11], s72 offen offset:1040 lds
    buffer_load_dwordx4 v234, s[8:11], s72 offen offset:2080 lds
    buffer_load_dwordx4 v235, s[8:11], s72 offen offset:3120 lds
    s_add_u32 m0, s67, 8320
    s_add_u32 s72, s75, 256
    buffer_load_dwordx4 v16, s[8:11], s72 offen offset:0 lds
    buffer_load_dwordx4 v25, s[8:11], s72 offen offset:1040 lds
    buffer_load_dwordx4 v234, s[8:11], s72 offen offset:2080 lds
    buffer_load_dwordx4 v235, s[8:11], s72 offen offset:3120 lds
    s_and_b32 s63, s2, 3
    s_waitcnt lgkmcnt(0)
    s_mov_b32 s20, s60
    s_and_b32 s21, s61, 0xffff
    s_mov_b32 s22, 0x10000000
    s_mov_b32 s23, 0x20000
    s_mov_b32 s28, s50
    s_and_b32 s29, s51, 0xffff
    s_mov_b32 s30, 0x2400
    s_mov_b32 s31, 0x20000
    s_mul_i32 s96, s64, 1966080
    buffer_load_dword v21, off, s[20:23], s96 sc1
    s_mul_i32 s68, s63, 3
    s_add_u32 s68, s68, s65
    s_mul_i32 s88, s68, 768
    s_mov_b32 s16, s54
    s_and_b32 s17, s55, 0xffff
    s_mov_b32 s18, 0x480
    s_mov_b32 s19, 0x20000
    s_lshl_b32 s70, s65, 2
    s_add_u32 s70, s70, s63
    s_mul_i32 s70, s70, 96
    v_min_u32 v20, 23, v1
    v_lshlrev_b32 v20, 2, v20
    buffer_load_dword v19, v20, s[16:19], s70 offen
    s_lshl_b32 s70, s63, 8
    s_add_u32 s70, s70, 1152
    s_cmp_eq_u32 s65, 3
    s_cselect_b32 s7, s70, s88
    s_mov_b32 s70, 911
    s_cselect_b32 s4, 21846, s70
    s_mov_b32 s70, 4289659136
    s_cselect_b32 s5, 27264, s70
    s_mov_b32 s70, 73728
    s_cselect_b32 s6, 128, s70
    s_mov_b32 s70, 128
    s_cselect_b32 s26, 1152, s70
    s_mul_i32 s70, s62, 192
    s_add_u32 s71, s70, s88
    v_min_u32 v221, 47, v1
    v_lshlrev_b32 v26, 2, v221
    buffer_load_dword v220, v26, s[28:31], s71 offen
    v_lshlrev_b32 v221, 3, v221
    s_lshl_b32 s70, s70, 1
    s_mul_i32 s97, s64, 43
    s_lshr_b32 s97, s97, 8
    s_mul_i32 s97, s97, 6
    s_sub_u32 s97, s64, s97
    s_mul_i32 s97, s97, 0
    s_lshl_b32 s71, s97, 8
    s_sub_u32 s70, s70, s71
    v_add_u32 v221, s70, v221
    v_add_u32 v27, 1536, v221
    v_min_u32 v221, v221, v27
    v_add_u32 v221, 149760, v221
    v_bfe_u32 v26, v1, 3, 1
    v_mul_u32_u24 v26, 1040, v26
    v_and_b32 v27, 7, v1
    v_lshl_add_u32 v26, v27, 7, v26
    v_lshrrev_b32 v27, 4, v1
    v_lshl_add_u32 v26, v27, 3, v26
    v_add_u32 v26, s67, v26
    v_bfe_u32 v27, v1, 1, 2
    v_xor_b32 v28, 0, v27
    v_lshl_add_u32 v216, v28, 5, v26
    v_xor_b32 v28, 1, v27
    v_lshl_add_u32 v217, v28, 5, v26
    v_xor_b32 v28, 2, v27
    v_lshl_add_u32 v218, v28, 5, v26
    v_xor_b32 v28, 3, v27
    v_lshl_add_u32 v219, v28, 5, v26
    s_lshl_b32 s68, s65, 2
    s_add_u32 s68, s68, s63
    s_min_u32 s68, s68, 11
    s_mul_i32 s68, s68, 3
    s_add_u32 s70, s68, 0
    s_and_b32 s71, s70, 3
    s_lshr_b32 s70, s70, 2
    s_mul_i32 s82, s78, 3
    s_sub_u32 s70, s70, s82
    s_add_u32 s82, s70, 9
    s_min_u32 s70, s70, s82
    s_mul_i32 s70, s70, 4160
    v_xor_b32 v28, s71, v27
    v_lshl_add_u32 v28, v28, 5, v26
    v_add_u32 v29, s70, v28
    s_add_u32 s70, s68, 1
    s_and_b32 s71, s70, 3
    s_lshr_b32 s70, s70, 2
    s_mul_i32 s82, s78, 3
    s_sub_u32 s70, s70, s82
    s_add_u32 s82, s70, 9
    s_min_u32 s70, s70, s82
    s_mul_i32 s70, s70, 4160
    v_xor_b32 v28, s71, v27
    v_lshl_add_u32 v28, v28, 5, v26
    v_add_u32 v30, s70, v28
    s_add_u32 s70, s68, 2
    s_and_b32 s71, s70, 3
    s_lshr_b32 s70, s70, 2
    s_mul_i32 s82, s78, 3
    s_sub_u32 s70, s70, s82
    s_add_u32 s82, s70, 9
    s_min_u32 s70, s70, s82
    s_mul_i32 s70, s70, 4160
    v_xor_b32 v28, s71, v27
    v_lshl_add_u32 v28, v28, 5, v26
    v_add_u32 v31, s70, v28
    v_mov_b32 v224, 0x3f803f80
    v_mov_b32 v225, 0x3f803f80
    v_mov_b32 v226, 0x3f803f80
    v_mov_b32 v227, 0x3f803f80
    s_lshl_b32 s68, s63, 2
    s_add_u32 s68, s68, 4
    s_cmp_eq_u32 s65, 3
    s_cselect_b32 s68, 0, s68
    s_add_u32 s68, s68, s62
    s_mov_b64 exec, 0
    s_cmp_eq_u32 s68, 0
    s_cbranch_scc1 L_pad_a0_0
    s_cmp_eq_u32 s68, 1
    s_cbranch_scc1 L_pad_a1_0
    s_cmp_eq_u32 s68, 2
    s_cbranch_scc1 L_pad_a2_0
    s_cmp_eq_u32 s68, 3
    s_cbranch_scc1 L_pad_a3_0
    s_cmp_eq_u32 s62, 0
    s_cbranch_scc1 L_pad_m0_0
    s_cmp_eq_u32 s62, 1
    s_cbranch_scc1 L_pad_m1_0
    s_cmp_eq_u32 s62, 2
    s_cbranch_scc1 L_pad_m2_0
    s_cmp_eq_u32 s63, 0
    s_cbranch_scc1 L_pad_v0_0
    s_cmp_eq_u32 s63, 1
    s_cbranch_scc1 L_pad_v1_0
    s_cmp_eq_u32 s63, 2
    s_cbranch_scc1 L_pad_v2_0
    s_cmp_eq_u32 s63, 3
    s_cbranch_scc1 L_pad_v3_0
L_walk_ret:
    s_mov_b64 exec, -1
    s_nop 0
    s_add_u32 m0, s67, 12480
    s_add_u32 s72, s76, 0
    buffer_load_dwordx4 v16, s[8:11], s72 offen offset:0 lds
    buffer_load_dwordx4 v25, s[8:11], s72 offen offset:1040 lds
    buffer_load_dwordx4 v234, s[8:11], s72 offen offset:2080 lds
    buffer_load_dwordx4 v235, s[8:11], s72 offen offset:3120 lds
    s_mul_i32 s68, s62, 442368
    s_add_u32 s68, s68, s88
    s_add_u32 s79, s68, 768
    s_lshl_b32 s71, s97, 7
    s_add_u32 s68, s68, s71
    s_mul_i32 s70, s62, 55296
    s_lshl_b32 s71, s63, 8
    s_add_u32 s70, s70, s71
    s_add_u32 s70, s70, 1152
    s_cmp_eq_u32 s65, 3
    s_cselect_b32 s73, s70, s68
    s_cselect_b32 s12, s42, s48
    s_cselect_b32 s13, s43, s49
    s_mov_b32 s68, 5308416
    s_cselect_b32 s14, 1990656, s68
    s_mov_b32 s68, 1474560
    s_cselect_b32 s84, 220928, s68
    s_mov_b32 s68, 147456
    s_cselect_b32 s85, 128, s68
    s_mov_b32 s68, 9216
    s_cselect_b32 s68, 3456, s68
    s_cselect_b32 s3, s63, 0
    s_cselect_b32 s27, 0x3fb8aa3b, 1.0
    s_mov_b32 s70, 1769472
    s_cselect_b32 s84, 221184, s70
    s_mul_i32 s70, s84, s78
    s_add_u32 s73, s73, s70
    s_waitcnt vmcnt(15)
    ds_read_b64 v[32:33], v216 offset:0
    ds_read_b64 v[34:35], v217 offset:0
    ds_read_b64 v[36:37], v216 offset:2080
    ds_read_b64 v[38:39], v217 offset:2080
    ds_read_b64 v[40:41], v218 offset:0
    ds_read_b64 v[42:43], v219 offset:0
    ds_read_b64 v[44:45], v218 offset:2080
    ds_read_b64 v[46:47], v219 offset:2080
    s_waitcnt lgkmcnt(6)
    v_mfma_f32_16x16x32_bf16 v[180:183], v[32:35], v[32:35], 0
    s_add_u32 m0, s67, 16640
    v_mfma_f32_16x16x32_bf16 v[176:179], v[224:227], v[32:35], 0
    s_add_u32 s72, s76, 128
    s_waitcnt lgkmcnt(4)
    v_mfma_f32_16x16x32_bf16 v[200:203], v[36:39], v[36:39], 0
    buffer_load_dwordx4 v16, s[8:11], s72 offen offset:0 lds
    v_mfma_f32_16x16x32_bf16 v[196:199], v[224:227], v[36:39], 0
    buffer_load_dwordx4 v25, s[8:11], s72 offen offset:1040 lds
    s_waitcnt lgkmcnt(2)
    v_mfma_f32_16x16x32_bf16 v[180:183], v[40:43], v[40:43], v[180:183]
    buffer_load_dwordx4 v234, s[8:11], s72 offen offset:2080 lds
    v_mfma_f32_16x16x32_bf16 v[176:179], v[224:227], v[40:43], v[176:179]
    buffer_load_dwordx4 v235, s[8:11], s72 offen offset:3120 lds
    s_cmp_eq_u32 s78, 2
    s_cselect_b32 s70, -3538944, s84
    s_add_u32 s29, s73, s70
    s_cmp_eq_u32 s78, 1
    s_cselect_b32 s70, -3538944, s84
    s_add_u32 s30, s29, s70
    s_and_b32 s13, s13, 0xffff
    s_mov_b32 s15, 0x20000
    v_mul_u32_u24 v14, s68, v22
    v_add_u32 v14, v14, v23
    s_lshl_b32 s68, s68, 3
    s_sub_u32 s68, s68, 1024
    v_add_u32 v15, s68, v14
    v_add_u32 v17, 8192, v16
    s_waitcnt vmcnt(15) lgkmcnt(0)
    v_mfma_f32_16x16x32_bf16 v[200:203], v[44:47], v[44:47], v[200:203]
    ds_read_b64 v[48:49], v216 offset:4160
    ds_read_b64 v[50:51], v217 offset:4160
    ds_read_b64 v[52:53], v216 offset:6240
    ds_read_b64 v[54:55], v217 offset:6240
    v_mfma_f32_16x16x32_bf16 v[196:199], v[224:227], v[44:47], v[196:199]
    ds_read_b64 v[56:57], v218 offset:4160
    ds_read_b64 v[58:59], v219 offset:4160
    ds_read_b64 v[60:61], v218 offset:6240
    ds_read_b64 v[62:63], v219 offset:6240
    s_waitcnt lgkmcnt(6)
    v_mfma_f32_16x16x32_bf16 v[180:183], v[48:51], v[48:51], v[180:183]
    s_add_u32 m0, s67, 20800
    v_mfma_f32_16x16x32_bf16 v[176:179], v[224:227], v[48:51], v[176:179]
    s_add_u32 s72, s76, 256
    s_waitcnt lgkmcnt(4)
    v_mfma_f32_16x16x32_bf16 v[200:203], v[52:55], v[52:55], v[200:203]
    buffer_load_dwordx4 v16, s[8:11], s72 offen offset:0 lds
    v_mfma_f32_16x16x32_bf16 v[196:199], v[224:227], v[52:55], v[196:199]
    buffer_load_dwordx4 v25, s[8:11], s72 offen offset:1040 lds
    s_waitcnt lgkmcnt(2)
    v_mfma_f32_16x16x32_bf16 v[180:183], v[56:59], v[56:59], v[180:183]
    buffer_load_dwordx4 v234, s[8:11], s72 offen offset:2080 lds
    v_mfma_f32_16x16x32_bf16 v[176:179], v[224:227], v[56:59], v[176:179]
    buffer_load_dwordx4 v235, s[8:11], s72 offen offset:3120 lds
    v_lshlrev_b32 v18, 4, v1
    v_lshrrev_b32 v26, 2, v1
    v_lshlrev_b32 v26, 7, v26
    v_and_b32 v27, 3, v1
    v_lshl_add_u32 v26, v27, 3, v26
    v_bfe_u32 v27, v1, 3, 2
    s_add_u32 s68, s3, 0
    s_and_b32 s70, s68, 3
    s_lshr_b32 s68, s68, 2
    s_lshl_b32 s68, s68, 11
    v_xor_b32 v28, s70, v27
    v_lshl_add_u32 v28, v28, 5, v26
    s_waitcnt vmcnt(15) lgkmcnt(0)
    v_mfma_f32_16x16x32_bf16 v[200:203], v[60:63], v[60:63], v[200:203]
    ds_read_b64 v[64:65], v216 offset:8320
    ds_read_b64 v[66:67], v217 offset:8320
    ds_read_b64 v[68:69], v216 offset:10400
    ds_read_b64 v[70:71], v217 offset:10400
    v_mfma_f32_16x16x32_bf16 v[196:199], v[224:227], v[60:63], v[196:199]
    ds_read_b64 v[72:73], v218 offset:8320
    ds_read_b64 v[74:75], v219 offset:8320
    ds_read_b64 v[76:77], v218 offset:10400
    ds_read_b64 v[78:79], v219 offset:10400
    s_waitcnt lgkmcnt(6)
    v_mfma_f32_16x16x32_bf16 v[180:183], v[64:67], v[64:67], v[180:183]
    s_add_u32 m0, s67, 24960
    v_mfma_f32_16x16x32_bf16 v[176:179], v[224:227], v[64:67], v[176:179]
    s_add_u32 s72, s77, 0
    s_waitcnt lgkmcnt(4)
    v_mfma_f32_16x16x32_bf16 v[200:203], v[68:71], v[68:71], v[200:203]
    buffer_load_dwordx4 v16, s[8:11], s72 offen offset:0 lds
    v_mfma_f32_16x16x32_bf16 v[196:199], v[224:227], v[68:71], v[196:199]
    buffer_load_dwordx4 v25, s[8:11], s72 offen offset:1040 lds
    s_waitcnt lgkmcnt(2)
    v_mfma_f32_16x16x32_bf16 v[180:183], v[72:75], v[72:75], v[180:183]
    buffer_load_dwordx4 v234, s[8:11], s72 offen offset:2080 lds
    v_mfma_f32_16x16x32_bf16 v[176:179], v[224:227], v[72:75], v[176:179]
    buffer_load_dwordx4 v235, s[8:11], s72 offen offset:3120 lds
    v_add_u32 v2, s68, v28
    s_add_u32 s68, s3, 1
    s_and_b32 s70, s68, 3
    s_lshr_b32 s68, s68, 2
    s_lshl_b32 s68, s68, 11
    v_xor_b32 v28, s70, v27
    v_lshl_add_u32 v28, v28, 5, v26
    v_add_u32 v3, s68, v28
    s_add_u32 s68, s3, 2
    s_and_b32 s70, s68, 3
    s_lshr_b32 s68, s68, 2
    s_lshl_b32 s68, s68, 11
    s_waitcnt vmcnt(12) lgkmcnt(0)
    v_mfma_f32_16x16x32_bf16 v[200:203], v[76:79], v[76:79], v[200:203]
    ds_read_b64 v[80:81], v216 offset:12480
    ds_read_b64 v[82:83], v217 offset:12480
    ds_read_b64 v[84:85], v216 offset:14560
    ds_read_b64 v[86:87], v217 offset:14560
    v_mfma_f32_16x16x32_bf16 v[196:199], v[224:227], v[76:79], v[196:199]
    ds_read_b64 v[88:89], v218 offset:12480
    ds_read_b64 v[90:91], v219 offset:12480
    ds_read_b64 v[92:93], v218 offset:14560
    ds_read_b64 v[94:95], v219 offset:14560
    s_waitcnt lgkmcnt(6)
    v_mfma_f32_16x16x32_bf16 v[180:183], v[80:83], v[80:83], v[180:183]
    s_add_u32 m0, s67, 29120
    v_mfma_f32_16x16x32_bf16 v[176:179], v[224:227], v[80:83], v[176:179]
    s_add_u32 s72, s77, 128
    s_waitcnt lgkmcnt(4)
    v_mfma_f32_16x16x32_bf16 v[200:203], v[84:87], v[84:87], v[200:203]
    buffer_load_dwordx4 v16, s[8:11], s72 offen offset:0 lds
    v_mfma_f32_16x16x32_bf16 v[196:199], v[224:227], v[84:87], v[196:199]
    buffer_load_dwordx4 v25, s[8:11], s72 offen offset:1040 lds
    s_waitcnt lgkmcnt(2)
    v_mfma_f32_16x16x32_bf16 v[180:183], v[88:91], v[88:91], v[180:183]
    buffer_load_dwordx4 v234, s[8:11], s72 offen offset:2080 lds
    v_mfma_f32_16x16x32_bf16 v[176:179], v[224:227], v[88:91], v[176:179]
    buffer_load_dwordx4 v235, s[8:11], s72 offen offset:3120 lds
    v_xor_b32 v28, s70, v27
    v_lshl_add_u32 v28, v28, 5, v26
    v_add_u32 v4, s68, v28
    s_add_u32 s68, s3, 3
    s_and_b32 s70, s68, 3
    s_lshr_b32 s68, s68, 2
    s_lshl_b32 s68, s68, 11
    v_xor_b32 v28, s70, v27
    v_lshl_add_u32 v28, v28, 5, v26
    v_add_u32 v5, s68, v28
    v_add_u32 v6, 0x10000, v2
    v_add_u32 v7, 0x10000, v3
    s_waitcnt vmcnt(12) lgkmcnt(0)
    v_mfma_f32_16x16x32_bf16 v[200:203], v[92:95], v[92:95], v[200:203]
    ds_read_b64 v[96:97], v216 offset:16640
    ds_read_b64 v[98:99], v217 offset:16640
    ds_read_b64 v[100:101], v216 offset:18720
    ds_read_b64 v[102:103], v217 offset:18720
    v_mfma_f32_16x16x32_bf16 v[196:199], v[224:227], v[92:95], v[196:199]
    ds_read_b64 v[104:105], v218 offset:16640
    ds_read_b64 v[106:107], v219 offset:16640
    ds_read_b64 v[108:109], v218 offset:18720
    ds_read_b64 v[110:111], v219 offset:18720
    s_waitcnt lgkmcnt(6)
    v_mfma_f32_16x16x32_bf16 v[180:183], v[96:99], v[96:99], v[180:183]
    s_add_u32 m0, s67, 33280
    v_mfma_f32_16x16x32_bf16 v[176:179], v[224:227], v[96:99], v[176:179]
    s_add_u32 s72, s77, 256
    s_waitcnt lgkmcnt(4)
    v_mfma_f32_16x16x32_bf16 v[200:203], v[100:103], v[100:103], v[200:203]
    buffer_load_dwordx4 v16, s[8:11], s72 offen offset:0 lds
    v_mfma_f32_16x16x32_bf16 v[196:199], v[224:227], v[100:103], v[196:199]
    buffer_load_dwordx4 v25, s[8:11], s72 offen offset:1040 lds
    s_waitcnt lgkmcnt(2)
    v_mfma_f32_16x16x32_bf16 v[180:183], v[104:107], v[104:107], v[180:183]
    buffer_load_dwordx4 v234, s[8:11], s72 offen offset:2080 lds
    v_mfma_f32_16x16x32_bf16 v[176:179], v[224:227], v[104:107], v[176:179]
    buffer_load_dwordx4 v235, s[8:11], s72 offen offset:3120 lds
    v_add_u32 v8, 0x10000, v4
    v_add_u32 v9, 0x10000, v5
    v_add_u32 v10, 0x20000, v2
    v_add_u32 v11, 0x20000, v3
    v_add_u32 v12, 0x20000, v4
    v_add_u32 v13, 0x20000, v5
    v_mov_b32 v222, 1.0
    s_mov_b32 s32, 0x100001
    s_mov_b32 s33, 0x10000100
    s_mov_b32 s34, 0x200002
    s_mov_b32 s35, 0x20000200
    s_mov_b32 s36, 0x400004
    s_waitcnt vmcnt(12) lgkmcnt(0)
    v_mfma_f32_16x16x32_bf16 v[200:203], v[108:111], v[108:111], v[200:203]
    ds_read_b64 v[112:113], v216 offset:20800
    ds_read_b64 v[114:115], v217 offset:20800
    ds_read_b64 v[116:117], v216 offset:22880
    ds_read_b64 v[118:119], v217 offset:22880
    v_mfma_f32_16x16x32_bf16 v[196:199], v[224:227], v[108:111], v[196:199]
    ds_read_b64 v[120:121], v218 offset:20800
    ds_read_b64 v[122:123], v219 offset:20800
    ds_read_b64 v[124:125], v218 offset:22880
    ds_read_b64 v[126:127], v219 offset:22880
    s_waitcnt lgkmcnt(6)
    v_mfma_f32_16x16x32_bf16 v[180:183], v[112:115], v[112:115], v[180:183]
    v_mfma_f32_16x16x32_bf16 v[176:179], v[224:227], v[112:115], v[176:179]
    s_waitcnt lgkmcnt(4)
    v_mfma_f32_16x16x32_bf16 v[200:203], v[116:119], v[116:119], v[200:203]
    v_mfma_f32_16x16x32_bf16 v[196:199], v[224:227], v[116:119], v[196:199]
    s_waitcnt lgkmcnt(2)
    v_mfma_f32_16x16x32_bf16 v[180:183], v[120:123], v[120:123], v[180:183]
    v_mfma_f32_16x16x32_bf16 v[176:179], v[224:227], v[120:123], v[176:179]
    s_mov_b32 s37, 0x40000400
    s_mov_b32 s38, 0x800008
    s_mov_b32 s39, 0x80000800
    v_mov_b32 v228, 0
    v_mov_b32 v229, 0
    v_mov_b32 v232, 0
    v_mov_b32 v233, 0
    v_mov_b32 v26, 0x3f80
    v_cndmask_b32 v230, 0, v26, s[32:33]
    v_cndmask_b32 v230, v230, v222, s[34:35]
    v_cndmask_b32 v231, 0, v26, s[36:37]
    v_cndmask_b32 v231, v231, v222, s[38:39]
    s_waitcnt vmcnt(8) lgkmcnt(0)
    v_mfma_f32_16x16x32_bf16 v[200:203], v[124:127], v[124:127], v[200:203]
    ds_read_b64 v[128:129], v216 offset:24960
    ds_read_b64 v[130:131], v217 offset:24960
    ds_read_b64 v[132:133], v216 offset:27040
    ds_read_b64 v[134:135], v217 offset:27040
    v_mfma_f32_16x16x32_bf16 v[196:199], v[224:227], v[124:127], v[196:199]
    ds_read_b64 v[136:137], v218 offset:24960
    ds_read_b64 v[138:139], v219 offset:24960
    ds_read_b64 v[140:141], v218 offset:27040
    ds_read_b64 v[142:143], v219 offset:27040
    s_waitcnt lgkmcnt(6)
    v_mfma_f32_16x16x32_bf16 v[180:183], v[128:131], v[128:131], v[180:183]
    v_mfma_f32_16x16x32_bf16 v[176:179], v[224:227], v[128:131], v[176:179]
    s_waitcnt lgkmcnt(4)
    v_mfma_f32_16x16x32_bf16 v[200:203], v[132:135], v[132:135], v[200:203]
    v_mfma_f32_16x16x32_bf16 v[196:199], v[224:227], v[132:135], v[196:199]
    s_waitcnt lgkmcnt(2)
    v_mfma_f32_16x16x32_bf16 v[180:183], v[136:139], v[136:139], v[180:183]
    v_mfma_f32_16x16x32_bf16 v[176:179], v[224:227], v[136:139], v[176:179]
    s_waitcnt vmcnt(4) lgkmcnt(0)
    v_mfma_f32_16x16x32_bf16 v[200:203], v[140:143], v[140:143], v[200:203]
    ds_read_b64 v[144:145], v216 offset:29120
    ds_read_b64 v[146:147], v217 offset:29120
    ds_read_b64 v[148:149], v216 offset:31200
    ds_read_b64 v[150:151], v217 offset:31200
    v_mfma_f32_16x16x32_bf16 v[196:199], v[224:227], v[140:143], v[196:199]
    ds_read_b64 v[152:153], v218 offset:29120
    ds_read_b64 v[154:155], v219 offset:29120
    ds_read_b64 v[156:157], v218 offset:31200
    ds_read_b64 v[158:159], v219 offset:31200
    s_waitcnt lgkmcnt(6)
    v_mfma_f32_16x16x32_bf16 v[180:183], v[144:147], v[144:147], v[180:183]
    v_mfma_f32_16x16x32_bf16 v[176:179], v[224:227], v[144:147], v[176:179]
    s_waitcnt lgkmcnt(4)
    v_mfma_f32_16x16x32_bf16 v[200:203], v[148:151], v[148:151], v[200:203]
    v_mfma_f32_16x16x32_bf16 v[196:199], v[224:227], v[148:151], v[196:199]
    s_waitcnt lgkmcnt(2)
    v_mfma_f32_16x16x32_bf16 v[180:183], v[152:155], v[152:155], v[180:183]
    v_mfma_f32_16x16x32_bf16 v[176:179], v[224:227], v[152:155], v[176:179]
    s_waitcnt vmcnt(0) lgkmcnt(0)
    v_mfma_f32_16x16x32_bf16 v[200:203], v[156:159], v[156:159], v[200:203]
    ds_read_b64 v[160:161], v216 offset:33280
    ds_read_b64 v[162:163], v217 offset:33280
    ds_read_b64 v[164:165], v216 offset:35360
    ds_read_b64 v[166:167], v217 offset:35360
    v_mfma_f32_16x16x32_bf16 v[196:199], v[224:227], v[156:159], v[196:199]
    ds_read_b64 v[168:169], v218 offset:33280
    ds_read_b64 v[170:171], v219 offset:33280
    ds_read_b64 v[172:173], v218 offset:35360
    ds_read_b64 v[174:175], v219 offset:35360
    s_waitcnt lgkmcnt(6)
    v_mfma_f32_16x16x32_bf16 v[180:183], v[160:163], v[160:163], v[180:183]
    ds_read_b64 a[244:245], v29 offset:0
    v_mfma_f32_16x16x32_bf16 v[176:179], v[224:227], v[160:163], v[176:179]
    ds_read_b64 a[248:249], v30 offset:0
    s_waitcnt lgkmcnt(6)
    v_mfma_f32_16x16x32_bf16 v[200:203], v[164:167], v[164:167], v[200:203]
    ds_read_b64 a[252:253], v31 offset:0
    v_mfma_f32_16x16x32_bf16 v[196:199], v[224:227], v[164:167], v[196:199]
    ds_read_b64 a[246:247], v29 offset:2080
    s_waitcnt lgkmcnt(6)
    v_mfma_f32_16x16x32_bf16 v[180:183], v[168:171], v[168:171], v[180:183]
    ds_read_b64 a[250:251], v30 offset:2080
    v_mfma_f32_16x16x32_bf16 v[176:179], v[224:227], v[168:171], v[176:179]
    ds_read_b64 a[254:255], v31 offset:2080
    s_waitcnt lgkmcnt(6)
    v_mfma_f32_16x16x32_bf16 v[200:203], v[172:175], v[172:175], v[200:203]
    v_mfma_f32_16x16x32_bf16 v[196:199], v[224:227], v[172:175], v[196:199]
    s_nop 1
    v_cndmask_b32 v192, 0, v180, s[32:33]
    s_nop 3
    v_cndmask_b32 v212, 0, v200, s[32:33]
    s_waitcnt lgkmcnt(0)
    v_cndmask_b32 v192, v192, v181, s[34:35]
    v_cndmask_b32 v212, v212, v201, s[34:35]
    v_cndmask_b32 v192, v192, v182, s[36:37]
    v_cndmask_b32 v212, v212, v202, s[36:37]
    v_cndmask_b32 v192, v192, v183, s[38:39]
    v_cndmask_b32 v212, v212, v203, s[38:39]
    s_mov_b32 s72, s73
    v_mfma_f32_16x16x4_f32 v[184:187], v222, v192, 0
    v_mfma_f32_16x16x4_f32 v[204:207], v222, v212, 0
    v_mul_f32 v190, 0x3ae38e39, v176
    v_mul_f32 v210, 0x3ae38e39, v196
    v_cvt_pk_bf16_f32 v192, v190, v190
    v_cvt_pk_bf16_f32 v212, v210, v210
    s_add_u32 m0, s67, 0
    v_lshlrev_b32 v192, 16, v192
    v_lshlrev_b32 v212, 16, v212
    v_xor_b32 v176, 0x80000000, v192
    v_xor_b32 v196, 0x80000000, v212
    v_xor_b32 v177, 0x80000000, v192
    v_xor_b32 v197, 0x80000000, v212
    buffer_load_dwordx4 v14, s[12:15], s72 offen lds
    v_xor_b32 v178, 0x80000000, v192
    v_xor_b32 v198, 0x80000000, v212
    v_xor_b32 v179, 0x80000000, v192
    v_xor_b32 v199, 0x80000000, v212
    v_mul_f32 v191, 0x3ae38e39, v184
    v_mul_f32 v211, 0x3ae38e39, v204
    buffer_load_dwordx4 v15, s[12:15], s72 offen offset:1024 lds
    v_fma_f32 v191, -v190, v190, v191
    v_fma_f32 v211, -v210, v210, v211
    v_max_f32 v191, 0, v191
    v_max_f32 v211, 0, v211
    s_add_u32 m0, s67, 2048
    v_cvt_pk_bf16_f32 v191, v191, v191
    v_cvt_pk_bf16_f32 v211, v211, v211
    v_lshlrev_b32 v191, 16, v191
    v_lshlrev_b32 v211, 16, v211
    v_add_f32 v191, 0x3727c5ac, v191
    v_add_f32 v211, 0x3727c5ac, v211
    s_add_u32 s72, s72, s85
    v_cvt_pk_bf16_f32 v191, v191, v191
    v_cvt_pk_bf16_f32 v211, v211, v211
    v_lshlrev_b32 v191, 16, v191
    v_lshlrev_b32 v211, 16, v211
    v_sqrt_f32 v191, v191
    v_sqrt_f32 v211, v211
    buffer_load_dwordx4 v14, s[12:15], s72 offen lds
    v_cvt_pk_bf16_f32 v191, v191, v191
    v_cvt_pk_bf16_f32 v211, v211, v211
    v_lshlrev_b32 v191, 16, v191
    v_lshlrev_b32 v211, 16, v211
    v_rcp_f32 v188, v191
    v_rcp_f32 v208, v211
    buffer_load_dwordx4 v15, s[12:15], s72 offen offset:1024 lds
    v_mul_f32 v188, s27, v188
    v_mul_f32 v208, s27, v208
    v_mfma_f32_16x16x32_bf16 v[236:239], v[230:233], v[32:35], v[176:179]
    s_add_u32 m0, s67, 4096
    v_mfma_f32_16x16x32_bf16 v[240:243], v[228:231], v[32:35], v[176:179]
    s_add_u32 s72, s72, s85
    v_mfma_f32_16x16x32_bf16 v[244:247], v[230:233], v[40:43], v[176:179]
    buffer_load_dwordx4 v14, s[12:15], s72 offen lds
    v_mfma_f32_16x16x32_bf16 v[248:251], v[228:231], v[40:43], v[176:179]
    buffer_load_dwordx4 v15, s[12:15], s72 offen offset:1024 lds
    s_nop 0
    v_mul_f32 v236, v236, v188
    v_mul_f32 v237, v237, v188
    v_mul_f32 v238, v238, v188
    v_mul_f32 v239, v239, v188
    v_cvt_pk_bf16_f32 v32, v236, v237
    v_cvt_pk_bf16_f32 v33, v238, v239
    v_mfma_f32_16x16x32_bf16 v[252:255], v[230:233], v[48:51], v[176:179]
    s_add_u32 m0, s67, 6144
    v_mul_f32 v240, v240, v188
    v_mul_f32 v241, v241, v188
    v_mul_f32 v242, v242, v188
    v_mul_f32 v243, v243, v188
    v_cvt_pk_bf16_f32 v34, v240, v241
    v_cvt_pk_bf16_f32 v35, v242, v243
    v_mfma_f32_16x16x32_bf16 v[236:239], v[228:231], v[48:51], v[176:179]
    s_mov_b32 s72, s29
    v_mul_f32 v244, v244, v188
    v_mul_f32 v245, v245, v188
    v_mul_f32 v246, v246, v188
    v_mul_f32 v247, v247, v188
    v_cvt_pk_bf16_f32 v40, v244, v245
    v_cvt_pk_bf16_f32 v41, v246, v247
    v_mfma_f32_16x16x32_bf16 v[240:243], v[230:233], v[56:59], v[176:179]
    buffer_load_dwordx4 v14, s[12:15], s72 offen lds
    v_mul_f32 v248, v248, v188
    v_mul_f32 v249, v249, v188
    v_mul_f32 v250, v250, v188
    v_mul_f32 v251, v251, v188
    v_cvt_pk_bf16_f32 v42, v248, v249
    v_cvt_pk_bf16_f32 v43, v250, v251
    v_mfma_f32_16x16x32_bf16 v[244:247], v[228:231], v[56:59], v[176:179]
    buffer_load_dwordx4 v15, s[12:15], s72 offen offset:1024 lds
    v_mul_f32 v252, v252, v188
    v_mul_f32 v253, v253, v188
L_pad_m0_0:
    s_cbranch_execz L_pad_m0_1
    v_mul_f32 v254, v254, v188
    v_mul_f32 v255, v255, v188
    v_cvt_pk_bf16_f32 v48, v252, v253
    v_cvt_pk_bf16_f32 v49, v254, v255
    v_mfma_f32_16x16x32_bf16 v[248:251], v[230:233], v[64:67], v[176:179]
    s_add_u32 m0, s67, 8192
    v_mul_f32 v236, v236, v188
    v_mul_f32 v237, v237, v188
    v_mul_f32 v238, v238, v188
    v_mul_f32 v239, v239, v188
    v_cvt_pk_bf16_f32 v50, v236, v237
    v_cvt_pk_bf16_f32 v51, v238, v239
    v_mfma_f32_16x16x32_bf16 v[252:255], v[228:231], v[64:67], v[176:179]
    s_add_u32 s72, s72, s85
    v_mul_f32 v240, v240, v188
    v_mul_f32 v241, v241, v188
    v_mul_f32 v242, v242, v188
    v_mul_f32 v243, v243, v188
    v_cvt_pk_bf16_f32 v56, v240, v241
    v_cvt_pk_bf16_f32 v57, v242, v243
    v_mfma_f32_16x16x32_bf16 v[236:239], v[230:233], v[72:75], v[176:179]
    buffer_load_dwordx4 v14, s[12:15], s72 offen lds
    v_mul_f32 v244, v244, v188
    v_mul_f32 v245, v245, v188
    v_mul_f32 v246, v246, v188
    v_mul_f32 v247, v247, v188
    v_cvt_pk_bf16_f32 v58, v244, v245
    v_cvt_pk_bf16_f32 v59, v246, v247
    v_mfma_f32_16x16x32_bf16 v[240:243], v[228:231], v[72:75], v[176:179]
    buffer_load_dwordx4 v15, s[12:15], s72 offen offset:1024 lds
    v_mul_f32 v248, v248, v188
    v_mul_f32 v249, v249, v188
    v_mul_f32 v250, v250, v188
    v_mul_f32 v251, v251, v188
    v_cvt_pk_bf16_f32 v64, v248, v249
    v_cvt_pk_bf16_f32 v65, v250, v251
    v_mfma_f32_16x16x32_bf16 v[244:247], v[230:233], v[80:83], v[176:179]
    s_add_u32 m0, s67, 10240
    v_mul_f32 v252, v252, v188
    v_mul_f32 v253, v253, v188
    v_mul_f32 v254, v254, v188
    v_mul_f32 v255, v255, v188
    v_cvt_pk_bf16_f32 v66, v252, v253
    v_cvt_pk_bf16_f32 v67, v254, v255
    v_mfma_f32_16x16x32_bf16 v[248:251], v[228:231], v[80:83], v[176:179]
    s_add_u32 s72, s72, s85
    v_mul_f32 v236, v236, v188
    v_mul_f32 v237, v237, v188
    v_mul_f32 v238, v238, v188
    v_mul_f32 v239, v239, v188
    v_cvt_pk_bf16_f32 v72, v236, v237
    v_cvt_pk_bf16_f32 v73, v238, v239
    v_mfma_f32_16x16x32_bf16 v[252:255], v[230:233], v[88:91], v[176:179]
    buffer_load_dwordx4 v14, s[12:15], s72 offen lds
    v_mul_f32 v240, v240, v188
    v_mul_f32 v241, v241, v188
    v_mul_f32 v242, v242, v188
    v_mul_f32 v243, v243, v188
    v_cvt_pk_bf16_f32 v74, v240, v241
    v_cvt_pk_bf16_f32 v75, v242, v243
    v_mfma_f32_16x16x32_bf16 v[236:239], v[228:231], v[88:91], v[176:179]
    buffer_load_dwordx4 v15, s[12:15], s72 offen offset:1024 lds
    v_mul_f32 v244, v244, v188
    v_mul_f32 v245, v245, v188
    v_mul_f32 v246, v246, v188
    v_mul_f32 v247, v247, v188
    v_cvt_pk_bf16_f32 v80, v244, v245
    v_cvt_pk_bf16_f32 v81, v246, v247
    v_mfma_f32_16x16x32_bf16 v[240:243], v[230:233], v[96:99], v[176:179]
    s_add_u32 m0, s67, 12288
    v_mul_f32 v248, v248, v188
    v_mul_f32 v249, v249, v188
    v_mul_f32 v250, v250, v188
    v_mul_f32 v251, v251, v188
    v_cvt_pk_bf16_f32 v82, v248, v249
    v_cvt_pk_bf16_f32 v83, v250, v251
    v_mfma_f32_16x16x32_bf16 v[244:247], v[228:231], v[96:99], v[176:179]
    s_mov_b32 s72, s30
    v_mul_f32 v252, v252, v188
    v_mul_f32 v253, v253, v188
    v_mul_f32 v254, v254, v188
    v_mul_f32 v255, v255, v188
    v_cvt_pk_bf16_f32 v88, v252, v253
    v_cvt_pk_bf16_f32 v89, v254, v255
    v_mfma_f32_16x16x32_bf16 v[248:251], v[230:233], v[104:107], v[176:179]
    buffer_load_dwordx4 v14, s[12:15], s72 offen lds
    v_mul_f32 v236, v236, v188
    v_mul_f32 v237, v237, v188
    v_mul_f32 v238, v238, v188
    v_mul_f32 v239, v239, v188
    v_cvt_pk_bf16_f32 v90, v236, v237
    v_cvt_pk_bf16_f32 v91, v238, v239
    v_mfma_f32_16x16x32_bf16 v[252:255], v[228:231], v[104:107], v[176:179]
    buffer_load_dwordx4 v15, s[12:15], s72 offen offset:1024 lds
    v_mul_f32 v240, v240, v188
    v_mul_f32 v241, v241, v188
    v_mul_f32 v242, v242, v188
    v_mul_f32 v243, v243, v188
    v_cvt_pk_bf16_f32 v96, v240, v241
    v_cvt_pk_bf16_f32 v97, v242, v243
    v_mfma_f32_16x16x32_bf16 v[236:239], v[230:233], v[112:115], v[176:179]
    s_add_u32 m0, s67, 14336
    v_mul_f32 v244, v244, v188
    v_mul_f32 v245, v245, v188
    v_mul_f32 v246, v246, v188
    v_mul_f32 v247, v247, v188
    v_cvt_pk_bf16_f32 v98, v244, v245
    v_cvt_pk_bf16_f32 v99, v246, v247
    v_mfma_f32_16x16x32_bf16 v[240:243], v[228:231], v[112:115], v[176:179]
    s_add_u32 s72, s72, s85
    v_mul_f32 v248, v248, v188
    v_mul_f32 v249, v249, v188
    v_mul_f32 v250, v250, v188
    v_mul_f32 v251, v251, v188
    v_cvt_pk_bf16_f32 v104, v248, v249
    v_cvt_pk_bf16_f32 v105, v250, v251
    v_mfma_f32_16x16x32_bf16 v[244:247], v[230:233], v[120:123], v[176:179]
    buffer_load_dwordx4 v14, s[12:15], s72 offen lds
    v_mul_f32 v252, v252, v188
    v_mul_f32 v253, v253, v188
    v_mul_f32 v254, v254, v188
    v_mul_f32 v255, v255, v188
    v_cvt_pk_bf16_f32 v106, v252, v253
    v_cvt_pk_bf16_f32 v107, v254, v255
    v_mfma_f32_16x16x32_bf16 v[248:251], v[228:231], v[120:123], v[176:179]
    buffer_load_dwordx4 v15, s[12:15], s72 offen offset:1024 lds
    v_mul_f32 v236, v236, v188
    v_mul_f32 v237, v237, v188
    v_mul_f32 v238, v238, v188
    v_mul_f32 v239, v239, v188
    v_cvt_pk_bf16_f32 v112, v236, v237
    v_cvt_pk_bf16_f32 v113, v238, v239
    v_mfma_f32_16x16x32_bf16 v[252:255], v[230:233], v[128:131], v[176:179]
    s_add_u32 m0, s67, 16384
    v_mul_f32 v240, v240, v188
    v_mul_f32 v241, v241, v188
    v_mul_f32 v242, v242, v188
    v_mul_f32 v243, v243, v188
    v_cvt_pk_bf16_f32 v114, v240, v241
    v_cvt_pk_bf16_f32 v115, v242, v243
    v_mfma_f32_16x16x32_bf16 v[236:239], v[228:231], v[128:131], v[176:179]
    s_add_u32 s72, s72, s85
    v_mul_f32 v244, v244, v188
    v_mul_f32 v245, v245, v188
    v_mul_f32 v246, v246, v188
    v_mul_f32 v247, v247, v188
    v_cvt_pk_bf16_f32 v120, v244, v245
    v_cvt_pk_bf16_f32 v121, v246, v247
    v_mfma_f32_16x16x32_bf16 v[240:243], v[230:233], v[136:139], v[176:179]
    buffer_load_dwordx4 v14, s[12:15], s72 offen lds
    v_mul_f32 v248, v248, v188
    v_mul_f32 v249, v249, v188
    v_mul_f32 v250, v250, v188
    v_mul_f32 v251, v251, v188
    v_cvt_pk_bf16_f32 v122, v248, v249
    v_cvt_pk_bf16_f32 v123, v250, v251
    v_mfma_f32_16x16x32_bf16 v[244:247], v[228:231], v[136:139], v[176:179]
    buffer_load_dwordx4 v15, s[12:15], s72 offen offset:1024 lds
    v_mul_f32 v252, v252, v188
    v_mul_f32 v253, v253, v188
    v_mul_f32 v254, v254, v188
    v_mul_f32 v255, v255, v188
    v_cvt_pk_bf16_f32 v128, v252, v253
    v_cvt_pk_bf16_f32 v129, v254, v255
    v_mfma_f32_16x16x32_bf16 v[248:251], v[230:233], v[144:147], v[176:179]
    s_add_u32 s24, s81, 0
    v_mul_f32 v236, v236, v188
    v_mul_f32 v237, v237, v188
    v_mul_f32 v238, v238, v188
    v_mul_f32 v239, v239, v188
    v_cvt_pk_bf16_f32 v130, v236, v237
    v_cvt_pk_bf16_f32 v131, v238, v239
    v_mfma_f32_16x16x32_bf16 v[252:255], v[228:231], v[144:147], v[176:179]
    s_min_u32 s24, s24, 215
    v_mul_f32 v240, v240, v188
    v_mul_f32 v241, v241, v188
    v_mul_f32 v242, v242, v188
    v_mul_f32 v243, v243, v188
    v_cvt_pk_bf16_f32 v136, v240, v241
    v_cvt_pk_bf16_f32 v137, v242, v243
    v_mfma_f32_16x16x32_bf16 v[236:239], v[230:233], v[152:155], v[176:179]
    s_mul_i32 s25, s24, s4
    v_mul_f32 v244, v244, v188
    v_mul_f32 v245, v245, v188
    v_mul_f32 v246, v246, v188
    v_mul_f32 v247, v247, v188
    v_cvt_pk_bf16_f32 v138, v244, v245
    v_cvt_pk_bf16_f32 v139, v246, v247
    v_mfma_f32_16x16x32_bf16 v[240:243], v[228:231], v[152:155], v[176:179]
    s_lshr_b32 s25, s25, 16
    v_mul_f32 v248, v248, v188
    v_mul_f32 v249, v249, v188
    v_mul_f32 v250, v250, v188
    v_mul_f32 v251, v251, v188
    v_cvt_pk_bf16_f32 v144, v248, v249
    v_cvt_pk_bf16_f32 v145, v250, v251
    v_mfma_f32_16x16x32_bf16 v[244:247], v[230:233], v[160:163], v[176:179]
    s_mul_i32 s25, s25, s5
    v_mul_f32 v252, v252, v188
    v_mul_f32 v253, v253, v188
    v_mul_f32 v254, v254, v188
    v_mul_f32 v255, v255, v188
    v_cvt_pk_bf16_f32 v146, v252, v253
    v_cvt_pk_bf16_f32 v147, v254, v255
    v_mfma_f32_16x16x32_bf16 v[248:251], v[228:231], v[160:163], v[176:179]
    s_mul_i32 s24, s24, s6
    v_mul_f32 v236, v236, v188
    v_mul_f32 v237, v237, v188
    v_mul_f32 v238, v238, v188
    v_mul_f32 v239, v239, v188
    v_cvt_pk_bf16_f32 v152, v236, v237
    v_cvt_pk_bf16_f32 v153, v238, v239
    v_mfma_f32_16x16x32_bf16 v[252:255], v[230:233], v[168:171], v[176:179]
    s_add_u32 s24, s24, s25
    v_mul_f32 v240, v240, v188
    v_mul_f32 v241, v241, v188
    v_mul_f32 v242, v242, v188
    v_mul_f32 v243, v243, v188
    v_cvt_pk_bf16_f32 v154, v240, v241
    v_cvt_pk_bf16_f32 v155, v242, v243
    v_mfma_f32_16x16x32_bf16 v[236:239], v[228:231], v[168:171], v[176:179]
    s_add_u32 s24, s24, s7
    v_mul_f32 v244, v244, v188
    v_mul_f32 v245, v245, v188
    v_mul_f32 v246, v246, v188
    v_mul_f32 v247, v247, v188
    v_cvt_pk_bf16_f32 v160, v244, v245
    v_cvt_pk_bf16_f32 v161, v246, v247
    v_mul_f32 v248, v248, v188
    v_mul_f32 v249, v249, v188
    v_mul_f32 v250, v250, v188
    v_mul_f32 v251, v251, v188
    v_cvt_pk_bf16_f32 v162, v248, v249
    v_cvt_pk_bf16_f32 v163, v250, v251
    v_mul_f32 v252, v252, v188
    v_mul_f32 v253, v253, v188
    v_mul_f32 v254, v254, v188
    v_mul_f32 v255, v255, v188
    v_cvt_pk_bf16_f32 v168, v252, v253
    v_cvt_pk_bf16_f32 v169, v254, v255
    v_mul_f32 v236, v236, v188
    v_mul_f32 v237, v237, v188
    v_mul_f32 v238, v238, v188
    v_mul_f32 v239, v239, v188
    v_cvt_pk_bf16_f32 v170, v236, v237
    v_cvt_pk_bf16_f32 v171, v238, v239
    v_mfma_f32_16x16x32_bf16 v[236:239], v[230:233], v[36:39], v[196:199]
    buffer_load_dwordx4 a[212:215], v14, s[12:15], s24 offen
    v_mfma_f32_16x16x32_bf16 v[240:243], v[228:231], v[36:39], v[196:199]
    s_add_u32 s24, s24, s26
    v_mfma_f32_16x16x32_bf16 v[244:247], v[230:233], v[44:47], v[196:199]
    buffer_load_dwordx4 a[216:219], v14, s[12:15], s24 offen
    v_mfma_f32_16x16x32_bf16 v[248:251], v[228:231], v[44:47], v[196:199]
    s_add_u32 s24, s81, 64
    s_nop 0
    v_mul_f32 v236, v236, v208
    v_mul_f32 v237, v237, v208
    v_mul_f32 v238, v238, v208
    v_mul_f32 v239, v239, v208
    v_cvt_pk_bf16_f32 v36, v236, v237
    v_cvt_pk_bf16_f32 v37, v238, v239
    v_mfma_f32_16x16x32_bf16 v[252:255], v[230:233], v[52:55], v[196:199]
    s_min_u32 s24, s24, 215
    v_mul_f32 v240, v240, v208
    v_mul_f32 v241, v241, v208
    v_mul_f32 v242, v242, v208
    v_mul_f32 v243, v243, v208
    v_cvt_pk_bf16_f32 v38, v240, v241
    v_cvt_pk_bf16_f32 v39, v242, v243
    v_mfma_f32_16x16x32_bf16 v[236:239], v[228:231], v[52:55], v[196:199]
    s_mul_i32 s25, s24, s4
    v_readfirstlane_b32 s66, v21
    v_mul_f32 v244, v244, v208
    v_mul_f32 v245, v245, v208
    v_mul_f32 v246, v246, v208
    v_mul_f32 v247, v247, v208
    v_cvt_pk_bf16_f32 v44, v244, v245
    v_cvt_pk_bf16_f32 v45, v246, v247
    v_mfma_f32_16x16x32_bf16 v[240:243], v[230:233], v[60:63], v[196:199]
    s_lshr_b32 s25, s25, 16
    v_mul_f32 v248, v248, v208
    v_mul_f32 v249, v249, v208
    v_mul_f32 v250, v250, v208
    v_mul_f32 v251, v251, v208
    v_cvt_pk_bf16_f32 v46, v248, v249
    v_cvt_pk_bf16_f32 v47, v250, v251
    v_mfma_f32_16x16x32_bf16 v[244:247], v[228:231], v[60:63], v[196:199]
    s_mul_i32 s25, s25, s5
    v_mul_f32 v252, v252, v208
    v_mul_f32 v253, v253, v208
    v_mul_f32 v254, v254, v208
    v_mul_f32 v255, v255, v208
    v_cvt_pk_bf16_f32 v52, v252, v253
    v_cvt_pk_bf16_f32 v53, v254, v255
    v_mfma_f32_16x16x32_bf16 v[248:251], v[230:233], v[68:71], v[196:199]
    s_mul_i32 s24, s24, s6
    v_mul_f32 v236, v236, v208
    v_mul_f32 v237, v237, v208
    v_mul_f32 v238, v238, v208
    v_mul_f32 v239, v239, v208
    v_cvt_pk_bf16_f32 v54, v236, v237
    v_cvt_pk_bf16_f32 v55, v238, v239
    v_mfma_f32_16x16x32_bf16 v[252:255], v[228:231], v[68:71], v[196:199]
    s_add_u32 s24, s24, s25
    v_mul_f32 v240, v240, v208
    v_mul_f32 v241, v241, v208
    v_mul_f32 v242, v242, v208
    v_mul_f32 v243, v243, v208
    v_cvt_pk_bf16_f32 v60, v240, v241
    v_cvt_pk_bf16_f32 v61, v242, v243
    v_mfma_f32_16x16x32_bf16 v[236:239], v[230:233], v[76:79], v[196:199]
    s_add_u32 s24, s24, s7
    v_mul_f32 v244, v244, v208
    v_mul_f32 v245, v245, v208
    v_mul_f32 v246, v246, v208
    v_mul_f32 v247, v247, v208
    v_cvt_pk_bf16_f32 v62, v244, v245
    v_cvt_pk_bf16_f32 v63, v246, v247
    v_mfma_f32_16x16x32_bf16 v[240:243], v[228:231], v[76:79], v[196:199]
    buffer_load_dwordx4 a[220:223], v14, s[12:15], s24 offen
    v_lshlrev_b32 v26, 16, v220
    v_mul_f32 v248, v248, v208
    v_mul_f32 v249, v249, v208
    v_mul_f32 v250, v250, v208
    v_mul_f32 v251, v251, v208
    v_cvt_pk_bf16_f32 v68, v248, v249
    v_cvt_pk_bf16_f32 v69, v250, v251
    v_mfma_f32_16x16x32_bf16 v[244:247], v[230:233], v[84:87], v[196:199]
    s_add_u32 s24, s24, s26
    v_mul_f32 v252, v252, v208
    v_mul_f32 v253, v253, v208
    v_mul_f32 v254, v254, v208
    v_mul_f32 v255, v255, v208
    v_cvt_pk_bf16_f32 v70, v252, v253
    v_cvt_pk_bf16_f32 v71, v254, v255
    v_mfma_f32_16x16x32_bf16 v[248:251], v[228:231], v[84:87], v[196:199]
    buffer_load_dwordx4 a[224:227], v14, s[12:15], s24 offen
    v_mul_f32 v236, v236, v208
    v_mul_f32 v237, v237, v208
    v_mul_f32 v238, v238, v208
    v_mul_f32 v239, v239, v208
    v_cvt_pk_bf16_f32 v76, v236, v237
    v_cvt_pk_bf16_f32 v77, v238, v239
    v_mfma_f32_16x16x32_bf16 v[252:255], v[230:233], v[92:95], v[196:199]
    s_add_u32 s24, s81, 128
    v_mul_f32 v240, v240, v208
    v_mul_f32 v241, v241, v208
    v_mul_f32 v242, v242, v208
    v_mul_f32 v243, v243, v208
    v_cvt_pk_bf16_f32 v78, v240, v241
    v_cvt_pk_bf16_f32 v79, v242, v243
    v_mfma_f32_16x16x32_bf16 v[236:239], v[228:231], v[92:95], v[196:199]
    s_min_u32 s24, s24, 215
    v_mul_f32 v244, v244, v208
    v_mul_f32 v245, v245, v208
    v_mul_f32 v246, v246, v208
    v_mul_f32 v247, v247, v208
    v_cvt_pk_bf16_f32 v84, v244, v245
    v_cvt_pk_bf16_f32 v85, v246, v247
    v_mfma_f32_16x16x32_bf16 v[240:243], v[230:233], v[100:103], v[196:199]
    s_mul_i32 s25, s24, s4
    v_mul_f32 v248, v248, v208
    v_mul_f32 v249, v249, v208
    v_mul_f32 v250, v250, v208
    v_mul_f32 v251, v251, v208
    v_cvt_pk_bf16_f32 v86, v248, v249
    v_cvt_pk_bf16_f32 v87, v250, v251
    v_mfma_f32_16x16x32_bf16 v[244:247], v[228:231], v[100:103], v[196:199]
    s_lshr_b32 s25, s25, 16
    v_and_b32 v27, 0xffff0000, v220
    v_mul_f32 v252, v252, v208
    v_mul_f32 v253, v253, v208
    v_mul_f32 v254, v254, v208
    v_mul_f32 v255, v255, v208
    v_cvt_pk_bf16_f32 v92, v252, v253
    v_cvt_pk_bf16_f32 v93, v254, v255
    v_mfma_f32_16x16x32_bf16 v[248:251], v[230:233], v[108:111], v[196:199]
    s_mul_i32 s25, s25, s5
    v_mul_f32 v236, v236, v208
    v_mul_f32 v237, v237, v208
    v_mul_f32 v238, v238, v208
    v_mul_f32 v239, v239, v208
    v_cvt_pk_bf16_f32 v94, v236, v237
    v_cvt_pk_bf16_f32 v95, v238, v239
    v_mfma_f32_16x16x32_bf16 v[252:255], v[228:231], v[108:111], v[196:199]
    s_mul_i32 s24, s24, s6
    v_mul_f32 v240, v240, v208
    v_mul_f32 v241, v241, v208
    v_mul_f32 v242, v242, v208
    v_mul_f32 v243, v243, v208
    v_cvt_pk_bf16_f32 v100, v240, v241
    v_cvt_pk_bf16_f32 v101, v242, v243
    v_mfma_f32_16x16x32_bf16 v[236:239], v[230:233], v[116:119], v[196:199]
    s_add_u32 s24, s24, s25
    v_mul_f32 v244, v244, v208
    v_mul_f32 v245, v245, v208
    v_mul_f32 v246, v246, v208
    v_mul_f32 v247, v247, v208
    v_cvt_pk_bf16_f32 v102, v244, v245
    v_cvt_pk_bf16_f32 v103, v246, v247
    v_mfma_f32_16x16x32_bf16 v[240:243], v[228:231], v[116:119], v[196:199]
    s_add_u32 s24, s24, s7
    v_mul_f32 v248, v248, v208
    v_mul_f32 v249, v249, v208
    v_mul_f32 v250, v250, v208
    v_mul_f32 v251, v251, v208
    v_cvt_pk_bf16_f32 v108, v248, v249
    v_cvt_pk_bf16_f32 v109, v250, v251
    v_mfma_f32_16x16x32_bf16 v[244:247], v[230:233], v[124:127], v[196:199]
    buffer_load_dwordx4 a[228:231], v14, s[12:15], s24 offen
    v_mul_f32 v252, v252, v208
    v_mul_f32 v253, v253, v208
    v_mul_f32 v254, v254, v208
    v_mul_f32 v255, v255, v208
    v_cvt_pk_bf16_f32 v110, v252, v253
    v_cvt_pk_bf16_f32 v111, v254, v255
    v_mfma_f32_16x16x32_bf16 v[248:251], v[228:231], v[124:127], v[196:199]
    s_add_u32 s24, s24, s26
    ds_write_b64 v221, v[26:27]
    v_mul_f32 v236, v236, v208
    v_mul_f32 v237, v237, v208
    v_mul_f32 v238, v238, v208
    v_mul_f32 v239, v239, v208
    v_cvt_pk_bf16_f32 v116, v236, v237
    v_cvt_pk_bf16_f32 v117, v238, v239
    v_mfma_f32_16x16x32_bf16 v[252:255], v[230:233], v[132:135], v[196:199]
    buffer_load_dwordx4 a[232:235], v14, s[12:15], s24 offen
    v_mul_f32 v240, v240, v208
    v_mul_f32 v241, v241, v208
    v_mul_f32 v242, v242, v208
    v_mul_f32 v243, v243, v208
    v_cvt_pk_bf16_f32 v118, v240, v241
    v_cvt_pk_bf16_f32 v119, v242, v243
    v_mfma_f32_16x16x32_bf16 v[236:239], v[228:231], v[132:135], v[196:199]
    s_add_u32 s24, s81, 192
    v_mul_f32 v244, v244, v208
    v_mul_f32 v245, v245, v208
    v_mul_f32 v246, v246, v208
    v_mul_f32 v247, v247, v208
    v_cvt_pk_bf16_f32 v124, v244, v245
    v_cvt_pk_bf16_f32 v125, v246, v247
    v_mfma_f32_16x16x32_bf16 v[240:243], v[230:233], v[140:143], v[196:199]
    s_min_u32 s24, s24, 215
    v_mul_f32 v248, v248, v208
    v_mul_f32 v249, v249, v208
    v_mul_f32 v250, v250, v208
    v_mul_f32 v251, v251, v208
    v_cvt_pk_bf16_f32 v126, v248, v249
    v_cvt_pk_bf16_f32 v127, v250, v251
    v_mfma_f32_16x16x32_bf16 v[244:247], v[228:231], v[140:143], v[196:199]
    s_mul_i32 s25, s24, s4
    v_mul_f32 v252, v252, v208
    v_mul_f32 v253, v253, v208
    v_mul_f32 v254, v254, v208
    v_mul_f32 v255, v255, v208
    v_cvt_pk_bf16_f32 v132, v252, v253
    v_cvt_pk_bf16_f32 v133, v254, v255
    v_mfma_f32_16x16x32_bf16 v[248:251], v[230:233], v[148:151], v[196:199]
    s_lshr_b32 s25, s25, 16
    v_mul_f32 v236, v236, v208
    v_mul_f32 v237, v237, v208
    v_mul_f32 v238, v238, v208
    v_mul_f32 v239, v239, v208
    v_cvt_pk_bf16_f32 v134, v236, v237
    v_cvt_pk_bf16_f32 v135, v238, v239
    v_mfma_f32_16x16x32_bf16 v[252:255], v[228:231], v[148:151], v[196:199]
    s_mul_i32 s25, s25, s5
    v_add_u32 v20, 163072, v20
    v_mul_f32 v240, v240, v208
    v_mul_f32 v241, v241, v208
    v_mul_f32 v242, v242, v208
    v_mul_f32 v243, v243, v208
    v_cvt_pk_bf16_f32 v140, v240, v241
    v_cvt_pk_bf16_f32 v141, v242, v243
    v_mfma_f32_16x16x32_bf16 v[236:239], v[230:233], v[156:159], v[196:199]
    s_mul_i32 s24, s24, s6
    v_mul_f32 v244, v244, v208
    v_mul_f32 v245, v245, v208
    v_mul_f32 v246, v246, v208
    v_mul_f32 v247, v247, v208
    v_cvt_pk_bf16_f32 v142, v244, v245
    v_cvt_pk_bf16_f32 v143, v246, v247
    v_mfma_f32_16x16x32_bf16 v[240:243], v[228:231], v[156:159], v[196:199]
    s_add_u32 s24, s24, s25
    v_mul_f32 v248, v248, v208
    v_mul_f32 v249, v249, v208
    v_mul_f32 v250, v250, v208
    v_mul_f32 v251, v251, v208
    v_cvt_pk_bf16_f32 v148, v248, v249
    v_cvt_pk_bf16_f32 v149, v250, v251
    v_mfma_f32_16x16x32_bf16 v[244:247], v[230:233], v[164:167], v[196:199]
    s_add_u32 s24, s24, s7
    v_mul_f32 v252, v252, v208
    v_mul_f32 v253, v253, v208
    v_mul_f32 v254, v254, v208
    v_mul_f32 v255, v255, v208
    v_cvt_pk_bf16_f32 v150, v252, v253
    v_cvt_pk_bf16_f32 v151, v254, v255
    v_mfma_f32_16x16x32_bf16 v[248:251], v[228:231], v[164:167], v[196:199]
    buffer_load_dwordx4 a[236:239], v14, s[12:15], s24 offen
    v_mul_f32 v236, v236, v208
    v_mul_f32 v237, v237, v208
    v_mul_f32 v238, v238, v208
    v_mul_f32 v239, v239, v208
    v_cvt_pk_bf16_f32 v156, v236, v237
    v_cvt_pk_bf16_f32 v157, v238, v239
    v_mfma_f32_16x16x32_bf16 v[252:255], v[230:233], v[172:175], v[196:199]
    s_add_u32 s24, s24, s26
    v_mul_f32 v240, v240, v208
    v_mul_f32 v241, v241, v208
    v_mul_f32 v242, v242, v208
    v_mul_f32 v243, v243, v208
    v_cvt_pk_bf16_f32 v158, v240, v241
    v_cvt_pk_bf16_f32 v159, v242, v243
    v_mfma_f32_16x16x32_bf16 v[236:239], v[228:231], v[172:175], v[196:199]
    buffer_load_dwordx4 a[240:243], v14, s[12:15], s24 offen
    ds_write_b32 v20, v19
    v_mul_f32 v244, v244, v208
    v_mul_f32 v245, v245, v208
    v_mul_f32 v246, v246, v208
    v_mul_f32 v247, v247, v208
    v_cvt_pk_bf16_f32 v164, v244, v245
    v_cvt_pk_bf16_f32 v165, v246, v247
    v_mul_f32 v248, v248, v208
    v_mul_f32 v249, v249, v208
    v_mul_f32 v250, v250, v208
    v_mul_f32 v251, v251, v208
    v_cvt_pk_bf16_f32 v166, v248, v249
    v_cvt_pk_bf16_f32 v167, v250, v251
    v_mul_f32 v252, v252, v208
    v_mul_f32 v253, v253, v208
    v_mul_f32 v254, v254, v208
    v_mul_f32 v255, v255, v208
    v_cvt_pk_bf16_f32 v172, v252, v253
    v_cvt_pk_bf16_f32 v173, v254, v255
    v_mul_f32 v236, v236, v208
    v_mul_f32 v237, v237, v208
    v_mul_f32 v238, v238, v208
    v_mul_f32 v239, v239, v208
    v_cvt_pk_bf16_f32 v174, v236, v237
    v_cvt_pk_bf16_f32 v175, v238, v239
    s_cmp_eq_u32 s65, 3
    s_cbranch_scc1 L_attn
    v_lshrrev_b32 v19, 4, v1
    v_lshlrev_b32 v19, 4, v19
    v_add_u32 v19, 149760, v19
    s_waitcnt vmcnt(20) lgkmcnt(0)
    s_barrier
    ds_read_b128 v[176:179], v19 offset:0
    ds_read_b128 v[184:187], v19 offset:64
    ds_read_b128 v[192:195], v19 offset:128
    ds_read_b128 v[200:203], v19 offset:192
    ds_read_b64_tr_b16 a[0:1], v2 offset:0
    ds_read_b64_tr_b16 a[2:3], v2 offset:2048
    ds_read_b64_tr_b16 a[4:5], v2 offset:4096
    ds_read_b64_tr_b16 a[6:7], v2 offset:37440
    ds_read_b64_tr_b16 a[8:9], v2 offset:39488
    ds_read_b64_tr_b16 a[10:11], v2 offset:41536
    ds_read_b64_tr_b16 a[12:13], v6 offset:9344
    ds_read_b64_tr_b16 a[14:15], v6 offset:11392
    ds_read_b64_tr_b16 a[16:17], v6 offset:13440
    ds_read_b64_tr_b16 a[18:19], v6 offset:46784
    ds_read_b64_tr_b16 a[20:21], v6 offset:48832
    ds_read_b64_tr_b16 a[22:23], v6 offset:50880
    ds_read_b64_tr_b16 a[24:25], v3 offset:0
    ds_read_b64_tr_b16 a[26:27], v3 offset:2048
    ds_read_b64_tr_b16 a[28:29], v3 offset:4096
    ds_read_b64_tr_b16 a[30:31], v3 offset:37440
    s_waitcnt lgkmcnt(14)
    v_mfma_f32_16x16x32_bf16 v[180:183], a[0:3], v[36:39], v[176:179]
    s_mov_b32 s16, s52
    ds_read_b64_tr_b16 a[32:33], v3 offset:39488
    s_waitcnt lgkmcnt(13)
    v_mfma_f32_16x16x32_bf16 v[180:183], a[4:7], v[44:47], v[180:183]
    s_add_u32 m0, s67, 18432
    ds_read_b64_tr_b16 a[34:35], v3 offset:41536
    v_mfma_f32_16x16x32_bf16 v[176:179], a[0:3], v[32:35], v[176:179]
    s_add_u32 s72, s73, 128
    ds_read_b64_tr_b16 a[36:37], v7 offset:9344
    buffer_load_dwordx4 v14, s[12:15], s72 offen lds
    v_mfma_f32_16x16x32_bf16 v[176:179], a[4:7], v[40:43], v[176:179]
    s_and_b32 s17, s53, 0xffff
    ds_read_b64_tr_b16 a[38:39], v7 offset:11392
    s_waitcnt lgkmcnt(14)
    v_mfma_f32_16x16x32_bf16 v[180:183], a[8:11], v[52:55], v[180:183]
    ds_read_b64_tr_b16 a[40:41], v7 offset:13440
    s_waitcnt lgkmcnt(13)
    v_mfma_f32_16x16x32_bf16 v[180:183], a[12:15], v[60:63], v[180:183]
    ds_read_b64_tr_b16 a[42:43], v7 offset:46784
    v_mfma_f32_16x16x32_bf16 v[176:179], a[8:11], v[48:51], v[176:179]
    s_mov_b32 s18, 0x510000
    ds_read_b64_tr_b16 a[44:45], v7 offset:48832
    buffer_load_dwordx4 v15, s[12:15], s72 offen offset:1024 lds
    v_mfma_f32_16x16x32_bf16 v[176:179], a[12:15], v[56:59], v[176:179]
    s_waitcnt lgkmcnt(7)
    ds_read_b64_tr_b16 a[46:47], v7 offset:50880
    v_mfma_f32_16x16x32_bf16 v[180:183], a[16:19], v[68:71], v[180:183]
    ds_read_b64_tr_b16 a[0:1], v4 offset:0
    v_mfma_f32_16x16x32_bf16 v[180:183], a[20:23], v[76:79], v[180:183]
    s_add_u32 m0, s67, 20480
    ds_read_b64_tr_b16 a[2:3], v4 offset:2048
    v_mfma_f32_16x16x32_bf16 v[176:179], a[16:19], v[64:67], v[176:179]
    s_add_u32 s72, s73, 147584
    ds_read_b64_tr_b16 a[4:5], v4 offset:4096
    buffer_load_dwordx4 v14, s[12:15], s72 offen lds
    v_mfma_f32_16x16x32_bf16 v[176:179], a[20:23], v[72:75], v[176:179]
    s_mov_b32 s19, 0x20000
    ds_read_b64_tr_b16 a[6:7], v4 offset:37440
    v_mfma_f32_16x16x32_bf16 v[188:191], a[24:27], v[36:39], v[184:187]
    s_mov_b32 s4, s44
    ds_read_b64_tr_b16 a[8:9], v4 offset:39488
    v_mfma_f32_16x16x32_bf16 v[188:191], a[28:31], v[44:47], v[188:191]
    ds_read_b64_tr_b16 a[10:11], v4 offset:41536
    v_mfma_f32_16x16x32_bf16 v[184:187], a[24:27], v[32:35], v[184:187]
    ds_read_b64_tr_b16 a[12:13], v8 offset:9344
    buffer_load_dwordx4 v15, s[12:15], s72 offen offset:1024 lds
    v_mfma_f32_16x16x32_bf16 v[184:187], a[28:31], v[40:43], v[184:187]
    s_waitcnt lgkmcnt(7)
    ds_read_b64_tr_b16 a[14:15], v8 offset:11392
    v_mfma_f32_16x16x32_bf16 v[188:191], a[32:35], v[52:55], v[188:191]
    s_and_b32 s5, s45, 0xffff
    ds_read_b64_tr_b16 a[16:17], v8 offset:13440
    v_mfma_f32_16x16x32_bf16 v[188:191], a[36:39], v[60:63], v[188:191]
    s_add_u32 m0, s67, 22528
    ds_read_b64_tr_b16 a[18:19], v8 offset:46784
    v_mfma_f32_16x16x32_bf16 v[184:187], a[32:35], v[48:51], v[184:187]
    s_add_u32 s72, s73, 295040
    ds_read_b64_tr_b16 a[20:21], v8 offset:48832
    buffer_load_dwordx4 v14, s[12:15], s72 offen lds
    v_mfma_f32_16x16x32_bf16 v[184:187], a[36:39], v[56:59], v[184:187]
    s_mov_b32 s6, 0xa2000
    ds_read_b64_tr_b16 a[22:23], v8 offset:50880
    v_mfma_f32_16x16x32_bf16 v[188:191], a[40:43], v[68:71], v[188:191]
    ds_read_b64_tr_b16 a[24:25], v5 offset:0
    v_mfma_f32_16x16x32_bf16 v[188:191], a[44:47], v[76:79], v[188:191]
    ds_read_b64_tr_b16 a[26:27], v5 offset:2048
    v_mfma_f32_16x16x32_bf16 v[184:187], a[40:43], v[64:67], v[184:187]
    s_mov_b32 s7, 0x20000
    ds_read_b64_tr_b16 a[28:29], v5 offset:4096
    buffer_load_dwordx4 v15, s[12:15], s72 offen offset:1024 lds
    v_mfma_f32_16x16x32_bf16 v[184:187], a[44:47], v[72:75], v[184:187]
    s_waitcnt lgkmcnt(7)
    ds_read_b64_tr_b16 a[30:31], v5 offset:37440
    v_mfma_f32_16x16x32_bf16 v[196:199], a[0:3], v[36:39], v[192:195]
    ds_read_b64_tr_b16 a[32:33], v5 offset:39488
    v_mfma_f32_16x16x32_bf16 v[196:199], a[4:7], v[44:47], v[196:199]
    s_add_u32 m0, s67, 24576
    ds_read_b64_tr_b16 a[34:35], v5 offset:41536
    v_mfma_f32_16x16x32_bf16 v[192:195], a[0:3], v[32:35], v[192:195]
    s_add_u32 s72, s29, 128
    ds_read_b64_tr_b16 a[36:37], v9 offset:9344
    buffer_load_dwordx4 v14, s[12:15], s72 offen lds
    v_mfma_f32_16x16x32_bf16 v[192:195], a[4:7], v[40:43], v[192:195]
    s_mul_i32 s89, s63, 1327104
    ds_read_b64_tr_b16 a[38:39], v9 offset:11392
    v_mfma_f32_16x16x32_bf16 v[196:199], a[8:11], v[52:55], v[196:199]
    s_mul_i32 s69, s65, 384
    ds_read_b64_tr_b16 a[40:41], v9 offset:13440
    v_mfma_f32_16x16x32_bf16 v[196:199], a[12:15], v[60:63], v[196:199]
    ds_read_b64_tr_b16 a[42:43], v9 offset:46784
    v_mfma_f32_16x16x32_bf16 v[192:195], a[8:11], v[48:51], v[192:195]
    ds_read_b64_tr_b16 a[44:45], v9 offset:48832
    buffer_load_dwordx4 v15, s[12:15], s72 offen offset:1024 lds
    v_mfma_f32_16x16x32_bf16 v[192:195], a[12:15], v[56:59], v[192:195]
    s_waitcnt vmcnt(22) lgkmcnt(7)
    ds_read_b64_tr_b16 a[46:47], v9 offset:50880
    v_mfma_f32_16x16x32_bf16 v[196:199], a[16:19], v[68:71], v[196:199]
    s_barrier
    ds_read_b64_tr_b16 a[0:1], v2 offset:6144
    v_mfma_f32_16x16x32_bf16 v[196:199], a[20:23], v[76:79], v[196:199]
    s_add_u32 m0, s67, 26624
    ds_read_b64_tr_b16 a[2:3], v2 offset:8192
    v_mfma_f32_16x16x32_bf16 v[192:195], a[16:19], v[64:67], v[192:195]
    s_add_u32 s72, s29, 147584
L_pad_m1_0:
    s_cbranch_execz L_pad_m1_1
    ds_read_b64_tr_b16 a[4:5], v2 offset:10240
    buffer_load_dwordx4 v14, s[12:15], s72 offen lds
    v_mfma_f32_16x16x32_bf16 v[192:195], a[20:23], v[72:75], v[192:195]
    s_add_u32 s89, s89, s69
    ds_read_b64_tr_b16 a[6:7], v2 offset:43584
    v_mfma_f32_16x16x32_bf16 v[204:207], a[24:27], v[36:39], v[200:203]
    s_lshl_b32 s69, s65, 2
    ds_read_b64_tr_b16 a[8:9], v2 offset:45632
    v_mfma_f32_16x16x32_bf16 v[204:207], a[28:31], v[44:47], v[204:207]
    ds_read_b64_tr_b16 a[10:11], v2 offset:47680
    v_mfma_f32_16x16x32_bf16 v[200:203], a[24:27], v[32:35], v[200:203]
    s_add_u32 s69, s69, s63
    ds_read_b64_tr_b16 a[12:13], v6 offset:15488
    buffer_load_dwordx4 v15, s[12:15], s72 offen offset:1024 lds
    v_mfma_f32_16x16x32_bf16 v[200:203], a[28:31], v[40:43], v[200:203]
    s_waitcnt lgkmcnt(7)
    ds_read_b64_tr_b16 a[14:15], v6 offset:17536
    v_mfma_f32_16x16x32_bf16 v[204:207], a[32:35], v[52:55], v[204:207]
    ds_read_b64_tr_b16 a[16:17], v6 offset:19584
    v_mfma_f32_16x16x32_bf16 v[204:207], a[36:39], v[60:63], v[204:207]
    s_add_u32 m0, s67, 28672
    ds_read_b64_tr_b16 a[18:19], v6 offset:52928
    v_mfma_f32_16x16x32_bf16 v[200:203], a[32:35], v[48:51], v[200:203]
    s_add_u32 s72, s29, 295040
    ds_read_b64_tr_b16 a[20:21], v6 offset:54976
    buffer_load_dwordx4 v14, s[12:15], s72 offen lds
    v_mfma_f32_16x16x32_bf16 v[200:203], a[36:39], v[56:59], v[200:203]
    s_mul_i32 s88, s69, 96
    ds_read_b64_tr_b16 a[22:23], v6 offset:57024
    v_mfma_f32_16x16x32_bf16 v[204:207], a[40:43], v[68:71], v[204:207]
    s_and_b32 s3, s88, 0xffffff80
    ds_read_b64_tr_b16 a[24:25], v3 offset:6144
    v_mfma_f32_16x16x32_bf16 v[204:207], a[44:47], v[76:79], v[204:207]
    ds_read_b64_tr_b16 a[26:27], v3 offset:8192
    v_mfma_f32_16x16x32_bf16 v[200:203], a[40:43], v[64:67], v[200:203]
    ds_read_b64_tr_b16 a[28:29], v3 offset:10240
    buffer_load_dwordx4 v15, s[12:15], s72 offen offset:1024 lds
    v_mfma_f32_16x16x32_bf16 v[200:203], a[44:47], v[72:75], v[200:203]
    s_waitcnt lgkmcnt(7)
    ds_read_b64_tr_b16 a[30:31], v3 offset:43584
    v_mfma_f32_16x16x32_bf16 v[180:183], a[0:3], v[84:87], v[180:183]
    ds_read_b64_tr_b16 a[32:33], v3 offset:45632
    ds_read_b128 v[208:211], v19 offset:256
    v_mfma_f32_16x16x32_bf16 v[180:183], a[4:7], v[92:95], v[180:183]
    s_add_u32 m0, s67, 30720
    ds_read_b64_tr_b16 a[34:35], v3 offset:47680
    v_mfma_f32_16x16x32_bf16 v[176:179], a[0:3], v[80:83], v[176:179]
    s_add_u32 s72, s30, 128
    ds_read_b64_tr_b16 a[36:37], v7 offset:15488
    buffer_load_dwordx4 v14, s[12:15], s72 offen lds
    v_mfma_f32_16x16x32_bf16 v[176:179], a[4:7], v[88:91], v[176:179]
    s_add_u32 s46, s81, 0
    ds_read_b64_tr_b16 a[38:39], v7 offset:17536
    v_mfma_f32_16x16x32_bf16 v[180:183], a[8:11], v[100:103], v[180:183]
    s_min_u32 s46, s46, 431
    ds_read_b64_tr_b16 a[40:41], v7 offset:19584
    v_mfma_f32_16x16x32_bf16 v[180:183], a[12:15], v[108:111], v[180:183]
    s_mul_i32 s47, s46, 21846
    ds_read_b64_tr_b16 a[42:43], v7 offset:52928
    v_mfma_f32_16x16x32_bf16 v[176:179], a[8:11], v[96:99], v[176:179]
    s_lshr_b32 s47, s47, 16
    ds_read_b64_tr_b16 a[44:45], v7 offset:54976
    v_mfma_f32_16x16x32_bf16 v[176:179], a[12:15], v[104:107], v[176:179]
    s_waitcnt lgkmcnt(8)
    ds_read_b64_tr_b16 a[46:47], v7 offset:57024
    v_mfma_f32_16x16x32_bf16 v[180:183], a[16:19], v[116:119], v[180:183]
    s_mul_i32 s47, s47, 8832
    ds_read_b64_tr_b16 a[0:1], v4 offset:6144
    v_mfma_f32_16x16x32_bf16 v[180:183], a[20:23], v[124:127], v[180:183]
    s_mul_i32 s46, s46, 128
    ds_read_b64_tr_b16 a[2:3], v4 offset:8192
    v_mfma_f32_16x16x32_bf16 v[176:179], a[16:19], v[112:115], v[176:179]
    s_add_u32 s46, s46, s47
    ds_read_b64_tr_b16 a[4:5], v4 offset:10240
    v_mfma_f32_16x16x32_bf16 v[176:179], a[20:23], v[120:123], v[176:179]
    s_add_u32 s46, s46, s89
    ds_read_b64_tr_b16 a[6:7], v4 offset:43584
    buffer_load_dwordx4 a[144:147], v16, s[16:19], s46 offen offset:0
    v_mfma_f32_16x16x32_bf16 v[188:191], a[24:27], v[84:87], v[188:191]
    ds_read_b64_tr_b16 a[8:9], v4 offset:45632
    buffer_load_dwordx4 v15, s[12:15], s72 offen offset:1024 lds
    v_mfma_f32_16x16x32_bf16 v[188:191], a[28:31], v[92:95], v[188:191]
    s_add_u32 s46, s81, 64
    ds_read_b64_tr_b16 a[10:11], v4 offset:47680
    ds_read_b128 v[216:219], v19 offset:320
    v_mfma_f32_16x16x32_bf16 v[184:187], a[24:27], v[80:83], v[184:187]
    s_min_u32 s46, s46, 431
    ds_read_b64_tr_b16 a[12:13], v8 offset:15488
    v_mfma_f32_16x16x32_bf16 v[184:187], a[28:31], v[88:91], v[184:187]
    s_waitcnt lgkmcnt(8)
    ds_read_b64_tr_b16 a[14:15], v8 offset:17536
    v_mfma_f32_16x16x32_bf16 v[188:191], a[32:35], v[100:103], v[188:191]
    s_mul_i32 s47, s46, 21846
    ds_read_b64_tr_b16 a[16:17], v8 offset:19584
    v_mfma_f32_16x16x32_bf16 v[188:191], a[36:39], v[108:111], v[188:191]
    s_lshr_b32 s47, s47, 16
    ds_read_b64_tr_b16 a[18:19], v8 offset:52928
    v_mfma_f32_16x16x32_bf16 v[184:187], a[32:35], v[96:99], v[184:187]
    s_mul_i32 s47, s47, 8832
    ds_read_b64_tr_b16 a[20:21], v8 offset:54976
    v_mfma_f32_16x16x32_bf16 v[184:187], a[36:39], v[104:107], v[184:187]
    s_mul_i32 s46, s46, 128
    ds_read_b64_tr_b16 a[22:23], v8 offset:57024
    v_mfma_f32_16x16x32_bf16 v[188:191], a[40:43], v[116:119], v[188:191]
    s_add_u32 s46, s46, s47
    ds_read_b64_tr_b16 a[24:25], v5 offset:6144
    v_mfma_f32_16x16x32_bf16 v[188:191], a[44:47], v[124:127], v[188:191]
    s_add_u32 s46, s46, s89
    ds_read_b64_tr_b16 a[26:27], v5 offset:8192
    buffer_load_dwordx4 a[148:151], v16, s[16:19], s46 offen offset:0
    v_mfma_f32_16x16x32_bf16 v[184:187], a[40:43], v[112:115], v[184:187]
    s_add_u32 m0, s67, 32768
    ds_read_b64_tr_b16 a[28:29], v5 offset:10240
    v_mfma_f32_16x16x32_bf16 v[184:187], a[44:47], v[120:123], v[184:187]
    s_waitcnt lgkmcnt(7)
    ds_read_b64_tr_b16 a[30:31], v5 offset:43584
    v_mfma_f32_16x16x32_bf16 v[196:199], a[0:3], v[84:87], v[196:199]
    s_add_u32 s72, s30, 147584
    ds_read_b64_tr_b16 a[32:33], v5 offset:45632
    buffer_load_dwordx4 v14, s[12:15], s72 offen lds
    v_mfma_f32_16x16x32_bf16 v[196:199], a[4:7], v[92:95], v[196:199]
    ds_read_b64_tr_b16 a[34:35], v5 offset:47680
    ds_read_b128 v[224:227], v19 offset:384
    v_mfma_f32_16x16x32_bf16 v[192:195], a[0:3], v[80:83], v[192:195]
    ds_read_b64_tr_b16 a[36:37], v9 offset:15488
    buffer_load_dwordx4 v15, s[12:15], s72 offen offset:1024 lds
    v_mfma_f32_16x16x32_bf16 v[192:195], a[4:7], v[88:91], v[192:195]
    s_add_u32 s46, s81, 128
    ds_read_b64_tr_b16 a[38:39], v9 offset:17536
    v_mfma_f32_16x16x32_bf16 v[196:199], a[8:11], v[100:103], v[196:199]
    s_min_u32 s46, s46, 431
    ds_read_b64_tr_b16 a[40:41], v9 offset:19584
    v_mfma_f32_16x16x32_bf16 v[196:199], a[12:15], v[108:111], v[196:199]
    s_mul_i32 s47, s46, 21846
    ds_read_b64_tr_b16 a[42:43], v9 offset:52928
    v_mfma_f32_16x16x32_bf16 v[192:195], a[8:11], v[96:99], v[192:195]
    s_lshr_b32 s47, s47, 16
    ds_read_b64_tr_b16 a[44:45], v9 offset:54976
    v_mfma_f32_16x16x32_bf16 v[192:195], a[12:15], v[104:107], v[192:195]
    s_waitcnt vmcnt(26) lgkmcnt(8)
    ds_read_b64_tr_b16 a[46:47], v9 offset:57024
    v_mfma_f32_16x16x32_bf16 v[196:199], a[16:19], v[116:119], v[196:199]
    s_barrier
    ds_read_b64_tr_b16 a[0:1], v2 offset:12288
    v_mfma_f32_16x16x32_bf16 v[196:199], a[20:23], v[124:127], v[196:199]
    s_mul_i32 s47, s47, 8832
    ds_read_b64_tr_b16 a[2:3], v2 offset:14336
    v_mfma_f32_16x16x32_bf16 v[192:195], a[16:19], v[112:115], v[192:195]
    s_mul_i32 s46, s46, 128
    ds_read_b64_tr_b16 a[4:5], v2 offset:16384
    v_mfma_f32_16x16x32_bf16 v[192:195], a[20:23], v[120:123], v[192:195]
    s_add_u32 s46, s46, s47
    ds_read_b64_tr_b16 a[6:7], v2 offset:49728
    v_mfma_f32_16x16x32_bf16 v[204:207], a[24:27], v[84:87], v[204:207]
    s_add_u32 s46, s46, s89
    ds_read_b64_tr_b16 a[8:9], v2 offset:51776
    buffer_load_dwordx4 a[152:155], v16, s[16:19], s46 offen offset:0
    v_mfma_f32_16x16x32_bf16 v[204:207], a[28:31], v[92:95], v[204:207]
    s_add_u32 m0, s67, 34816
    ds_read_b64_tr_b16 a[10:11], v2 offset:53824
    ds_read_b128 v[232:235], v19 offset:448
    v_mfma_f32_16x16x32_bf16 v[200:203], a[24:27], v[80:83], v[200:203]
    s_add_u32 s72, s30, 295040
    ds_read_b64_tr_b16 a[12:13], v6 offset:21632
    buffer_load_dwordx4 v14, s[12:15], s72 offen lds
    v_mfma_f32_16x16x32_bf16 v[200:203], a[28:31], v[88:91], v[200:203]
    s_waitcnt lgkmcnt(8)
    ds_read_b64_tr_b16 a[14:15], v6 offset:23680
    v_mfma_f32_16x16x32_bf16 v[204:207], a[32:35], v[100:103], v[204:207]
    s_add_u32 s46, s81, 192
    ds_read_b64_tr_b16 a[16:17], v6 offset:25728
    v_mfma_f32_16x16x32_bf16 v[204:207], a[36:39], v[108:111], v[204:207]
    s_min_u32 s46, s46, 431
    ds_read_b64_tr_b16 a[18:19], v6 offset:59072
    v_mfma_f32_16x16x32_bf16 v[200:203], a[32:35], v[96:99], v[200:203]
    s_mul_i32 s47, s46, 21846
    ds_read_b64_tr_b16 a[20:21], v6 offset:61120
    v_mfma_f32_16x16x32_bf16 v[200:203], a[36:39], v[104:107], v[200:203]
    s_lshr_b32 s47, s47, 16
    ds_read_b64_tr_b16 a[22:23], v6 offset:63168
    v_mfma_f32_16x16x32_bf16 v[204:207], a[40:43], v[116:119], v[204:207]
    s_mul_i32 s47, s47, 8832
    ds_read_b64_tr_b16 a[24:25], v3 offset:12288
    v_mfma_f32_16x16x32_bf16 v[204:207], a[44:47], v[124:127], v[204:207]
    s_mul_i32 s46, s46, 128
    ds_read_b64_tr_b16 a[26:27], v3 offset:14336
    v_mfma_f32_16x16x32_bf16 v[200:203], a[40:43], v[112:115], v[200:203]
    s_add_u32 s46, s46, s47
    ds_read_b64_tr_b16 a[28:29], v3 offset:16384
    v_mfma_f32_16x16x32_bf16 v[200:203], a[44:47], v[120:123], v[200:203]
    s_waitcnt lgkmcnt(7)
    ds_read_b64_tr_b16 a[30:31], v3 offset:49728
    s_add_u32 s46, s46, s89
    buffer_load_dwordx4 a[156:159], v16, s[16:19], s46 offen offset:0
    buffer_load_dwordx4 v15, s[12:15], s72 offen offset:1024 lds
    v_mfma_f32_16x16x32_bf16 v[180:183], a[0:3], v[132:135], v[180:183]
    ds_read_b64_tr_b16 a[32:33], v3 offset:51776
    v_mfma_f32_16x16x32_bf16 v[180:183], a[4:7], v[140:143], v[180:183]
    s_add_u32 m0, s67, 0
    ds_read_b64_tr_b16 a[34:35], v3 offset:53824
    v_mfma_f32_16x16x32_bf16 v[176:179], a[0:3], v[128:131], v[176:179]
    s_add_u32 s72, s73, 256
    ds_read_b64_tr_b16 a[36:37], v7 offset:21632
    buffer_load_dwordx4 v14, s[12:15], s72 offen lds
    v_mfma_f32_16x16x32_bf16 v[176:179], a[4:7], v[136:139], v[176:179]
    s_add_u32 s46, s81, 256
    ds_read_b64_tr_b16 a[38:39], v7 offset:23680
    v_mfma_f32_16x16x32_bf16 v[180:183], a[8:11], v[148:151], v[180:183]
    s_min_u32 s46, s46, 431
    ds_read_b64_tr_b16 a[40:41], v7 offset:25728
    v_mfma_f32_16x16x32_bf16 v[180:183], a[12:15], v[156:159], v[180:183]
    s_mul_i32 s47, s46, 21846
    ds_read_b64_tr_b16 a[42:43], v7 offset:59072
    v_mfma_f32_16x16x32_bf16 v[176:179], a[8:11], v[144:147], v[176:179]
    s_lshr_b32 s47, s47, 16
    ds_read_b64_tr_b16 a[44:45], v7 offset:61120
    v_mfma_f32_16x16x32_bf16 v[176:179], a[12:15], v[152:155], v[176:179]
    s_waitcnt lgkmcnt(7)
    ds_read_b64_tr_b16 a[46:47], v7 offset:63168
    v_mfma_f32_16x16x32_bf16 v[180:183], a[16:19], v[164:167], v[180:183]
    s_mul_i32 s47, s47, 8832
    ds_read_b64_tr_b16 a[0:1], v4 offset:12288
    v_mfma_f32_16x16x32_bf16 v[180:183], a[20:23], v[172:175], v[180:183]
    s_mul_i32 s46, s46, 128
    ds_read_b64_tr_b16 a[2:3], v4 offset:14336
    v_mfma_f32_16x16x32_bf16 v[176:179], a[16:19], v[160:163], v[176:179]
    s_add_u32 s46, s46, s47
    ds_read_b64_tr_b16 a[4:5], v4 offset:16384
    v_mfma_f32_16x16x32_bf16 v[176:179], a[20:23], v[168:171], v[176:179]
    s_add_u32 s46, s46, s89
    ds_read_b64_tr_b16 a[6:7], v4 offset:49728
    buffer_load_dwordx4 a[160:163], v16, s[16:19], s46 offen offset:0
    v_mfma_f32_16x16x32_bf16 v[188:191], a[24:27], v[132:135], v[188:191]
    ds_read_b64_tr_b16 a[8:9], v4 offset:51776
    buffer_load_dwordx4 v15, s[12:15], s72 offen offset:1024 lds
    v_mfma_f32_16x16x32_bf16 v[188:191], a[28:31], v[140:143], v[188:191]
    s_add_u32 s46, s81, 320
    ds_read_b64_tr_b16 a[10:11], v4 offset:53824
    v_mfma_f32_16x16x32_bf16 v[184:187], a[24:27], v[128:131], v[184:187]
    s_min_u32 s46, s46, 431
    ds_read_b64_tr_b16 a[12:13], v8 offset:21632
    v_mfma_f32_16x16x32_bf16 v[184:187], a[28:31], v[136:139], v[184:187]
    s_waitcnt lgkmcnt(7)
    ds_read_b64_tr_b16 a[14:15], v8 offset:23680
    v_mfma_f32_16x16x32_bf16 v[188:191], a[32:35], v[148:151], v[188:191]
    s_mul_i32 s47, s46, 21846
    ds_read_b64_tr_b16 a[16:17], v8 offset:25728
    v_mfma_f32_16x16x32_bf16 v[188:191], a[36:39], v[156:159], v[188:191]
    s_lshr_b32 s47, s47, 16
    ds_read_b64_tr_b16 a[18:19], v8 offset:59072
    v_mfma_f32_16x16x32_bf16 v[184:187], a[32:35], v[144:147], v[184:187]
    s_mul_i32 s47, s47, 8832
    ds_read_b64_tr_b16 a[20:21], v8 offset:61120
    v_mfma_f32_16x16x32_bf16 v[184:187], a[36:39], v[152:155], v[184:187]
    s_mul_i32 s46, s46, 128
    ds_read_b64_tr_b16 a[22:23], v8 offset:63168
    v_mfma_f32_16x16x32_bf16 v[188:191], a[40:43], v[164:167], v[188:191]
    s_add_u32 s46, s46, s47
    ds_read_b64_tr_b16 a[24:25], v5 offset:12288
    v_mfma_f32_16x16x32_bf16 v[188:191], a[44:47], v[172:175], v[188:191]
    s_add_u32 s46, s46, s89
    ds_read_b64_tr_b16 a[26:27], v5 offset:14336
    buffer_load_dwordx4 a[164:167], v16, s[16:19], s46 offen offset:0
    v_mfma_f32_16x16x32_bf16 v[184:187], a[40:43], v[160:163], v[184:187]
    s_add_u32 m0, s67, 2048
    ds_read_b64_tr_b16 a[28:29], v5 offset:16384
    v_mfma_f32_16x16x32_bf16 v[184:187], a[44:47], v[168:171], v[184:187]
    s_waitcnt lgkmcnt(7)
    ds_read_b64_tr_b16 a[30:31], v5 offset:49728
    v_mfma_f32_16x16x32_bf16 v[196:199], a[0:3], v[132:135], v[196:199]
    s_add_u32 s72, s73, 147712
    ds_read_b64_tr_b16 a[32:33], v5 offset:51776
    buffer_load_dwordx4 v14, s[12:15], s72 offen lds
    v_mfma_f32_16x16x32_bf16 v[196:199], a[4:7], v[140:143], v[196:199]
    s_add_u32 s46, s81, 384
    ds_read_b64_tr_b16 a[34:35], v5 offset:53824
    v_mfma_f32_16x16x32_bf16 v[192:195], a[0:3], v[128:131], v[192:195]
    s_min_u32 s46, s46, 431
    ds_read_b64_tr_b16 a[36:37], v9 offset:21632
    v_mfma_f32_16x16x32_bf16 v[192:195], a[4:7], v[136:139], v[192:195]
    s_mul_i32 s47, s46, 21846
    ds_read_b64_tr_b16 a[38:39], v9 offset:23680
    v_mfma_f32_16x16x32_bf16 v[196:199], a[8:11], v[148:151], v[196:199]
    s_lshr_b32 s47, s47, 16
    ds_read_b64_tr_b16 a[40:41], v9 offset:25728
    v_mfma_f32_16x16x32_bf16 v[196:199], a[12:15], v[156:159], v[196:199]
    s_mul_i32 s47, s47, 8832
    ds_read_b64_tr_b16 a[42:43], v9 offset:59072
    v_mfma_f32_16x16x32_bf16 v[192:195], a[8:11], v[144:147], v[192:195]
    s_mul_i32 s46, s46, 128
    ds_read_b64_tr_b16 a[44:45], v9 offset:61120
    v_mfma_f32_16x16x32_bf16 v[192:195], a[12:15], v[152:155], v[192:195]
    s_waitcnt vmcnt(21) lgkmcnt(7)
    ds_read_b64_tr_b16 a[46:47], v9 offset:63168
    v_mfma_f32_16x16x32_bf16 v[196:199], a[16:19], v[164:167], v[196:199]
    s_barrier
    ds_read_b64_tr_b16 a[0:1], v2 offset:18432
    v_mfma_f32_16x16x32_bf16 v[196:199], a[20:23], v[172:175], v[196:199]
    s_add_u32 s46, s46, s47
    ds_read_b64_tr_b16 a[2:3], v2 offset:20480
    v_mfma_f32_16x16x32_bf16 v[192:195], a[16:19], v[160:163], v[192:195]
    s_add_u32 s46, s46, s89
    ds_read_b64_tr_b16 a[4:5], v2 offset:22528
    buffer_load_dwordx4 a[168:171], v16, s[16:19], s46 offen offset:0
    v_mfma_f32_16x16x32_bf16 v[192:195], a[20:23], v[168:171], v[192:195]
    ds_read_b64_tr_b16 a[6:7], v2 offset:55872
    buffer_load_dwordx4 v15, s[12:15], s72 offen offset:1024 lds
    v_mfma_f32_16x16x32_bf16 v[204:207], a[24:27], v[132:135], v[204:207]
    s_add_u32 s46, s81, 0
    ds_read_b64_tr_b16 a[8:9], v2 offset:57920
    v_mfma_f32_16x16x32_bf16 v[204:207], a[28:31], v[140:143], v[204:207]
    s_min_u32 s46, s46, 143
    ds_read_b64_tr_b16 a[10:11], v2 offset:59968
    v_mfma_f32_16x16x32_bf16 v[200:203], a[24:27], v[128:131], v[200:203]
    s_mul_i32 s47, s46, 32768
    ds_read_b64_tr_b16 a[12:13], v6 offset:27776
    v_mfma_f32_16x16x32_bf16 v[200:203], a[28:31], v[136:139], v[200:203]
    s_waitcnt lgkmcnt(7)
    ds_read_b64_tr_b16 a[14:15], v6 offset:29824
    v_mfma_f32_16x16x32_bf16 v[204:207], a[32:35], v[148:151], v[204:207]
    s_lshr_b32 s47, s47, 16
    ds_read_b64_tr_b16 a[16:17], v6 offset:31872
    v_mfma_f32_16x16x32_bf16 v[204:207], a[36:39], v[156:159], v[204:207]
    s_mul_i32 s47, s47, 8960
    ds_read_b64_tr_b16 a[18:19], v6 offset:65216
    v_mfma_f32_16x16x32_bf16 v[200:203], a[32:35], v[144:147], v[200:203]
    s_mul_i32 s46, s46, 128
    ds_read_b64_tr_b16 a[20:21], v10 offset:1728
    v_mfma_f32_16x16x32_bf16 v[200:203], a[36:39], v[152:155], v[200:203]
    s_add_u32 s46, s46, s47
    ds_read_b64_tr_b16 a[22:23], v10 offset:3776
    v_mfma_f32_16x16x32_bf16 v[204:207], a[40:43], v[164:167], v[204:207]
    s_add_u32 s46, s46, s3
    ds_read_b64_tr_b16 a[24:25], v3 offset:18432
    buffer_load_dwordx4 a[176:179], v16, s[4:7], s46 offen offset:0
    v_mfma_f32_16x16x32_bf16 v[204:207], a[44:47], v[172:175], v[204:207]
    s_add_u32 m0, s67, 4096
    ds_read_b64_tr_b16 a[26:27], v3 offset:20480
    v_mfma_f32_16x16x32_bf16 v[200:203], a[40:43], v[160:163], v[200:203]
    s_add_u32 s72, s73, 295168
    ds_read_b64_tr_b16 a[28:29], v3 offset:22528
    buffer_load_dwordx4 v14, s[12:15], s72 offen lds
    v_mfma_f32_16x16x32_bf16 v[200:203], a[44:47], v[168:171], v[200:203]
    s_waitcnt lgkmcnt(7)
    ds_read_b64_tr_b16 a[30:31], v3 offset:55872
    s_add_u32 s46, s81, 64
    s_min_u32 s46, s46, 143
    s_mul_i32 s47, s46, 32768
    s_lshr_b32 s47, s47, 16
    s_mul_i32 s47, s47, 8960
    s_mul_i32 s46, s46, 128
    s_add_u32 s46, s46, s47
    s_add_u32 s46, s46, s3
    buffer_load_dwordx4 a[180:183], v16, s[4:7], s46 offen offset:0
    buffer_load_dwordx4 v15, s[12:15], s72 offen offset:1024 lds
    s_add_u32 s46, s81, 128
    s_min_u32 s46, s46, 143
    s_mul_i32 s47, s46, 32768
    s_lshr_b32 s47, s47, 16
    s_mul_i32 s47, s47, 8960
    s_mul_i32 s46, s46, 128
    s_add_u32 s46, s46, s47
    s_add_u32 s46, s46, s3
    buffer_load_dwordx4 a[184:187], v16, s[4:7], s46 offen offset:0
    v_mfma_f32_16x16x32_bf16 v[212:215], a[0:3], v[36:39], v[208:211]
    s_mov_b32 s24, s56
    ds_read_b64_tr_b16 a[32:33], v3 offset:57920
    v_mfma_f32_16x16x32_bf16 v[212:215], a[4:7], v[44:47], v[212:215]
    s_and_b32 s25, s57, 0xffff
    ds_read_b64_tr_b16 a[34:35], v3 offset:59968
    v_mfma_f32_16x16x32_bf16 v[208:211], a[0:3], v[32:35], v[208:211]
    s_mov_b32 s26, 0x240000
    ds_read_b64_tr_b16 a[36:37], v7 offset:27776
    v_mfma_f32_16x16x32_bf16 v[208:211], a[4:7], v[40:43], v[208:211]
    s_add_u32 m0, s67, 6144
    ds_read_b64_tr_b16 a[38:39], v7 offset:29824
    v_mfma_f32_16x16x32_bf16 v[212:215], a[8:11], v[52:55], v[212:215]
    s_add_u32 s72, s29, 256
    ds_read_b64_tr_b16 a[40:41], v7 offset:31872
    buffer_load_dwordx4 v14, s[12:15], s72 offen lds
    v_mfma_f32_16x16x32_bf16 v[212:215], a[12:15], v[60:63], v[212:215]
    s_mov_b32 s27, 0x20000
    ds_read_b64_tr_b16 a[42:43], v7 offset:65216
    v_mfma_f32_16x16x32_bf16 v[208:211], a[8:11], v[48:51], v[208:211]
    s_mul_i32 s74, s62, 18432
    ds_read_b64_tr_b16 a[44:45], v11 offset:1728
    v_mfma_f32_16x16x32_bf16 v[208:211], a[12:15], v[56:59], v[208:211]
    s_waitcnt lgkmcnt(7)
    ds_read_b64_tr_b16 a[46:47], v11 offset:3776
    v_mfma_f32_16x16x32_bf16 v[212:215], a[16:19], v[68:71], v[212:215]
    s_add_u32 s74, s74, s89
    ds_read_b64_tr_b16 a[0:1], v4 offset:18432
    v_mfma_f32_16x16x32_bf16 v[212:215], a[20:23], v[76:79], v[212:215]
    s_mul_i32 s69, s63, 442368
    ds_read_b64_tr_b16 a[2:3], v4 offset:20480
    v_mfma_f32_16x16x32_bf16 v[208:211], a[16:19], v[64:67], v[208:211]
    s_mul_i32 s70, s62, 36864
    ds_read_b64_tr_b16 a[4:5], v4 offset:22528
    v_mfma_f32_16x16x32_bf16 v[208:211], a[20:23], v[72:75], v[208:211]
    s_add_u32 s69, s69, s70
    ds_read_b64_tr_b16 a[6:7], v4 offset:55872
    v_mfma_f32_16x16x32_bf16 v[220:223], a[24:27], v[36:39], v[216:219]
    s_add_u32 s69, s69, s96
    ds_read_b64_tr_b16 a[8:9], v4 offset:57920
    buffer_load_dwordx4 v15, s[12:15], s72 offen offset:1024 lds
    v_mfma_f32_16x16x32_bf16 v[220:223], a[28:31], v[44:47], v[220:223]
    s_add_u32 s69, s69, 0x30000
    ds_read_b64_tr_b16 a[10:11], v4 offset:59968
    v_mfma_f32_16x16x32_bf16 v[216:219], a[24:27], v[32:35], v[216:219]
    s_add_u32 s70, s65, 2
    ds_read_b64_tr_b16 a[12:13], v8 offset:27776
    v_mul_f32 v176, v176, |v176|
    v_mfma_f32_16x16x32_bf16 v[216:219], a[28:31], v[40:43], v[216:219]
    s_waitcnt lgkmcnt(7)
    ds_read_b64_tr_b16 a[14:15], v8 offset:29824
    v_mul_f32 v177, v177, |v177|
    v_mfma_f32_16x16x32_bf16 v[220:223], a[32:35], v[52:55], v[220:223]
    ds_read_b64_tr_b16 a[16:17], v8 offset:31872
    v_mul_f32 v178, v178, |v178|
    v_mfma_f32_16x16x32_bf16 v[220:223], a[36:39], v[60:63], v[220:223]
    ds_read_b64_tr_b16 a[18:19], v8 offset:65216
    v_mfma_f32_16x16x32_bf16 v[216:219], a[32:35], v[48:51], v[216:219]
    ds_read_b64_tr_b16 a[20:21], v12 offset:1728
    v_mul_f32 v179, v179, |v179|
    v_mfma_f32_16x16x32_bf16 v[216:219], a[36:39], v[56:59], v[216:219]
    s_add_u32 m0, s67, 8192
    ds_read_b64_tr_b16 a[22:23], v12 offset:3776
    v_cvt_pk_bf16_f32 v240, v176, v177
    v_mfma_f32_16x16x32_bf16 v[220:223], a[40:43], v[68:71], v[220:223]
    s_add_u32 s72, s29, 147712
    ds_read_b64_tr_b16 a[24:25], v5 offset:18432
    buffer_load_dwordx4 v14, s[12:15], s72 offen lds
    v_mfma_f32_16x16x32_bf16 v[220:223], a[44:47], v[76:79], v[220:223]
    ds_read_b64_tr_b16 a[26:27], v5 offset:20480
    v_cvt_pk_bf16_f32 v241, v178, v179
    v_mfma_f32_16x16x32_bf16 v[216:219], a[40:43], v[64:67], v[216:219]
    ds_read_b64_tr_b16 a[28:29], v5 offset:22528
    v_mul_f32 v184, v184, |v184|
    v_mfma_f32_16x16x32_bf16 v[216:219], a[44:47], v[72:75], v[216:219]
    s_waitcnt lgkmcnt(7)
    ds_read_b64_tr_b16 a[30:31], v5 offset:55872
    v_mul_f32 v185, v185, |v185|
    v_mfma_f32_16x16x32_bf16 v[228:231], a[0:3], v[36:39], v[224:227]
    ds_read_b64_tr_b16 a[32:33], v5 offset:57920
    v_mul_f32 v186, v186, |v186|
    v_mfma_f32_16x16x32_bf16 v[228:231], a[4:7], v[44:47], v[228:231]
    ds_read_b64_tr_b16 a[34:35], v5 offset:59968
    v_mul_f32 v187, v187, |v187|
    v_mfma_f32_16x16x32_bf16 v[224:227], a[0:3], v[32:35], v[224:227]
    ds_read_b64_tr_b16 a[36:37], v9 offset:27776
    v_cvt_pk_bf16_f32 v242, v184, v185
    v_mfma_f32_16x16x32_bf16 v[224:227], a[4:7], v[40:43], v[224:227]
    ds_read_b64_tr_b16 a[38:39], v9 offset:29824
    v_cvt_pk_bf16_f32 v243, v186, v187
    v_mfma_f32_16x16x32_bf16 v[228:231], a[8:11], v[52:55], v[228:231]
    ds_read_b64_tr_b16 a[40:41], v9 offset:31872
    buffer_load_dwordx4 v15, s[12:15], s72 offen offset:1024 lds
    v_mfma_f32_16x16x32_bf16 v[228:231], a[12:15], v[60:63], v[228:231]
    ds_read_b64_tr_b16 a[42:43], v9 offset:65216
    v_pk_max_i16 v240, v240, 0
    v_mfma_f32_16x16x32_bf16 v[224:227], a[8:11], v[48:51], v[224:227]
    ds_read_b64_tr_b16 a[44:45], v13 offset:1728
    v_pk_max_i16 v241, v241, 0
    v_mfma_f32_16x16x32_bf16 v[224:227], a[12:15], v[56:59], v[224:227]
    s_waitcnt vmcnt(26) lgkmcnt(7)
    ds_read_b64_tr_b16 a[46:47], v13 offset:3776
    v_pk_max_i16 v242, v242, 0
    v_mfma_f32_16x16x32_bf16 v[228:231], a[16:19], v[68:71], v[228:231]
    s_barrier
    ds_read_b64_tr_b16 a[0:1], v2 offset:24576
    v_mfma_f32_16x16x32_bf16 v[228:231], a[20:23], v[76:79], v[228:231]
    ds_read_b64_tr_b16 a[2:3], v2 offset:26624
    v_pk_max_i16 v243, v243, 0
    v_mfma_f32_16x16x32_bf16 v[224:227], a[16:19], v[64:67], v[224:227]
    ds_read_b64_tr_b16 a[4:5], v2 offset:28672
    v_accvgpr_write_b32 a48, v240
    v_mfma_f32_16x16x32_bf16 v[224:227], a[20:23], v[72:75], v[224:227]
    s_add_u32 m0, s67, 10240
    ds_read_b64_tr_b16 a[6:7], v2 offset:62016
    v_accvgpr_write_b32 a49, v241
    v_mfma_f32_16x16x32_bf16 v[236:239], a[24:27], v[36:39], v[232:235]
    s_add_u32 s72, s29, 295168
    ds_read_b64_tr_b16 a[8:9], v2 offset:64064
    buffer_load_dwordx4 v14, s[12:15], s72 offen lds
    v_mfma_f32_16x16x32_bf16 v[236:239], a[28:31], v[44:47], v[236:239]
    ds_read_b64_tr_b16 a[10:11], v6 offset:576
    v_accvgpr_write_b32 a50, v242
    v_mfma_f32_16x16x32_bf16 v[232:235], a[24:27], v[32:35], v[232:235]
    ds_read_b64_tr_b16 a[12:13], v6 offset:33920
    v_accvgpr_write_b32 a51, v243
    v_mfma_f32_16x16x32_bf16 v[232:235], a[28:31], v[40:43], v[232:235]
    s_waitcnt lgkmcnt(7)
    ds_read_b64_tr_b16 a[14:15], v6 offset:35968
    v_mul_f32 v180, v180, |v180|
    v_mfma_f32_16x16x32_bf16 v[236:239], a[32:35], v[52:55], v[236:239]
    ds_read_b64_tr_b16 a[16:17], v6 offset:38016
    v_mul_f32 v181, v181, |v181|
    v_mfma_f32_16x16x32_bf16 v[236:239], a[36:39], v[60:63], v[236:239]
    ds_read_b64_tr_b16 a[18:19], v10 offset:5824
    v_mul_f32 v182, v182, |v182|
    v_mfma_f32_16x16x32_bf16 v[232:235], a[32:35], v[48:51], v[232:235]
    ds_read_b64_tr_b16 a[20:21], v10 offset:7872
    v_mul_f32 v183, v183, |v183|
    v_mfma_f32_16x16x32_bf16 v[232:235], a[36:39], v[56:59], v[232:235]
    ds_read_b64_tr_b16 a[22:23], v10 offset:9920
    v_cvt_pk_bf16_f32 v244, v180, v181
    v_mfma_f32_16x16x32_bf16 v[236:239], a[40:43], v[68:71], v[236:239]
    ds_read_b64_tr_b16 a[24:25], v3 offset:24576
    buffer_load_dwordx4 v15, s[12:15], s72 offen offset:1024 lds
    v_mfma_f32_16x16x32_bf16 v[236:239], a[44:47], v[76:79], v[236:239]
    ds_read_b64_tr_b16 a[26:27], v3 offset:26624
    v_cvt_pk_bf16_f32 v245, v182, v183
    v_mfma_f32_16x16x32_bf16 v[232:235], a[40:43], v[64:67], v[232:235]
    ds_read_b64_tr_b16 a[28:29], v3 offset:28672
    v_mul_f32 v188, v188, |v188|
    v_mfma_f32_16x16x32_bf16 v[232:235], a[44:47], v[72:75], v[232:235]
    s_waitcnt lgkmcnt(7)
    ds_read_b64_tr_b16 a[30:31], v3 offset:62016
    v_mul_f32 v189, v189, |v189|
    v_mfma_f32_16x16x32_bf16 v[212:215], a[0:3], v[84:87], v[212:215]
    ds_read_b64_tr_b16 a[32:33], v3 offset:64064
    s_cmp_ge_u32 s70, 3
    s_cselect_b32 s71, 3, 0
    s_sub_u32 s70, s70, s71
    v_mfma_f32_16x16x32_bf16 v[212:215], a[4:7], v[92:95], v[212:215]
    s_mul_i32 s71, s70, 147456
    ds_read_b64_tr_b16 a[34:35], v7 offset:576
    v_mfma_f32_16x16x32_bf16 v[208:211], a[0:3], v[80:83], v[208:211]
    s_add_u32 s77, s69, s71
    ds_read_b64_tr_b16 a[36:37], v7 offset:33920
    v_mfma_f32_16x16x32_bf16 v[208:211], a[4:7], v[88:91], v[208:211]
    s_add_u32 m0, s67, 12288
    ds_read_b64_tr_b16 a[38:39], v7 offset:35968
    v_mfma_f32_16x16x32_bf16 v[212:215], a[8:11], v[100:103], v[212:215]
    s_add_u32 s72, s30, 256
    ds_read_b64_tr_b16 a[40:41], v7 offset:38016
    buffer_load_dwordx4 v14, s[12:15], s72 offen lds
    v_mfma_f32_16x16x32_bf16 v[212:215], a[12:15], v[108:111], v[212:215]
    s_mul_i32 s71, s70, 442368
    ds_read_b64_tr_b16 a[42:43], v11 offset:5824
    v_mfma_f32_16x16x32_bf16 v[208:211], a[8:11], v[96:99], v[208:211]
    s_add_u32 s85, s74, s71
    ds_read_b64_tr_b16 a[44:45], v11 offset:7872
    v_mfma_f32_16x16x32_bf16 v[208:211], a[12:15], v[104:107], v[208:211]
    s_waitcnt lgkmcnt(7)
    ds_read_b64_tr_b16 a[46:47], v11 offset:9920
    v_mfma_f32_16x16x32_bf16 v[212:215], a[16:19], v[116:119], v[212:215]
    s_add_u32 s70, s65, 1
L_pad_m2_0:
    s_cbranch_execz L_pad_m2_1
    ds_read_b64_tr_b16 a[0:1], v4 offset:24576
    s_cmp_ge_u32 s70, 3
    s_cselect_b32 s71, 3, 0
    s_sub_u32 s70, s70, s71
    v_mfma_f32_16x16x32_bf16 v[212:215], a[20:23], v[124:127], v[212:215]
    s_mul_i32 s71, s70, 147456
    ds_read_b64_tr_b16 a[2:3], v4 offset:26624
    v_mfma_f32_16x16x32_bf16 v[208:211], a[16:19], v[112:115], v[208:211]
    s_add_u32 s76, s69, s71
    ds_read_b64_tr_b16 a[4:5], v4 offset:28672
    v_mfma_f32_16x16x32_bf16 v[208:211], a[20:23], v[120:123], v[208:211]
    s_mul_i32 s71, s70, 442368
    ds_read_b64_tr_b16 a[6:7], v4 offset:62016
    v_mfma_f32_16x16x32_bf16 v[220:223], a[24:27], v[84:87], v[220:223]
    s_add_u32 s84, s74, s71
    ds_read_b64_tr_b16 a[8:9], v4 offset:64064
    buffer_load_dwordx4 v15, s[12:15], s72 offen offset:1024 lds
    v_mfma_f32_16x16x32_bf16 v[220:223], a[28:31], v[92:95], v[220:223]
    s_add_u32 s70, s65, 0
    ds_read_b64_tr_b16 a[10:11], v8 offset:576
    v_mfma_f32_16x16x32_bf16 v[216:219], a[24:27], v[80:83], v[216:219]
    ds_read_b64_tr_b16 a[12:13], v8 offset:33920
    v_mul_f32 v190, v190, |v190|
    v_mfma_f32_16x16x32_bf16 v[216:219], a[28:31], v[88:91], v[216:219]
    s_waitcnt lgkmcnt(7)
    ds_read_b64_tr_b16 a[14:15], v8 offset:35968
    v_mul_f32 v191, v191, |v191|
    v_mfma_f32_16x16x32_bf16 v[220:223], a[32:35], v[100:103], v[220:223]
    ds_read_b64_tr_b16 a[16:17], v8 offset:38016
    v_cvt_pk_bf16_f32 v246, v188, v189
    v_mfma_f32_16x16x32_bf16 v[220:223], a[36:39], v[108:111], v[220:223]
    ds_read_b64_tr_b16 a[18:19], v12 offset:5824
    v_mfma_f32_16x16x32_bf16 v[216:219], a[32:35], v[96:99], v[216:219]
    ds_read_b64_tr_b16 a[20:21], v12 offset:7872
    v_cvt_pk_bf16_f32 v247, v190, v191
    v_mfma_f32_16x16x32_bf16 v[216:219], a[36:39], v[104:107], v[216:219]
    s_add_u32 m0, s67, 14336
    ds_read_b64_tr_b16 a[22:23], v12 offset:9920
    v_pk_max_i16 v244, v244, 0
    v_mfma_f32_16x16x32_bf16 v[220:223], a[40:43], v[116:119], v[220:223]
    s_add_u32 s72, s30, 147712
    ds_read_b64_tr_b16 a[24:25], v5 offset:24576
    buffer_load_dwordx4 v14, s[12:15], s72 offen lds
    v_mfma_f32_16x16x32_bf16 v[220:223], a[44:47], v[124:127], v[220:223]
    ds_read_b64_tr_b16 a[26:27], v5 offset:26624
    v_pk_max_i16 v245, v245, 0
    v_mfma_f32_16x16x32_bf16 v[216:219], a[40:43], v[112:115], v[216:219]
    ds_read_b64_tr_b16 a[28:29], v5 offset:28672
    v_pk_max_i16 v246, v246, 0
    v_mfma_f32_16x16x32_bf16 v[216:219], a[44:47], v[120:123], v[216:219]
    s_waitcnt lgkmcnt(7)
    ds_read_b64_tr_b16 a[30:31], v5 offset:62016
    v_pk_max_i16 v247, v247, 0
    v_mfma_f32_16x16x32_bf16 v[228:231], a[0:3], v[84:87], v[228:231]
    ds_read_b64_tr_b16 a[32:33], v5 offset:64064
    v_accvgpr_write_b32 a52, v244
    v_mfma_f32_16x16x32_bf16 v[228:231], a[4:7], v[92:95], v[228:231]
    ds_read_b64_tr_b16 a[34:35], v9 offset:576
    v_accvgpr_write_b32 a53, v245
    v_mfma_f32_16x16x32_bf16 v[224:227], a[0:3], v[80:83], v[224:227]
    ds_read_b64_tr_b16 a[36:37], v9 offset:33920
    v_accvgpr_write_b32 a54, v246
    v_mfma_f32_16x16x32_bf16 v[224:227], a[4:7], v[88:91], v[224:227]
    ds_read_b64_tr_b16 a[38:39], v9 offset:35968
    v_accvgpr_write_b32 a55, v247
    v_mfma_f32_16x16x32_bf16 v[228:231], a[8:11], v[100:103], v[228:231]
    ds_read_b64_tr_b16 a[40:41], v9 offset:38016
    buffer_load_dwordx4 v15, s[12:15], s72 offen offset:1024 lds
    v_mfma_f32_16x16x32_bf16 v[228:231], a[12:15], v[108:111], v[228:231]
    ds_read_b64_tr_b16 a[42:43], v13 offset:5824
    ds_read_b128 v[176:179], v19 offset:512
    v_mfma_f32_16x16x32_bf16 v[224:227], a[8:11], v[96:99], v[224:227]
    ds_read_b64_tr_b16 a[44:45], v13 offset:7872
    ds_read_b128 v[184:187], v19 offset:576
    v_mfma_f32_16x16x32_bf16 v[224:227], a[12:15], v[104:107], v[224:227]
    s_waitcnt vmcnt(22) lgkmcnt(9)
    ds_read_b64_tr_b16 a[46:47], v13 offset:9920
    v_mul_f32 v192, v192, |v192|
    v_mfma_f32_16x16x32_bf16 v[228:231], a[16:19], v[116:119], v[228:231]
    s_barrier
    ds_read_b64_tr_b16 a[0:1], v2 offset:30720
    v_mfma_f32_16x16x32_bf16 v[228:231], a[20:23], v[124:127], v[228:231]
    ds_read_b64_tr_b16 a[2:3], v2 offset:32768
    v_mul_f32 v193, v193, |v193|
    v_mfma_f32_16x16x32_bf16 v[224:227], a[16:19], v[112:115], v[224:227]
    ds_read_b64_tr_b16 a[4:5], v2 offset:34816
    v_mul_f32 v194, v194, |v194|
    v_mfma_f32_16x16x32_bf16 v[224:227], a[20:23], v[120:123], v[224:227]
    s_add_u32 m0, s67, 16384
    ds_read_b64_tr_b16 a[6:7], v6 offset:2624
    v_mul_f32 v195, v195, |v195|
    v_mfma_f32_16x16x32_bf16 v[236:239], a[24:27], v[84:87], v[236:239]
    s_add_u32 s72, s30, 295168
    ds_read_b64_tr_b16 a[8:9], v6 offset:4672
    buffer_load_dwordx4 v14, s[12:15], s72 offen lds
    v_mfma_f32_16x16x32_bf16 v[236:239], a[28:31], v[92:95], v[236:239]
    ds_read_b64_tr_b16 a[10:11], v6 offset:6720
    v_cvt_pk_bf16_f32 v248, v192, v193
    v_mfma_f32_16x16x32_bf16 v[232:235], a[24:27], v[80:83], v[232:235]
    ds_read_b64_tr_b16 a[12:13], v6 offset:40064
    v_cvt_pk_bf16_f32 v249, v194, v195
    v_mfma_f32_16x16x32_bf16 v[232:235], a[28:31], v[88:91], v[232:235]
    s_waitcnt lgkmcnt(7)
    ds_read_b64_tr_b16 a[14:15], v6 offset:42112
    v_mul_f32 v200, v200, |v200|
    v_mfma_f32_16x16x32_bf16 v[236:239], a[32:35], v[100:103], v[236:239]
    ds_read_b64_tr_b16 a[16:17], v6 offset:44160
    v_mul_f32 v201, v201, |v201|
    v_mfma_f32_16x16x32_bf16 v[236:239], a[36:39], v[108:111], v[236:239]
    ds_read_b64_tr_b16 a[18:19], v10 offset:11968
    v_mul_f32 v202, v202, |v202|
    v_mfma_f32_16x16x32_bf16 v[232:235], a[32:35], v[96:99], v[232:235]
    ds_read_b64_tr_b16 a[20:21], v10 offset:14016
    v_mul_f32 v203, v203, |v203|
    v_mfma_f32_16x16x32_bf16 v[232:235], a[36:39], v[104:107], v[232:235]
    ds_read_b64_tr_b16 a[22:23], v10 offset:16064
    v_cvt_pk_bf16_f32 v250, v200, v201
    v_mfma_f32_16x16x32_bf16 v[236:239], a[40:43], v[116:119], v[236:239]
    ds_read_b64_tr_b16 a[24:25], v3 offset:30720
    buffer_load_dwordx4 v15, s[12:15], s72 offen offset:1024 lds
    v_mfma_f32_16x16x32_bf16 v[236:239], a[44:47], v[124:127], v[236:239]
    ds_read_b64_tr_b16 a[26:27], v3 offset:32768
    v_cvt_pk_bf16_f32 v251, v202, v203
    v_mfma_f32_16x16x32_bf16 v[232:235], a[40:43], v[112:115], v[232:235]
    ds_read_b64_tr_b16 a[28:29], v3 offset:34816
    v_pk_max_i16 v248, v248, 0
    v_mfma_f32_16x16x32_bf16 v[232:235], a[44:47], v[120:123], v[232:235]
    s_waitcnt lgkmcnt(7)
    ds_read_b64_tr_b16 a[30:31], v7 offset:2624
    v_pk_max_i16 v249, v249, 0
    v_mfma_f32_16x16x32_bf16 v[212:215], a[0:3], v[132:135], v[212:215]
    ds_read_b64_tr_b16 a[32:33], v7 offset:4672
    s_cmp_ge_u32 s70, 3
    s_cselect_b32 s71, 3, 0
    s_sub_u32 s70, s70, s71
    v_mfma_f32_16x16x32_bf16 v[212:215], a[4:7], v[140:143], v[212:215]
    s_mul_i32 s71, s70, 147456
    ds_read_b64_tr_b16 a[34:35], v7 offset:6720
    v_mfma_f32_16x16x32_bf16 v[208:211], a[0:3], v[128:131], v[208:211]
    s_add_u32 s75, s69, s71
    ds_read_b64_tr_b16 a[36:37], v7 offset:40064
    v_mfma_f32_16x16x32_bf16 v[208:211], a[4:7], v[136:139], v[208:211]
    s_add_u32 m0, s67, 18432
    ds_read_b64_tr_b16 a[38:39], v7 offset:42112
    v_mfma_f32_16x16x32_bf16 v[212:215], a[8:11], v[148:151], v[212:215]
    s_add_u32 s72, s73, 384
    ds_read_b64_tr_b16 a[40:41], v7 offset:44160
    buffer_load_dwordx4 v14, s[12:15], s72 offen lds
    v_mfma_f32_16x16x32_bf16 v[212:215], a[12:15], v[156:159], v[212:215]
    s_mul_i32 s71, s70, 442368
    ds_read_b64_tr_b16 a[42:43], v11 offset:11968
    v_mfma_f32_16x16x32_bf16 v[208:211], a[8:11], v[144:147], v[208:211]
    s_add_u32 s74, s74, s71
    ds_read_b64_tr_b16 a[44:45], v11 offset:14016
    v_mfma_f32_16x16x32_bf16 v[208:211], a[12:15], v[152:155], v[208:211]
    s_waitcnt lgkmcnt(7)
    ds_read_b64_tr_b16 a[46:47], v11 offset:16064
    v_mfma_f32_16x16x32_bf16 v[212:215], a[16:19], v[164:167], v[212:215]
    s_lshl_b32 s68, s63, 2
    ds_read_b64_tr_b16 a[0:1], v4 offset:30720
    v_mfma_f32_16x16x32_bf16 v[212:215], a[20:23], v[172:175], v[212:215]
    s_add_u32 s68, s68, s62
    ds_read_b64_tr_b16 a[2:3], v4 offset:32768
    v_mfma_f32_16x16x32_bf16 v[208:211], a[16:19], v[160:163], v[208:211]
    s_lshl_b32 s68, s68, 9
    ds_read_b64_tr_b16 a[4:5], v4 offset:34816
    v_mfma_f32_16x16x32_bf16 v[208:211], a[20:23], v[168:171], v[208:211]
    s_add_u32 s68, s68, s96
    ds_read_b64_tr_b16 a[6:7], v8 offset:2624
    v_mfma_f32_16x16x32_bf16 v[220:223], a[24:27], v[132:135], v[220:223]
    s_add_u32 s68, s68, 128
    ds_read_b64_tr_b16 a[8:9], v8 offset:4672
    buffer_load_dwordx4 v15, s[12:15], s72 offen offset:1024 lds
    v_mfma_f32_16x16x32_bf16 v[220:223], a[28:31], v[140:143], v[220:223]
    ds_read_b64_tr_b16 a[10:11], v8 offset:6720
    v_min_u32 v20, 2, v1
    v_mfma_f32_16x16x32_bf16 v[216:219], a[24:27], v[128:131], v[216:219]
    ds_read_b64_tr_b16 a[12:13], v8 offset:40064
    v_lshlrev_b32 v20, 7, v20
    v_mfma_f32_16x16x32_bf16 v[216:219], a[28:31], v[136:139], v[216:219]
    s_waitcnt lgkmcnt(7)
    ds_read_b64_tr_b16 a[14:15], v8 offset:42112
    v_pk_max_i16 v250, v250, 0
    v_mfma_f32_16x16x32_bf16 v[220:223], a[32:35], v[148:151], v[220:223]
    ds_read_b64_tr_b16 a[16:17], v8 offset:44160
    v_pk_max_i16 v251, v251, 0
    v_mfma_f32_16x16x32_bf16 v[220:223], a[36:39], v[156:159], v[220:223]
    ds_read_b64_tr_b16 a[18:19], v12 offset:11968
    v_accvgpr_write_b32 a56, v248
    v_mfma_f32_16x16x32_bf16 v[216:219], a[32:35], v[144:147], v[216:219]
    ds_read_b64_tr_b16 a[20:21], v12 offset:14016
    v_accvgpr_write_b32 a57, v249
    v_mfma_f32_16x16x32_bf16 v[216:219], a[36:39], v[152:155], v[216:219]
    s_add_u32 m0, s67, 20480
    ds_read_b64_tr_b16 a[22:23], v12 offset:16064
    v_accvgpr_write_b32 a58, v250
    v_mfma_f32_16x16x32_bf16 v[220:223], a[40:43], v[164:167], v[220:223]
    s_add_u32 s72, s73, 147840
    ds_read_b64_tr_b16 a[24:25], v5 offset:30720
    buffer_load_dwordx4 v14, s[12:15], s72 offen lds
    v_mfma_f32_16x16x32_bf16 v[220:223], a[44:47], v[172:175], v[220:223]
    ds_read_b64_tr_b16 a[26:27], v5 offset:32768
    v_accvgpr_write_b32 a59, v251
    v_mfma_f32_16x16x32_bf16 v[216:219], a[40:43], v[160:163], v[216:219]
    ds_read_b64_tr_b16 a[28:29], v5 offset:34816
    v_mul_f32 v196, v196, |v196|
    v_mfma_f32_16x16x32_bf16 v[216:219], a[44:47], v[168:171], v[216:219]
    s_waitcnt lgkmcnt(7)
    ds_read_b64_tr_b16 a[30:31], v9 offset:2624
    v_mul_f32 v197, v197, |v197|
    v_mfma_f32_16x16x32_bf16 v[228:231], a[0:3], v[132:135], v[228:231]
    ds_read_b64_tr_b16 a[32:33], v9 offset:4672
    v_mul_f32 v198, v198, |v198|
    v_mfma_f32_16x16x32_bf16 v[228:231], a[4:7], v[140:143], v[228:231]
    ds_read_b64_tr_b16 a[34:35], v9 offset:6720
    v_mul_f32 v199, v199, |v199|
    v_mfma_f32_16x16x32_bf16 v[224:227], a[0:3], v[128:131], v[224:227]
    ds_read_b64_tr_b16 a[36:37], v9 offset:40064
    v_cvt_pk_bf16_f32 v252, v196, v197
    v_mfma_f32_16x16x32_bf16 v[224:227], a[4:7], v[136:139], v[224:227]
    ds_read_b64_tr_b16 a[38:39], v9 offset:42112
    v_cvt_pk_bf16_f32 v253, v198, v199
    v_mfma_f32_16x16x32_bf16 v[228:231], a[8:11], v[148:151], v[228:231]
    ds_read_b64_tr_b16 a[40:41], v9 offset:44160
    buffer_load_dwordx4 v15, s[12:15], s72 offen offset:1024 lds
    v_mfma_f32_16x16x32_bf16 v[228:231], a[12:15], v[156:159], v[228:231]
    ds_read_b64_tr_b16 a[42:43], v13 offset:11968
    v_mul_f32 v204, v204, |v204|
    v_mfma_f32_16x16x32_bf16 v[224:227], a[8:11], v[144:147], v[224:227]
    ds_read_b64_tr_b16 a[44:45], v13 offset:14016
    v_mul_f32 v205, v205, |v205|
    v_mfma_f32_16x16x32_bf16 v[224:227], a[12:15], v[152:155], v[224:227]
    s_waitcnt vmcnt(17) lgkmcnt(7)
    ds_read_b64_tr_b16 a[46:47], v13 offset:16064
    v_mul_f32 v206, v206, |v206|
    v_mfma_f32_16x16x32_bf16 v[228:231], a[16:19], v[164:167], v[228:231]
    s_barrier
    ds_read_b64_tr_b16 a[0:1], v2 offset:0
    v_mfma_f32_16x16x32_bf16 v[228:231], a[20:23], v[172:175], v[228:231]
    ds_read_b64_tr_b16 a[2:3], v2 offset:2048
    v_mul_f32 v207, v207, |v207|
    v_mfma_f32_16x16x32_bf16 v[224:227], a[16:19], v[160:163], v[224:227]
    ds_read_b64_tr_b16 a[4:5], v2 offset:4096
    v_cvt_pk_bf16_f32 v254, v204, v205
    v_mfma_f32_16x16x32_bf16 v[224:227], a[20:23], v[168:171], v[224:227]
    s_add_u32 m0, s67, 22528
    ds_read_b64_tr_b16 a[6:7], v2 offset:37440
    v_cvt_pk_bf16_f32 v255, v206, v207
    v_mfma_f32_16x16x32_bf16 v[236:239], a[24:27], v[132:135], v[236:239]
    s_add_u32 s72, s73, 295296
    ds_read_b64_tr_b16 a[8:9], v2 offset:39488
    buffer_load_dwordx4 v14, s[12:15], s72 offen lds
    v_mfma_f32_16x16x32_bf16 v[236:239], a[28:31], v[140:143], v[236:239]
    ds_read_b64_tr_b16 a[10:11], v2 offset:41536
    v_pk_max_i16 v252, v252, 0
    v_mfma_f32_16x16x32_bf16 v[232:235], a[24:27], v[128:131], v[232:235]
    ds_read_b64_tr_b16 a[12:13], v6 offset:9344
    v_pk_max_i16 v253, v253, 0
    v_mfma_f32_16x16x32_bf16 v[232:235], a[28:31], v[136:139], v[232:235]
    s_waitcnt lgkmcnt(7)
    ds_read_b64_tr_b16 a[14:15], v6 offset:11392
    v_pk_max_i16 v254, v254, 0
    v_mfma_f32_16x16x32_bf16 v[236:239], a[32:35], v[148:151], v[236:239]
    ds_read_b64_tr_b16 a[16:17], v6 offset:13440
    v_pk_max_i16 v255, v255, 0
    v_mfma_f32_16x16x32_bf16 v[236:239], a[36:39], v[156:159], v[236:239]
    ds_read_b64_tr_b16 a[18:19], v6 offset:46784
    v_accvgpr_write_b32 a60, v252
    v_mfma_f32_16x16x32_bf16 v[232:235], a[32:35], v[144:147], v[232:235]
    ds_read_b64_tr_b16 a[20:21], v6 offset:48832
    v_accvgpr_write_b32 a61, v253
    v_mfma_f32_16x16x32_bf16 v[232:235], a[36:39], v[152:155], v[232:235]
    ds_read_b64_tr_b16 a[22:23], v6 offset:50880
    v_accvgpr_write_b32 a62, v254
    v_mfma_f32_16x16x32_bf16 v[236:239], a[40:43], v[164:167], v[236:239]
    ds_read_b64_tr_b16 a[24:25], v3 offset:0
    buffer_load_dwordx4 v15, s[12:15], s72 offen offset:1024 lds
    v_mfma_f32_16x16x32_bf16 v[236:239], a[44:47], v[172:175], v[236:239]
    ds_read_b64_tr_b16 a[26:27], v3 offset:2048
    v_accvgpr_write_b32 a63, v255
    v_mfma_f32_16x16x32_bf16 v[232:235], a[40:43], v[160:163], v[232:235]
    ds_read_b64_tr_b16 a[28:29], v3 offset:4096
    ds_read_b128 v[192:195], v19 offset:640
    v_mfma_f32_16x16x32_bf16 v[232:235], a[44:47], v[168:171], v[232:235]
    s_waitcnt lgkmcnt(8)
    ds_read_b64_tr_b16 a[30:31], v3 offset:37440
    ds_read_b128 v[200:203], v19 offset:704
    v_mfma_f32_16x16x32_bf16 v[180:183], a[0:3], v[36:39], v[176:179]
    ds_read_b64_tr_b16 a[32:33], v3 offset:39488
    v_add_u32 v20, s68, v20
    v_mfma_f32_16x16x32_bf16 v[180:183], a[4:7], v[44:47], v[180:183]
    s_lshl_b32 s69, s65, 7
    ds_read_b64_tr_b16 a[34:35], v3 offset:41536
    v_mfma_f32_16x16x32_bf16 v[176:179], a[0:3], v[32:35], v[176:179]
    s_add_u32 s90, s68, s69
    ds_read_b64_tr_b16 a[36:37], v7 offset:9344
    v_mfma_f32_16x16x32_bf16 v[176:179], a[4:7], v[40:43], v[176:179]
    s_add_u32 m0, s67, 24576
    ds_read_b64_tr_b16 a[38:39], v7 offset:11392
    v_mfma_f32_16x16x32_bf16 v[180:183], a[8:11], v[52:55], v[180:183]
    s_add_u32 s72, s29, 384
    ds_read_b64_tr_b16 a[40:41], v7 offset:13440
    buffer_load_dwordx4 v14, s[12:15], s72 offen lds
    v_mfma_f32_16x16x32_bf16 v[180:183], a[12:15], v[60:63], v[180:183]
    s_mul_i32 s83, s62, 147456
    ds_read_b64_tr_b16 a[42:43], v7 offset:46784
    v_mfma_f32_16x16x32_bf16 v[176:179], a[8:11], v[48:51], v[176:179]
    s_add_u32 s83, s83, s88
    ds_read_b64_tr_b16 a[44:45], v7 offset:48832
    v_mfma_f32_16x16x32_bf16 v[176:179], a[12:15], v[56:59], v[176:179]
    s_waitcnt lgkmcnt(8)
    ds_read_b64_tr_b16 a[46:47], v7 offset:50880
    v_mul_f32 v208, v208, |v208|
    v_mfma_f32_16x16x32_bf16 v[180:183], a[16:19], v[68:71], v[180:183]
    ds_read_b64_tr_b16 a[0:1], v4 offset:0
    v_mul_f32 v209, v209, |v209|
    v_mfma_f32_16x16x32_bf16 v[180:183], a[20:23], v[76:79], v[180:183]
    ds_read_b64_tr_b16 a[2:3], v4 offset:2048
    v_mfma_f32_16x16x32_bf16 v[176:179], a[16:19], v[64:67], v[176:179]
    ds_read_b64_tr_b16 a[4:5], v4 offset:4096
    v_mul_f32 v210, v210, |v210|
    v_mfma_f32_16x16x32_bf16 v[176:179], a[20:23], v[72:75], v[176:179]
    ds_read_b64_tr_b16 a[6:7], v4 offset:37440
    v_mul_f32 v211, v211, |v211|
    v_mfma_f32_16x16x32_bf16 v[188:191], a[24:27], v[36:39], v[184:187]
    ds_read_b64_tr_b16 a[8:9], v4 offset:39488
    buffer_load_dwordx4 v15, s[12:15], s72 offen offset:1024 lds
    v_mfma_f32_16x16x32_bf16 v[188:191], a[28:31], v[44:47], v[188:191]
    ds_read_b64_tr_b16 a[10:11], v4 offset:41536
    v_cvt_pk_bf16_f32 v240, v208, v209
    v_mfma_f32_16x16x32_bf16 v[184:187], a[24:27], v[32:35], v[184:187]
    ds_read_b64_tr_b16 a[12:13], v8 offset:9344
    v_cvt_pk_bf16_f32 v241, v210, v211
    v_mfma_f32_16x16x32_bf16 v[184:187], a[28:31], v[40:43], v[184:187]
    s_waitcnt lgkmcnt(7)
    ds_read_b64_tr_b16 a[14:15], v8 offset:11392
    v_mfma_f32_16x16x32_bf16 v[188:191], a[32:35], v[52:55], v[188:191]
    ds_read_b64_tr_b16 a[16:17], v8 offset:13440
    v_mul_f32 v216, v216, |v216|
    v_mfma_f32_16x16x32_bf16 v[188:191], a[36:39], v[60:63], v[188:191]
    ds_read_b64_tr_b16 a[18:19], v8 offset:46784
    v_mul_f32 v217, v217, |v217|
    v_mfma_f32_16x16x32_bf16 v[184:187], a[32:35], v[48:51], v[184:187]
    ds_read_b64_tr_b16 a[20:21], v8 offset:48832
    v_mul_f32 v218, v218, |v218|
    v_mfma_f32_16x16x32_bf16 v[184:187], a[36:39], v[56:59], v[184:187]
    s_add_u32 m0, s67, 26624
    ds_read_b64_tr_b16 a[22:23], v8 offset:50880
    v_mfma_f32_16x16x32_bf16 v[188:191], a[40:43], v[68:71], v[188:191]
    s_add_u32 s72, s29, 147840
    ds_read_b64_tr_b16 a[24:25], v5 offset:0
    buffer_load_dwordx4 v14, s[12:15], s72 offen lds
    v_mfma_f32_16x16x32_bf16 v[188:191], a[44:47], v[76:79], v[188:191]
    ds_read_b64_tr_b16 a[26:27], v5 offset:2048
    v_mul_f32 v219, v219, |v219|
    v_mfma_f32_16x16x32_bf16 v[184:187], a[40:43], v[64:67], v[184:187]
    ds_read_b64_tr_b16 a[28:29], v5 offset:4096
    v_cvt_pk_bf16_f32 v242, v216, v217
    v_mfma_f32_16x16x32_bf16 v[184:187], a[44:47], v[72:75], v[184:187]
    s_waitcnt lgkmcnt(7)
    ds_read_b64_tr_b16 a[30:31], v5 offset:37440
    v_cvt_pk_bf16_f32 v243, v218, v219
    v_mfma_f32_16x16x32_bf16 v[196:199], a[0:3], v[36:39], v[192:195]
    ds_read_b64_tr_b16 a[32:33], v5 offset:39488
    v_pk_max_i16 v240, v240, 0
    v_mfma_f32_16x16x32_bf16 v[196:199], a[4:7], v[44:47], v[196:199]
    ds_read_b64_tr_b16 a[34:35], v5 offset:41536
    v_mfma_f32_16x16x32_bf16 v[192:195], a[0:3], v[32:35], v[192:195]
    ds_read_b64_tr_b16 a[36:37], v9 offset:9344
    v_pk_max_i16 v241, v241, 0
    v_mfma_f32_16x16x32_bf16 v[192:195], a[4:7], v[40:43], v[192:195]
    ds_read_b64_tr_b16 a[38:39], v9 offset:11392
    v_pk_max_i16 v242, v242, 0
    v_mfma_f32_16x16x32_bf16 v[196:199], a[8:11], v[52:55], v[196:199]
    ds_read_b64_tr_b16 a[40:41], v9 offset:13440
    buffer_load_dwordx4 v15, s[12:15], s72 offen offset:1024 lds
    v_mfma_f32_16x16x32_bf16 v[196:199], a[12:15], v[60:63], v[196:199]
    ds_read_b64_tr_b16 a[42:43], v9 offset:46784
    v_pk_max_i16 v243, v243, 0
    v_mfma_f32_16x16x32_bf16 v[192:195], a[8:11], v[48:51], v[192:195]
    ds_read_b64_tr_b16 a[44:45], v9 offset:48832
    v_accvgpr_write_b32 a64, v240
    v_mfma_f32_16x16x32_bf16 v[192:195], a[12:15], v[56:59], v[192:195]
    s_waitcnt vmcnt(16) lgkmcnt(7)
    ds_read_b64_tr_b16 a[46:47], v9 offset:50880
    v_mfma_f32_16x16x32_bf16 v[196:199], a[16:19], v[68:71], v[196:199]
    s_barrier
    ds_read_b64_tr_b16 a[0:1], v2 offset:6144
    v_mfma_f32_16x16x32_bf16 v[196:199], a[20:23], v[76:79], v[196:199]
    ds_read_b64_tr_b16 a[2:3], v2 offset:8192
    v_accvgpr_write_b32 a65, v241
    v_mfma_f32_16x16x32_bf16 v[192:195], a[16:19], v[64:67], v[192:195]
    ds_read_b64_tr_b16 a[4:5], v2 offset:10240
    v_accvgpr_write_b32 a66, v242
    v_mfma_f32_16x16x32_bf16 v[192:195], a[20:23], v[72:75], v[192:195]
    s_add_u32 m0, s67, 28672
    ds_read_b64_tr_b16 a[6:7], v2 offset:43584
    v_accvgpr_write_b32 a67, v243
    v_mfma_f32_16x16x32_bf16 v[204:207], a[24:27], v[36:39], v[200:203]
    s_add_u32 s72, s29, 295296
    ds_read_b64_tr_b16 a[8:9], v2 offset:45632
    buffer_load_dwordx4 v14, s[12:15], s72 offen lds
    v_mfma_f32_16x16x32_bf16 v[204:207], a[28:31], v[44:47], v[204:207]
    ds_read_b64_tr_b16 a[10:11], v2 offset:47680
    v_mul_f32 v212, v212, |v212|
    v_mfma_f32_16x16x32_bf16 v[200:203], a[24:27], v[32:35], v[200:203]
    ds_read_b64_tr_b16 a[12:13], v6 offset:15488
    v_mul_f32 v213, v213, |v213|
    v_mfma_f32_16x16x32_bf16 v[200:203], a[28:31], v[40:43], v[200:203]
    s_waitcnt lgkmcnt(7)
    ds_read_b64_tr_b16 a[14:15], v6 offset:17536
    v_mul_f32 v214, v214, |v214|
    v_mfma_f32_16x16x32_bf16 v[204:207], a[32:35], v[52:55], v[204:207]
    ds_read_b64_tr_b16 a[16:17], v6 offset:19584
    v_mul_f32 v215, v215, |v215|
    v_mfma_f32_16x16x32_bf16 v[204:207], a[36:39], v[60:63], v[204:207]
    ds_read_b64_tr_b16 a[18:19], v6 offset:52928
    v_mfma_f32_16x16x32_bf16 v[200:203], a[32:35], v[48:51], v[200:203]
    ds_read_b64_tr_b16 a[20:21], v6 offset:54976
    v_cvt_pk_bf16_f32 v244, v212, v213
    v_mfma_f32_16x16x32_bf16 v[200:203], a[36:39], v[56:59], v[200:203]
    ds_read_b64_tr_b16 a[22:23], v6 offset:57024
    v_cvt_pk_bf16_f32 v245, v214, v215
    v_mfma_f32_16x16x32_bf16 v[204:207], a[40:43], v[68:71], v[204:207]
    ds_read_b64_tr_b16 a[24:25], v3 offset:6144
    buffer_load_dwordx4 v15, s[12:15], s72 offen offset:1024 lds
    v_mfma_f32_16x16x32_bf16 v[204:207], a[44:47], v[76:79], v[204:207]
    ds_read_b64_tr_b16 a[26:27], v3 offset:8192
    v_mul_f32 v220, v220, |v220|
    v_mfma_f32_16x16x32_bf16 v[200:203], a[40:43], v[64:67], v[200:203]
    ds_read_b64_tr_b16 a[28:29], v3 offset:10240
    v_mul_f32 v221, v221, |v221|
    v_mfma_f32_16x16x32_bf16 v[200:203], a[44:47], v[72:75], v[200:203]
    s_waitcnt lgkmcnt(7)
    ds_read_b64_tr_b16 a[30:31], v3 offset:43584
    v_mfma_f32_16x16x32_bf16 v[180:183], a[0:3], v[84:87], v[180:183]
    ds_read_b64_tr_b16 a[32:33], v3 offset:45632
    v_mul_f32 v222, v222, |v222|
    v_mfma_f32_16x16x32_bf16 v[180:183], a[4:7], v[92:95], v[180:183]
    ds_read_b64_tr_b16 a[34:35], v3 offset:47680
    v_mul_f32 v223, v223, |v223|
    v_mfma_f32_16x16x32_bf16 v[176:179], a[0:3], v[80:83], v[176:179]
    ds_read_b64_tr_b16 a[36:37], v7 offset:15488
    v_mfma_f32_16x16x32_bf16 v[176:179], a[4:7], v[88:91], v[176:179]
    s_add_u32 m0, s67, 30720
    ds_read_b64_tr_b16 a[38:39], v7 offset:17536
    v_cvt_pk_bf16_f32 v246, v220, v221
    v_mfma_f32_16x16x32_bf16 v[180:183], a[8:11], v[100:103], v[180:183]
    s_add_u32 s72, s30, 384
    ds_read_b64_tr_b16 a[40:41], v7 offset:19584
    buffer_load_dwordx4 v14, s[12:15], s72 offen lds
    v_mfma_f32_16x16x32_bf16 v[180:183], a[12:15], v[108:111], v[180:183]
    ds_read_b64_tr_b16 a[42:43], v7 offset:52928
    v_cvt_pk_bf16_f32 v247, v222, v223
    v_mfma_f32_16x16x32_bf16 v[176:179], a[8:11], v[96:99], v[176:179]
    ds_read_b64_tr_b16 a[44:45], v7 offset:54976
    v_pk_max_i16 v244, v244, 0
    v_mfma_f32_16x16x32_bf16 v[176:179], a[12:15], v[104:107], v[176:179]
    s_waitcnt lgkmcnt(7)
    ds_read_b64_tr_b16 a[46:47], v7 offset:57024
    v_mfma_f32_16x16x32_bf16 v[180:183], a[16:19], v[116:119], v[180:183]
    ds_read_b64_tr_b16 a[0:1], v4 offset:6144
    v_pk_max_i16 v245, v245, 0
    v_mfma_f32_16x16x32_bf16 v[180:183], a[20:23], v[124:127], v[180:183]
    ds_read_b64_tr_b16 a[2:3], v4 offset:8192
    v_mfma_f32_16x16x32_bf16 v[176:179], a[16:19], v[112:115], v[176:179]
    ds_read_b64_tr_b16 a[4:5], v4 offset:10240
    v_pk_max_i16 v246, v246, 0
    v_mfma_f32_16x16x32_bf16 v[176:179], a[20:23], v[120:123], v[176:179]
    ds_read_b64_tr_b16 a[6:7], v4 offset:43584
    v_mfma_f32_16x16x32_bf16 v[188:191], a[24:27], v[84:87], v[188:191]
    ds_read_b64_tr_b16 a[8:9], v4 offset:45632
    buffer_load_dwordx4 v15, s[12:15], s72 offen offset:1024 lds
    v_mfma_f32_16x16x32_bf16 v[188:191], a[28:31], v[92:95], v[188:191]
    ds_read_b64_tr_b16 a[10:11], v4 offset:47680
    v_pk_max_i16 v247, v247, 0
    v_mfma_f32_16x16x32_bf16 v[184:187], a[24:27], v[80:83], v[184:187]
    ds_read_b64_tr_b16 a[12:13], v8 offset:15488
    v_accvgpr_write_b32 a68, v244
    v_mfma_f32_16x16x32_bf16 v[184:187], a[28:31], v[88:91], v[184:187]
    s_waitcnt lgkmcnt(7)
    ds_read_b64_tr_b16 a[14:15], v8 offset:17536
    v_accvgpr_write_b32 a69, v245
    v_mfma_f32_16x16x32_bf16 v[188:191], a[32:35], v[100:103], v[188:191]
    ds_read_b64_tr_b16 a[16:17], v8 offset:19584
    v_mfma_f32_16x16x32_bf16 v[188:191], a[36:39], v[108:111], v[188:191]
    ds_read_b64_tr_b16 a[18:19], v8 offset:52928
    v_accvgpr_write_b32 a70, v246
    v_mfma_f32_16x16x32_bf16 v[184:187], a[32:35], v[96:99], v[184:187]
    ds_read_b64_tr_b16 a[20:21], v8 offset:54976
    v_accvgpr_write_b32 a71, v247
    v_mfma_f32_16x16x32_bf16 v[184:187], a[36:39], v[104:107], v[184:187]
    s_add_u32 m0, s67, 32768
    ds_read_b64_tr_b16 a[22:23], v8 offset:57024
    v_mfma_f32_16x16x32_bf16 v[188:191], a[40:43], v[116:119], v[188:191]
    s_add_u32 s72, s30, 147840
    ds_read_b64_tr_b16 a[24:25], v5 offset:6144
    buffer_load_dwordx4 v14, s[12:15], s72 offen lds
    v_mfma_f32_16x16x32_bf16 v[188:191], a[44:47], v[124:127], v[188:191]
    ds_read_b64_tr_b16 a[26:27], v5 offset:8192
    ds_read_b128 v[208:211], v19 offset:768
    v_mfma_f32_16x16x32_bf16 v[184:187], a[40:43], v[112:115], v[184:187]
    ds_read_b64_tr_b16 a[28:29], v5 offset:10240
    ds_read_b128 v[216:219], v19 offset:832
    v_mfma_f32_16x16x32_bf16 v[184:187], a[44:47], v[120:123], v[184:187]
    s_waitcnt lgkmcnt(9)
    ds_read_b64_tr_b16 a[30:31], v5 offset:43584
    v_mfma_f32_16x16x32_bf16 v[196:199], a[0:3], v[84:87], v[196:199]
    ds_read_b64_tr_b16 a[32:33], v5 offset:45632
    v_mul_f32 v224, v224, |v224|
    v_mfma_f32_16x16x32_bf16 v[196:199], a[4:7], v[92:95], v[196:199]
    ds_read_b64_tr_b16 a[34:35], v5 offset:47680
    v_mul_f32 v225, v225, |v225|
    v_mfma_f32_16x16x32_bf16 v[192:195], a[0:3], v[80:83], v[192:195]
    ds_read_b64_tr_b16 a[36:37], v9 offset:15488
    v_mfma_f32_16x16x32_bf16 v[192:195], a[4:7], v[88:91], v[192:195]
    ds_read_b64_tr_b16 a[38:39], v9 offset:17536
    v_mul_f32 v226, v226, |v226|
    v_mfma_f32_16x16x32_bf16 v[196:199], a[8:11], v[100:103], v[196:199]
    ds_read_b64_tr_b16 a[40:41], v9 offset:19584
    buffer_load_dwordx4 v15, s[12:15], s72 offen offset:1024 lds
    v_mfma_f32_16x16x32_bf16 v[196:199], a[12:15], v[108:111], v[196:199]
    ds_read_b64_tr_b16 a[42:43], v9 offset:52928
    v_mul_f32 v227, v227, |v227|
    v_mfma_f32_16x16x32_bf16 v[192:195], a[8:11], v[96:99], v[192:195]
    ds_read_b64_tr_b16 a[44:45], v9 offset:54976
    v_cvt_pk_bf16_f32 v248, v224, v225
    v_mfma_f32_16x16x32_bf16 v[192:195], a[12:15], v[104:107], v[192:195]
    s_waitcnt vmcnt(16) lgkmcnt(7)
    ds_read_b64_tr_b16 a[46:47], v9 offset:57024
    v_mfma_f32_16x16x32_bf16 v[196:199], a[16:19], v[116:119], v[196:199]
    s_barrier
    ds_read_b64_tr_b16 a[0:1], v2 offset:12288
    v_mfma_f32_16x16x32_bf16 v[196:199], a[20:23], v[124:127], v[196:199]
    ds_read_b64_tr_b16 a[2:3], v2 offset:14336
L_pad_m0_1:
    s_cbranch_execz L_pad_m0_2
    v_cvt_pk_bf16_f32 v249, v226, v227
    v_mfma_f32_16x16x32_bf16 v[192:195], a[16:19], v[112:115], v[192:195]
    ds_read_b64_tr_b16 a[4:5], v2 offset:16384
    v_mul_f32 v232, v232, |v232|
    v_mfma_f32_16x16x32_bf16 v[192:195], a[20:23], v[120:123], v[192:195]
    s_add_u32 m0, s67, 34816
    ds_read_b64_tr_b16 a[6:7], v2 offset:49728
    v_mfma_f32_16x16x32_bf16 v[204:207], a[24:27], v[84:87], v[204:207]
    s_add_u32 s72, s30, 295296
    ds_read_b64_tr_b16 a[8:9], v2 offset:51776
    buffer_load_dwordx4 v14, s[12:15], s72 offen lds
    v_mfma_f32_16x16x32_bf16 v[204:207], a[28:31], v[92:95], v[204:207]
    ds_read_b64_tr_b16 a[10:11], v2 offset:53824
    v_mul_f32 v233, v233, |v233|
    v_mfma_f32_16x16x32_bf16 v[200:203], a[24:27], v[80:83], v[200:203]
    ds_read_b64_tr_b16 a[12:13], v6 offset:21632
    v_mul_f32 v234, v234, |v234|
    v_mfma_f32_16x16x32_bf16 v[200:203], a[28:31], v[88:91], v[200:203]
    s_waitcnt lgkmcnt(7)
    ds_read_b64_tr_b16 a[14:15], v6 offset:23680
    v_mul_f32 v235, v235, |v235|
    v_mfma_f32_16x16x32_bf16 v[204:207], a[32:35], v[100:103], v[204:207]
    ds_read_b64_tr_b16 a[16:17], v6 offset:25728
    v_mfma_f32_16x16x32_bf16 v[204:207], a[36:39], v[108:111], v[204:207]
    ds_read_b64_tr_b16 a[18:19], v6 offset:59072
    v_cvt_pk_bf16_f32 v250, v232, v233
    v_mfma_f32_16x16x32_bf16 v[200:203], a[32:35], v[96:99], v[200:203]
    ds_read_b64_tr_b16 a[20:21], v6 offset:61120
    v_cvt_pk_bf16_f32 v251, v234, v235
    v_mfma_f32_16x16x32_bf16 v[200:203], a[36:39], v[104:107], v[200:203]
    ds_read_b64_tr_b16 a[22:23], v6 offset:63168
    v_mfma_f32_16x16x32_bf16 v[204:207], a[40:43], v[116:119], v[204:207]
    ds_read_b64_tr_b16 a[24:25], v3 offset:12288
    buffer_load_dwordx4 v15, s[12:15], s72 offen offset:1024 lds
    v_mfma_f32_16x16x32_bf16 v[204:207], a[44:47], v[124:127], v[204:207]
    ds_read_b64_tr_b16 a[26:27], v3 offset:14336
    v_pk_max_i16 v248, v248, 0
    v_mfma_f32_16x16x32_bf16 v[200:203], a[40:43], v[112:115], v[200:203]
    ds_read_b64_tr_b16 a[28:29], v3 offset:16384
    v_pk_max_i16 v249, v249, 0
    v_mfma_f32_16x16x32_bf16 v[200:203], a[44:47], v[120:123], v[200:203]
    s_waitcnt lgkmcnt(7)
    ds_read_b64_tr_b16 a[30:31], v3 offset:49728
    v_mfma_f32_16x16x32_bf16 v[180:183], a[0:3], v[132:135], v[180:183]
    ds_read_b64_tr_b16 a[32:33], v3 offset:51776
    v_pk_max_i16 v250, v250, 0
    v_mfma_f32_16x16x32_bf16 v[180:183], a[4:7], v[140:143], v[180:183]
    ds_read_b64_tr_b16 a[34:35], v3 offset:53824
    v_pk_max_i16 v251, v251, 0
    v_mfma_f32_16x16x32_bf16 v[176:179], a[0:3], v[128:131], v[176:179]
    s_add_u32 m0, s67, 0
    ds_read_b64_tr_b16 a[36:37], v7 offset:21632
    v_mfma_f32_16x16x32_bf16 v[176:179], a[4:7], v[136:139], v[176:179]
    s_add_u32 s72, s73, 512
    ds_read_b64_tr_b16 a[38:39], v7 offset:23680
    buffer_load_dwordx4 v14, s[12:15], s72 offen lds
    v_mfma_f32_16x16x32_bf16 v[180:183], a[8:11], v[148:151], v[180:183]
    ds_read_b64_tr_b16 a[40:41], v7 offset:25728
    v_accvgpr_write_b32 a72, v248
    v_mfma_f32_16x16x32_bf16 v[180:183], a[12:15], v[156:159], v[180:183]
    ds_read_b64_tr_b16 a[42:43], v7 offset:59072
    v_accvgpr_write_b32 a73, v249
    v_mfma_f32_16x16x32_bf16 v[176:179], a[8:11], v[144:147], v[176:179]
    ds_read_b64_tr_b16 a[44:45], v7 offset:61120
    v_accvgpr_write_b32 a74, v250
    v_mfma_f32_16x16x32_bf16 v[176:179], a[12:15], v[152:155], v[176:179]
    s_waitcnt lgkmcnt(7)
    ds_read_b64_tr_b16 a[46:47], v7 offset:63168
    v_mfma_f32_16x16x32_bf16 v[180:183], a[16:19], v[164:167], v[180:183]
    ds_read_b64_tr_b16 a[0:1], v4 offset:12288
    v_accvgpr_write_b32 a75, v251
    v_mfma_f32_16x16x32_bf16 v[180:183], a[20:23], v[172:175], v[180:183]
    ds_read_b64_tr_b16 a[2:3], v4 offset:14336
    buffer_load_dwordx4 v15, s[12:15], s72 offen offset:1024 lds
    v_mfma_f32_16x16x32_bf16 v[176:179], a[16:19], v[160:163], v[176:179]
    ds_read_b64_tr_b16 a[4:5], v4 offset:16384
    v_mul_f32 v228, v228, |v228|
    v_mfma_f32_16x16x32_bf16 v[176:179], a[20:23], v[168:171], v[176:179]
    ds_read_b64_tr_b16 a[6:7], v4 offset:49728
    v_mfma_f32_16x16x32_bf16 v[188:191], a[24:27], v[132:135], v[188:191]
    ds_read_b64_tr_b16 a[8:9], v4 offset:51776
    v_mul_f32 v229, v229, |v229|
    v_mfma_f32_16x16x32_bf16 v[188:191], a[28:31], v[140:143], v[188:191]
    ds_read_b64_tr_b16 a[10:11], v4 offset:53824
    v_mul_f32 v230, v230, |v230|
    v_mfma_f32_16x16x32_bf16 v[184:187], a[24:27], v[128:131], v[184:187]
    ds_read_b64_tr_b16 a[12:13], v8 offset:21632
    v_mfma_f32_16x16x32_bf16 v[184:187], a[28:31], v[136:139], v[184:187]
    s_waitcnt lgkmcnt(7)
    ds_read_b64_tr_b16 a[14:15], v8 offset:23680
    v_mul_f32 v231, v231, |v231|
    v_mfma_f32_16x16x32_bf16 v[188:191], a[32:35], v[148:151], v[188:191]
    s_add_u32 s82, s75, 0
    ds_read_b64_tr_b16 a[16:17], v8 offset:25728
    buffer_store_dwordx4 a[48:51], v18, s[20:23], s82 offen offset:0 sc1
    v_mfma_f32_16x16x32_bf16 v[188:191], a[36:39], v[156:159], v[188:191]
    ds_read_b64_tr_b16 a[18:19], v8 offset:59072
    v_cvt_pk_bf16_f32 v252, v228, v229
    v_mfma_f32_16x16x32_bf16 v[184:187], a[32:35], v[144:147], v[184:187]
    ds_read_b64_tr_b16 a[20:21], v8 offset:61120
    v_cvt_pk_bf16_f32 v253, v230, v231
    v_mfma_f32_16x16x32_bf16 v[184:187], a[36:39], v[152:155], v[184:187]
    ds_read_b64_tr_b16 a[22:23], v8 offset:63168
    v_mfma_f32_16x16x32_bf16 v[188:191], a[40:43], v[164:167], v[188:191]
    s_add_u32 m0, s67, 2048
    ds_read_b64_tr_b16 a[24:25], v5 offset:12288
    v_mul_f32 v236, v236, |v236|
    v_mfma_f32_16x16x32_bf16 v[188:191], a[44:47], v[172:175], v[188:191]
    s_add_u32 s72, s73, 147968
    ds_read_b64_tr_b16 a[26:27], v5 offset:14336
    buffer_load_dwordx4 v14, s[12:15], s72 offen lds
    v_mfma_f32_16x16x32_bf16 v[184:187], a[40:43], v[160:163], v[184:187]
    ds_read_b64_tr_b16 a[28:29], v5 offset:16384
    v_mul_f32 v237, v237, |v237|
    v_mfma_f32_16x16x32_bf16 v[184:187], a[44:47], v[168:171], v[184:187]
    s_waitcnt lgkmcnt(7)
    ds_read_b64_tr_b16 a[30:31], v5 offset:49728
    v_mfma_f32_16x16x32_bf16 v[196:199], a[0:3], v[132:135], v[196:199]
    ds_read_b64_tr_b16 a[32:33], v5 offset:51776
    v_mul_f32 v238, v238, |v238|
    v_mfma_f32_16x16x32_bf16 v[196:199], a[4:7], v[140:143], v[196:199]
    ds_read_b64_tr_b16 a[34:35], v5 offset:53824
    v_mul_f32 v239, v239, |v239|
    v_mfma_f32_16x16x32_bf16 v[192:195], a[0:3], v[128:131], v[192:195]
    ds_read_b64_tr_b16 a[36:37], v9 offset:21632
    v_mfma_f32_16x16x32_bf16 v[192:195], a[4:7], v[136:139], v[192:195]
    ds_read_b64_tr_b16 a[38:39], v9 offset:23680
    buffer_load_dwordx4 v15, s[12:15], s72 offen offset:1024 lds
    v_mfma_f32_16x16x32_bf16 v[196:199], a[8:11], v[148:151], v[196:199]
    ds_read_b64_tr_b16 a[40:41], v9 offset:25728
    v_cvt_pk_bf16_f32 v254, v236, v237
    v_mfma_f32_16x16x32_bf16 v[196:199], a[12:15], v[156:159], v[196:199]
    ds_read_b64_tr_b16 a[42:43], v9 offset:59072
    v_cvt_pk_bf16_f32 v255, v238, v239
    v_mfma_f32_16x16x32_bf16 v[192:195], a[8:11], v[144:147], v[192:195]
    ds_read_b64_tr_b16 a[44:45], v9 offset:61120
    v_pk_max_i16 v252, v252, 0
    v_mfma_f32_16x16x32_bf16 v[192:195], a[12:15], v[152:155], v[192:195]
    s_waitcnt vmcnt(17) lgkmcnt(7)
    ds_read_b64_tr_b16 a[46:47], v9 offset:63168
    v_mfma_f32_16x16x32_bf16 v[196:199], a[16:19], v[164:167], v[196:199]
    s_barrier
    ds_read_b64_tr_b16 a[0:1], v2 offset:18432
    v_mfma_f32_16x16x32_bf16 v[196:199], a[20:23], v[172:175], v[196:199]
    s_add_u32 m0, s67, 4096
    ds_read_b64_tr_b16 a[2:3], v2 offset:20480
    v_pk_max_i16 v253, v253, 0
    v_mfma_f32_16x16x32_bf16 v[192:195], a[16:19], v[160:163], v[192:195]
    s_add_u32 s72, s73, 295424
    ds_read_b64_tr_b16 a[4:5], v2 offset:22528
    buffer_load_dwordx4 v14, s[12:15], s72 offen lds
    v_mfma_f32_16x16x32_bf16 v[192:195], a[20:23], v[168:171], v[192:195]
    ds_read_b64_tr_b16 a[6:7], v2 offset:55872
    v_pk_max_i16 v254, v254, 0
    v_mfma_f32_16x16x32_bf16 v[204:207], a[24:27], v[132:135], v[204:207]
    ds_read_b64_tr_b16 a[8:9], v2 offset:57920
    v_pk_max_i16 v255, v255, 0
    v_mfma_f32_16x16x32_bf16 v[204:207], a[28:31], v[140:143], v[204:207]
    ds_read_b64_tr_b16 a[10:11], v2 offset:59968
    v_accvgpr_write_b32 a76, v252
    v_mfma_f32_16x16x32_bf16 v[200:203], a[24:27], v[128:131], v[200:203]
    ds_read_b64_tr_b16 a[12:13], v6 offset:27776
    v_mfma_f32_16x16x32_bf16 v[200:203], a[28:31], v[136:139], v[200:203]
    s_waitcnt lgkmcnt(7)
    ds_read_b64_tr_b16 a[14:15], v6 offset:29824
    buffer_store_dwordx4 a[52:55], v18, s[20:23], s82 offen offset:1024 sc1
    v_mfma_f32_16x16x32_bf16 v[204:207], a[32:35], v[148:151], v[204:207]
    ds_read_b64_tr_b16 a[16:17], v6 offset:31872
    v_accvgpr_write_b32 a77, v253
    v_mfma_f32_16x16x32_bf16 v[204:207], a[36:39], v[156:159], v[204:207]
    ds_read_b64_tr_b16 a[18:19], v6 offset:65216
    v_accvgpr_write_b32 a78, v254
    v_mfma_f32_16x16x32_bf16 v[200:203], a[32:35], v[144:147], v[200:203]
    ds_read_b64_tr_b16 a[20:21], v10 offset:1728
    v_accvgpr_write_b32 a79, v255
    v_mfma_f32_16x16x32_bf16 v[200:203], a[36:39], v[152:155], v[200:203]
    ds_read_b64_tr_b16 a[22:23], v10 offset:3776
    v_mfma_f32_16x16x32_bf16 v[204:207], a[40:43], v[164:167], v[204:207]
    ds_read_b64_tr_b16 a[24:25], v3 offset:18432
    ds_read_b128 v[224:227], v19 offset:896
    v_mfma_f32_16x16x32_bf16 v[204:207], a[44:47], v[172:175], v[204:207]
    ds_read_b64_tr_b16 a[26:27], v3 offset:20480
    buffer_load_dwordx4 v15, s[12:15], s72 offen offset:1024 lds
    v_mfma_f32_16x16x32_bf16 v[200:203], a[40:43], v[160:163], v[200:203]
    ds_read_b64_tr_b16 a[28:29], v3 offset:22528
    ds_read_b128 v[232:235], v19 offset:960
    v_mfma_f32_16x16x32_bf16 v[200:203], a[44:47], v[168:171], v[200:203]
    s_waitcnt lgkmcnt(9)
    ds_read_b64_tr_b16 a[30:31], v3 offset:55872
    v_mfma_f32_16x16x32_bf16 v[212:215], a[0:3], v[36:39], v[208:211]
    ds_read_b64_tr_b16 a[32:33], v3 offset:57920
    v_mul_f32 v176, v176, |v176|
    v_mfma_f32_16x16x32_bf16 v[212:215], a[4:7], v[44:47], v[212:215]
    ds_read_b64_tr_b16 a[34:35], v3 offset:59968
    v_mul_f32 v177, v177, |v177|
    v_mfma_f32_16x16x32_bf16 v[208:211], a[0:3], v[32:35], v[208:211]
    s_add_u32 m0, s67, 6144
    ds_read_b64_tr_b16 a[36:37], v7 offset:27776
    v_mfma_f32_16x16x32_bf16 v[208:211], a[4:7], v[40:43], v[208:211]
    s_add_u32 s72, s29, 512
    ds_read_b64_tr_b16 a[38:39], v7 offset:29824
    buffer_load_dwordx4 v14, s[12:15], s72 offen lds
    v_mfma_f32_16x16x32_bf16 v[212:215], a[8:11], v[52:55], v[212:215]
    ds_read_b64_tr_b16 a[40:41], v7 offset:31872
    v_mul_f32 v178, v178, |v178|
    v_mfma_f32_16x16x32_bf16 v[212:215], a[12:15], v[60:63], v[212:215]
    ds_read_b64_tr_b16 a[42:43], v7 offset:65216
    v_mul_f32 v179, v179, |v179|
    v_mfma_f32_16x16x32_bf16 v[208:211], a[8:11], v[48:51], v[208:211]
    ds_read_b64_tr_b16 a[44:45], v11 offset:1728
    v_cvt_pk_bf16_f32 v240, v176, v177
    v_mfma_f32_16x16x32_bf16 v[208:211], a[12:15], v[56:59], v[208:211]
    s_waitcnt lgkmcnt(7)
    ds_read_b64_tr_b16 a[46:47], v11 offset:3776
    v_mfma_f32_16x16x32_bf16 v[212:215], a[16:19], v[68:71], v[212:215]
    ds_read_b64_tr_b16 a[0:1], v4 offset:18432
    v_cvt_pk_bf16_f32 v241, v178, v179
    v_mfma_f32_16x16x32_bf16 v[212:215], a[20:23], v[76:79], v[212:215]
    ds_read_b64_tr_b16 a[2:3], v4 offset:20480
    buffer_load_dwordx4 v15, s[12:15], s72 offen offset:1024 lds
    v_mfma_f32_16x16x32_bf16 v[208:211], a[16:19], v[64:67], v[208:211]
    ds_read_b64_tr_b16 a[4:5], v4 offset:22528
    v_mul_f32 v184, v184, |v184|
    v_mfma_f32_16x16x32_bf16 v[208:211], a[20:23], v[72:75], v[208:211]
    ds_read_b64_tr_b16 a[6:7], v4 offset:55872
    v_mfma_f32_16x16x32_bf16 v[220:223], a[24:27], v[36:39], v[216:219]
    ds_read_b64_tr_b16 a[8:9], v4 offset:57920
    v_mul_f32 v185, v185, |v185|
    v_mfma_f32_16x16x32_bf16 v[220:223], a[28:31], v[44:47], v[220:223]
    ds_read_b64_tr_b16 a[10:11], v4 offset:59968
    v_mul_f32 v186, v186, |v186|
    v_mfma_f32_16x16x32_bf16 v[216:219], a[24:27], v[32:35], v[216:219]
    ds_read_b64_tr_b16 a[12:13], v8 offset:27776
    v_mfma_f32_16x16x32_bf16 v[216:219], a[28:31], v[40:43], v[216:219]
    s_waitcnt lgkmcnt(7)
    ds_read_b64_tr_b16 a[14:15], v8 offset:29824
    buffer_store_dwordx4 a[56:59], v18, s[20:23], s82 offen offset:2048 sc1
    v_mfma_f32_16x16x32_bf16 v[220:223], a[32:35], v[52:55], v[220:223]
    ds_read_b64_tr_b16 a[16:17], v8 offset:31872
    v_mul_f32 v187, v187, |v187|
    v_mfma_f32_16x16x32_bf16 v[220:223], a[36:39], v[60:63], v[220:223]
    ds_read_b64_tr_b16 a[18:19], v8 offset:65216
    v_cvt_pk_bf16_f32 v242, v184, v185
    v_mfma_f32_16x16x32_bf16 v[216:219], a[32:35], v[48:51], v[216:219]
    ds_read_b64_tr_b16 a[20:21], v12 offset:1728
    v_cvt_pk_bf16_f32 v243, v186, v187
    v_mfma_f32_16x16x32_bf16 v[216:219], a[36:39], v[56:59], v[216:219]
    ds_read_b64_tr_b16 a[22:23], v12 offset:3776
    v_mfma_f32_16x16x32_bf16 v[220:223], a[40:43], v[68:71], v[220:223]
    s_add_u32 m0, s67, 8192
    ds_read_b64_tr_b16 a[24:25], v5 offset:18432
    v_pk_max_i16 v240, v240, 0
    v_mfma_f32_16x16x32_bf16 v[220:223], a[44:47], v[76:79], v[220:223]
    s_add_u32 s72, s29, 147968
    ds_read_b64_tr_b16 a[26:27], v5 offset:20480
    buffer_load_dwordx4 v14, s[12:15], s72 offen lds
    v_mfma_f32_16x16x32_bf16 v[216:219], a[40:43], v[64:67], v[216:219]
    ds_read_b64_tr_b16 a[28:29], v5 offset:22528
    v_pk_max_i16 v241, v241, 0
    v_mfma_f32_16x16x32_bf16 v[216:219], a[44:47], v[72:75], v[216:219]
    s_waitcnt lgkmcnt(7)
    ds_read_b64_tr_b16 a[30:31], v5 offset:55872
    v_mfma_f32_16x16x32_bf16 v[228:231], a[0:3], v[36:39], v[224:227]
    ds_read_b64_tr_b16 a[32:33], v5 offset:57920
    v_pk_max_i16 v242, v242, 0
    v_mfma_f32_16x16x32_bf16 v[228:231], a[4:7], v[44:47], v[228:231]
    ds_read_b64_tr_b16 a[34:35], v5 offset:59968
    v_pk_max_i16 v243, v243, 0
    v_mfma_f32_16x16x32_bf16 v[224:227], a[0:3], v[32:35], v[224:227]
    ds_read_b64_tr_b16 a[36:37], v9 offset:27776
    v_mfma_f32_16x16x32_bf16 v[224:227], a[4:7], v[40:43], v[224:227]
    ds_read_b64_tr_b16 a[38:39], v9 offset:29824
    buffer_load_dwordx4 v15, s[12:15], s72 offen offset:1024 lds
    v_mfma_f32_16x16x32_bf16 v[228:231], a[8:11], v[52:55], v[228:231]
    ds_read_b64_tr_b16 a[40:41], v9 offset:31872
    v_accvgpr_write_b32 a80, v240
    v_mfma_f32_16x16x32_bf16 v[228:231], a[12:15], v[60:63], v[228:231]
    ds_read_b64_tr_b16 a[42:43], v9 offset:65216
    v_accvgpr_write_b32 a81, v241
    v_mfma_f32_16x16x32_bf16 v[224:227], a[8:11], v[48:51], v[224:227]
    ds_read_b64_tr_b16 a[44:45], v13 offset:1728
    v_accvgpr_write_b32 a82, v242
    v_mfma_f32_16x16x32_bf16 v[224:227], a[12:15], v[56:59], v[224:227]
    s_waitcnt vmcnt(19) lgkmcnt(7)
    ds_read_b64_tr_b16 a[46:47], v13 offset:3776
    v_mfma_f32_16x16x32_bf16 v[228:231], a[16:19], v[68:71], v[228:231]
    s_barrier
    ds_read_b64_tr_b16 a[0:1], v2 offset:24576
    v_mfma_f32_16x16x32_bf16 v[228:231], a[20:23], v[76:79], v[228:231]
    s_add_u32 m0, s67, 10240
    ds_read_b64_tr_b16 a[2:3], v2 offset:26624
    v_accvgpr_write_b32 a83, v243
    v_mfma_f32_16x16x32_bf16 v[224:227], a[16:19], v[64:67], v[224:227]
    s_add_u32 s72, s29, 295424
    ds_read_b64_tr_b16 a[4:5], v2 offset:28672
    buffer_load_dwordx4 v14, s[12:15], s72 offen lds
    v_mfma_f32_16x16x32_bf16 v[224:227], a[20:23], v[72:75], v[224:227]
    ds_read_b64_tr_b16 a[6:7], v2 offset:62016
    v_mul_f32 v180, v180, |v180|
    v_mfma_f32_16x16x32_bf16 v[236:239], a[24:27], v[36:39], v[232:235]
    ds_read_b64_tr_b16 a[8:9], v2 offset:64064
    v_mul_f32 v181, v181, |v181|
    v_mfma_f32_16x16x32_bf16 v[236:239], a[28:31], v[44:47], v[236:239]
    ds_read_b64_tr_b16 a[10:11], v6 offset:576
    v_mul_f32 v182, v182, |v182|
    v_mfma_f32_16x16x32_bf16 v[232:235], a[24:27], v[32:35], v[232:235]
    ds_read_b64_tr_b16 a[12:13], v6 offset:33920
    v_mfma_f32_16x16x32_bf16 v[232:235], a[28:31], v[40:43], v[232:235]
    s_waitcnt lgkmcnt(7)
    ds_read_b64_tr_b16 a[14:15], v6 offset:35968
    buffer_store_dwordx4 a[60:63], v18, s[20:23], s82 offen offset:3072 sc1
    v_mfma_f32_16x16x32_bf16 v[236:239], a[32:35], v[52:55], v[236:239]
    ds_read_b64_tr_b16 a[16:17], v6 offset:38016
    v_mul_f32 v183, v183, |v183|
    v_mfma_f32_16x16x32_bf16 v[236:239], a[36:39], v[60:63], v[236:239]
    ds_read_b64_tr_b16 a[18:19], v10 offset:5824
    v_cvt_pk_bf16_f32 v244, v180, v181
    v_mfma_f32_16x16x32_bf16 v[232:235], a[32:35], v[48:51], v[232:235]
    ds_read_b64_tr_b16 a[20:21], v10 offset:7872
    v_cvt_pk_bf16_f32 v245, v182, v183
    v_mfma_f32_16x16x32_bf16 v[232:235], a[36:39], v[56:59], v[232:235]
    ds_read_b64_tr_b16 a[22:23], v10 offset:9920
    v_mfma_f32_16x16x32_bf16 v[236:239], a[40:43], v[68:71], v[236:239]
    ds_read_b64_tr_b16 a[24:25], v3 offset:24576
    v_mul_f32 v188, v188, |v188|
    v_mfma_f32_16x16x32_bf16 v[236:239], a[44:47], v[76:79], v[236:239]
    ds_read_b64_tr_b16 a[26:27], v3 offset:26624
    buffer_load_dwordx4 v15, s[12:15], s72 offen offset:1024 lds
    v_mfma_f32_16x16x32_bf16 v[232:235], a[40:43], v[64:67], v[232:235]
    ds_read_b64_tr_b16 a[28:29], v3 offset:28672
    v_mul_f32 v189, v189, |v189|
    v_mfma_f32_16x16x32_bf16 v[232:235], a[44:47], v[72:75], v[232:235]
    s_waitcnt lgkmcnt(7)
    ds_read_b64_tr_b16 a[30:31], v3 offset:62016
    v_mfma_f32_16x16x32_bf16 v[212:215], a[0:3], v[84:87], v[212:215]
    ds_read_b64_tr_b16 a[32:33], v3 offset:64064
    v_mul_f32 v190, v190, |v190|
    v_mfma_f32_16x16x32_bf16 v[212:215], a[4:7], v[92:95], v[212:215]
    ds_read_b64_tr_b16 a[34:35], v7 offset:576
    v_mul_f32 v191, v191, |v191|
    v_mfma_f32_16x16x32_bf16 v[208:211], a[0:3], v[80:83], v[208:211]
    s_add_u32 m0, s67, 12288
    ds_read_b64_tr_b16 a[36:37], v7 offset:33920
    v_mfma_f32_16x16x32_bf16 v[208:211], a[4:7], v[88:91], v[208:211]
    s_add_u32 s72, s30, 512
    ds_read_b64_tr_b16 a[38:39], v7 offset:35968
    buffer_load_dwordx4 v14, s[12:15], s72 offen lds
    v_mfma_f32_16x16x32_bf16 v[212:215], a[8:11], v[100:103], v[212:215]
    ds_read_b64_tr_b16 a[40:41], v7 offset:38016
    v_cvt_pk_bf16_f32 v246, v188, v189
    v_mfma_f32_16x16x32_bf16 v[212:215], a[12:15], v[108:111], v[212:215]
    ds_read_b64_tr_b16 a[42:43], v11 offset:5824
    v_cvt_pk_bf16_f32 v247, v190, v191
    v_mfma_f32_16x16x32_bf16 v[208:211], a[8:11], v[96:99], v[208:211]
    ds_read_b64_tr_b16 a[44:45], v11 offset:7872
    v_pk_max_i16 v244, v244, 0
    v_mfma_f32_16x16x32_bf16 v[208:211], a[12:15], v[104:107], v[208:211]
    s_waitcnt lgkmcnt(7)
    ds_read_b64_tr_b16 a[46:47], v11 offset:9920
    v_mfma_f32_16x16x32_bf16 v[212:215], a[16:19], v[116:119], v[212:215]
    ds_read_b64_tr_b16 a[0:1], v4 offset:24576
    v_pk_max_i16 v245, v245, 0
    v_mfma_f32_16x16x32_bf16 v[212:215], a[20:23], v[124:127], v[212:215]
    ds_read_b64_tr_b16 a[2:3], v4 offset:26624
    buffer_load_dwordx4 v15, s[12:15], s72 offen offset:1024 lds
    v_mfma_f32_16x16x32_bf16 v[208:211], a[16:19], v[112:115], v[208:211]
    ds_read_b64_tr_b16 a[4:5], v4 offset:28672
    v_pk_max_i16 v246, v246, 0
    v_mfma_f32_16x16x32_bf16 v[208:211], a[20:23], v[120:123], v[208:211]
    ds_read_b64_tr_b16 a[6:7], v4 offset:62016
    v_mfma_f32_16x16x32_bf16 v[220:223], a[24:27], v[84:87], v[220:223]
    ds_read_b64_tr_b16 a[8:9], v4 offset:64064
    v_pk_max_i16 v247, v247, 0
    v_mfma_f32_16x16x32_bf16 v[220:223], a[28:31], v[92:95], v[220:223]
    ds_read_b64_tr_b16 a[10:11], v8 offset:576
    v_accvgpr_write_b32 a84, v244
    v_mfma_f32_16x16x32_bf16 v[216:219], a[24:27], v[80:83], v[216:219]
    ds_read_b64_tr_b16 a[12:13], v8 offset:33920
    v_mfma_f32_16x16x32_bf16 v[216:219], a[28:31], v[88:91], v[216:219]
    s_waitcnt lgkmcnt(7)
    ds_read_b64_tr_b16 a[14:15], v8 offset:35968
    v_accvgpr_write_b32 a85, v245
    v_mfma_f32_16x16x32_bf16 v[220:223], a[32:35], v[100:103], v[220:223]
    s_add_u32 s82, s75, 4096
    ds_read_b64_tr_b16 a[16:17], v8 offset:38016
    buffer_store_dwordx4 a[64:67], v18, s[20:23], s82 offen offset:0 sc1
    v_mfma_f32_16x16x32_bf16 v[220:223], a[36:39], v[108:111], v[220:223]
    ds_read_b64_tr_b16 a[18:19], v12 offset:5824
    v_accvgpr_write_b32 a86, v246
    v_mfma_f32_16x16x32_bf16 v[216:219], a[32:35], v[96:99], v[216:219]
    ds_read_b64_tr_b16 a[20:21], v12 offset:7872
    v_accvgpr_write_b32 a87, v247
    v_mfma_f32_16x16x32_bf16 v[216:219], a[36:39], v[104:107], v[216:219]
    ds_read_b64_tr_b16 a[22:23], v12 offset:9920
    v_mfma_f32_16x16x32_bf16 v[220:223], a[40:43], v[116:119], v[220:223]
    s_add_u32 m0, s67, 14336
    ds_read_b64_tr_b16 a[24:25], v5 offset:24576
    ds_read_b128 v[176:179], v19 offset:1024
    v_mfma_f32_16x16x32_bf16 v[220:223], a[44:47], v[124:127], v[220:223]
    s_add_u32 s72, s30, 147968
    ds_read_b64_tr_b16 a[26:27], v5 offset:26624
    buffer_load_dwordx4 v14, s[12:15], s72 offen lds
    v_mfma_f32_16x16x32_bf16 v[216:219], a[40:43], v[112:115], v[216:219]
    ds_read_b64_tr_b16 a[28:29], v5 offset:28672
    ds_read_b128 v[184:187], v19 offset:1088
    v_mfma_f32_16x16x32_bf16 v[216:219], a[44:47], v[120:123], v[216:219]
    s_waitcnt lgkmcnt(9)
    ds_read_b64_tr_b16 a[30:31], v5 offset:62016
    v_mfma_f32_16x16x32_bf16 v[228:231], a[0:3], v[84:87], v[228:231]
    ds_read_b64_tr_b16 a[32:33], v5 offset:64064
    v_mul_f32 v192, v192, |v192|
    v_mfma_f32_16x16x32_bf16 v[228:231], a[4:7], v[92:95], v[228:231]
    ds_read_b64_tr_b16 a[34:35], v9 offset:576
    v_mul_f32 v193, v193, |v193|
    v_mfma_f32_16x16x32_bf16 v[224:227], a[0:3], v[80:83], v[224:227]
    ds_read_b64_tr_b16 a[36:37], v9 offset:33920
    v_mfma_f32_16x16x32_bf16 v[224:227], a[4:7], v[88:91], v[224:227]
    ds_read_b64_tr_b16 a[38:39], v9 offset:35968
    buffer_load_dwordx4 v15, s[12:15], s72 offen offset:1024 lds
    v_mfma_f32_16x16x32_bf16 v[228:231], a[8:11], v[100:103], v[228:231]
    ds_read_b64_tr_b16 a[40:41], v9 offset:38016
    v_mul_f32 v194, v194, |v194|
    v_mfma_f32_16x16x32_bf16 v[228:231], a[12:15], v[108:111], v[228:231]
    ds_read_b64_tr_b16 a[42:43], v13 offset:5824
    v_mul_f32 v195, v195, |v195|
    v_mfma_f32_16x16x32_bf16 v[224:227], a[8:11], v[96:99], v[224:227]
    ds_read_b64_tr_b16 a[44:45], v13 offset:7872
    v_cvt_pk_bf16_f32 v248, v192, v193
    v_mfma_f32_16x16x32_bf16 v[224:227], a[12:15], v[104:107], v[224:227]
    s_waitcnt vmcnt(21) lgkmcnt(7)
    ds_read_b64_tr_b16 a[46:47], v13 offset:9920
    v_mfma_f32_16x16x32_bf16 v[228:231], a[16:19], v[116:119], v[228:231]
    s_barrier
    ds_read_b64_tr_b16 a[0:1], v2 offset:30720
    v_mfma_f32_16x16x32_bf16 v[228:231], a[20:23], v[124:127], v[228:231]
    s_add_u32 m0, s67, 16384
    ds_read_b64_tr_b16 a[2:3], v2 offset:32768
    v_cvt_pk_bf16_f32 v249, v194, v195
    v_mfma_f32_16x16x32_bf16 v[224:227], a[16:19], v[112:115], v[224:227]
    s_add_u32 s72, s30, 295424
    ds_read_b64_tr_b16 a[4:5], v2 offset:34816
    buffer_load_dwordx4 v14, s[12:15], s72 offen lds
    v_mfma_f32_16x16x32_bf16 v[224:227], a[20:23], v[120:123], v[224:227]
    ds_read_b64_tr_b16 a[6:7], v6 offset:2624
    v_mul_f32 v200, v200, |v200|
    v_mfma_f32_16x16x32_bf16 v[236:239], a[24:27], v[84:87], v[236:239]
    ds_read_b64_tr_b16 a[8:9], v6 offset:4672
    v_mul_f32 v201, v201, |v201|
    v_mfma_f32_16x16x32_bf16 v[236:239], a[28:31], v[92:95], v[236:239]
    ds_read_b64_tr_b16 a[10:11], v6 offset:6720
    v_mul_f32 v202, v202, |v202|
    v_mfma_f32_16x16x32_bf16 v[232:235], a[24:27], v[80:83], v[232:235]
    ds_read_b64_tr_b16 a[12:13], v6 offset:40064
    v_mfma_f32_16x16x32_bf16 v[232:235], a[28:31], v[88:91], v[232:235]
    s_waitcnt lgkmcnt(7)
    ds_read_b64_tr_b16 a[14:15], v6 offset:42112
    buffer_store_dwordx4 a[68:71], v18, s[20:23], s82 offen offset:1024 sc1
    v_mfma_f32_16x16x32_bf16 v[236:239], a[32:35], v[100:103], v[236:239]
    ds_read_b64_tr_b16 a[16:17], v6 offset:44160
    v_mul_f32 v203, v203, |v203|
    v_mfma_f32_16x16x32_bf16 v[236:239], a[36:39], v[108:111], v[236:239]
    ds_read_b64_tr_b16 a[18:19], v10 offset:11968
    v_cvt_pk_bf16_f32 v250, v200, v201
    v_mfma_f32_16x16x32_bf16 v[232:235], a[32:35], v[96:99], v[232:235]
    ds_read_b64_tr_b16 a[20:21], v10 offset:14016
    v_cvt_pk_bf16_f32 v251, v202, v203
    v_mfma_f32_16x16x32_bf16 v[232:235], a[36:39], v[104:107], v[232:235]
    ds_read_b64_tr_b16 a[22:23], v10 offset:16064
    v_mfma_f32_16x16x32_bf16 v[236:239], a[40:43], v[116:119], v[236:239]
    ds_read_b64_tr_b16 a[24:25], v3 offset:30720
    v_pk_max_i16 v248, v248, 0
    v_mfma_f32_16x16x32_bf16 v[236:239], a[44:47], v[124:127], v[236:239]
    ds_read_b64_tr_b16 a[26:27], v3 offset:32768
    buffer_load_dwordx4 v15, s[12:15], s72 offen offset:1024 lds
    v_mfma_f32_16x16x32_bf16 v[232:235], a[40:43], v[112:115], v[232:235]
    ds_read_b64_tr_b16 a[28:29], v3 offset:34816
    v_pk_max_i16 v249, v249, 0
    v_mfma_f32_16x16x32_bf16 v[232:235], a[44:47], v[120:123], v[232:235]
    s_waitcnt lgkmcnt(7)
    ds_read_b64_tr_b16 a[30:31], v7 offset:2624
    v_mfma_f32_16x16x32_bf16 v[212:215], a[0:3], v[132:135], v[212:215]
    ds_read_b64_tr_b16 a[32:33], v7 offset:4672
    v_pk_max_i16 v250, v250, 0
    v_mfma_f32_16x16x32_bf16 v[212:215], a[4:7], v[140:143], v[212:215]
    ds_read_b64_tr_b16 a[34:35], v7 offset:6720
    v_pk_max_i16 v251, v251, 0
    v_mfma_f32_16x16x32_bf16 v[208:211], a[0:3], v[128:131], v[208:211]
    s_add_u32 m0, s67, 18432
    ds_read_b64_tr_b16 a[36:37], v7 offset:40064
    v_mfma_f32_16x16x32_bf16 v[208:211], a[4:7], v[136:139], v[208:211]
    s_add_u32 s72, s73, 640
    ds_read_b64_tr_b16 a[38:39], v7 offset:42112
    buffer_load_dwordx4 v14, s[12:15], s72 offen lds
    v_mfma_f32_16x16x32_bf16 v[212:215], a[8:11], v[148:151], v[212:215]
    ds_read_b64_tr_b16 a[40:41], v7 offset:44160
    v_accvgpr_write_b32 a88, v248
    v_mfma_f32_16x16x32_bf16 v[212:215], a[12:15], v[156:159], v[212:215]
    ds_read_b64_tr_b16 a[42:43], v11 offset:11968
    v_accvgpr_write_b32 a89, v249
    v_mfma_f32_16x16x32_bf16 v[208:211], a[8:11], v[144:147], v[208:211]
    ds_read_b64_tr_b16 a[44:45], v11 offset:14016
    v_accvgpr_write_b32 a90, v250
    v_mfma_f32_16x16x32_bf16 v[208:211], a[12:15], v[152:155], v[208:211]
    s_waitcnt lgkmcnt(7)
    ds_read_b64_tr_b16 a[46:47], v11 offset:16064
    v_mfma_f32_16x16x32_bf16 v[212:215], a[16:19], v[164:167], v[212:215]
    ds_read_b64_tr_b16 a[0:1], v4 offset:30720
    v_accvgpr_write_b32 a91, v251
    v_mfma_f32_16x16x32_bf16 v[212:215], a[20:23], v[172:175], v[212:215]
    ds_read_b64_tr_b16 a[2:3], v4 offset:32768
    buffer_load_dwordx4 v15, s[12:15], s72 offen offset:1024 lds
    v_mfma_f32_16x16x32_bf16 v[208:211], a[16:19], v[160:163], v[208:211]
    ds_read_b64_tr_b16 a[4:5], v4 offset:34816
    v_mul_f32 v196, v196, |v196|
    v_mfma_f32_16x16x32_bf16 v[208:211], a[20:23], v[168:171], v[208:211]
    ds_read_b64_tr_b16 a[6:7], v8 offset:2624
    v_mfma_f32_16x16x32_bf16 v[220:223], a[24:27], v[132:135], v[220:223]
    ds_read_b64_tr_b16 a[8:9], v8 offset:4672
    v_mul_f32 v197, v197, |v197|
    v_mfma_f32_16x16x32_bf16 v[220:223], a[28:31], v[140:143], v[220:223]
    ds_read_b64_tr_b16 a[10:11], v8 offset:6720
    v_mul_f32 v198, v198, |v198|
    v_mfma_f32_16x16x32_bf16 v[216:219], a[24:27], v[128:131], v[216:219]
    ds_read_b64_tr_b16 a[12:13], v8 offset:40064
L_pad_m1_1:
    s_cbranch_execz L_pad_m1_2
    v_mfma_f32_16x16x32_bf16 v[216:219], a[28:31], v[136:139], v[216:219]
    s_waitcnt lgkmcnt(7)
    ds_read_b64_tr_b16 a[14:15], v8 offset:42112
    buffer_store_dwordx4 a[72:75], v18, s[20:23], s82 offen offset:2048 sc1
    v_mfma_f32_16x16x32_bf16 v[220:223], a[32:35], v[148:151], v[220:223]
    ds_read_b64_tr_b16 a[16:17], v8 offset:44160
    v_mul_f32 v199, v199, |v199|
    v_mfma_f32_16x16x32_bf16 v[220:223], a[36:39], v[156:159], v[220:223]
    ds_read_b64_tr_b16 a[18:19], v12 offset:11968
    v_cvt_pk_bf16_f32 v252, v196, v197
    v_mfma_f32_16x16x32_bf16 v[216:219], a[32:35], v[144:147], v[216:219]
    ds_read_b64_tr_b16 a[20:21], v12 offset:14016
    v_cvt_pk_bf16_f32 v253, v198, v199
    v_mfma_f32_16x16x32_bf16 v[216:219], a[36:39], v[152:155], v[216:219]
    ds_read_b64_tr_b16 a[22:23], v12 offset:16064
    v_mfma_f32_16x16x32_bf16 v[220:223], a[40:43], v[164:167], v[220:223]
    s_add_u32 m0, s67, 20480
    ds_read_b64_tr_b16 a[24:25], v5 offset:30720
    v_mul_f32 v204, v204, |v204|
    v_mfma_f32_16x16x32_bf16 v[220:223], a[44:47], v[172:175], v[220:223]
    s_add_u32 s72, s73, 148096
    ds_read_b64_tr_b16 a[26:27], v5 offset:32768
    buffer_load_dwordx4 v14, s[12:15], s72 offen lds
    v_mfma_f32_16x16x32_bf16 v[216:219], a[40:43], v[160:163], v[216:219]
    ds_read_b64_tr_b16 a[28:29], v5 offset:34816
    v_mul_f32 v205, v205, |v205|
    v_mfma_f32_16x16x32_bf16 v[216:219], a[44:47], v[168:171], v[216:219]
    s_waitcnt lgkmcnt(7)
    ds_read_b64_tr_b16 a[30:31], v9 offset:2624
    v_mfma_f32_16x16x32_bf16 v[228:231], a[0:3], v[132:135], v[228:231]
    ds_read_b64_tr_b16 a[32:33], v9 offset:4672
    v_mul_f32 v206, v206, |v206|
    v_mfma_f32_16x16x32_bf16 v[228:231], a[4:7], v[140:143], v[228:231]
    ds_read_b64_tr_b16 a[34:35], v9 offset:6720
    v_mul_f32 v207, v207, |v207|
    v_mfma_f32_16x16x32_bf16 v[224:227], a[0:3], v[128:131], v[224:227]
    ds_read_b64_tr_b16 a[36:37], v9 offset:40064
    v_mfma_f32_16x16x32_bf16 v[224:227], a[4:7], v[136:139], v[224:227]
    ds_read_b64_tr_b16 a[38:39], v9 offset:42112
    buffer_load_dwordx4 v15, s[12:15], s72 offen offset:1024 lds
    v_mfma_f32_16x16x32_bf16 v[228:231], a[8:11], v[148:151], v[228:231]
    ds_read_b64_tr_b16 a[40:41], v9 offset:44160
    v_cvt_pk_bf16_f32 v254, v204, v205
    v_mfma_f32_16x16x32_bf16 v[228:231], a[12:15], v[156:159], v[228:231]
    ds_read_b64_tr_b16 a[42:43], v13 offset:11968
    v_cvt_pk_bf16_f32 v255, v206, v207
    v_mfma_f32_16x16x32_bf16 v[224:227], a[8:11], v[144:147], v[224:227]
    ds_read_b64_tr_b16 a[44:45], v13 offset:14016
    v_pk_max_i16 v252, v252, 0
    v_mfma_f32_16x16x32_bf16 v[224:227], a[12:15], v[152:155], v[224:227]
    s_waitcnt vmcnt(21) lgkmcnt(7)
    ds_read_b64_tr_b16 a[46:47], v13 offset:16064
    v_mfma_f32_16x16x32_bf16 v[228:231], a[16:19], v[164:167], v[228:231]
    s_barrier
    ds_read_b64_tr_b16 a[0:1], v2 offset:0
    v_mfma_f32_16x16x32_bf16 v[228:231], a[20:23], v[172:175], v[228:231]
    s_add_u32 m0, s67, 22528
    ds_read_b64_tr_b16 a[2:3], v2 offset:2048
    v_pk_max_i16 v253, v253, 0
    v_mfma_f32_16x16x32_bf16 v[224:227], a[16:19], v[160:163], v[224:227]
    s_add_u32 s72, s73, 295552
    ds_read_b64_tr_b16 a[4:5], v2 offset:4096
    buffer_load_dwordx4 v14, s[12:15], s72 offen lds
    v_mfma_f32_16x16x32_bf16 v[224:227], a[20:23], v[168:171], v[224:227]
    ds_read_b64_tr_b16 a[6:7], v2 offset:37440
    v_pk_max_i16 v254, v254, 0
    v_mfma_f32_16x16x32_bf16 v[236:239], a[24:27], v[132:135], v[236:239]
    ds_read_b64_tr_b16 a[8:9], v2 offset:39488
    v_pk_max_i16 v255, v255, 0
    v_mfma_f32_16x16x32_bf16 v[236:239], a[28:31], v[140:143], v[236:239]
    ds_read_b64_tr_b16 a[10:11], v2 offset:41536
    v_accvgpr_write_b32 a92, v252
    v_mfma_f32_16x16x32_bf16 v[232:235], a[24:27], v[128:131], v[232:235]
    ds_read_b64_tr_b16 a[12:13], v6 offset:9344
    v_mfma_f32_16x16x32_bf16 v[232:235], a[28:31], v[136:139], v[232:235]
    s_waitcnt lgkmcnt(7)
    ds_read_b64_tr_b16 a[14:15], v6 offset:11392
    buffer_store_dwordx4 a[76:79], v18, s[20:23], s82 offen offset:3072 sc1
    v_mfma_f32_16x16x32_bf16 v[236:239], a[32:35], v[148:151], v[236:239]
    ds_read_b64_tr_b16 a[16:17], v6 offset:13440
    v_accvgpr_write_b32 a93, v253
    v_mfma_f32_16x16x32_bf16 v[236:239], a[36:39], v[156:159], v[236:239]
    ds_read_b64_tr_b16 a[18:19], v6 offset:46784
    v_accvgpr_write_b32 a94, v254
    v_mfma_f32_16x16x32_bf16 v[232:235], a[32:35], v[144:147], v[232:235]
    ds_read_b64_tr_b16 a[20:21], v6 offset:48832
    v_accvgpr_write_b32 a95, v255
    v_mfma_f32_16x16x32_bf16 v[232:235], a[36:39], v[152:155], v[232:235]
    ds_read_b64_tr_b16 a[22:23], v6 offset:50880
    v_mfma_f32_16x16x32_bf16 v[236:239], a[40:43], v[164:167], v[236:239]
    ds_read_b64_tr_b16 a[24:25], v3 offset:0
    ds_read_b128 v[192:195], v19 offset:1152
    v_mfma_f32_16x16x32_bf16 v[236:239], a[44:47], v[172:175], v[236:239]
    ds_read_b64_tr_b16 a[26:27], v3 offset:2048
    buffer_load_dwordx4 v15, s[12:15], s72 offen offset:1024 lds
    v_mfma_f32_16x16x32_bf16 v[232:235], a[40:43], v[160:163], v[232:235]
    ds_read_b64_tr_b16 a[28:29], v3 offset:4096
    ds_read_b128 v[200:203], v19 offset:1216
    v_mfma_f32_16x16x32_bf16 v[232:235], a[44:47], v[168:171], v[232:235]
    s_waitcnt lgkmcnt(9)
    ds_read_b64_tr_b16 a[30:31], v3 offset:37440
    v_mfma_f32_16x16x32_bf16 v[180:183], a[0:3], v[36:39], v[176:179]
    ds_read_b64_tr_b16 a[32:33], v3 offset:39488
    v_mul_f32 v208, v208, |v208|
    v_mfma_f32_16x16x32_bf16 v[180:183], a[4:7], v[44:47], v[180:183]
    ds_read_b64_tr_b16 a[34:35], v3 offset:41536
    v_mul_f32 v209, v209, |v209|
    v_mfma_f32_16x16x32_bf16 v[176:179], a[0:3], v[32:35], v[176:179]
    s_add_u32 m0, s67, 24576
    ds_read_b64_tr_b16 a[36:37], v7 offset:9344
    v_mfma_f32_16x16x32_bf16 v[176:179], a[4:7], v[40:43], v[176:179]
    s_add_u32 s72, s29, 640
    ds_read_b64_tr_b16 a[38:39], v7 offset:11392
    buffer_load_dwordx4 v14, s[12:15], s72 offen lds
    v_mfma_f32_16x16x32_bf16 v[180:183], a[8:11], v[52:55], v[180:183]
    ds_read_b64_tr_b16 a[40:41], v7 offset:13440
    v_mul_f32 v210, v210, |v210|
    v_mfma_f32_16x16x32_bf16 v[180:183], a[12:15], v[60:63], v[180:183]
    ds_read_b64_tr_b16 a[42:43], v7 offset:46784
    v_mul_f32 v211, v211, |v211|
    v_mfma_f32_16x16x32_bf16 v[176:179], a[8:11], v[48:51], v[176:179]
    ds_read_b64_tr_b16 a[44:45], v7 offset:48832
    v_cvt_pk_bf16_f32 v240, v208, v209
    v_mfma_f32_16x16x32_bf16 v[176:179], a[12:15], v[56:59], v[176:179]
    s_waitcnt lgkmcnt(7)
    ds_read_b64_tr_b16 a[46:47], v7 offset:50880
    v_mfma_f32_16x16x32_bf16 v[180:183], a[16:19], v[68:71], v[180:183]
    ds_read_b64_tr_b16 a[0:1], v4 offset:0
    v_cvt_pk_bf16_f32 v241, v210, v211
    v_mfma_f32_16x16x32_bf16 v[180:183], a[20:23], v[76:79], v[180:183]
    ds_read_b64_tr_b16 a[2:3], v4 offset:2048
    buffer_load_dwordx4 v15, s[12:15], s72 offen offset:1024 lds
    v_mfma_f32_16x16x32_bf16 v[176:179], a[16:19], v[64:67], v[176:179]
    ds_read_b64_tr_b16 a[4:5], v4 offset:4096
    v_mul_f32 v216, v216, |v216|
    v_mfma_f32_16x16x32_bf16 v[176:179], a[20:23], v[72:75], v[176:179]
    ds_read_b64_tr_b16 a[6:7], v4 offset:37440
    v_mfma_f32_16x16x32_bf16 v[188:191], a[24:27], v[36:39], v[184:187]
    ds_read_b64_tr_b16 a[8:9], v4 offset:39488
    v_mul_f32 v217, v217, |v217|
    v_mfma_f32_16x16x32_bf16 v[188:191], a[28:31], v[44:47], v[188:191]
    ds_read_b64_tr_b16 a[10:11], v4 offset:41536
    v_mul_f32 v218, v218, |v218|
    v_mfma_f32_16x16x32_bf16 v[184:187], a[24:27], v[32:35], v[184:187]
    ds_read_b64_tr_b16 a[12:13], v8 offset:9344
    v_mfma_f32_16x16x32_bf16 v[184:187], a[28:31], v[40:43], v[184:187]
    s_waitcnt lgkmcnt(7)
    ds_read_b64_tr_b16 a[14:15], v8 offset:11392
    v_mul_f32 v219, v219, |v219|
    v_mfma_f32_16x16x32_bf16 v[188:191], a[32:35], v[52:55], v[188:191]
    s_add_u32 s82, s75, 8192
    ds_read_b64_tr_b16 a[16:17], v8 offset:13440
    buffer_store_dwordx4 a[80:83], v18, s[20:23], s82 offen offset:0 sc1
    v_mfma_f32_16x16x32_bf16 v[188:191], a[36:39], v[60:63], v[188:191]
    ds_read_b64_tr_b16 a[18:19], v8 offset:46784
    v_cvt_pk_bf16_f32 v242, v216, v217
    v_mfma_f32_16x16x32_bf16 v[184:187], a[32:35], v[48:51], v[184:187]
    ds_read_b64_tr_b16 a[20:21], v8 offset:48832
    v_cvt_pk_bf16_f32 v243, v218, v219
    v_mfma_f32_16x16x32_bf16 v[184:187], a[36:39], v[56:59], v[184:187]
    ds_read_b64_tr_b16 a[22:23], v8 offset:50880
    v_mfma_f32_16x16x32_bf16 v[188:191], a[40:43], v[68:71], v[188:191]
    s_add_u32 m0, s67, 26624
    ds_read_b64_tr_b16 a[24:25], v5 offset:0
    v_pk_max_i16 v240, v240, 0
    v_mfma_f32_16x16x32_bf16 v[188:191], a[44:47], v[76:79], v[188:191]
    s_add_u32 s72, s29, 148096
    ds_read_b64_tr_b16 a[26:27], v5 offset:2048
    buffer_load_dwordx4 v14, s[12:15], s72 offen lds
    v_mfma_f32_16x16x32_bf16 v[184:187], a[40:43], v[64:67], v[184:187]
    ds_read_b64_tr_b16 a[28:29], v5 offset:4096
    v_pk_max_i16 v241, v241, 0
    v_mfma_f32_16x16x32_bf16 v[184:187], a[44:47], v[72:75], v[184:187]
    s_waitcnt lgkmcnt(7)
    ds_read_b64_tr_b16 a[30:31], v5 offset:37440
    v_mfma_f32_16x16x32_bf16 v[196:199], a[0:3], v[36:39], v[192:195]
    ds_read_b64_tr_b16 a[32:33], v5 offset:39488
    v_pk_max_i16 v242, v242, 0
    v_mfma_f32_16x16x32_bf16 v[196:199], a[4:7], v[44:47], v[196:199]
    ds_read_b64_tr_b16 a[34:35], v5 offset:41536
    v_pk_max_i16 v243, v243, 0
    v_mfma_f32_16x16x32_bf16 v[192:195], a[0:3], v[32:35], v[192:195]
    ds_read_b64_tr_b16 a[36:37], v9 offset:9344
    v_mfma_f32_16x16x32_bf16 v[192:195], a[4:7], v[40:43], v[192:195]
    ds_read_b64_tr_b16 a[38:39], v9 offset:11392
    buffer_load_dwordx4 v15, s[12:15], s72 offen offset:1024 lds
    v_mfma_f32_16x16x32_bf16 v[196:199], a[8:11], v[52:55], v[196:199]
    ds_read_b64_tr_b16 a[40:41], v9 offset:13440
    v_accvgpr_write_b32 a96, v240
    v_mfma_f32_16x16x32_bf16 v[196:199], a[12:15], v[60:63], v[196:199]
    ds_read_b64_tr_b16 a[42:43], v9 offset:46784
    v_accvgpr_write_b32 a97, v241
    v_mfma_f32_16x16x32_bf16 v[192:195], a[8:11], v[48:51], v[192:195]
    ds_read_b64_tr_b16 a[44:45], v9 offset:48832
    v_accvgpr_write_b32 a98, v242
    v_mfma_f32_16x16x32_bf16 v[192:195], a[12:15], v[56:59], v[192:195]
    s_waitcnt vmcnt(21) lgkmcnt(7)
    ds_read_b64_tr_b16 a[46:47], v9 offset:50880
    v_mfma_f32_16x16x32_bf16 v[196:199], a[16:19], v[68:71], v[196:199]
    s_barrier
    ds_read_b64_tr_b16 a[0:1], v2 offset:6144
    v_mfma_f32_16x16x32_bf16 v[196:199], a[20:23], v[76:79], v[196:199]
    s_add_u32 m0, s67, 28672
    ds_read_b64_tr_b16 a[2:3], v2 offset:8192
    v_accvgpr_write_b32 a99, v243
    v_mfma_f32_16x16x32_bf16 v[192:195], a[16:19], v[64:67], v[192:195]
    s_add_u32 s72, s29, 295552
    ds_read_b64_tr_b16 a[4:5], v2 offset:10240
    buffer_load_dwordx4 v14, s[12:15], s72 offen lds
    v_mfma_f32_16x16x32_bf16 v[192:195], a[20:23], v[72:75], v[192:195]
    ds_read_b64_tr_b16 a[6:7], v2 offset:43584
    v_mul_f32 v212, v212, |v212|
    v_mfma_f32_16x16x32_bf16 v[204:207], a[24:27], v[36:39], v[200:203]
    ds_read_b64_tr_b16 a[8:9], v2 offset:45632
    v_mul_f32 v213, v213, |v213|
    v_mfma_f32_16x16x32_bf16 v[204:207], a[28:31], v[44:47], v[204:207]
    ds_read_b64_tr_b16 a[10:11], v2 offset:47680
    v_mul_f32 v214, v214, |v214|
    v_mfma_f32_16x16x32_bf16 v[200:203], a[24:27], v[32:35], v[200:203]
    ds_read_b64_tr_b16 a[12:13], v6 offset:15488
    v_mfma_f32_16x16x32_bf16 v[200:203], a[28:31], v[40:43], v[200:203]
    s_waitcnt lgkmcnt(7)
    ds_read_b64_tr_b16 a[14:15], v6 offset:17536
    buffer_store_dwordx4 a[84:87], v18, s[20:23], s82 offen offset:1024 sc1
    v_mfma_f32_16x16x32_bf16 v[204:207], a[32:35], v[52:55], v[204:207]
    ds_read_b64_tr_b16 a[16:17], v6 offset:19584
    v_mul_f32 v215, v215, |v215|
    v_mfma_f32_16x16x32_bf16 v[204:207], a[36:39], v[60:63], v[204:207]
    ds_read_b64_tr_b16 a[18:19], v6 offset:52928
    v_cvt_pk_bf16_f32 v244, v212, v213
    v_mfma_f32_16x16x32_bf16 v[200:203], a[32:35], v[48:51], v[200:203]
    ds_read_b64_tr_b16 a[20:21], v6 offset:54976
    v_cvt_pk_bf16_f32 v245, v214, v215
    v_mfma_f32_16x16x32_bf16 v[200:203], a[36:39], v[56:59], v[200:203]
    ds_read_b64_tr_b16 a[22:23], v6 offset:57024
    v_mfma_f32_16x16x32_bf16 v[204:207], a[40:43], v[68:71], v[204:207]
    ds_read_b64_tr_b16 a[24:25], v3 offset:6144
    v_mul_f32 v220, v220, |v220|
    v_mfma_f32_16x16x32_bf16 v[204:207], a[44:47], v[76:79], v[204:207]
    ds_read_b64_tr_b16 a[26:27], v3 offset:8192
    buffer_load_dwordx4 v15, s[12:15], s72 offen offset:1024 lds
    v_mfma_f32_16x16x32_bf16 v[200:203], a[40:43], v[64:67], v[200:203]
    ds_read_b64_tr_b16 a[28:29], v3 offset:10240
    v_mul_f32 v221, v221, |v221|
    v_mfma_f32_16x16x32_bf16 v[200:203], a[44:47], v[72:75], v[200:203]
    s_waitcnt lgkmcnt(7)
    ds_read_b64_tr_b16 a[30:31], v3 offset:43584
    v_mfma_f32_16x16x32_bf16 v[180:183], a[0:3], v[84:87], v[180:183]
    ds_read_b64_tr_b16 a[32:33], v3 offset:45632
    v_mul_f32 v222, v222, |v222|
    v_mfma_f32_16x16x32_bf16 v[180:183], a[4:7], v[92:95], v[180:183]
    s_add_u32 m0, s67, 30720
    ds_read_b64_tr_b16 a[34:35], v3 offset:47680
    v_mul_f32 v223, v223, |v223|
    v_mfma_f32_16x16x32_bf16 v[176:179], a[0:3], v[80:83], v[176:179]
    s_add_u32 s72, s30, 640
    ds_read_b64_tr_b16 a[36:37], v7 offset:15488
    buffer_load_dwordx4 v14, s[12:15], s72 offen lds
    v_mfma_f32_16x16x32_bf16 v[176:179], a[4:7], v[88:91], v[176:179]
    ds_read_b64_tr_b16 a[38:39], v7 offset:17536
    v_cvt_pk_bf16_f32 v246, v220, v221
    v_mfma_f32_16x16x32_bf16 v[180:183], a[8:11], v[100:103], v[180:183]
    ds_read_b64_tr_b16 a[40:41], v7 offset:19584
    v_mfma_f32_16x16x32_bf16 v[180:183], a[12:15], v[108:111], v[180:183]
    ds_read_b64_tr_b16 a[42:43], v7 offset:52928
    v_cvt_pk_bf16_f32 v247, v222, v223
    v_mfma_f32_16x16x32_bf16 v[176:179], a[8:11], v[96:99], v[176:179]
    ds_read_b64_tr_b16 a[44:45], v7 offset:54976
    v_pk_max_i16 v244, v244, 0
    v_mfma_f32_16x16x32_bf16 v[176:179], a[12:15], v[104:107], v[176:179]
    s_waitcnt lgkmcnt(7)
    ds_read_b64_tr_b16 a[46:47], v7 offset:57024
    v_mfma_f32_16x16x32_bf16 v[180:183], a[16:19], v[116:119], v[180:183]
    ds_read_b64_tr_b16 a[0:1], v4 offset:6144
    s_waitcnt vmcnt(10)
    s_add_u32 s71, s66, 1
    v_mov_b32 v22, s71
    buffer_store_dword v22, off, s[20:23], s90 sc1
    v_mfma_f32_16x16x32_bf16 v[180:183], a[20:23], v[124:127], v[180:183]
    ds_read_b64_tr_b16 a[2:3], v4 offset:8192
    v_pk_max_i16 v245, v245, 0
    v_mfma_f32_16x16x32_bf16 v[176:179], a[16:19], v[112:115], v[176:179]
    ds_read_b64_tr_b16 a[4:5], v4 offset:10240
    v_pk_max_i16 v246, v246, 0
    v_mfma_f32_16x16x32_bf16 v[176:179], a[20:23], v[120:123], v[176:179]
    ds_read_b64_tr_b16 a[6:7], v4 offset:43584
    v_mfma_f32_16x16x32_bf16 v[188:191], a[24:27], v[84:87], v[188:191]
    ds_read_b64_tr_b16 a[8:9], v4 offset:45632
    v_pk_max_i16 v247, v247, 0
    v_mfma_f32_16x16x32_bf16 v[188:191], a[28:31], v[92:95], v[188:191]
    ds_read_b64_tr_b16 a[10:11], v4 offset:47680
    buffer_load_dwordx4 v15, s[12:15], s72 offen offset:1024 lds
    v_mfma_f32_16x16x32_bf16 v[184:187], a[24:27], v[80:83], v[184:187]
    ds_read_b64_tr_b16 a[12:13], v8 offset:15488
    v_accvgpr_write_b32 a100, v244
    v_mfma_f32_16x16x32_bf16 v[184:187], a[28:31], v[88:91], v[184:187]
    s_waitcnt lgkmcnt(7)
    ds_read_b64_tr_b16 a[14:15], v8 offset:17536
    v_accvgpr_write_b32 a101, v245
    v_mfma_f32_16x16x32_bf16 v[188:191], a[32:35], v[100:103], v[188:191]
    ds_read_b64_tr_b16 a[16:17], v8 offset:19584
    v_mfma_f32_16x16x32_bf16 v[188:191], a[36:39], v[108:111], v[188:191]
    s_add_u32 m0, s67, 32768
    ds_read_b64_tr_b16 a[18:19], v8 offset:52928
    v_accvgpr_write_b32 a102, v246
    v_mfma_f32_16x16x32_bf16 v[184:187], a[32:35], v[96:99], v[184:187]
    s_add_u32 s72, s30, 148096
    ds_read_b64_tr_b16 a[20:21], v8 offset:54976
    buffer_load_dwordx4 v14, s[12:15], s72 offen lds
    v_mfma_f32_16x16x32_bf16 v[184:187], a[36:39], v[104:107], v[184:187]
    ds_read_b64_tr_b16 a[22:23], v8 offset:57024
    v_accvgpr_write_b32 a103, v247
    v_mfma_f32_16x16x32_bf16 v[188:191], a[40:43], v[116:119], v[188:191]
    ds_read_b64_tr_b16 a[24:25], v5 offset:6144
    ds_read_b128 v[208:211], v19 offset:1280
    v_mfma_f32_16x16x32_bf16 v[188:191], a[44:47], v[124:127], v[188:191]
    ds_read_b64_tr_b16 a[26:27], v5 offset:8192
    v_mfma_f32_16x16x32_bf16 v[184:187], a[40:43], v[112:115], v[184:187]
    ds_read_b64_tr_b16 a[28:29], v5 offset:10240
    ds_read_b128 v[216:219], v19 offset:1344
    v_mfma_f32_16x16x32_bf16 v[184:187], a[44:47], v[120:123], v[184:187]
    s_waitcnt lgkmcnt(9)
    ds_read_b64_tr_b16 a[30:31], v5 offset:43584
    v_mfma_f32_16x16x32_bf16 v[196:199], a[0:3], v[84:87], v[196:199]
    ds_read_b64_tr_b16 a[32:33], v5 offset:45632
    buffer_store_dwordx4 a[88:91], v18, s[20:23], s82 offen offset:2048 sc1
    v_mfma_f32_16x16x32_bf16 v[196:199], a[4:7], v[92:95], v[196:199]
    ds_read_b64_tr_b16 a[34:35], v5 offset:47680
    v_mul_f32 v224, v224, |v224|
    v_mfma_f32_16x16x32_bf16 v[192:195], a[0:3], v[80:83], v[192:195]
    ds_read_b64_tr_b16 a[36:37], v9 offset:15488
    v_mul_f32 v225, v225, |v225|
    v_mfma_f32_16x16x32_bf16 v[192:195], a[4:7], v[88:91], v[192:195]
    ds_read_b64_tr_b16 a[38:39], v9 offset:17536
    v_mul_f32 v226, v226, |v226|
    v_mfma_f32_16x16x32_bf16 v[196:199], a[8:11], v[100:103], v[196:199]
    ds_read_b64_tr_b16 a[40:41], v9 offset:19584
    v_mfma_f32_16x16x32_bf16 v[196:199], a[12:15], v[108:111], v[196:199]
    ds_read_b64_tr_b16 a[42:43], v9 offset:52928
    buffer_load_dwordx4 v15, s[12:15], s72 offen offset:1024 lds
    v_mfma_f32_16x16x32_bf16 v[192:195], a[8:11], v[96:99], v[192:195]
    ds_read_b64_tr_b16 a[44:45], v9 offset:54976
    v_mul_f32 v227, v227, |v227|
    v_mfma_f32_16x16x32_bf16 v[192:195], a[12:15], v[104:107], v[192:195]
    s_waitcnt lgkmcnt(7)
    ds_read_b64_tr_b16 a[46:47], v9 offset:57024
    v_cvt_pk_bf16_f32 v248, v224, v225
    v_mfma_f32_16x16x32_bf16 v[196:199], a[16:19], v[116:119], v[196:199]
    s_barrier
    ds_read_b64_tr_b16 a[0:1], v2 offset:12288
    v_mfma_f32_16x16x32_bf16 v[196:199], a[20:23], v[124:127], v[196:199]
    s_add_u32 m0, s67, 34816
    ds_read_b64_tr_b16 a[2:3], v2 offset:14336
    v_cvt_pk_bf16_f32 v249, v226, v227
    v_mfma_f32_16x16x32_bf16 v[192:195], a[16:19], v[112:115], v[192:195]
    s_add_u32 s72, s30, 295552
    ds_read_b64_tr_b16 a[4:5], v2 offset:16384
    buffer_load_dwordx4 v14, s[12:15], s72 offen lds
    v_mfma_f32_16x16x32_bf16 v[192:195], a[20:23], v[120:123], v[192:195]
    ds_read_b64_tr_b16 a[6:7], v2 offset:49728
    v_mul_f32 v232, v232, |v232|
    v_mfma_f32_16x16x32_bf16 v[204:207], a[24:27], v[84:87], v[204:207]
    ds_read_b64_tr_b16 a[8:9], v2 offset:51776
    v_mul_f32 v233, v233, |v233|
    v_mfma_f32_16x16x32_bf16 v[204:207], a[28:31], v[92:95], v[204:207]
    ds_read_b64_tr_b16 a[10:11], v2 offset:53824
    v_mul_f32 v234, v234, |v234|
    v_mfma_f32_16x16x32_bf16 v[200:203], a[24:27], v[80:83], v[200:203]
    ds_read_b64_tr_b16 a[12:13], v6 offset:21632
    v_mfma_f32_16x16x32_bf16 v[200:203], a[28:31], v[88:91], v[200:203]
    s_waitcnt lgkmcnt(7)
    ds_read_b64_tr_b16 a[14:15], v6 offset:23680
    v_mul_f32 v235, v235, |v235|
    v_mfma_f32_16x16x32_bf16 v[204:207], a[32:35], v[100:103], v[204:207]
    ds_read_b64_tr_b16 a[16:17], v6 offset:25728
    buffer_store_dwordx4 a[92:95], v18, s[20:23], s82 offen offset:3072 sc1
    v_mfma_f32_16x16x32_bf16 v[204:207], a[36:39], v[108:111], v[204:207]
    ds_read_b64_tr_b16 a[18:19], v6 offset:59072
    v_cvt_pk_bf16_f32 v250, v232, v233
    v_mfma_f32_16x16x32_bf16 v[200:203], a[32:35], v[96:99], v[200:203]
    ds_read_b64_tr_b16 a[20:21], v6 offset:61120
    v_cvt_pk_bf16_f32 v251, v234, v235
    v_mfma_f32_16x16x32_bf16 v[200:203], a[36:39], v[104:107], v[200:203]
    ds_read_b64_tr_b16 a[22:23], v6 offset:63168
    v_mfma_f32_16x16x32_bf16 v[204:207], a[40:43], v[116:119], v[204:207]
    ds_read_b64_tr_b16 a[24:25], v3 offset:12288
    v_pk_max_i16 v248, v248, 0
    v_mfma_f32_16x16x32_bf16 v[204:207], a[44:47], v[124:127], v[204:207]
    ds_read_b64_tr_b16 a[26:27], v3 offset:14336
    buffer_load_dwordx4 v15, s[12:15], s72 offen offset:1024 lds
    v_mfma_f32_16x16x32_bf16 v[200:203], a[40:43], v[112:115], v[200:203]
    ds_read_b64_tr_b16 a[28:29], v3 offset:16384
    v_pk_max_i16 v249, v249, 0
    v_mfma_f32_16x16x32_bf16 v[200:203], a[44:47], v[120:123], v[200:203]
    s_waitcnt lgkmcnt(7)
    ds_read_b64_tr_b16 a[30:31], v3 offset:49728
    v_mfma_f32_16x16x32_bf16 v[180:183], a[0:3], v[132:135], v[180:183]
    ds_read_b64_tr_b16 a[32:33], v3 offset:51776
    v_pk_max_i16 v250, v250, 0
    v_mfma_f32_16x16x32_bf16 v[180:183], a[4:7], v[140:143], v[180:183]
    ds_read_b64_tr_b16 a[34:35], v3 offset:53824
    v_pk_max_i16 v251, v251, 0
    v_mfma_f32_16x16x32_bf16 v[176:179], a[0:3], v[128:131], v[176:179]
    s_add_u32 m0, s67, 0
    ds_read_b64_tr_b16 a[36:37], v7 offset:21632
    v_mfma_f32_16x16x32_bf16 v[176:179], a[4:7], v[136:139], v[176:179]
    s_add_u32 s72, s74, 0
    ds_read_b64_tr_b16 a[38:39], v7 offset:23680
    buffer_load_dwordx4 v16, s[16:19], s72 offen lds
    v_mfma_f32_16x16x32_bf16 v[180:183], a[8:11], v[148:151], v[180:183]
    ds_read_b64_tr_b16 a[40:41], v7 offset:25728
    v_accvgpr_write_b32 a104, v248
    v_mfma_f32_16x16x32_bf16 v[180:183], a[12:15], v[156:159], v[180:183]
    ds_read_b64_tr_b16 a[42:43], v7 offset:59072
    v_accvgpr_write_b32 a105, v249
    v_mfma_f32_16x16x32_bf16 v[176:179], a[8:11], v[144:147], v[176:179]
    ds_read_b64_tr_b16 a[44:45], v7 offset:61120
    v_accvgpr_write_b32 a106, v250
    v_mfma_f32_16x16x32_bf16 v[176:179], a[12:15], v[152:155], v[176:179]
    s_waitcnt lgkmcnt(7)
    ds_read_b64_tr_b16 a[46:47], v7 offset:63168
    v_mfma_f32_16x16x32_bf16 v[180:183], a[16:19], v[164:167], v[180:183]
    ds_read_b64_tr_b16 a[0:1], v4 offset:12288
    v_accvgpr_write_b32 a107, v251
    v_mfma_f32_16x16x32_bf16 v[180:183], a[20:23], v[172:175], v[180:183]
    ds_read_b64_tr_b16 a[2:3], v4 offset:14336
    v_mfma_f32_16x16x32_bf16 v[176:179], a[16:19], v[160:163], v[176:179]
    ds_read_b64_tr_b16 a[4:5], v4 offset:16384
    buffer_load_dwordx4 v17, s[16:19], s72 offen offset:1024 lds
    v_mfma_f32_16x16x32_bf16 v[176:179], a[20:23], v[168:171], v[176:179]
    ds_read_b64_tr_b16 a[6:7], v4 offset:49728
    v_mul_f32 v228, v228, |v228|
    v_mfma_f32_16x16x32_bf16 v[188:191], a[24:27], v[132:135], v[188:191]
    ds_read_b64_tr_b16 a[8:9], v4 offset:51776
    v_mul_f32 v229, v229, |v229|
    v_mfma_f32_16x16x32_bf16 v[188:191], a[28:31], v[140:143], v[188:191]
    ds_read_b64_tr_b16 a[10:11], v4 offset:53824
    v_mul_f32 v230, v230, |v230|
    v_mfma_f32_16x16x32_bf16 v[184:187], a[24:27], v[128:131], v[184:187]
    ds_read_b64_tr_b16 a[12:13], v8 offset:21632
    v_mfma_f32_16x16x32_bf16 v[184:187], a[28:31], v[136:139], v[184:187]
    s_waitcnt lgkmcnt(7)
    ds_read_b64_tr_b16 a[14:15], v8 offset:23680
    v_mul_f32 v231, v231, |v231|
    v_mfma_f32_16x16x32_bf16 v[188:191], a[32:35], v[148:151], v[188:191]
    s_add_u32 m0, s67, 2048
    ds_read_b64_tr_b16 a[16:17], v8 offset:25728
    v_mfma_f32_16x16x32_bf16 v[188:191], a[36:39], v[156:159], v[188:191]
    s_add_u32 s72, s74, 128
    ds_read_b64_tr_b16 a[18:19], v8 offset:59072
    buffer_load_dwordx4 v16, s[16:19], s72 offen lds
    v_mfma_f32_16x16x32_bf16 v[184:187], a[32:35], v[144:147], v[184:187]
    ds_read_b64_tr_b16 a[20:21], v8 offset:61120
    v_cvt_pk_bf16_f32 v252, v228, v229
    v_mfma_f32_16x16x32_bf16 v[184:187], a[36:39], v[152:155], v[184:187]
    ds_read_b64_tr_b16 a[22:23], v8 offset:63168
    v_cvt_pk_bf16_f32 v253, v230, v231
    v_mfma_f32_16x16x32_bf16 v[188:191], a[40:43], v[164:167], v[188:191]
    ds_read_b64_tr_b16 a[24:25], v5 offset:12288
    v_mul_f32 v236, v236, |v236|
    v_mfma_f32_16x16x32_bf16 v[188:191], a[44:47], v[172:175], v[188:191]
    ds_read_b64_tr_b16 a[26:27], v5 offset:14336
    v_mfma_f32_16x16x32_bf16 v[184:187], a[40:43], v[160:163], v[184:187]
    ds_read_b64_tr_b16 a[28:29], v5 offset:16384
    v_mul_f32 v237, v237, |v237|
    v_mfma_f32_16x16x32_bf16 v[184:187], a[44:47], v[168:171], v[184:187]
    s_waitcnt lgkmcnt(7)
    ds_read_b64_tr_b16 a[30:31], v5 offset:49728
    v_mfma_f32_16x16x32_bf16 v[196:199], a[0:3], v[132:135], v[196:199]
    ds_read_b64_tr_b16 a[32:33], v5 offset:51776
    buffer_load_dword v21, v20, s[20:23], 0 offen sc1
    v_mfma_f32_16x16x32_bf16 v[196:199], a[4:7], v[140:143], v[196:199]
    ds_read_b64_tr_b16 a[34:35], v5 offset:53824
    v_mul_f32 v238, v238, |v238|
    v_mfma_f32_16x16x32_bf16 v[192:195], a[0:3], v[128:131], v[192:195]
    ds_read_b64_tr_b16 a[36:37], v9 offset:21632
    v_mul_f32 v239, v239, |v239|
    v_mfma_f32_16x16x32_bf16 v[192:195], a[4:7], v[136:139], v[192:195]
    ds_read_b64_tr_b16 a[38:39], v9 offset:23680
    v_cvt_pk_bf16_f32 v254, v236, v237
    v_mfma_f32_16x16x32_bf16 v[196:199], a[8:11], v[148:151], v[196:199]
    ds_read_b64_tr_b16 a[40:41], v9 offset:25728
    v_mfma_f32_16x16x32_bf16 v[196:199], a[12:15], v[156:159], v[196:199]
    ds_read_b64_tr_b16 a[42:43], v9 offset:59072
    v_cvt_pk_bf16_f32 v255, v238, v239
    v_mfma_f32_16x16x32_bf16 v[192:195], a[8:11], v[144:147], v[192:195]
    ds_read_b64_tr_b16 a[44:45], v9 offset:61120
    buffer_load_dwordx4 v17, s[16:19], s72 offen offset:1024 lds
    v_mfma_f32_16x16x32_bf16 v[192:195], a[12:15], v[152:155], v[192:195]
    s_waitcnt vmcnt(22) lgkmcnt(7)
    ds_read_b64_tr_b16 a[46:47], v9 offset:63168
    v_pk_max_i16 v252, v252, 0
    v_mfma_f32_16x16x32_bf16 v[196:199], a[16:19], v[164:167], v[196:199]
    s_barrier
    ds_read_b64_tr_b16 a[0:1], v2 offset:18432
    v_mfma_f32_16x16x32_bf16 v[196:199], a[20:23], v[172:175], v[196:199]
    ds_read_b64_tr_b16 a[2:3], v2 offset:20480
    v_pk_max_i16 v253, v253, 0
    v_mfma_f32_16x16x32_bf16 v[192:195], a[16:19], v[160:163], v[192:195]
    ds_read_b64_tr_b16 a[4:5], v2 offset:22528
    v_pk_max_i16 v254, v254, 0
    v_mfma_f32_16x16x32_bf16 v[192:195], a[20:23], v[168:171], v[192:195]
    ds_read_b64_tr_b16 a[6:7], v2 offset:55872
    v_mfma_f32_16x16x32_bf16 v[204:207], a[24:27], v[132:135], v[204:207]
    s_add_u32 m0, s67, 4096
    ds_read_b64_tr_b16 a[8:9], v2 offset:57920
    v_pk_max_i16 v255, v255, 0
    v_mfma_f32_16x16x32_bf16 v[204:207], a[28:31], v[140:143], v[204:207]
    s_add_u32 s72, s74, 256
    ds_read_b64_tr_b16 a[10:11], v2 offset:59968
    buffer_load_dwordx4 v16, s[16:19], s72 offen lds
    v_mfma_f32_16x16x32_bf16 v[200:203], a[24:27], v[128:131], v[200:203]
    ds_read_b64_tr_b16 a[12:13], v6 offset:27776
    v_accvgpr_write_b32 a108, v252
    v_mfma_f32_16x16x32_bf16 v[200:203], a[28:31], v[136:139], v[200:203]
    s_waitcnt lgkmcnt(7)
    ds_read_b64_tr_b16 a[14:15], v6 offset:29824
    v_accvgpr_write_b32 a109, v253
    v_mfma_f32_16x16x32_bf16 v[204:207], a[32:35], v[148:151], v[204:207]
    ds_read_b64_tr_b16 a[16:17], v6 offset:31872
    v_mfma_f32_16x16x32_bf16 v[204:207], a[36:39], v[156:159], v[204:207]
    ds_read_b64_tr_b16 a[18:19], v6 offset:65216
    v_accvgpr_write_b32 a110, v254
    v_mfma_f32_16x16x32_bf16 v[200:203], a[32:35], v[144:147], v[200:203]
    ds_read_b64_tr_b16 a[20:21], v10 offset:1728
    v_accvgpr_write_b32 a111, v255
    v_mfma_f32_16x16x32_bf16 v[200:203], a[36:39], v[152:155], v[200:203]
L_pad_m2_1:
    s_cbranch_execz L_pad_m2_2
    ds_read_b64_tr_b16 a[22:23], v10 offset:3776
    v_mfma_f32_16x16x32_bf16 v[204:207], a[40:43], v[164:167], v[204:207]
    ds_read_b64_tr_b16 a[24:25], v3 offset:18432
    buffer_load_dwordx4 v17, s[16:19], s72 offen offset:1024 lds
    v_mfma_f32_16x16x32_bf16 v[204:207], a[44:47], v[172:175], v[204:207]
    ds_read_b64_tr_b16 a[26:27], v3 offset:20480
    ds_read_b128 v[224:227], v19 offset:1408
    v_mfma_f32_16x16x32_bf16 v[200:203], a[40:43], v[160:163], v[200:203]
    ds_read_b64_tr_b16 a[28:29], v3 offset:22528
    ds_read_b128 v[232:235], v19 offset:1472
    v_mfma_f32_16x16x32_bf16 v[200:203], a[44:47], v[168:171], v[200:203]
    s_waitcnt lgkmcnt(9)
    ds_read_b64_tr_b16 a[30:31], v3 offset:55872
    v_mfma_f32_16x16x32_bf16 v[212:215], a[0:3], v[36:39], v[208:211]
    ds_read_b64_tr_b16 a[32:33], v3 offset:57920
    v_mul_f32 v176, v176, |v176|
    v_mfma_f32_16x16x32_bf16 v[212:215], a[4:7], v[44:47], v[212:215]
    ds_read_b64_tr_b16 a[34:35], v3 offset:59968
    v_mul_f32 v177, v177, |v177|
    v_mfma_f32_16x16x32_bf16 v[208:211], a[0:3], v[32:35], v[208:211]
    s_add_u32 m0, s67, 6144
    ds_read_b64_tr_b16 a[36:37], v7 offset:27776
    v_mfma_f32_16x16x32_bf16 v[208:211], a[4:7], v[40:43], v[208:211]
    s_add_u32 s72, s74, 73728
    ds_read_b64_tr_b16 a[38:39], v7 offset:29824
    buffer_load_dwordx4 v16, s[16:19], s72 offen lds
    v_mfma_f32_16x16x32_bf16 v[212:215], a[8:11], v[52:55], v[212:215]
    ds_read_b64_tr_b16 a[40:41], v7 offset:31872
    v_mul_f32 v178, v178, |v178|
    v_mfma_f32_16x16x32_bf16 v[212:215], a[12:15], v[60:63], v[212:215]
    ds_read_b64_tr_b16 a[42:43], v7 offset:65216
    v_mul_f32 v179, v179, |v179|
    v_mfma_f32_16x16x32_bf16 v[208:211], a[8:11], v[48:51], v[208:211]
    ds_read_b64_tr_b16 a[44:45], v11 offset:1728
    v_mfma_f32_16x16x32_bf16 v[208:211], a[12:15], v[56:59], v[208:211]
    s_waitcnt lgkmcnt(7)
    ds_read_b64_tr_b16 a[46:47], v11 offset:3776
    v_cvt_pk_bf16_f32 v240, v176, v177
    v_mfma_f32_16x16x32_bf16 v[212:215], a[16:19], v[68:71], v[212:215]
    ds_read_b64_tr_b16 a[0:1], v4 offset:18432
    v_mfma_f32_16x16x32_bf16 v[212:215], a[20:23], v[76:79], v[212:215]
    ds_read_b64_tr_b16 a[2:3], v4 offset:20480
    buffer_load_dwordx4 v17, s[16:19], s72 offen offset:1024 lds
    v_mfma_f32_16x16x32_bf16 v[208:211], a[16:19], v[64:67], v[208:211]
    ds_read_b64_tr_b16 a[4:5], v4 offset:22528
    v_cvt_pk_bf16_f32 v241, v178, v179
    v_mfma_f32_16x16x32_bf16 v[208:211], a[20:23], v[72:75], v[208:211]
    ds_read_b64_tr_b16 a[6:7], v4 offset:55872
    v_mul_f32 v184, v184, |v184|
    v_mfma_f32_16x16x32_bf16 v[220:223], a[24:27], v[36:39], v[216:219]
    ds_read_b64_tr_b16 a[8:9], v4 offset:57920
    v_mul_f32 v185, v185, |v185|
    v_mfma_f32_16x16x32_bf16 v[220:223], a[28:31], v[44:47], v[220:223]
    ds_read_b64_tr_b16 a[10:11], v4 offset:59968
    v_mfma_f32_16x16x32_bf16 v[216:219], a[24:27], v[32:35], v[216:219]
    ds_read_b64_tr_b16 a[12:13], v8 offset:27776
    v_mul_f32 v186, v186, |v186|
    v_mfma_f32_16x16x32_bf16 v[216:219], a[28:31], v[40:43], v[216:219]
    s_waitcnt lgkmcnt(7)
    ds_read_b64_tr_b16 a[14:15], v8 offset:29824
    v_mfma_f32_16x16x32_bf16 v[220:223], a[32:35], v[52:55], v[220:223]
    s_add_u32 s82, s75, 12288
    ds_read_b64_tr_b16 a[16:17], v8 offset:31872
    buffer_store_dwordx4 a[96:99], v18, s[20:23], s82 offen offset:0 sc1
    v_mfma_f32_16x16x32_bf16 v[220:223], a[36:39], v[60:63], v[220:223]
    ds_read_b64_tr_b16 a[18:19], v8 offset:65216
    v_mul_f32 v187, v187, |v187|
    v_mfma_f32_16x16x32_bf16 v[216:219], a[32:35], v[48:51], v[216:219]
    ds_read_b64_tr_b16 a[20:21], v12 offset:1728
    v_cvt_pk_bf16_f32 v242, v184, v185
    v_mfma_f32_16x16x32_bf16 v[216:219], a[36:39], v[56:59], v[216:219]
    ds_read_b64_tr_b16 a[22:23], v12 offset:3776
    v_mfma_f32_16x16x32_bf16 v[220:223], a[40:43], v[68:71], v[220:223]
    s_add_u32 m0, s67, 8192
    ds_read_b64_tr_b16 a[24:25], v5 offset:18432
    v_cvt_pk_bf16_f32 v243, v186, v187
    v_mfma_f32_16x16x32_bf16 v[220:223], a[44:47], v[76:79], v[220:223]
    s_add_u32 s72, s74, 73856
    ds_read_b64_tr_b16 a[26:27], v5 offset:20480
    buffer_load_dwordx4 v16, s[16:19], s72 offen lds
    v_mfma_f32_16x16x32_bf16 v[216:219], a[40:43], v[64:67], v[216:219]
    ds_read_b64_tr_b16 a[28:29], v5 offset:22528
    v_pk_max_i16 v240, v240, 0
    v_mfma_f32_16x16x32_bf16 v[216:219], a[44:47], v[72:75], v[216:219]
    s_waitcnt lgkmcnt(7)
    ds_read_b64_tr_b16 a[30:31], v5 offset:55872
    v_mfma_f32_16x16x32_bf16 v[228:231], a[0:3], v[36:39], v[224:227]
    ds_read_b64_tr_b16 a[32:33], v5 offset:57920
    v_pk_max_i16 v241, v241, 0
    v_mfma_f32_16x16x32_bf16 v[228:231], a[4:7], v[44:47], v[228:231]
    ds_read_b64_tr_b16 a[34:35], v5 offset:59968
    v_pk_max_i16 v242, v242, 0
    v_mfma_f32_16x16x32_bf16 v[224:227], a[0:3], v[32:35], v[224:227]
    ds_read_b64_tr_b16 a[36:37], v9 offset:27776
    v_mfma_f32_16x16x32_bf16 v[224:227], a[4:7], v[40:43], v[224:227]
    ds_read_b64_tr_b16 a[38:39], v9 offset:29824
    buffer_load_dwordx4 v17, s[16:19], s72 offen offset:1024 lds
    v_mfma_f32_16x16x32_bf16 v[228:231], a[8:11], v[52:55], v[228:231]
    ds_read_b64_tr_b16 a[40:41], v9 offset:31872
    v_pk_max_i16 v243, v243, 0
    v_mfma_f32_16x16x32_bf16 v[228:231], a[12:15], v[60:63], v[228:231]
    ds_read_b64_tr_b16 a[42:43], v9 offset:65216
    v_accvgpr_write_b32 a112, v240
    v_mfma_f32_16x16x32_bf16 v[224:227], a[8:11], v[48:51], v[224:227]
    ds_read_b64_tr_b16 a[44:45], v13 offset:1728
    v_mfma_f32_16x16x32_bf16 v[224:227], a[12:15], v[56:59], v[224:227]
    s_waitcnt vmcnt(21) lgkmcnt(7)
    ds_read_b64_tr_b16 a[46:47], v13 offset:3776
    v_accvgpr_write_b32 a113, v241
    v_mfma_f32_16x16x32_bf16 v[228:231], a[16:19], v[68:71], v[228:231]
    s_barrier
    ds_read_b64_tr_b16 a[0:1], v2 offset:24576
    v_mfma_f32_16x16x32_bf16 v[228:231], a[20:23], v[76:79], v[228:231]
    s_add_u32 m0, s67, 10240
    ds_read_b64_tr_b16 a[2:3], v2 offset:26624
    v_accvgpr_write_b32 a114, v242
    v_mfma_f32_16x16x32_bf16 v[224:227], a[16:19], v[64:67], v[224:227]
    s_add_u32 s72, s74, 73984
    ds_read_b64_tr_b16 a[4:5], v2 offset:28672
    buffer_load_dwordx4 v16, s[16:19], s72 offen lds
    v_mfma_f32_16x16x32_bf16 v[224:227], a[20:23], v[72:75], v[224:227]
    ds_read_b64_tr_b16 a[6:7], v2 offset:62016
    v_accvgpr_write_b32 a115, v243
    v_mfma_f32_16x16x32_bf16 v[236:239], a[24:27], v[36:39], v[232:235]
    ds_read_b64_tr_b16 a[8:9], v2 offset:64064
    v_mul_f32 v180, v180, |v180|
    v_mfma_f32_16x16x32_bf16 v[236:239], a[28:31], v[44:47], v[236:239]
    ds_read_b64_tr_b16 a[10:11], v6 offset:576
    v_mfma_f32_16x16x32_bf16 v[232:235], a[24:27], v[32:35], v[232:235]
    ds_read_b64_tr_b16 a[12:13], v6 offset:33920
    v_mul_f32 v181, v181, |v181|
    v_mfma_f32_16x16x32_bf16 v[232:235], a[28:31], v[40:43], v[232:235]
    s_waitcnt lgkmcnt(7)
    ds_read_b64_tr_b16 a[14:15], v6 offset:35968
    buffer_store_dwordx4 a[100:103], v18, s[20:23], s82 offen offset:1024 sc1
    v_mfma_f32_16x16x32_bf16 v[236:239], a[32:35], v[52:55], v[236:239]
    ds_read_b64_tr_b16 a[16:17], v6 offset:38016
    v_mul_f32 v182, v182, |v182|
    v_mfma_f32_16x16x32_bf16 v[236:239], a[36:39], v[60:63], v[236:239]
    ds_read_b64_tr_b16 a[18:19], v10 offset:5824
    v_mfma_f32_16x16x32_bf16 v[232:235], a[32:35], v[48:51], v[232:235]
    ds_read_b64_tr_b16 a[20:21], v10 offset:7872
    v_mul_f32 v183, v183, |v183|
    v_mfma_f32_16x16x32_bf16 v[232:235], a[36:39], v[56:59], v[232:235]
    ds_read_b64_tr_b16 a[22:23], v10 offset:9920
    v_mfma_f32_16x16x32_bf16 v[236:239], a[40:43], v[68:71], v[236:239]
    ds_read_b64_tr_b16 a[24:25], v3 offset:24576
    v_cvt_pk_bf16_f32 v244, v180, v181
    v_mfma_f32_16x16x32_bf16 v[236:239], a[44:47], v[76:79], v[236:239]
    ds_read_b64_tr_b16 a[26:27], v3 offset:26624
    buffer_load_dwordx4 v17, s[16:19], s72 offen offset:1024 lds
    v_mfma_f32_16x16x32_bf16 v[232:235], a[40:43], v[64:67], v[232:235]
    ds_read_b64_tr_b16 a[28:29], v3 offset:28672
    v_cvt_pk_bf16_f32 v245, v182, v183
    v_mfma_f32_16x16x32_bf16 v[232:235], a[44:47], v[72:75], v[232:235]
    s_waitcnt lgkmcnt(7)
    ds_read_b64_tr_b16 a[30:31], v3 offset:62016
    v_mfma_f32_16x16x32_bf16 v[212:215], a[0:3], v[84:87], v[212:215]
    ds_read_b64_tr_b16 a[32:33], v3 offset:64064
    v_mul_f32 v188, v188, |v188|
    v_mfma_f32_16x16x32_bf16 v[212:215], a[4:7], v[92:95], v[212:215]
    s_add_u32 m0, s67, 12288
    ds_read_b64_tr_b16 a[34:35], v7 offset:576
    v_mul_f32 v189, v189, |v189|
    v_mfma_f32_16x16x32_bf16 v[208:211], a[0:3], v[80:83], v[208:211]
    s_add_u32 s72, s74, 147456
    ds_read_b64_tr_b16 a[36:37], v7 offset:33920
    buffer_load_dwordx4 v16, s[16:19], s72 offen lds
    v_mfma_f32_16x16x32_bf16 v[208:211], a[4:7], v[88:91], v[208:211]
    ds_read_b64_tr_b16 a[38:39], v7 offset:35968
    v_mul_f32 v190, v190, |v190|
    v_mfma_f32_16x16x32_bf16 v[212:215], a[8:11], v[100:103], v[212:215]
    ds_read_b64_tr_b16 a[40:41], v7 offset:38016
    v_mfma_f32_16x16x32_bf16 v[212:215], a[12:15], v[108:111], v[212:215]
    ds_read_b64_tr_b16 a[42:43], v11 offset:5824
    s_add_u32 s71, s66, 1
    s_waitcnt vmcnt(12)
    v_subrev_u32 v21, s71, v21
    v_cmp_gt_u32 vcc, 8, v21
    s_nop 0
    s_cmp_eq_u64 vcc, exec
    s_cbranch_scc0 L_slow_1
L_back_2:
    v_mfma_f32_16x16x32_bf16 v[208:211], a[8:11], v[96:99], v[208:211]
    s_add_u32 s70, s76, 0
    ds_read_b64_tr_b16 a[44:45], v11 offset:7872
    buffer_load_dwordx4 a[144:147], v18, s[20:23], s70 offen offset:0 sc1
    v_mfma_f32_16x16x32_bf16 v[208:211], a[12:15], v[104:107], v[208:211]
    s_waitcnt lgkmcnt(7)
    ds_read_b64_tr_b16 a[46:47], v11 offset:9920
    v_mul_f32 v191, v191, |v191|
    v_mfma_f32_16x16x32_bf16 v[212:215], a[16:19], v[116:119], v[212:215]
    ds_read_b64_tr_b16 a[0:1], v4 offset:24576
    v_cvt_pk_bf16_f32 v246, v188, v189
    v_mfma_f32_16x16x32_bf16 v[212:215], a[20:23], v[124:127], v[212:215]
    ds_read_b64_tr_b16 a[2:3], v4 offset:26624
    v_cvt_pk_bf16_f32 v247, v190, v191
    v_mfma_f32_16x16x32_bf16 v[208:211], a[16:19], v[112:115], v[208:211]
    ds_read_b64_tr_b16 a[4:5], v4 offset:28672
    buffer_load_dwordx4 v17, s[16:19], s72 offen offset:1024 lds
    v_mfma_f32_16x16x32_bf16 v[208:211], a[20:23], v[120:123], v[208:211]
    ds_read_b64_tr_b16 a[6:7], v4 offset:62016
    v_pk_max_i16 v244, v244, 0
    v_mfma_f32_16x16x32_bf16 v[220:223], a[24:27], v[84:87], v[220:223]
    ds_read_b64_tr_b16 a[8:9], v4 offset:64064
    v_pk_max_i16 v245, v245, 0
    v_mfma_f32_16x16x32_bf16 v[220:223], a[28:31], v[92:95], v[220:223]
    ds_read_b64_tr_b16 a[10:11], v8 offset:576
    v_mfma_f32_16x16x32_bf16 v[216:219], a[24:27], v[80:83], v[216:219]
    ds_read_b64_tr_b16 a[12:13], v8 offset:33920
    buffer_store_dwordx4 a[104:107], v18, s[20:23], s82 offen offset:2048 sc1
    v_mfma_f32_16x16x32_bf16 v[216:219], a[28:31], v[88:91], v[216:219]
    s_waitcnt lgkmcnt(7)
    ds_read_b64_tr_b16 a[14:15], v8 offset:35968
    v_pk_max_i16 v246, v246, 0
    v_mfma_f32_16x16x32_bf16 v[220:223], a[32:35], v[100:103], v[220:223]
    ds_read_b64_tr_b16 a[16:17], v8 offset:38016
    v_pk_max_i16 v247, v247, 0
    v_mfma_f32_16x16x32_bf16 v[220:223], a[36:39], v[108:111], v[220:223]
    ds_read_b64_tr_b16 a[18:19], v12 offset:5824
    v_accvgpr_write_b32 a116, v244
    v_mfma_f32_16x16x32_bf16 v[216:219], a[32:35], v[96:99], v[216:219]
    ds_read_b64_tr_b16 a[20:21], v12 offset:7872
    buffer_load_dwordx4 a[148:151], v18, s[20:23], s70 offen offset:1024 sc1
    v_mfma_f32_16x16x32_bf16 v[216:219], a[36:39], v[104:107], v[216:219]
    ds_read_b64_tr_b16 a[22:23], v12 offset:9920
    v_accvgpr_write_b32 a117, v245
    v_mfma_f32_16x16x32_bf16 v[220:223], a[40:43], v[116:119], v[220:223]
    ds_read_b64_tr_b16 a[24:25], v5 offset:24576
    v_mfma_f32_16x16x32_bf16 v[220:223], a[44:47], v[124:127], v[220:223]
    s_add_u32 m0, s67, 14336
    ds_read_b64_tr_b16 a[26:27], v5 offset:26624
    v_accvgpr_write_b32 a118, v246
    v_mfma_f32_16x16x32_bf16 v[216:219], a[40:43], v[112:115], v[216:219]
    s_add_u32 s72, s74, 147584
    ds_read_b64_tr_b16 a[28:29], v5 offset:28672
    buffer_load_dwordx4 v16, s[16:19], s72 offen lds
    v_mfma_f32_16x16x32_bf16 v[216:219], a[44:47], v[120:123], v[216:219]
    s_waitcnt lgkmcnt(7)
    ds_read_b64_tr_b16 a[30:31], v5 offset:62016
    v_accvgpr_write_b32 a119, v247
    v_mfma_f32_16x16x32_bf16 v[228:231], a[0:3], v[84:87], v[228:231]
    ds_read_b64_tr_b16 a[32:33], v5 offset:64064
    v_mul_f32 v192, v192, |v192|
    v_mfma_f32_16x16x32_bf16 v[228:231], a[4:7], v[92:95], v[228:231]
    ds_read_b64_tr_b16 a[34:35], v9 offset:576
    v_mfma_f32_16x16x32_bf16 v[224:227], a[0:3], v[80:83], v[224:227]
    ds_read_b64_tr_b16 a[36:37], v9 offset:33920
    buffer_load_dwordx4 v17, s[16:19], s72 offen offset:1024 lds
    v_mfma_f32_16x16x32_bf16 v[224:227], a[4:7], v[88:91], v[224:227]
    ds_read_b64_tr_b16 a[38:39], v9 offset:35968
    v_mul_f32 v193, v193, |v193|
    v_mfma_f32_16x16x32_bf16 v[228:231], a[8:11], v[100:103], v[228:231]
    ds_read_b64_tr_b16 a[40:41], v9 offset:38016
    v_mul_f32 v194, v194, |v194|
    v_mfma_f32_16x16x32_bf16 v[228:231], a[12:15], v[108:111], v[228:231]
    ds_read_b64_tr_b16 a[42:43], v13 offset:5824
    v_mfma_f32_16x16x32_bf16 v[224:227], a[8:11], v[96:99], v[224:227]
    ds_read_b64_tr_b16 a[44:45], v13 offset:7872
    buffer_load_dwordx4 a[152:155], v18, s[20:23], s70 offen offset:2048 sc1
    v_mfma_f32_16x16x32_bf16 v[224:227], a[12:15], v[104:107], v[224:227]
    s_waitcnt lgkmcnt(7)
    ds_read_b64_tr_b16 a[46:47], v13 offset:9920
    v_mul_f32 v195, v195, |v195|
    v_mfma_f32_16x16x32_bf16 v[228:231], a[16:19], v[116:119], v[228:231]
    s_barrier
    ds_read_b64_tr_b16 a[0:1], v2 offset:30720
    v_mfma_f32_16x16x32_bf16 v[228:231], a[20:23], v[124:127], v[228:231]
    s_add_u32 m0, s67, 16384
    ds_read_b64_tr_b16 a[2:3], v2 offset:32768
    v_cvt_pk_bf16_f32 v248, v192, v193
    v_mfma_f32_16x16x32_bf16 v[224:227], a[16:19], v[112:115], v[224:227]
    s_add_u32 s72, s74, 147712
    ds_read_b64_tr_b16 a[4:5], v2 offset:34816
    buffer_load_dwordx4 v16, s[16:19], s72 offen lds
    v_mfma_f32_16x16x32_bf16 v[224:227], a[20:23], v[120:123], v[224:227]
    ds_read_b64_tr_b16 a[6:7], v6 offset:2624
    v_cvt_pk_bf16_f32 v249, v194, v195
    v_mfma_f32_16x16x32_bf16 v[236:239], a[24:27], v[84:87], v[236:239]
    ds_read_b64_tr_b16 a[8:9], v6 offset:4672
    v_mul_f32 v200, v200, |v200|
    v_mfma_f32_16x16x32_bf16 v[236:239], a[28:31], v[92:95], v[236:239]
    ds_read_b64_tr_b16 a[10:11], v6 offset:6720
    v_mul_f32 v201, v201, |v201|
    v_mfma_f32_16x16x32_bf16 v[232:235], a[24:27], v[80:83], v[232:235]
    ds_read_b64_tr_b16 a[12:13], v6 offset:40064
    buffer_store_dwordx4 a[108:111], v18, s[20:23], s82 offen offset:3072 sc1
    v_mfma_f32_16x16x32_bf16 v[232:235], a[28:31], v[88:91], v[232:235]
    s_waitcnt lgkmcnt(7)
    ds_read_b64_tr_b16 a[14:15], v6 offset:42112
    v_mul_f32 v202, v202, |v202|
    v_mfma_f32_16x16x32_bf16 v[236:239], a[32:35], v[100:103], v[236:239]
    ds_read_b64_tr_b16 a[16:17], v6 offset:44160
    v_mul_f32 v203, v203, |v203|
    v_mfma_f32_16x16x32_bf16 v[236:239], a[36:39], v[108:111], v[236:239]
    ds_read_b64_tr_b16 a[18:19], v10 offset:11968
    v_mfma_f32_16x16x32_bf16 v[232:235], a[32:35], v[96:99], v[232:235]
    ds_read_b64_tr_b16 a[20:21], v10 offset:14016
    buffer_load_dwordx4 a[156:159], v18, s[20:23], s70 offen offset:3072 sc1
    v_mfma_f32_16x16x32_bf16 v[232:235], a[36:39], v[104:107], v[232:235]
    ds_read_b64_tr_b16 a[22:23], v10 offset:16064
    v_cvt_pk_bf16_f32 v250, v200, v201
    v_mfma_f32_16x16x32_bf16 v[236:239], a[40:43], v[116:119], v[236:239]
    ds_read_b64_tr_b16 a[24:25], v3 offset:30720
    v_cvt_pk_bf16_f32 v251, v202, v203
    v_mfma_f32_16x16x32_bf16 v[236:239], a[44:47], v[124:127], v[236:239]
    ds_read_b64_tr_b16 a[26:27], v3 offset:32768
    v_mfma_f32_16x16x32_bf16 v[232:235], a[40:43], v[112:115], v[232:235]
    ds_read_b64_tr_b16 a[28:29], v3 offset:34816
    buffer_load_dwordx4 v17, s[16:19], s72 offen offset:1024 lds
    v_mfma_f32_16x16x32_bf16 v[232:235], a[44:47], v[120:123], v[232:235]
    s_waitcnt lgkmcnt(7)
    ds_read_b64_tr_b16 a[30:31], v7 offset:2624
    v_pk_max_i16 v248, v248, 0
    v_mfma_f32_16x16x32_bf16 v[212:215], a[0:3], v[132:135], v[212:215]
    ds_read_b64_tr_b16 a[32:33], v7 offset:4672
    v_pk_max_i16 v249, v249, 0
    v_mfma_f32_16x16x32_bf16 v[212:215], a[4:7], v[140:143], v[212:215]
    s_add_u32 m0, s67, 18432
    ds_read_b64_tr_b16 a[34:35], v7 offset:6720
    v_pk_max_i16 v250, v250, 0
    v_mfma_f32_16x16x32_bf16 v[208:211], a[0:3], v[128:131], v[208:211]
    s_add_u32 s72, s74, 221184
    ds_read_b64_tr_b16 a[36:37], v7 offset:40064
    buffer_load_dwordx4 v16, s[16:19], s72 offen lds
    v_mfma_f32_16x16x32_bf16 v[208:211], a[4:7], v[136:139], v[208:211]
    ds_read_b64_tr_b16 a[38:39], v7 offset:42112
    v_pk_max_i16 v251, v251, 0
    v_mfma_f32_16x16x32_bf16 v[212:215], a[8:11], v[148:151], v[212:215]
    ds_read_b64_tr_b16 a[40:41], v7 offset:44160
    v_mfma_f32_16x16x32_bf16 v[212:215], a[12:15], v[156:159], v[212:215]
    ds_read_b64_tr_b16 a[42:43], v11 offset:11968
    v_accvgpr_write_b32 a120, v248
    v_mfma_f32_16x16x32_bf16 v[208:211], a[8:11], v[144:147], v[208:211]
    ds_read_b64_tr_b16 a[44:45], v11 offset:14016
    v_mfma_f32_16x16x32_bf16 v[208:211], a[12:15], v[152:155], v[208:211]
    s_waitcnt lgkmcnt(7)
    ds_read_b64_tr_b16 a[46:47], v11 offset:16064
    v_accvgpr_write_b32 a121, v249
    v_mfma_f32_16x16x32_bf16 v[212:215], a[16:19], v[164:167], v[212:215]
    s_add_u32 s70, s77, 0
    ds_read_b64_tr_b16 a[0:1], v4 offset:30720
    buffer_load_dwordx4 a[160:163], v18, s[20:23], s70 offen offset:0 sc1
    v_mfma_f32_16x16x32_bf16 v[212:215], a[20:23], v[172:175], v[212:215]
    ds_read_b64_tr_b16 a[2:3], v4 offset:32768
    v_accvgpr_write_b32 a122, v250
    v_mfma_f32_16x16x32_bf16 v[208:211], a[16:19], v[160:163], v[208:211]
    ds_read_b64_tr_b16 a[4:5], v4 offset:34816
    v_accvgpr_write_b32 a123, v251
    v_mfma_f32_16x16x32_bf16 v[208:211], a[20:23], v[168:171], v[208:211]
    ds_read_b64_tr_b16 a[6:7], v8 offset:2624
    v_mfma_f32_16x16x32_bf16 v[220:223], a[24:27], v[132:135], v[220:223]
    ds_read_b64_tr_b16 a[8:9], v8 offset:4672
    buffer_load_dwordx4 v17, s[16:19], s72 offen offset:1024 lds
    v_mfma_f32_16x16x32_bf16 v[220:223], a[28:31], v[140:143], v[220:223]
    ds_read_b64_tr_b16 a[10:11], v8 offset:6720
    v_mul_f32 v196, v196, |v196|
    v_mfma_f32_16x16x32_bf16 v[216:219], a[24:27], v[128:131], v[216:219]
    ds_read_b64_tr_b16 a[12:13], v8 offset:40064
    v_mul_f32 v197, v197, |v197|
    v_mfma_f32_16x16x32_bf16 v[216:219], a[28:31], v[136:139], v[216:219]
    s_waitcnt lgkmcnt(7)
    ds_read_b64_tr_b16 a[14:15], v8 offset:42112
    v_mfma_f32_16x16x32_bf16 v[220:223], a[32:35], v[148:151], v[220:223]
    ds_read_b64_tr_b16 a[16:17], v8 offset:44160
    buffer_load_dwordx4 a[164:167], v18, s[20:23], s70 offen offset:1024 sc1
    v_mfma_f32_16x16x32_bf16 v[220:223], a[36:39], v[156:159], v[220:223]
    ds_read_b64_tr_b16 a[18:19], v12 offset:11968
    v_mul_f32 v198, v198, |v198|
    v_mfma_f32_16x16x32_bf16 v[216:219], a[32:35], v[144:147], v[216:219]
    ds_read_b64_tr_b16 a[20:21], v12 offset:14016
    v_mul_f32 v199, v199, |v199|
    v_mfma_f32_16x16x32_bf16 v[216:219], a[36:39], v[152:155], v[216:219]
    ds_read_b64_tr_b16 a[22:23], v12 offset:16064
    v_cvt_pk_bf16_f32 v252, v196, v197
    v_mfma_f32_16x16x32_bf16 v[220:223], a[40:43], v[164:167], v[220:223]
    s_add_u32 m0, s67, 20480
    ds_read_b64_tr_b16 a[24:25], v5 offset:30720
    v_mfma_f32_16x16x32_bf16 v[220:223], a[44:47], v[172:175], v[220:223]
    s_add_u32 s72, s74, 221312
    ds_read_b64_tr_b16 a[26:27], v5 offset:32768
    buffer_load_dwordx4 v16, s[16:19], s72 offen lds
    v_mfma_f32_16x16x32_bf16 v[216:219], a[40:43], v[160:163], v[216:219]
    ds_read_b64_tr_b16 a[28:29], v5 offset:34816
    v_cvt_pk_bf16_f32 v253, v198, v199
    v_mfma_f32_16x16x32_bf16 v[216:219], a[44:47], v[168:171], v[216:219]
    s_waitcnt lgkmcnt(7)
    ds_read_b64_tr_b16 a[30:31], v9 offset:2624
    v_mul_f32 v204, v204, |v204|
    v_mfma_f32_16x16x32_bf16 v[228:231], a[0:3], v[132:135], v[228:231]
    ds_read_b64_tr_b16 a[32:33], v9 offset:4672
    v_mul_f32 v205, v205, |v205|
    v_mfma_f32_16x16x32_bf16 v[228:231], a[4:7], v[140:143], v[228:231]
    ds_read_b64_tr_b16 a[34:35], v9 offset:6720
    v_mfma_f32_16x16x32_bf16 v[224:227], a[0:3], v[128:131], v[224:227]
    ds_read_b64_tr_b16 a[36:37], v9 offset:40064
    buffer_load_dwordx4 v17, s[16:19], s72 offen offset:1024 lds
    v_mfma_f32_16x16x32_bf16 v[224:227], a[4:7], v[136:139], v[224:227]
    ds_read_b64_tr_b16 a[38:39], v9 offset:42112
    v_mul_f32 v206, v206, |v206|
    v_mfma_f32_16x16x32_bf16 v[228:231], a[8:11], v[148:151], v[228:231]
    ds_read_b64_tr_b16 a[40:41], v9 offset:44160
    v_mul_f32 v207, v207, |v207|
    v_mfma_f32_16x16x32_bf16 v[228:231], a[12:15], v[156:159], v[228:231]
    ds_read_b64_tr_b16 a[42:43], v13 offset:11968
    v_mfma_f32_16x16x32_bf16 v[224:227], a[8:11], v[144:147], v[224:227]
    ds_read_b64_tr_b16 a[44:45], v13 offset:14016
    v_cvt_pk_bf16_f32 v254, v204, v205
    v_mfma_f32_16x16x32_bf16 v[224:227], a[12:15], v[152:155], v[224:227]
    s_waitcnt vmcnt(26) lgkmcnt(7)
    ds_read_b64_tr_b16 a[46:47], v13 offset:16064
    buffer_load_dwordx4 a[168:171], v18, s[20:23], s70 offen offset:2048 sc1
    v_mfma_f32_16x16x32_bf16 v[228:231], a[16:19], v[164:167], v[228:231]
    s_barrier
    ds_read_b64_tr_b16 a[0:1], v2 offset:0
    v_mfma_f32_16x16x32_bf16 v[228:231], a[20:23], v[172:175], v[228:231]
    ds_read_b64_tr_b16 a[2:3], v2 offset:37440
    v_cvt_pk_bf16_f32 v255, v206, v207
    v_mfma_f32_16x16x32_bf16 v[224:227], a[16:19], v[160:163], v[224:227]
    ds_read_b64_tr_b16 a[4:5], v6 offset:9344
    v_pk_max_i16 v252, v252, 0
    v_mfma_f32_16x16x32_bf16 v[224:227], a[20:23], v[168:171], v[224:227]
    s_add_u32 m0, s67, 22528
    ds_read_b64_tr_b16 a[6:7], v6 offset:46784
    v_pk_max_i16 v253, v253, 0
    v_mfma_f32_16x16x32_bf16 v[236:239], a[24:27], v[132:135], v[236:239]
    s_add_u32 s72, s74, 221440
    ds_read_b64_tr_b16 a[8:9], v3 offset:0
    buffer_load_dwordx4 v16, s[16:19], s72 offen lds
    v_mfma_f32_16x16x32_bf16 v[236:239], a[28:31], v[140:143], v[236:239]
    ds_read_b64_tr_b16 a[10:11], v3 offset:37440
    v_pk_max_i16 v254, v254, 0
    v_mfma_f32_16x16x32_bf16 v[232:235], a[24:27], v[128:131], v[232:235]
    ds_read_b64_tr_b16 a[12:13], v7 offset:9344
    v_mfma_f32_16x16x32_bf16 v[232:235], a[28:31], v[136:139], v[232:235]
    s_waitcnt lgkmcnt(7)
    ds_read_b64_tr_b16 a[14:15], v7 offset:46784
    v_pk_max_i16 v255, v255, 0
    v_mfma_f32_16x16x32_bf16 v[236:239], a[32:35], v[148:151], v[236:239]
    ds_read_b64_tr_b16 a[16:17], v4 offset:0
    buffer_load_dwordx4 a[172:175], v18, s[20:23], s70 offen offset:3072 sc1
    v_mfma_f32_16x16x32_bf16 v[236:239], a[36:39], v[156:159], v[236:239]
    ds_read_b64_tr_b16 a[18:19], v4 offset:37440
    v_accvgpr_write_b32 a124, v252
    v_mfma_f32_16x16x32_bf16 v[232:235], a[32:35], v[144:147], v[232:235]
    ds_read_b64_tr_b16 a[20:21], v8 offset:9344
    v_accvgpr_write_b32 a125, v253
    v_mfma_f32_16x16x32_bf16 v[232:235], a[36:39], v[152:155], v[232:235]
    ds_read_b64_tr_b16 a[22:23], v8 offset:46784
    v_mfma_f32_16x16x32_bf16 v[236:239], a[40:43], v[164:167], v[236:239]
    ds_read_b64_tr_b16 a[24:25], v5 offset:0
    v_accvgpr_write_b32 a126, v254
    v_mfma_f32_16x16x32_bf16 v[236:239], a[44:47], v[172:175], v[236:239]
    ds_read_b64_tr_b16 a[26:27], v5 offset:37440
    buffer_load_dwordx4 v17, s[16:19], s72 offen offset:1024 lds
    v_mfma_f32_16x16x32_bf16 v[232:235], a[40:43], v[160:163], v[232:235]
    ds_read_b64_tr_b16 a[28:29], v9 offset:9344
    v_accvgpr_write_b32 a127, v255
    v_mfma_f32_16x16x32_bf16 v[232:235], a[44:47], v[168:171], v[232:235]
    s_waitcnt lgkmcnt(7)
    ds_read_b64_tr_b16 a[30:31], v9 offset:46784
    v_mfma_f32_16x16x32_bf16 v[32:35], a[0:3], a[48:51], 0
    ds_read_b64_tr_b16 a[32:33], v2 offset:2048
    v_mul_f32 v208, v208, |v208|
    v_mfma_f32_16x16x32_bf16 v[32:35], a[4:7], a[56:59], v[32:35]
    s_add_u32 m0, s67, 24576
    ds_read_b64_tr_b16 a[34:35], v2 offset:39488
    v_mul_f32 v209, v209, |v209|
    v_mfma_f32_16x16x32_bf16 v[36:39], a[0:3], a[52:55], 0
    s_add_u32 s72, s74, 294912
    ds_read_b64_tr_b16 a[36:37], v6 offset:11392
    buffer_load_dwordx4 v16, s[16:19], s72 offen lds
    v_mfma_f32_16x16x32_bf16 v[36:39], a[4:7], a[60:63], v[36:39]
    ds_read_b64_tr_b16 a[38:39], v6 offset:48832
    v_mul_f32 v210, v210, |v210|
    v_mfma_f32_16x16x32_bf16 v[40:43], a[8:11], a[48:51], 0
    ds_read_b64_tr_b16 a[40:41], v3 offset:2048
    v_mfma_f32_16x16x32_bf16 v[40:43], a[12:15], a[56:59], v[40:43]
    ds_read_b64_tr_b16 a[42:43], v3 offset:39488
    v_mul_f32 v211, v211, |v211|
    v_mfma_f32_16x16x32_bf16 v[44:47], a[8:11], a[52:55], 0
    ds_read_b64_tr_b16 a[44:45], v7 offset:11392
    v_mfma_f32_16x16x32_bf16 v[44:47], a[12:15], a[60:63], v[44:47]
    s_waitcnt lgkmcnt(7)
    ds_read_b64_tr_b16 a[46:47], v7 offset:48832
    v_cvt_pk_bf16_f32 v240, v208, v209
    v_mfma_f32_16x16x32_bf16 v[48:51], a[16:19], a[48:51], 0
    ds_read_b64_tr_b16 a[0:1], v4 offset:2048
    s_waitcnt vmcnt(13)
    s_add_u32 s71, s66, 2
    v_mov_b32 v22, s71
    buffer_store_dword v22, off, s[20:23], s90 sc1
    v_mfma_f32_16x16x32_bf16 v[48:51], a[20:23], a[56:59], v[48:51]
    ds_read_b64_tr_b16 a[2:3], v4 offset:39488
    v_cvt_pk_bf16_f32 v241, v210, v211
    v_mfma_f32_16x16x32_bf16 v[52:55], a[16:19], a[52:55], 0
    ds_read_b64_tr_b16 a[4:5], v8 offset:11392
    v_mfma_f32_16x16x32_bf16 v[52:55], a[20:23], a[60:63], v[52:55]
    ds_read_b64_tr_b16 a[6:7], v8 offset:48832
    v_mul_f32 v216, v216, |v216|
    v_mfma_f32_16x16x32_bf16 v[56:59], a[24:27], a[48:51], 0
    ds_read_b64_tr_b16 a[8:9], v5 offset:2048
    v_mul_f32 v217, v217, |v217|
    v_mfma_f32_16x16x32_bf16 v[56:59], a[28:31], a[56:59], v[56:59]
    ds_read_b64_tr_b16 a[10:11], v5 offset:39488
    buffer_load_dwordx4 v17, s[16:19], s72 offen offset:1024 lds
    v_mfma_f32_16x16x32_bf16 v[60:63], a[24:27], a[52:55], 0
    ds_read_b64_tr_b16 a[12:13], v9 offset:11392
    v_mul_f32 v218, v218, |v218|
    v_mfma_f32_16x16x32_bf16 v[60:63], a[28:31], a[60:63], v[60:63]
    s_waitcnt lgkmcnt(7)
    ds_read_b64_tr_b16 a[14:15], v9 offset:48832
    v_mfma_f32_16x16x32_bf16 v[64:67], a[32:35], a[48:51], 0
    ds_read_b64_tr_b16 a[16:17], v2 offset:4096
    v_mul_f32 v219, v219, |v219|
    v_mfma_f32_16x16x32_bf16 v[64:67], a[36:39], a[56:59], v[64:67]
    s_add_u32 m0, s67, 26624
    ds_read_b64_tr_b16 a[18:19], v2 offset:41536
    v_mfma_f32_16x16x32_bf16 v[68:71], a[32:35], a[52:55], 0
    s_add_u32 s72, s74, 295040
    ds_read_b64_tr_b16 a[20:21], v6 offset:13440
    buffer_load_dwordx4 v16, s[16:19], s72 offen lds
    v_mfma_f32_16x16x32_bf16 v[68:71], a[36:39], a[60:63], v[68:71]
    ds_read_b64_tr_b16 a[22:23], v6 offset:50880
    v_cvt_pk_bf16_f32 v242, v216, v217
    v_mfma_f32_16x16x32_bf16 v[72:75], a[40:43], a[48:51], 0
    ds_read_b64_tr_b16 a[24:25], v3 offset:4096
    v_cvt_pk_bf16_f32 v243, v218, v219
    v_mfma_f32_16x16x32_bf16 v[72:75], a[44:47], a[56:59], v[72:75]
    ds_read_b64_tr_b16 a[26:27], v3 offset:41536
    v_mfma_f32_16x16x32_bf16 v[76:79], a[40:43], a[52:55], 0
L_pad_m0_2:
    s_cbranch_execz L_pad_m0_3
    ds_read_b64_tr_b16 a[28:29], v7 offset:13440
    v_pk_max_i16 v240, v240, 0
    v_mfma_f32_16x16x32_bf16 v[76:79], a[44:47], a[60:63], v[76:79]
    s_waitcnt lgkmcnt(7)
    ds_read_b64_tr_b16 a[30:31], v7 offset:50880
    v_mfma_f32_16x16x32_bf16 v[80:83], a[0:3], a[48:51], 0
    s_add_u32 s82, s75, 16384
    ds_read_b64_tr_b16 a[32:33], v4 offset:4096
    buffer_store_dwordx4 a[112:115], v18, s[20:23], s82 offen offset:0 sc1
    v_mfma_f32_16x16x32_bf16 v[80:83], a[4:7], a[56:59], v[80:83]
    ds_read_b64_tr_b16 a[34:35], v4 offset:41536
    v_pk_max_i16 v241, v241, 0
    v_mfma_f32_16x16x32_bf16 v[84:87], a[0:3], a[52:55], 0
    ds_read_b64_tr_b16 a[36:37], v8 offset:13440
    v_pk_max_i16 v242, v242, 0
    v_mfma_f32_16x16x32_bf16 v[84:87], a[4:7], a[60:63], v[84:87]
    ds_read_b64_tr_b16 a[38:39], v8 offset:50880
    v_pk_max_i16 v243, v243, 0
    v_mfma_f32_16x16x32_bf16 v[88:91], a[8:11], a[48:51], 0
    ds_read_b64_tr_b16 a[40:41], v5 offset:4096
    v_mfma_f32_16x16x32_bf16 v[88:91], a[12:15], a[56:59], v[88:91]
    ds_read_b64_tr_b16 a[42:43], v5 offset:41536
    buffer_load_dwordx4 v17, s[16:19], s72 offen offset:1024 lds
    v_mfma_f32_16x16x32_bf16 v[92:95], a[8:11], a[52:55], 0
    ds_read_b64_tr_b16 a[44:45], v9 offset:13440
    v_accvgpr_write_b32 a128, v240
    v_mfma_f32_16x16x32_bf16 v[92:95], a[12:15], a[60:63], v[92:95]
    s_waitcnt lgkmcnt(7)
    ds_read_b64_tr_b16 a[46:47], v9 offset:50880
    v_accvgpr_write_b32 a129, v241
    v_mfma_f32_16x16x32_bf16 v[96:99], a[16:19], a[48:51], 0
    s_barrier
    ds_read_b64_tr_b16 a[0:1], v2 offset:6144
    v_mfma_f32_16x16x32_bf16 v[96:99], a[20:23], a[56:59], v[96:99]
    s_add_u32 m0, s67, 28672
    ds_read_b64_tr_b16 a[2:3], v2 offset:43584
    v_accvgpr_write_b32 a130, v242
    v_mfma_f32_16x16x32_bf16 v[100:103], a[16:19], a[52:55], 0
    s_add_u32 s72, s74, 295168
    ds_read_b64_tr_b16 a[4:5], v6 offset:15488
    buffer_load_dwordx4 v16, s[16:19], s72 offen lds
    v_mfma_f32_16x16x32_bf16 v[100:103], a[20:23], a[60:63], v[100:103]
    ds_read_b64_tr_b16 a[6:7], v6 offset:52928
    v_accvgpr_write_b32 a131, v243
    v_mfma_f32_16x16x32_bf16 v[104:107], a[24:27], a[48:51], 0
    ds_read_b64_tr_b16 a[8:9], v3 offset:6144
    v_mul_f32 v212, v212, |v212|
    v_mfma_f32_16x16x32_bf16 v[104:107], a[28:31], a[56:59], v[104:107]
    ds_read_b64_tr_b16 a[10:11], v3 offset:43584
    v_mfma_f32_16x16x32_bf16 v[108:111], a[24:27], a[52:55], 0
    ds_read_b64_tr_b16 a[12:13], v7 offset:15488
    v_mul_f32 v213, v213, |v213|
    v_mfma_f32_16x16x32_bf16 v[108:111], a[28:31], a[60:63], v[108:111]
    s_waitcnt lgkmcnt(7)
    ds_read_b64_tr_b16 a[14:15], v7 offset:52928
    v_mfma_f32_16x16x32_bf16 v[112:115], a[32:35], a[48:51], 0
    ds_read_b64_tr_b16 a[16:17], v4 offset:6144
    buffer_store_dwordx4 a[116:119], v18, s[20:23], s82 offen offset:1024 sc1
    v_mfma_f32_16x16x32_bf16 v[112:115], a[36:39], a[56:59], v[112:115]
    ds_read_b64_tr_b16 a[18:19], v4 offset:43584
    v_mul_f32 v214, v214, |v214|
    v_mfma_f32_16x16x32_bf16 v[116:119], a[32:35], a[52:55], 0
    ds_read_b64_tr_b16 a[20:21], v8 offset:15488
    v_mul_f32 v215, v215, |v215|
    v_mfma_f32_16x16x32_bf16 v[116:119], a[36:39], a[60:63], v[116:119]
    ds_read_b64_tr_b16 a[22:23], v8 offset:52928
    v_mfma_f32_16x16x32_bf16 v[120:123], a[40:43], a[48:51], 0
    ds_read_b64_tr_b16 a[24:25], v5 offset:6144
    v_cvt_pk_bf16_f32 v244, v212, v213
    v_mfma_f32_16x16x32_bf16 v[120:123], a[44:47], a[56:59], v[120:123]
    ds_read_b64_tr_b16 a[26:27], v5 offset:43584
    buffer_load_dwordx4 v17, s[16:19], s72 offen offset:1024 lds
    v_mfma_f32_16x16x32_bf16 v[124:127], a[40:43], a[52:55], 0
    ds_read_b64_tr_b16 a[28:29], v9 offset:15488
    v_cvt_pk_bf16_f32 v245, v214, v215
    v_mfma_f32_16x16x32_bf16 v[124:127], a[44:47], a[60:63], v[124:127]
    s_waitcnt lgkmcnt(7)
    ds_read_b64_tr_b16 a[30:31], v9 offset:52928
    v_mfma_f32_16x16x32_bf16 v[32:35], a[0:3], a[64:67], v[32:35]
    ds_read_b64_tr_b16 a[32:33], v2 offset:8192
    v_mul_f32 v220, v220, |v220|
    v_mfma_f32_16x16x32_bf16 v[32:35], a[4:7], a[72:75], v[32:35]
    s_add_u32 m0, s67, 30720
    ds_read_b64_tr_b16 a[34:35], v2 offset:45632
    v_mul_f32 v221, v221, |v221|
    v_mfma_f32_16x16x32_bf16 v[36:39], a[0:3], a[68:71], v[36:39]
    s_add_u32 s72, s74, 368640
    ds_read_b64_tr_b16 a[36:37], v6 offset:17536
    buffer_load_dwordx4 v16, s[16:19], s72 offen lds
    v_mfma_f32_16x16x32_bf16 v[36:39], a[4:7], a[76:79], v[36:39]
    ds_read_b64_tr_b16 a[38:39], v6 offset:54976
    v_mul_f32 v222, v222, |v222|
    v_mfma_f32_16x16x32_bf16 v[40:43], a[8:11], a[64:67], v[40:43]
    ds_read_b64_tr_b16 a[40:41], v3 offset:8192
    v_mfma_f32_16x16x32_bf16 v[40:43], a[12:15], a[72:75], v[40:43]
    ds_read_b64_tr_b16 a[42:43], v3 offset:45632
    v_mul_f32 v223, v223, |v223|
    v_mfma_f32_16x16x32_bf16 v[44:47], a[8:11], a[68:71], v[44:47]
    s_add_u32 s70, s76, 4096
    ds_read_b64_tr_b16 a[44:45], v7 offset:17536
    buffer_load_dwordx4 a[176:179], v18, s[20:23], s70 offen offset:0 sc1
    v_mfma_f32_16x16x32_bf16 v[44:47], a[12:15], a[76:79], v[44:47]
    s_waitcnt lgkmcnt(7)
    ds_read_b64_tr_b16 a[46:47], v7 offset:54976
    v_cvt_pk_bf16_f32 v246, v220, v221
    v_mfma_f32_16x16x32_bf16 v[48:51], a[16:19], a[64:67], v[48:51]
    ds_read_b64_tr_b16 a[0:1], v4 offset:8192
    v_cvt_pk_bf16_f32 v247, v222, v223
    v_mfma_f32_16x16x32_bf16 v[48:51], a[20:23], a[72:75], v[48:51]
    ds_read_b64_tr_b16 a[2:3], v4 offset:45632
    v_mfma_f32_16x16x32_bf16 v[52:55], a[16:19], a[68:71], v[52:55]
    ds_read_b64_tr_b16 a[4:5], v8 offset:17536
    buffer_load_dwordx4 v17, s[16:19], s72 offen offset:1024 lds
    v_mfma_f32_16x16x32_bf16 v[52:55], a[20:23], a[76:79], v[52:55]
    ds_read_b64_tr_b16 a[6:7], v8 offset:54976
    v_pk_max_i16 v244, v244, 0
    v_mfma_f32_16x16x32_bf16 v[56:59], a[24:27], a[64:67], v[56:59]
    ds_read_b64_tr_b16 a[8:9], v5 offset:8192
    v_pk_max_i16 v245, v245, 0
    v_mfma_f32_16x16x32_bf16 v[56:59], a[28:31], a[72:75], v[56:59]
    ds_read_b64_tr_b16 a[10:11], v5 offset:45632
    v_mfma_f32_16x16x32_bf16 v[60:63], a[24:27], a[68:71], v[60:63]
    ds_read_b64_tr_b16 a[12:13], v9 offset:17536
    buffer_store_dwordx4 a[120:123], v18, s[20:23], s82 offen offset:2048 sc1
    v_mfma_f32_16x16x32_bf16 v[60:63], a[28:31], a[76:79], v[60:63]
    s_waitcnt lgkmcnt(7)
    ds_read_b64_tr_b16 a[14:15], v9 offset:54976
    v_pk_max_i16 v246, v246, 0
    v_mfma_f32_16x16x32_bf16 v[64:67], a[32:35], a[64:67], v[64:67]
    ds_read_b64_tr_b16 a[16:17], v2 offset:10240
    v_pk_max_i16 v247, v247, 0
    v_mfma_f32_16x16x32_bf16 v[64:67], a[36:39], a[72:75], v[64:67]
    ds_read_b64_tr_b16 a[18:19], v2 offset:47680
    v_accvgpr_write_b32 a132, v244
    v_mfma_f32_16x16x32_bf16 v[68:71], a[32:35], a[68:71], v[68:71]
    ds_read_b64_tr_b16 a[20:21], v6 offset:19584
    buffer_load_dwordx4 a[180:183], v18, s[20:23], s70 offen offset:1024 sc1
    v_mfma_f32_16x16x32_bf16 v[68:71], a[36:39], a[76:79], v[68:71]
    ds_read_b64_tr_b16 a[22:23], v6 offset:57024
    v_accvgpr_write_b32 a133, v245
    v_mfma_f32_16x16x32_bf16 v[72:75], a[40:43], a[64:67], v[72:75]
    ds_read_b64_tr_b16 a[24:25], v3 offset:10240
    v_mfma_f32_16x16x32_bf16 v[72:75], a[44:47], a[72:75], v[72:75]
    s_add_u32 m0, s67, 32768
    ds_read_b64_tr_b16 a[26:27], v3 offset:47680
    v_accvgpr_write_b32 a134, v246
    v_mfma_f32_16x16x32_bf16 v[76:79], a[40:43], a[68:71], v[76:79]
    s_add_u32 s72, s74, 368768
    ds_read_b64_tr_b16 a[28:29], v7 offset:19584
    buffer_load_dwordx4 v16, s[16:19], s72 offen lds
    v_mfma_f32_16x16x32_bf16 v[76:79], a[44:47], a[76:79], v[76:79]
    s_waitcnt lgkmcnt(7)
    ds_read_b64_tr_b16 a[30:31], v7 offset:57024
    v_accvgpr_write_b32 a135, v247
    v_mfma_f32_16x16x32_bf16 v[80:83], a[0:3], a[64:67], v[80:83]
    ds_read_b64_tr_b16 a[32:33], v4 offset:10240
    v_mul_f32 v224, v224, |v224|
    v_mfma_f32_16x16x32_bf16 v[80:83], a[4:7], a[72:75], v[80:83]
    ds_read_b64_tr_b16 a[34:35], v4 offset:47680
    v_mfma_f32_16x16x32_bf16 v[84:87], a[0:3], a[68:71], v[84:87]
    ds_read_b64_tr_b16 a[36:37], v8 offset:19584
    buffer_load_dwordx4 v17, s[16:19], s72 offen offset:1024 lds
    v_mfma_f32_16x16x32_bf16 v[84:87], a[4:7], a[76:79], v[84:87]
    ds_read_b64_tr_b16 a[38:39], v8 offset:57024
    v_mul_f32 v225, v225, |v225|
    v_mfma_f32_16x16x32_bf16 v[88:91], a[8:11], a[64:67], v[88:91]
    ds_read_b64_tr_b16 a[40:41], v5 offset:10240
    v_mul_f32 v226, v226, |v226|
    v_mfma_f32_16x16x32_bf16 v[88:91], a[12:15], a[72:75], v[88:91]
    ds_read_b64_tr_b16 a[42:43], v5 offset:47680
    v_mfma_f32_16x16x32_bf16 v[92:95], a[8:11], a[68:71], v[92:95]
    ds_read_b64_tr_b16 a[44:45], v9 offset:19584
    buffer_load_dwordx4 a[184:187], v18, s[20:23], s70 offen offset:2048 sc1
    v_mfma_f32_16x16x32_bf16 v[92:95], a[12:15], a[76:79], v[92:95]
    s_waitcnt vmcnt(27) lgkmcnt(7)
    ds_read_b64_tr_b16 a[46:47], v9 offset:57024
    v_mul_f32 v227, v227, |v227|
    v_mfma_f32_16x16x32_bf16 v[96:99], a[16:19], a[64:67], v[96:99]
    s_barrier
    ds_read_b64_tr_b16 a[0:1], v2 offset:12288
    v_mfma_f32_16x16x32_bf16 v[96:99], a[20:23], a[72:75], v[96:99]
    s_add_u32 m0, s67, 34816
    ds_read_b64_tr_b16 a[2:3], v2 offset:49728
    v_cvt_pk_bf16_f32 v248, v224, v225
    v_mfma_f32_16x16x32_bf16 v[100:103], a[16:19], a[68:71], v[100:103]
    s_add_u32 s72, s74, 368896
    ds_read_b64_tr_b16 a[4:5], v6 offset:21632
    buffer_load_dwordx4 v16, s[16:19], s72 offen lds
    v_mfma_f32_16x16x32_bf16 v[100:103], a[20:23], a[76:79], v[100:103]
    ds_read_b64_tr_b16 a[6:7], v6 offset:59072
    v_cvt_pk_bf16_f32 v249, v226, v227
    v_mfma_f32_16x16x32_bf16 v[104:107], a[24:27], a[64:67], v[104:107]
    ds_read_b64_tr_b16 a[8:9], v3 offset:12288
    v_mul_f32 v232, v232, |v232|
    v_mfma_f32_16x16x32_bf16 v[104:107], a[28:31], a[72:75], v[104:107]
    ds_read_b64_tr_b16 a[10:11], v3 offset:49728
    v_mul_f32 v233, v233, |v233|
    v_mfma_f32_16x16x32_bf16 v[108:111], a[24:27], a[68:71], v[108:111]
    ds_read_b64_tr_b16 a[12:13], v7 offset:21632
    buffer_store_dwordx4 a[124:127], v18, s[20:23], s82 offen offset:3072 sc1
    v_mfma_f32_16x16x32_bf16 v[108:111], a[28:31], a[76:79], v[108:111]
    s_waitcnt lgkmcnt(7)
    ds_read_b64_tr_b16 a[14:15], v7 offset:59072
    v_mul_f32 v234, v234, |v234|
    v_mfma_f32_16x16x32_bf16 v[112:115], a[32:35], a[64:67], v[112:115]
    ds_read_b64_tr_b16 a[16:17], v4 offset:12288
    v_mul_f32 v235, v235, |v235|
    v_mfma_f32_16x16x32_bf16 v[112:115], a[36:39], a[72:75], v[112:115]
    ds_read_b64_tr_b16 a[18:19], v4 offset:49728
    v_mfma_f32_16x16x32_bf16 v[116:119], a[32:35], a[68:71], v[116:119]
    ds_read_b64_tr_b16 a[20:21], v8 offset:21632
    buffer_load_dwordx4 a[188:191], v18, s[20:23], s70 offen offset:3072 sc1
    v_mfma_f32_16x16x32_bf16 v[116:119], a[36:39], a[76:79], v[116:119]
    ds_read_b64_tr_b16 a[22:23], v8 offset:59072
    v_cvt_pk_bf16_f32 v250, v232, v233
    v_mfma_f32_16x16x32_bf16 v[120:123], a[40:43], a[64:67], v[120:123]
    ds_read_b64_tr_b16 a[24:25], v5 offset:12288
    v_cvt_pk_bf16_f32 v251, v234, v235
    v_mfma_f32_16x16x32_bf16 v[120:123], a[44:47], a[72:75], v[120:123]
    ds_read_b64_tr_b16 a[26:27], v5 offset:49728
    v_mfma_f32_16x16x32_bf16 v[124:127], a[40:43], a[68:71], v[124:127]
    ds_read_b64_tr_b16 a[28:29], v9 offset:21632
    buffer_load_dwordx4 v17, s[16:19], s72 offen offset:1024 lds
    v_mfma_f32_16x16x32_bf16 v[124:127], a[44:47], a[76:79], v[124:127]
    s_waitcnt lgkmcnt(7)
    ds_read_b64_tr_b16 a[30:31], v9 offset:59072
    v_pk_max_i16 v248, v248, 0
    v_mfma_f32_16x16x32_bf16 v[32:35], a[0:3], a[80:83], v[32:35]
    ds_read_b64_tr_b16 a[32:33], v2 offset:14336
    v_pk_max_i16 v249, v249, 0
    v_mfma_f32_16x16x32_bf16 v[32:35], a[4:7], a[88:91], v[32:35]
    s_add_u32 m0, s67, 0
    ds_read_b64_tr_b16 a[34:35], v2 offset:51776
    v_pk_max_i16 v250, v250, 0
    v_mfma_f32_16x16x32_bf16 v[36:39], a[0:3], a[84:87], v[36:39]
    s_add_u32 s72, s84, 0
    ds_read_b64_tr_b16 a[36:37], v6 offset:23680
    buffer_load_dwordx4 v16, s[16:19], s72 offen lds
    v_mfma_f32_16x16x32_bf16 v[36:39], a[4:7], a[92:95], v[36:39]
    ds_read_b64_tr_b16 a[38:39], v6 offset:61120
    v_pk_max_i16 v251, v251, 0
    v_mfma_f32_16x16x32_bf16 v[40:43], a[8:11], a[80:83], v[40:43]
    ds_read_b64_tr_b16 a[40:41], v3 offset:14336
    v_mfma_f32_16x16x32_bf16 v[40:43], a[12:15], a[88:91], v[40:43]
    ds_read_b64_tr_b16 a[42:43], v3 offset:51776
    v_accvgpr_write_b32 a136, v248
    v_mfma_f32_16x16x32_bf16 v[44:47], a[8:11], a[84:87], v[44:47]
    s_add_u32 s70, s77, 4096
    ds_read_b64_tr_b16 a[44:45], v7 offset:23680
    buffer_load_dwordx4 a[192:195], v18, s[20:23], s70 offen offset:0 sc1
    v_mfma_f32_16x16x32_bf16 v[44:47], a[12:15], a[92:95], v[44:47]
    s_waitcnt lgkmcnt(7)
    ds_read_b64_tr_b16 a[46:47], v7 offset:61120
    v_accvgpr_write_b32 a137, v249
    v_mfma_f32_16x16x32_bf16 v[48:51], a[16:19], a[80:83], v[48:51]
    ds_read_b64_tr_b16 a[0:1], v4 offset:14336
    v_accvgpr_write_b32 a138, v250
    v_mfma_f32_16x16x32_bf16 v[48:51], a[20:23], a[88:91], v[48:51]
    ds_read_b64_tr_b16 a[2:3], v4 offset:51776
    v_mfma_f32_16x16x32_bf16 v[52:55], a[16:19], a[84:87], v[52:55]
    ds_read_b64_tr_b16 a[4:5], v8 offset:23680
    buffer_load_dwordx4 v17, s[16:19], s72 offen offset:1024 lds
    v_mfma_f32_16x16x32_bf16 v[52:55], a[20:23], a[92:95], v[52:55]
    ds_read_b64_tr_b16 a[6:7], v8 offset:61120
    v_accvgpr_write_b32 a139, v251
    v_mfma_f32_16x16x32_bf16 v[56:59], a[24:27], a[80:83], v[56:59]
    ds_read_b64_tr_b16 a[8:9], v5 offset:14336
    v_mul_f32 v228, v228, |v228|
    v_mfma_f32_16x16x32_bf16 v[56:59], a[28:31], a[88:91], v[56:59]
    ds_read_b64_tr_b16 a[10:11], v5 offset:51776
    v_mfma_f32_16x16x32_bf16 v[60:63], a[24:27], a[84:87], v[60:63]
    ds_read_b64_tr_b16 a[12:13], v9 offset:23680
    v_mul_f32 v229, v229, |v229|
    v_mfma_f32_16x16x32_bf16 v[60:63], a[28:31], a[92:95], v[60:63]
    s_waitcnt lgkmcnt(7)
    ds_read_b64_tr_b16 a[14:15], v9 offset:61120
    buffer_load_dwordx4 a[196:199], v18, s[20:23], s70 offen offset:1024 sc1
    v_mfma_f32_16x16x32_bf16 v[64:67], a[32:35], a[80:83], v[64:67]
    ds_read_b64_tr_b16 a[16:17], v2 offset:16384
    v_mul_f32 v230, v230, |v230|
    v_mfma_f32_16x16x32_bf16 v[64:67], a[36:39], a[88:91], v[64:67]
    ds_read_b64_tr_b16 a[18:19], v2 offset:53824
    v_mul_f32 v231, v231, |v231|
    v_mfma_f32_16x16x32_bf16 v[68:71], a[32:35], a[84:87], v[68:71]
    s_add_u32 m0, s67, 2048
    ds_read_b64_tr_b16 a[20:21], v6 offset:25728
    v_mfma_f32_16x16x32_bf16 v[68:71], a[36:39], a[92:95], v[68:71]
    s_add_u32 s72, s84, 128
    ds_read_b64_tr_b16 a[22:23], v6 offset:63168
    buffer_load_dwordx4 v16, s[16:19], s72 offen lds
    v_mfma_f32_16x16x32_bf16 v[72:75], a[40:43], a[80:83], v[72:75]
    ds_read_b64_tr_b16 a[24:25], v3 offset:16384
    v_cvt_pk_bf16_f32 v252, v228, v229
    v_mfma_f32_16x16x32_bf16 v[72:75], a[44:47], a[88:91], v[72:75]
    ds_read_b64_tr_b16 a[26:27], v3 offset:53824
    v_cvt_pk_bf16_f32 v253, v230, v231
    v_mfma_f32_16x16x32_bf16 v[76:79], a[40:43], a[84:87], v[76:79]
    ds_read_b64_tr_b16 a[28:29], v7 offset:25728
    v_mfma_f32_16x16x32_bf16 v[76:79], a[44:47], a[92:95], v[76:79]
    s_waitcnt lgkmcnt(7)
    ds_read_b64_tr_b16 a[30:31], v7 offset:63168
    v_mul_f32 v236, v236, |v236|
    v_mfma_f32_16x16x32_bf16 v[80:83], a[0:3], a[80:83], v[80:83]
    ds_read_b64_tr_b16 a[32:33], v4 offset:16384
    buffer_load_dwordx4 a[200:203], v18, s[20:23], s70 offen offset:2048 sc1
    v_mfma_f32_16x16x32_bf16 v[80:83], a[4:7], a[88:91], v[80:83]
    ds_read_b64_tr_b16 a[34:35], v4 offset:53824
    v_mul_f32 v237, v237, |v237|
    v_mfma_f32_16x16x32_bf16 v[84:87], a[0:3], a[84:87], v[84:87]
    ds_read_b64_tr_b16 a[36:37], v8 offset:25728
    v_mul_f32 v238, v238, |v238|
    v_mfma_f32_16x16x32_bf16 v[84:87], a[4:7], a[92:95], v[84:87]
    ds_read_b64_tr_b16 a[38:39], v8 offset:63168
    v_mfma_f32_16x16x32_bf16 v[88:91], a[8:11], a[80:83], v[88:91]
    ds_read_b64_tr_b16 a[40:41], v5 offset:16384
    buffer_load_dwordx4 v17, s[16:19], s72 offen offset:1024 lds
    v_mfma_f32_16x16x32_bf16 v[88:91], a[12:15], a[88:91], v[88:91]
    ds_read_b64_tr_b16 a[42:43], v5 offset:53824
    v_mul_f32 v239, v239, |v239|
    v_mfma_f32_16x16x32_bf16 v[92:95], a[8:11], a[84:87], v[92:95]
    ds_read_b64_tr_b16 a[44:45], v9 offset:25728
    v_cvt_pk_bf16_f32 v254, v236, v237
    v_mfma_f32_16x16x32_bf16 v[92:95], a[12:15], a[92:95], v[92:95]
    s_waitcnt vmcnt(28) lgkmcnt(7)
    ds_read_b64_tr_b16 a[46:47], v9 offset:63168
    v_mfma_f32_16x16x32_bf16 v[96:99], a[16:19], a[80:83], v[96:99]
    s_barrier
    ds_read_b64_tr_b16 a[0:1], v2 offset:18432
    v_mfma_f32_16x16x32_bf16 v[96:99], a[20:23], a[88:91], v[96:99]
    ds_read_b64_tr_b16 a[2:3], v2 offset:55872
    buffer_load_dwordx4 a[204:207], v18, s[20:23], s70 offen offset:3072 sc1
    v_mfma_f32_16x16x32_bf16 v[100:103], a[16:19], a[84:87], v[100:103]
    ds_read_b64_tr_b16 a[4:5], v6 offset:27776
    v_cvt_pk_bf16_f32 v255, v238, v239
    v_mfma_f32_16x16x32_bf16 v[100:103], a[20:23], a[92:95], v[100:103]
    ds_read_b64_tr_b16 a[6:7], v6 offset:65216
    v_pk_max_i16 v252, v252, 0
    v_mfma_f32_16x16x32_bf16 v[104:107], a[24:27], a[80:83], v[104:107]
    s_add_u32 m0, s67, 4096
    ds_read_b64_tr_b16 a[8:9], v3 offset:18432
    v_pk_max_i16 v253, v253, 0
    v_mfma_f32_16x16x32_bf16 v[104:107], a[28:31], a[88:91], v[104:107]
    s_add_u32 s72, s84, 256
    ds_read_b64_tr_b16 a[10:11], v3 offset:55872
    buffer_load_dwordx4 v16, s[16:19], s72 offen lds
    v_mfma_f32_16x16x32_bf16 v[108:111], a[24:27], a[84:87], v[108:111]
    ds_read_b64_tr_b16 a[12:13], v7 offset:27776
    v_pk_max_i16 v254, v254, 0
    v_mfma_f32_16x16x32_bf16 v[108:111], a[28:31], a[92:95], v[108:111]
    s_waitcnt lgkmcnt(7)
    ds_read_b64_tr_b16 a[14:15], v7 offset:65216
    v_pk_max_i16 v255, v255, 0
    v_mfma_f32_16x16x32_bf16 v[112:115], a[32:35], a[80:83], v[112:115]
    ds_read_b64_tr_b16 a[16:17], v4 offset:18432
    v_accvgpr_write_b32 a140, v252
    v_mfma_f32_16x16x32_bf16 v[112:115], a[36:39], a[88:91], v[112:115]
    ds_read_b64_tr_b16 a[18:19], v4 offset:55872
    buffer_load_dword v21, v20, s[20:23], 0 offen sc1
    v_mfma_f32_16x16x32_bf16 v[116:119], a[32:35], a[84:87], v[116:119]
    ds_read_b64_tr_b16 a[20:21], v8 offset:27776
    v_accvgpr_write_b32 a141, v253
    v_mfma_f32_16x16x32_bf16 v[116:119], a[36:39], a[92:95], v[116:119]
    ds_read_b64_tr_b16 a[22:23], v8 offset:65216
    v_mfma_f32_16x16x32_bf16 v[120:123], a[40:43], a[80:83], v[120:123]
    ds_read_b64_tr_b16 a[24:25], v5 offset:18432
    v_accvgpr_write_b32 a142, v254
    v_mfma_f32_16x16x32_bf16 v[120:123], a[44:47], a[88:91], v[120:123]
    ds_read_b64_tr_b16 a[26:27], v5 offset:55872
    buffer_load_dwordx4 v17, s[16:19], s72 offen offset:1024 lds
    v_mfma_f32_16x16x32_bf16 v[124:127], a[40:43], a[84:87], v[124:127]
    ds_read_b64_tr_b16 a[28:29], v9 offset:27776
    v_accvgpr_write_b32 a143, v255
    v_mfma_f32_16x16x32_bf16 v[124:127], a[44:47], a[92:95], v[124:127]
    s_waitcnt lgkmcnt(7)
    ds_read_b64_tr_b16 a[30:31], v9 offset:65216
    v_mfma_f32_16x16x32_bf16 v[32:35], a[0:3], a[96:99], v[32:35]
    s_mul_i32 s68, s63, 442368
    ds_read_b64_tr_b16 a[32:33], v2 offset:20480
    v_mfma_f32_16x16x32_bf16 v[32:35], a[4:7], a[104:107], v[32:35]
    ds_read_b64_tr_b16 a[34:35], v2 offset:57920
    v_mfma_f32_16x16x32_bf16 v[36:39], a[0:3], a[100:103], v[36:39]
    s_add_u32 m0, s67, 6144
    ds_read_b64_tr_b16 a[36:37], v6 offset:29824
    v_mfma_f32_16x16x32_bf16 v[36:39], a[4:7], a[108:111], v[36:39]
    s_add_u32 s72, s85, 0
    ds_read_b64_tr_b16 a[38:39], v10 offset:1728
    buffer_load_dwordx4 v16, s[16:19], s72 offen lds
    v_mfma_f32_16x16x32_bf16 v[40:43], a[8:11], a[96:99], v[40:43]
    s_sub_u32 s79, s75, s68
    ds_read_b64_tr_b16 a[40:41], v3 offset:20480
    v_mfma_f32_16x16x32_bf16 v[40:43], a[12:15], a[104:107], v[40:43]
    s_add_u32 s79, s79, 24576
    ds_read_b64_tr_b16 a[42:43], v3 offset:57920
    v_mfma_f32_16x16x32_bf16 v[44:47], a[8:11], a[100:103], v[44:47]
    ds_read_b64_tr_b16 a[44:45], v7 offset:29824
    v_mfma_f32_16x16x32_bf16 v[44:47], a[12:15], a[108:111], v[44:47]
    s_waitcnt lgkmcnt(7)
    ds_read_b64_tr_b16 a[46:47], v11 offset:1728
    v_mfma_f32_16x16x32_bf16 v[48:51], a[16:19], a[96:99], v[48:51]
    s_mul_i32 s68, s62, 3
    ds_read_b64_tr_b16 a[0:1], v4 offset:20480
    v_mfma_f32_16x16x32_bf16 v[48:51], a[20:23], a[104:107], v[48:51]
    ds_read_b64_tr_b16 a[2:3], v4 offset:57920
    buffer_load_dwordx4 v17, s[16:19], s72 offen offset:1024 lds
    v_mfma_f32_16x16x32_bf16 v[52:55], a[16:19], a[100:103], v[52:55]
    ds_read_b64_tr_b16 a[4:5], v8 offset:29824
    v_mfma_f32_16x16x32_bf16 v[52:55], a[20:23], a[108:111], v[52:55]
    s_add_u32 s68, s68, s65
    ds_read_b64_tr_b16 a[6:7], v12 offset:1728
    v_mfma_f32_16x16x32_bf16 v[56:59], a[24:27], a[96:99], v[56:59]
    ds_read_b64_tr_b16 a[8:9], v5 offset:20480
    v_mfma_f32_16x16x32_bf16 v[56:59], a[28:31], a[104:107], v[56:59]
    ds_read_b64_tr_b16 a[10:11], v5 offset:57920
    v_mfma_f32_16x16x32_bf16 v[60:63], a[24:27], a[100:103], v[60:63]
    s_lshl_b32 s68, s68, 9
    ds_read_b64_tr_b16 a[12:13], v9 offset:29824
    v_mfma_f32_16x16x32_bf16 v[60:63], a[28:31], a[108:111], v[60:63]
    s_waitcnt lgkmcnt(7)
    ds_read_b64_tr_b16 a[14:15], v13 offset:1728
    v_mfma_f32_16x16x32_bf16 v[64:67], a[32:35], a[96:99], v[64:67]
    s_add_u32 s82, s75, 20480
    ds_read_b64_tr_b16 a[16:17], v2 offset:22528
    buffer_store_dwordx4 a[128:131], v18, s[20:23], s82 offen offset:0 sc1
    v_mfma_f32_16x16x32_bf16 v[64:67], a[36:39], a[104:107], v[64:67]
    s_add_u32 s68, s68, s96
    ds_read_b64_tr_b16 a[18:19], v2 offset:59968
    v_mfma_f32_16x16x32_bf16 v[68:71], a[32:35], a[100:103], v[68:71]
    ds_read_b64_tr_b16 a[20:21], v6 offset:31872
    v_mfma_f32_16x16x32_bf16 v[68:71], a[36:39], a[108:111], v[68:71]
    s_add_u32 s68, s68, 10368
    ds_read_b64_tr_b16 a[22:23], v10 offset:3776
    v_mfma_f32_16x16x32_bf16 v[72:75], a[40:43], a[96:99], v[72:75]
    s_add_u32 m0, s67, 8192
    ds_read_b64_tr_b16 a[24:25], v3 offset:22528
    v_mfma_f32_16x16x32_bf16 v[72:75], a[44:47], a[104:107], v[72:75]
    s_add_u32 s72, s85, 128
    ds_read_b64_tr_b16 a[26:27], v3 offset:59968
    buffer_load_dwordx4 v16, s[16:19], s72 offen lds
    v_mfma_f32_16x16x32_bf16 v[76:79], a[40:43], a[100:103], v[76:79]
    s_lshl_b32 s69, s63, 7
    ds_read_b64_tr_b16 a[28:29], v7 offset:31872
    v_mfma_f32_16x16x32_bf16 v[76:79], a[44:47], a[108:111], v[76:79]
    s_waitcnt lgkmcnt(7)
    ds_read_b64_tr_b16 a[30:31], v11 offset:3776
    v_mfma_f32_16x16x32_bf16 v[80:83], a[0:3], a[96:99], v[80:83]
    ds_read_b64_tr_b16 a[32:33], v4 offset:22528
    v_mfma_f32_16x16x32_bf16 v[80:83], a[4:7], a[104:107], v[80:83]
    s_add_u32 s93, s68, s69
    ds_read_b64_tr_b16 a[34:35], v4 offset:59968
    v_mfma_f32_16x16x32_bf16 v[84:87], a[0:3], a[100:103], v[84:87]
    ds_read_b64_tr_b16 a[36:37], v8 offset:31872
    v_mfma_f32_16x16x32_bf16 v[84:87], a[4:7], a[108:111], v[84:87]
    ds_read_b64_tr_b16 a[38:39], v12 offset:3776
    buffer_load_dwordx4 v17, s[16:19], s72 offen offset:1024 lds
    v_mfma_f32_16x16x32_bf16 v[88:91], a[8:11], a[96:99], v[88:91]
    ds_read_b64_tr_b16 a[40:41], v5 offset:22528
    v_min_u32 v28, 3, v1
    v_mfma_f32_16x16x32_bf16 v[88:91], a[12:15], a[104:107], v[88:91]
    ds_read_b64_tr_b16 a[42:43], v5 offset:59968
    v_mfma_f32_16x16x32_bf16 v[92:95], a[8:11], a[100:103], v[92:95]
    ds_read_b64_tr_b16 a[44:45], v9 offset:31872
    v_mfma_f32_16x16x32_bf16 v[92:95], a[12:15], a[108:111], v[92:95]
    s_waitcnt vmcnt(28) lgkmcnt(7)
    ds_read_b64_tr_b16 a[46:47], v13 offset:3776
    v_lshlrev_b32 v28, 7, v28
    v_mfma_f32_16x16x32_bf16 v[96:99], a[16:19], a[96:99], v[96:99]
    s_barrier
    ds_read_b64_tr_b16 a[0:1], v2 offset:24576
    v_mfma_f32_16x16x32_bf16 v[96:99], a[20:23], a[104:107], v[96:99]
    s_add_u32 m0, s67, 10240
    ds_read_b64_tr_b16 a[2:3], v2 offset:62016
    v_add_u32 v25, s68, v28
    v_mfma_f32_16x16x32_bf16 v[100:103], a[16:19], a[100:103], v[100:103]
    s_add_u32 s72, s85, 256
    ds_read_b64_tr_b16 a[4:5], v6 offset:33920
    buffer_load_dwordx4 v16, s[16:19], s72 offen lds
    v_mfma_f32_16x16x32_bf16 v[100:103], a[20:23], a[108:111], v[100:103]
    ds_read_b64_tr_b16 a[6:7], v10 offset:5824
    v_mfma_f32_16x16x32_bf16 v[104:107], a[24:27], a[96:99], v[104:107]
    s_lshl_b32 s68, s62, 9
    ds_read_b64_tr_b16 a[8:9], v3 offset:24576
    v_mfma_f32_16x16x32_bf16 v[104:107], a[28:31], a[104:107], v[104:107]
    ds_read_b64_tr_b16 a[10:11], v3 offset:62016
    v_mfma_f32_16x16x32_bf16 v[108:111], a[24:27], a[100:103], v[108:111]
    ds_read_b64_tr_b16 a[12:13], v7 offset:33920
    v_mfma_f32_16x16x32_bf16 v[108:111], a[28:31], a[108:111], v[108:111]
    s_waitcnt lgkmcnt(7)
    ds_read_b64_tr_b16 a[14:15], v11 offset:5824
    buffer_store_dwordx4 a[132:135], v18, s[20:23], s82 offen offset:1024 sc1
    v_mfma_f32_16x16x32_bf16 v[112:115], a[32:35], a[96:99], v[112:115]
    s_add_u32 s68, s68, s96
    ds_read_b64_tr_b16 a[16:17], v4 offset:24576
    v_mfma_f32_16x16x32_bf16 v[112:115], a[36:39], a[104:107], v[112:115]
    ds_read_b64_tr_b16 a[18:19], v4 offset:62016
    v_mfma_f32_16x16x32_bf16 v[116:119], a[32:35], a[100:103], v[116:119]
    s_add_u32 s68, s68, 8320
    ds_read_b64_tr_b16 a[20:21], v8 offset:33920
    v_mfma_f32_16x16x32_bf16 v[116:119], a[36:39], a[108:111], v[116:119]
    ds_read_b64_tr_b16 a[22:23], v12 offset:5824
    v_mfma_f32_16x16x32_bf16 v[120:123], a[40:43], a[96:99], v[120:123]
    ds_read_b64_tr_b16 a[24:25], v5 offset:24576
    v_mfma_f32_16x16x32_bf16 v[120:123], a[44:47], a[104:107], v[120:123]
    ds_read_b64_tr_b16 a[26:27], v5 offset:62016
    buffer_load_dwordx4 v17, s[16:19], s72 offen offset:1024 lds
    v_mfma_f32_16x16x32_bf16 v[124:127], a[40:43], a[100:103], v[124:127]
    ds_read_b64_tr_b16 a[28:29], v9 offset:33920
    v_add_u32 v250, s68, v28
    v_mfma_f32_16x16x32_bf16 v[124:127], a[44:47], a[108:111], v[124:127]
    s_waitcnt lgkmcnt(7)
    ds_read_b64_tr_b16 a[30:31], v13 offset:5824
    v_mfma_f32_16x16x32_bf16 v[32:35], a[0:3], a[112:115], v[32:35]
    s_mul_i32 s78, s62, 36864
    ds_read_b64_tr_b16 a[32:33], v2 offset:26624
    v_mfma_f32_16x16x32_bf16 v[32:35], a[4:7], a[120:123], v[32:35]
    s_add_u32 m0, s67, 12288
    ds_read_b64_tr_b16 a[34:35], v2 offset:64064
    v_mfma_f32_16x16x32_bf16 v[36:39], a[0:3], a[116:119], v[36:39]
    s_add_u32 s72, s84, 73728
    ds_read_b64_tr_b16 a[36:37], v6 offset:35968
    buffer_load_dwordx4 v16, s[16:19], s72 offen lds
    v_mfma_f32_16x16x32_bf16 v[36:39], a[4:7], a[124:127], v[36:39]
    ds_read_b64_tr_b16 a[38:39], v10 offset:7872
    v_mfma_f32_16x16x32_bf16 v[40:43], a[8:11], a[112:115], v[40:43]
    s_add_u32 s78, s78, s96
    ds_read_b64_tr_b16 a[40:41], v3 offset:26624
    v_mfma_f32_16x16x32_bf16 v[40:43], a[12:15], a[120:123], v[40:43]
    ds_read_b64_tr_b16 a[42:43], v3 offset:64064
    s_add_u32 s71, s66, 2
    s_waitcnt vmcnt(10)
    v_subrev_u32 v21, s71, v21
    v_cmp_gt_u32 vcc, 8, v21
    s_nop 0
    s_cmp_eq_u64 vcc, exec
    s_cbranch_scc0 L_slow_4
L_back_5:
    v_mfma_f32_16x16x32_bf16 v[44:47], a[8:11], a[116:119], v[44:47]
    s_add_u32 s70, s76, 8192
L_pad_m1_2:
    s_cbranch_execz L_walk_ret
    ds_read_b64_tr_b16 a[44:45], v7 offset:35968
    buffer_load_dwordx4 a[208:211], v18, s[20:23], s70 offen offset:0 sc1
    v_mfma_f32_16x16x32_bf16 v[44:47], a[12:15], a[124:127], v[44:47]
    s_waitcnt lgkmcnt(7)
    ds_read_b64_tr_b16 a[46:47], v11 offset:7872
    v_mfma_f32_16x16x32_bf16 v[48:51], a[16:19], a[112:115], v[48:51]
    s_add_u32 s78, s78, 0x5000
    ds_read_b64_tr_b16 a[0:1], v4 offset:26624
    v_mfma_f32_16x16x32_bf16 v[48:51], a[20:23], a[120:123], v[48:51]
    ds_read_b64_tr_b16 a[2:3], v4 offset:64064
    v_mfma_f32_16x16x32_bf16 v[52:55], a[16:19], a[116:119], v[52:55]
    ds_read_b64_tr_b16 a[4:5], v8 offset:35968
    buffer_load_dwordx4 v17, s[16:19], s72 offen offset:1024 lds
    v_mfma_f32_16x16x32_bf16 v[52:55], a[20:23], a[124:127], v[52:55]
    ds_read_b64_tr_b16 a[6:7], v12 offset:7872
    v_mfma_f32_16x16x32_bf16 v[56:59], a[24:27], a[112:115], v[56:59]
    ds_read_b64_tr_b16 a[8:9], v5 offset:26624
    v_and_b32 v23, 15, v1
    v_mfma_f32_16x16x32_bf16 v[56:59], a[28:31], a[120:123], v[56:59]
    ds_read_b64_tr_b16 a[10:11], v5 offset:64064
    v_mfma_f32_16x16x32_bf16 v[60:63], a[24:27], a[116:119], v[60:63]
    ds_read_b64_tr_b16 a[12:13], v9 offset:35968
    buffer_store_dwordx4 a[136:139], v18, s[20:23], s82 offen offset:2048 sc1
    v_mfma_f32_16x16x32_bf16 v[60:63], a[28:31], a[124:127], v[60:63]
    s_waitcnt lgkmcnt(7)
    ds_read_b64_tr_b16 a[14:15], v13 offset:7872
    v_mfma_f32_16x16x32_bf16 v[64:67], a[32:35], a[112:115], v[64:67]
    ds_read_b64_tr_b16 a[16:17], v2 offset:28672
    v_mul_u32_u24 v23, 1152, v23
    v_mfma_f32_16x16x32_bf16 v[64:67], a[36:39], a[120:123], v[64:67]
    ds_read_b64_tr_b16 a[18:19], v6 offset:576
    v_mfma_f32_16x16x32_bf16 v[68:71], a[32:35], a[116:119], v[68:71]
    ds_read_b64_tr_b16 a[20:21], v6 offset:38016
    buffer_load_dwordx4 a[212:215], v18, s[20:23], s70 offen offset:1024 sc1
    v_mfma_f32_16x16x32_bf16 v[68:71], a[36:39], a[124:127], v[68:71]
    ds_read_b64_tr_b16 a[22:23], v10 offset:9920
    v_mfma_f32_16x16x32_bf16 v[72:75], a[40:43], a[112:115], v[72:75]
    ds_read_b64_tr_b16 a[24:25], v3 offset:28672
    v_lshrrev_b32 v24, 4, v1
    v_mfma_f32_16x16x32_bf16 v[72:75], a[44:47], a[120:123], v[72:75]
    s_add_u32 m0, s67, 14336
    ds_read_b64_tr_b16 a[26:27], v7 offset:576
    v_mfma_f32_16x16x32_bf16 v[76:79], a[40:43], a[116:119], v[76:79]
    s_add_u32 s72, s84, 73856
    ds_read_b64_tr_b16 a[28:29], v7 offset:38016
    buffer_load_dwordx4 v16, s[16:19], s72 offen lds
    v_mfma_f32_16x16x32_bf16 v[76:79], a[44:47], a[124:127], v[76:79]
    s_waitcnt lgkmcnt(7)
    ds_read_b64_tr_b16 a[30:31], v11 offset:9920
    v_mfma_f32_16x16x32_bf16 v[80:83], a[0:3], a[112:115], v[80:83]
    ds_read_b64_tr_b16 a[32:33], v4 offset:28672
    v_lshlrev_b32 v24, 3, v24
    v_mfma_f32_16x16x32_bf16 v[80:83], a[4:7], a[120:123], v[80:83]
    ds_read_b64_tr_b16 a[34:35], v8 offset:576
    v_mfma_f32_16x16x32_bf16 v[84:87], a[0:3], a[116:119], v[84:87]
    ds_read_b64_tr_b16 a[36:37], v8 offset:38016
    buffer_load_dwordx4 v17, s[16:19], s72 offen offset:1024 lds
    v_mfma_f32_16x16x32_bf16 v[84:87], a[4:7], a[124:127], v[84:87]
    ds_read_b64_tr_b16 a[38:39], v12 offset:9920
    v_mfma_f32_16x16x32_bf16 v[88:91], a[8:11], a[112:115], v[88:91]
    ds_read_b64_tr_b16 a[40:41], v5 offset:28672
    v_add_u32 v23, v23, v24
    v_mfma_f32_16x16x32_bf16 v[88:91], a[12:15], a[120:123], v[88:91]
    ds_read_b64_tr_b16 a[42:43], v9 offset:576
    v_mfma_f32_16x16x32_bf16 v[92:95], a[8:11], a[116:119], v[92:95]
    ds_read_b64_tr_b16 a[44:45], v9 offset:38016
    buffer_load_dwordx4 a[216:219], v18, s[20:23], s70 offen offset:2048 sc1
    v_mfma_f32_16x16x32_bf16 v[92:95], a[12:15], a[124:127], v[92:95]
    s_waitcnt lgkmcnt(7)
    ds_read_b64_tr_b16 a[46:47], v13 offset:9920
    v_mfma_f32_16x16x32_bf16 v[96:99], a[16:19], a[112:115], v[96:99]
    s_barrier
    ds_read_b64_tr_b16 a[0:1], v2 offset:30720
    v_mfma_f32_16x16x32_bf16 v[96:99], a[20:23], a[120:123], v[96:99]
    s_add_u32 m0, s67, 16384
    ds_read_b64_tr_b16 a[2:3], v6 offset:2624
    v_mfma_f32_16x16x32_bf16 v[100:103], a[16:19], a[116:119], v[100:103]
    s_add_u32 s72, s84, 73984
    ds_read_b64_tr_b16 a[4:5], v6 offset:40064
    buffer_load_dwordx4 v16, s[16:19], s72 offen lds
    v_mfma_f32_16x16x32_bf16 v[100:103], a[20:23], a[124:127], v[100:103]
    s_mul_i32 s89, s81, 36864
    ds_read_b64_tr_b16 a[6:7], v10 offset:11968
    v_mfma_f32_16x16x32_bf16 v[104:107], a[24:27], a[112:115], v[104:107]
    s_add_u32 s89, s89, s88
    ds_read_b64_tr_b16 a[8:9], v3 offset:30720
    v_mfma_f32_16x16x32_bf16 v[104:107], a[28:31], a[120:123], v[104:107]
    ds_read_b64_tr_b16 a[10:11], v7 offset:2624
    v_mfma_f32_16x16x32_bf16 v[108:111], a[24:27], a[116:119], v[108:111]
    ds_read_b64_tr_b16 a[12:13], v7 offset:40064
    buffer_store_dwordx4 a[140:143], v18, s[20:23], s82 offen offset:3072 sc1
    v_mfma_f32_16x16x32_bf16 v[108:111], a[28:31], a[124:127], v[108:111]
    s_waitcnt lgkmcnt(7)
    ds_read_b64_tr_b16 a[14:15], v11 offset:11968
    v_mfma_f32_16x16x32_bf16 v[112:115], a[32:35], a[112:115], v[112:115]
    s_add_u32 s91, s89, 18432
    ds_read_b64_tr_b16 a[16:17], v4 offset:30720
    v_mfma_f32_16x16x32_bf16 v[112:115], a[36:39], a[120:123], v[112:115]
    ds_read_b64_tr_b16 a[18:19], v8 offset:2624
    v_mfma_f32_16x16x32_bf16 v[116:119], a[32:35], a[116:119], v[116:119]
    ds_read_b64_tr_b16 a[20:21], v8 offset:40064
    buffer_load_dwordx4 a[220:223], v18, s[20:23], s70 offen offset:3072 sc1
    v_mfma_f32_16x16x32_bf16 v[116:119], a[36:39], a[124:127], v[116:119]
    ds_read_b64_tr_b16 a[22:23], v12 offset:11968
    v_mfma_f32_16x16x32_bf16 v[120:123], a[40:43], a[112:115], v[120:123]
    ds_read_b64_tr_b16 a[24:25], v5 offset:30720
    v_lshlrev_b32 v251, 3, v1
    v_mfma_f32_16x16x32_bf16 v[120:123], a[44:47], a[120:123], v[120:123]
    ds_read_b64_tr_b16 a[26:27], v9 offset:2624
    v_mfma_f32_16x16x32_bf16 v[124:127], a[40:43], a[116:119], v[124:127]
    ds_read_b64_tr_b16 a[28:29], v9 offset:40064
    buffer_load_dwordx4 v17, s[16:19], s72 offen offset:1024 lds
    v_mfma_f32_16x16x32_bf16 v[124:127], a[44:47], a[124:127], v[124:127]
    s_waitcnt lgkmcnt(7)
    ds_read_b64_tr_b16 a[30:31], v13 offset:11968
    v_mfma_f32_16x16x32_bf16 v[32:35], a[0:3], a[128:131], v[32:35]
    s_mov_b32 s32, 0x100001
    ds_read_b64_tr_b16 a[32:33], v2 offset:32768
    v_mfma_f32_16x16x32_bf16 v[32:35], a[4:7], a[136:139], v[32:35]
    s_add_u32 m0, s67, 18432
    ds_read_b64_tr_b16 a[34:35], v6 offset:4672
    v_mfma_f32_16x16x32_bf16 v[36:39], a[0:3], a[132:135], v[36:39]
    s_add_u32 s72, s85, 73728
    ds_read_b64_tr_b16 a[36:37], v6 offset:42112
    buffer_load_dwordx4 v16, s[16:19], s72 offen lds
    v_mfma_f32_16x16x32_bf16 v[36:39], a[4:7], a[140:143], v[36:39]
    s_mov_b32 s33, 0x10000100
    ds_read_b64_tr_b16 a[38:39], v10 offset:14016
    v_mfma_f32_16x16x32_bf16 v[40:43], a[8:11], a[128:131], v[40:43]
    s_mov_b32 s34, 0x200002
    ds_read_b64_tr_b16 a[40:41], v3 offset:32768
    v_mfma_f32_16x16x32_bf16 v[40:43], a[12:15], a[136:139], v[40:43]
    ds_read_b64_tr_b16 a[42:43], v7 offset:4672
    v_mfma_f32_16x16x32_bf16 v[44:47], a[8:11], a[132:135], v[44:47]
    s_mov_b32 s35, 0x20000200
    ds_read_b64_tr_b16 a[44:45], v7 offset:42112
    v_mfma_f32_16x16x32_bf16 v[44:47], a[12:15], a[140:143], v[44:47]
    s_waitcnt lgkmcnt(7)
    ds_read_b64_tr_b16 a[46:47], v11 offset:14016
    v_mfma_f32_16x16x32_bf16 v[48:51], a[16:19], a[128:131], v[48:51]
    s_add_u32 s70, s77, 8192
    ds_read_b64_tr_b16 a[0:1], v4 offset:32768
    buffer_load_dwordx4 a[224:227], v18, s[20:23], s70 offen offset:0 sc1
    v_mfma_f32_16x16x32_bf16 v[48:51], a[20:23], a[136:139], v[48:51]
    s_mov_b32 s36, 0x400004
    ds_read_b64_tr_b16 a[2:3], v8 offset:4672
    v_mfma_f32_16x16x32_bf16 v[52:55], a[16:19], a[132:135], v[52:55]
    s_mov_b32 s37, 0x40000400
    ds_read_b64_tr_b16 a[4:5], v8 offset:42112
    v_mfma_f32_16x16x32_bf16 v[52:55], a[20:23], a[140:143], v[52:55]
    ds_read_b64_tr_b16 a[6:7], v12 offset:14016
    v_mfma_f32_16x16x32_bf16 v[56:59], a[24:27], a[128:131], v[56:59]
    ds_read_b64_tr_b16 a[8:9], v5 offset:32768
    buffer_load_dwordx4 v17, s[16:19], s72 offen offset:1024 lds
    v_mfma_f32_16x16x32_bf16 v[56:59], a[28:31], a[136:139], v[56:59]
    s_mov_b32 s38, 0x800008
    ds_read_b64_tr_b16 a[10:11], v9 offset:4672
    v_mfma_f32_16x16x32_bf16 v[60:63], a[24:27], a[132:135], v[60:63]
    ds_read_b64_tr_b16 a[12:13], v9 offset:42112
    v_mfma_f32_16x16x32_bf16 v[60:63], a[28:31], a[140:143], v[60:63]
    s_waitcnt lgkmcnt(7)
    ds_read_b64_tr_b16 a[14:15], v13 offset:14016
    v_mfma_f32_16x16x32_bf16 v[64:67], a[32:35], a[128:131], v[64:67]
    s_mov_b32 s39, 0x80000800
    ds_read_b64_tr_b16 a[16:17], v2 offset:34816
    buffer_load_dwordx4 a[228:231], v18, s[20:23], s70 offen offset:1024 sc1
    v_mfma_f32_16x16x32_bf16 v[64:67], a[36:39], a[136:139], v[64:67]
    ds_read_b64_tr_b16 a[18:19], v6 offset:6720
    v_mov_b32 v136, 0
    v_mfma_f32_16x16x32_bf16 v[68:71], a[32:35], a[132:135], v[68:71]
    ds_read_b64_tr_b16 a[20:21], v6 offset:44160
    v_mfma_f32_16x16x32_bf16 v[68:71], a[36:39], a[140:143], v[68:71]
    ds_read_b64_tr_b16 a[22:23], v10 offset:16064
    v_mov_b32 v137, 0
    v_mfma_f32_16x16x32_bf16 v[72:75], a[40:43], a[128:131], v[72:75]
    s_add_u32 m0, s67, 20480
    ds_read_b64_tr_b16 a[24:25], v3 offset:34816
    v_mfma_f32_16x16x32_bf16 v[72:75], a[44:47], a[136:139], v[72:75]
    s_add_u32 s72, s85, 73856
    ds_read_b64_tr_b16 a[26:27], v7 offset:6720
    buffer_load_dwordx4 v16, s[16:19], s72 offen lds
    v_mfma_f32_16x16x32_bf16 v[76:79], a[40:43], a[132:135], v[76:79]
    ds_read_b64_tr_b16 a[28:29], v7 offset:44160
    v_mov_b32 v140, 0
    v_mfma_f32_16x16x32_bf16 v[76:79], a[44:47], a[140:143], v[76:79]
    s_waitcnt lgkmcnt(7)
    ds_read_b64_tr_b16 a[30:31], v11 offset:16064
    v_mfma_f32_16x16x32_bf16 v[80:83], a[0:3], a[128:131], v[80:83]
    ds_read_b64_tr_b16 a[32:33], v4 offset:34816
    v_mov_b32 v141, 0
    v_mfma_f32_16x16x32_bf16 v[80:83], a[4:7], a[136:139], v[80:83]
    ds_read_b64_tr_b16 a[34:35], v8 offset:6720
    v_mfma_f32_16x16x32_bf16 v[84:87], a[0:3], a[132:135], v[84:87]
    ds_read_b64_tr_b16 a[36:37], v8 offset:44160
    buffer_load_dwordx4 v17, s[16:19], s72 offen offset:1024 lds
    v_mfma_f32_16x16x32_bf16 v[84:87], a[4:7], a[140:143], v[84:87]
    ds_read_b64_tr_b16 a[38:39], v12 offset:16064
    v_mov_b32 v26, 0x3f80
    v_mfma_f32_16x16x32_bf16 v[88:91], a[8:11], a[128:131], v[88:91]
    ds_read_b64_tr_b16 a[40:41], v5 offset:34816
    v_mov_b32 v27, 1.0
    v_mfma_f32_16x16x32_bf16 v[88:91], a[12:15], a[136:139], v[88:91]
    ds_read_b64_tr_b16 a[42:43], v9 offset:6720
    v_mfma_f32_16x16x32_bf16 v[92:95], a[8:11], a[132:135], v[92:95]
    ds_read_b64_tr_b16 a[44:45], v9 offset:44160
    v_cndmask_b32 v138, 0, v26, s[32:33]
    v_mfma_f32_16x16x32_bf16 v[92:95], a[12:15], a[140:143], v[92:95]
    s_waitcnt vmcnt(26) lgkmcnt(7)
    ds_read_b64_tr_b16 a[46:47], v13 offset:16064
    buffer_load_dwordx4 a[232:235], v18, s[20:23], s70 offen offset:2048 sc1
    v_mfma_f32_16x16x32_bf16 v[96:99], a[16:19], a[128:131], v[96:99]
    s_barrier
    ds_read_b64_tr_b16 a[0:1], v2 offset:0
    v_mfma_f32_16x16x32_bf16 v[96:99], a[20:23], a[136:139], v[96:99]
    ds_read_b64_tr_b16 a[2:3], v2 offset:37440
    v_cndmask_b32 v138, v138, v27, s[34:35]
    v_mfma_f32_16x16x32_bf16 v[100:103], a[16:19], a[132:135], v[100:103]
    ds_read_b64_tr_b16 a[4:5], v6 offset:9344
    v_cndmask_b32 v139, 0, v26, s[36:37]
    v_mfma_f32_16x16x32_bf16 v[100:103], a[20:23], a[140:143], v[100:103]
    s_add_u32 m0, s67, 22528
    ds_read_b64_tr_b16 a[6:7], v6 offset:46784
    v_mfma_f32_16x16x32_bf16 v[104:107], a[24:27], a[128:131], v[104:107]
    s_add_u32 s72, s85, 73984
    ds_read_b64_tr_b16 a[8:9], v3 offset:0
    buffer_load_dwordx4 v16, s[16:19], s72 offen lds
    v_mfma_f32_16x16x32_bf16 v[104:107], a[28:31], a[136:139], v[104:107]
    ds_read_b64_tr_b16 a[10:11], v3 offset:37440
    v_cndmask_b32 v139, v139, v27, s[38:39]
    v_mfma_f32_16x16x32_bf16 v[108:111], a[24:27], a[132:135], v[108:111]
    ds_read_b64_tr_b16 a[12:13], v7 offset:9344
    v_mfma_f32_16x16x32_bf16 v[108:111], a[28:31], a[140:143], v[108:111]
    s_waitcnt lgkmcnt(7)
    ds_read_b64_tr_b16 a[14:15], v7 offset:46784
    v_add_u32 v26, 163072, v24
    v_mfma_f32_16x16x32_bf16 v[112:115], a[32:35], a[128:131], v[112:115]
    ds_read_b64_tr_b16 a[16:17], v4 offset:0
    buffer_load_dwordx4 a[236:239], v18, s[20:23], s70 offen offset:3072 sc1
    v_mfma_f32_16x16x32_bf16 v[112:115], a[36:39], a[136:139], v[112:115]
    ds_read_b64_tr_b16 a[18:19], v4 offset:37440
    ds_read_b64 v[128:129], v26 offset:0
    v_mfma_f32_16x16x32_bf16 v[116:119], a[32:35], a[132:135], v[116:119]
    ds_read_b64_tr_b16 a[20:21], v8 offset:9344
    v_mfma_f32_16x16x32_bf16 v[116:119], a[36:39], a[140:143], v[116:119]
    ds_read_b64_tr_b16 a[22:23], v8 offset:46784
    ds_read_b64 v[130:131], v26 offset:32
    v_mfma_f32_16x16x32_bf16 v[120:123], a[40:43], a[128:131], v[120:123]
    ds_read_b64_tr_b16 a[24:25], v5 offset:0
    v_mfma_f32_16x16x32_bf16 v[120:123], a[44:47], a[136:139], v[120:123]
    ds_read_b64_tr_b16 a[26:27], v5 offset:37440
    buffer_load_dwordx4 v17, s[16:19], s72 offen offset:1024 lds
    v_mfma_f32_16x16x32_bf16 v[124:127], a[40:43], a[132:135], v[124:127]
    ds_read_b64_tr_b16 a[28:29], v9 offset:9344
    ds_read_b64 v[132:133], v26 offset:64
    v_mfma_f32_16x16x32_bf16 v[124:127], a[44:47], a[140:143], v[124:127]
    s_waitcnt lgkmcnt(10)
    ds_read_b64_tr_b16 a[30:31], v9 offset:46784
    v_mfma_f32_16x16x32_bf16 v[32:35], a[0:3], a[144:147], v[32:35]
    ds_read_b64_tr_b16 a[32:33], v2 offset:2048
    v_add_u32 v26, 0, v1
    v_mfma_f32_16x16x32_bf16 v[32:35], a[4:7], a[152:155], v[32:35]
    s_add_u32 m0, s67, 24576
    ds_read_b64_tr_b16 a[34:35], v2 offset:39488
    v_mfma_f32_16x16x32_bf16 v[36:39], a[0:3], a[148:151], v[36:39]
    s_add_u32 s72, s84, 147456
    ds_read_b64_tr_b16 a[36:37], v6 offset:11392
    buffer_load_dwordx4 v16, s[16:19], s72 offen lds
    v_mfma_f32_16x16x32_bf16 v[36:39], a[4:7], a[156:159], v[36:39]
    ds_read_b64_tr_b16 a[38:39], v6 offset:48832
    v_mul_u32_u24 v27, 10923, v26
    v_mfma_f32_16x16x32_bf16 v[40:43], a[8:11], a[144:147], v[40:43]
    ds_read_b64_tr_b16 a[40:41], v3 offset:2048
    v_mfma_f32_16x16x32_bf16 v[40:43], a[12:15], a[152:155], v[40:43]
    ds_read_b64_tr_b16 a[42:43], v3 offset:39488
    v_mfma_f32_16x16x32_bf16 v[44:47], a[8:11], a[148:151], v[44:47]
    s_add_u32 s70, s76, 12288
    ds_read_b64_tr_b16 a[44:45], v7 offset:11392
    buffer_load_dwordx4 a[48:51], v18, s[20:23], s70 offen offset:0 sc1
    v_mfma_f32_16x16x32_bf16 v[44:47], a[12:15], a[156:159], v[44:47]
    s_waitcnt lgkmcnt(7)
    ds_read_b64_tr_b16 a[46:47], v7 offset:48832
    v_lshrrev_b32 v27, 16, v27
    v_mfma_f32_16x16x32_bf16 v[48:51], a[16:19], a[144:147], v[48:51]
    ds_read_b64_tr_b16 a[0:1], v4 offset:2048
    v_mfma_f32_16x16x32_bf16 v[48:51], a[20:23], a[152:155], v[48:51]
    ds_read_b64_tr_b16 a[2:3], v4 offset:39488
    v_mfma_f32_16x16x32_bf16 v[52:55], a[16:19], a[148:151], v[52:55]
    ds_read_b64_tr_b16 a[4:5], v8 offset:11392
    buffer_load_dwordx4 v17, s[16:19], s72 offen offset:1024 lds
    v_mfma_f32_16x16x32_bf16 v[52:55], a[20:23], a[156:159], v[52:55]
    ds_read_b64_tr_b16 a[6:7], v8 offset:48832
    v_mul_u32_u24 v27, 1056, v27
    v_mfma_f32_16x16x32_bf16 v[56:59], a[24:27], a[144:147], v[56:59]
    ds_read_b64_tr_b16 a[8:9], v5 offset:2048
    v_mfma_f32_16x16x32_bf16 v[56:59], a[28:31], a[152:155], v[56:59]
    ds_read_b64_tr_b16 a[10:11], v5 offset:39488
    v_add_u32 v14, v27, v18
    v_mfma_f32_16x16x32_bf16 v[60:63], a[24:27], a[148:151], v[60:63]
    ds_read_b64_tr_b16 a[12:13], v9 offset:11392
    v_mfma_f32_16x16x32_bf16 v[60:63], a[28:31], a[156:159], v[60:63]
    s_waitcnt lgkmcnt(7)
    ds_read_b64_tr_b16 a[14:15], v9 offset:48832
    buffer_load_dwordx4 a[52:55], v18, s[20:23], s70 offen offset:1024 sc1
    v_mfma_f32_16x16x32_bf16 v[64:67], a[32:35], a[144:147], v[64:67]
    ds_read_b64_tr_b16 a[16:17], v2 offset:4096
    v_mfma_f32_16x16x32_bf16 v[64:67], a[36:39], a[152:155], v[64:67]
    ds_read_b64_tr_b16 a[18:19], v2 offset:41536
    v_add_u32 v26, 64, v1
    v_mfma_f32_16x16x32_bf16 v[68:71], a[32:35], a[148:151], v[68:71]
    s_add_u32 m0, s67, 26624
    ds_read_b64_tr_b16 a[20:21], v6 offset:13440
    v_mfma_f32_16x16x32_bf16 v[68:71], a[36:39], a[156:159], v[68:71]
    s_add_u32 s72, s84, 147584
    ds_read_b64_tr_b16 a[22:23], v6 offset:50880
    buffer_load_dwordx4 v16, s[16:19], s72 offen lds
    v_mfma_f32_16x16x32_bf16 v[72:75], a[40:43], a[144:147], v[72:75]
    ds_read_b64_tr_b16 a[24:25], v3 offset:4096
    v_mul_u32_u24 v27, 10923, v26
    v_mfma_f32_16x16x32_bf16 v[72:75], a[44:47], a[152:155], v[72:75]
    ds_read_b64_tr_b16 a[26:27], v3 offset:41536
    v_mfma_f32_16x16x32_bf16 v[76:79], a[40:43], a[148:151], v[76:79]
    ds_read_b64_tr_b16 a[28:29], v7 offset:13440
    v_mfma_f32_16x16x32_bf16 v[76:79], a[44:47], a[156:159], v[76:79]
    s_waitcnt lgkmcnt(7)
    ds_read_b64_tr_b16 a[30:31], v7 offset:50880
    v_mfma_f32_16x16x32_bf16 v[80:83], a[0:3], a[144:147], v[80:83]
    ds_read_b64_tr_b16 a[32:33], v4 offset:4096
    s_waitcnt vmcnt(17)
    s_add_u32 s71, s66, 3
    v_mov_b32 v22, s71
    buffer_store_dword v22, off, s[20:23], s90 sc1
    v_mfma_f32_16x16x32_bf16 v[80:83], a[4:7], a[152:155], v[80:83]
    ds_read_b64_tr_b16 a[34:35], v4 offset:41536
    v_lshrrev_b32 v27, 16, v27
    v_mfma_f32_16x16x32_bf16 v[84:87], a[0:3], a[148:151], v[84:87]
    ds_read_b64_tr_b16 a[36:37], v8 offset:13440
    v_mfma_f32_16x16x32_bf16 v[84:87], a[4:7], a[156:159], v[84:87]
    ds_read_b64_tr_b16 a[38:39], v8 offset:50880
    v_mul_u32_u24 v27, 1056, v27
    v_mfma_f32_16x16x32_bf16 v[88:91], a[8:11], a[144:147], v[88:91]
    ds_read_b64_tr_b16 a[40:41], v5 offset:4096
    buffer_load_dwordx4 v17, s[16:19], s72 offen offset:1024 lds
    v_mfma_f32_16x16x32_bf16 v[88:91], a[12:15], a[152:155], v[88:91]
    ds_read_b64_tr_b16 a[42:43], v5 offset:41536
    v_mfma_f32_16x16x32_bf16 v[92:95], a[8:11], a[148:151], v[92:95]
    ds_read_b64_tr_b16 a[44:45], v9 offset:13440
    v_add_u32 v15, v27, v18
    v_mfma_f32_16x16x32_bf16 v[92:95], a[12:15], a[156:159], v[92:95]
    s_waitcnt lgkmcnt(7)
    ds_read_b64_tr_b16 a[46:47], v9 offset:50880
    v_mfma_f32_16x16x32_bf16 v[96:99], a[16:19], a[144:147], v[96:99]
    s_barrier
    ds_read_b64_tr_b16 a[0:1], v2 offset:6144
    v_mfma_f32_16x16x32_bf16 v[96:99], a[20:23], a[152:155], v[96:99]
    ds_read_b64_tr_b16 a[2:3], v2 offset:43584
    buffer_load_dwordx4 a[56:59], v18, s[20:23], s70 offen offset:2048 sc1
    v_mfma_f32_16x16x32_bf16 v[100:103], a[16:19], a[148:151], v[100:103]
    ds_read_b64_tr_b16 a[4:5], v6 offset:15488
    v_add_u32 v26, 128, v1
    v_mfma_f32_16x16x32_bf16 v[100:103], a[20:23], a[156:159], v[100:103]
    ds_read_b64_tr_b16 a[6:7], v6 offset:52928
    v_mfma_f32_16x16x32_bf16 v[104:107], a[24:27], a[144:147], v[104:107]
    s_add_u32 m0, s67, 28672
    ds_read_b64_tr_b16 a[8:9], v3 offset:6144
    v_mfma_f32_16x16x32_bf16 v[104:107], a[28:31], a[152:155], v[104:107]
    s_add_u32 s72, s84, 147712
    ds_read_b64_tr_b16 a[10:11], v3 offset:43584
    buffer_load_dwordx4 v16, s[16:19], s72 offen lds
    v_mfma_f32_16x16x32_bf16 v[108:111], a[24:27], a[148:151], v[108:111]
    ds_read_b64_tr_b16 a[12:13], v7 offset:15488
    v_mul_u32_u24 v27, 10923, v26
    v_mfma_f32_16x16x32_bf16 v[108:111], a[28:31], a[156:159], v[108:111]
    s_waitcnt lgkmcnt(7)
    ds_read_b64_tr_b16 a[14:15], v7 offset:52928
    v_mfma_f32_16x16x32_bf16 v[112:115], a[32:35], a[144:147], v[112:115]
    ds_read_b64_tr_b16 a[16:17], v4 offset:6144
    v_mfma_f32_16x16x32_bf16 v[112:115], a[36:39], a[152:155], v[112:115]
    ds_read_b64_tr_b16 a[18:19], v4 offset:43584
    buffer_load_dwordx4 a[60:63], v18, s[20:23], s70 offen offset:3072 sc1
    v_mfma_f32_16x16x32_bf16 v[116:119], a[32:35], a[148:151], v[116:119]
    ds_read_b64_tr_b16 a[20:21], v8 offset:15488
    v_lshrrev_b32 v27, 16, v27
    v_mfma_f32_16x16x32_bf16 v[116:119], a[36:39], a[156:159], v[116:119]
    ds_read_b64_tr_b16 a[22:23], v8 offset:52928
    v_mfma_f32_16x16x32_bf16 v[120:123], a[40:43], a[144:147], v[120:123]
    ds_read_b64_tr_b16 a[24:25], v5 offset:6144
    v_mul_u32_u24 v27, 1056, v27
    v_mfma_f32_16x16x32_bf16 v[120:123], a[44:47], a[152:155], v[120:123]
    ds_read_b64_tr_b16 a[26:27], v5 offset:43584
    buffer_load_dwordx4 v17, s[16:19], s72 offen offset:1024 lds
    v_mfma_f32_16x16x32_bf16 v[124:127], a[40:43], a[148:151], v[124:127]
    ds_read_b64_tr_b16 a[28:29], v9 offset:15488
    v_mfma_f32_16x16x32_bf16 v[124:127], a[44:47], a[156:159], v[124:127]
    s_waitcnt lgkmcnt(7)
    ds_read_b64_tr_b16 a[30:31], v9 offset:52928
    v_mfma_f32_16x16x32_bf16 v[32:35], a[0:3], a[160:163], v[32:35]
    ds_read_b64_tr_b16 a[32:33], v2 offset:8192
    v_add_u32 v19, v27, v18
    v_mfma_f32_16x16x32_bf16 v[32:35], a[4:7], a[168:171], v[32:35]
    ds_read_b64_tr_b16 a[34:35], v2 offset:45632
    v_mfma_f32_16x16x32_bf16 v[36:39], a[0:3], a[164:167], v[36:39]
    ds_read_b64_tr_b16 a[36:37], v6 offset:17536
    v_mfma_f32_16x16x32_bf16 v[36:39], a[4:7], a[172:175], v[36:39]
    s_add_u32 m0, s67, 30720
    ds_read_b64_tr_b16 a[38:39], v6 offset:54976
    v_lshrrev_b32 v26, 2, v1
    v_mfma_f32_16x16x32_bf16 v[40:43], a[8:11], a[160:163], v[40:43]
    s_add_u32 s72, s85, 147456
    ds_read_b64_tr_b16 a[40:41], v3 offset:8192
    buffer_load_dwordx4 v16, s[16:19], s72 offen lds
    v_mfma_f32_16x16x32_bf16 v[40:43], a[12:15], a[168:171], v[40:43]
    ds_read_b64_tr_b16 a[42:43], v3 offset:45632
    v_mfma_f32_16x16x32_bf16 v[44:47], a[8:11], a[164:167], v[44:47]
    ds_read_b64_tr_b16 a[44:45], v7 offset:17536
    v_mfma_f32_16x16x32_bf16 v[44:47], a[12:15], a[172:175], v[44:47]
    s_waitcnt lgkmcnt(7)
    ds_read_b64_tr_b16 a[46:47], v7 offset:54976
    v_mul_u32_u24 v26, 96, v26
    v_mfma_f32_16x16x32_bf16 v[48:51], a[16:19], a[160:163], v[48:51]
    ds_read_b64_tr_b16 a[0:1], v4 offset:8192
    v_mfma_f32_16x16x32_bf16 v[48:51], a[20:23], a[168:171], v[48:51]
    ds_read_b64_tr_b16 a[2:3], v4 offset:45632
    v_mfma_f32_16x16x32_bf16 v[52:55], a[16:19], a[164:167], v[52:55]
    ds_read_b64_tr_b16 a[4:5], v8 offset:17536
    v_mfma_f32_16x16x32_bf16 v[52:55], a[20:23], a[172:175], v[52:55]
    ds_read_b64_tr_b16 a[6:7], v8 offset:54976
    v_and_b32 v27, 3, v1
    v_mfma_f32_16x16x32_bf16 v[56:59], a[24:27], a[160:163], v[56:59]
    ds_read_b64_tr_b16 a[8:9], v5 offset:8192
    buffer_load_dwordx4 v17, s[16:19], s72 offen offset:1024 lds
    v_mfma_f32_16x16x32_bf16 v[56:59], a[28:31], a[168:171], v[56:59]
    ds_read_b64_tr_b16 a[10:11], v5 offset:45632
    v_mfma_f32_16x16x32_bf16 v[60:63], a[24:27], a[164:167], v[60:63]
    ds_read_b64_tr_b16 a[12:13], v9 offset:17536
    v_lshl_add_u32 v29, v27, 3, v26
    v_mfma_f32_16x16x32_bf16 v[60:63], a[28:31], a[172:175], v[60:63]
    s_waitcnt lgkmcnt(7)
    ds_read_b64_tr_b16 a[14:15], v9 offset:54976
    v_mfma_f32_16x16x32_bf16 v[64:67], a[32:35], a[160:163], v[64:67]
    ds_read_b64_tr_b16 a[16:17], v2 offset:10240
    v_mfma_f32_16x16x32_bf16 v[64:67], a[36:39], a[168:171], v[64:67]
    ds_read_b64_tr_b16 a[18:19], v2 offset:47680
    v_mfma_f32_16x16x32_bf16 v[68:71], a[32:35], a[164:167], v[68:71]
    ds_read_b64_tr_b16 a[20:21], v6 offset:19584
    v_add_u32 v30, 0x10000, v29
    v_mfma_f32_16x16x32_bf16 v[68:71], a[36:39], a[172:175], v[68:71]
    s_add_u32 m0, s67, 32768
    ds_read_b64_tr_b16 a[22:23], v6 offset:57024
    v_mfma_f32_16x16x32_bf16 v[72:75], a[40:43], a[160:163], v[72:75]
    s_add_u32 s72, s85, 147584
    ds_read_b64_tr_b16 a[24:25], v3 offset:10240
    buffer_load_dwordx4 v16, s[16:19], s72 offen lds
    v_mfma_f32_16x16x32_bf16 v[72:75], a[44:47], a[168:171], v[72:75]
    ds_read_b64_tr_b16 a[26:27], v3 offset:47680
    v_mfma_f32_16x16x32_bf16 v[76:79], a[40:43], a[164:167], v[76:79]
    ds_read_b64_tr_b16 a[28:29], v7 offset:19584
    v_add_u32 v31, 0x20000, v29
    v_mfma_f32_16x16x32_bf16 v[76:79], a[44:47], a[172:175], v[76:79]
    s_waitcnt lgkmcnt(7)
    ds_read_b64_tr_b16 a[30:31], v7 offset:57024
    v_mfma_f32_16x16x32_bf16 v[80:83], a[0:3], a[160:163], v[80:83]
    ds_read_b64_tr_b16 a[32:33], v4 offset:10240
    v_mfma_f32_16x16x32_bf16 v[80:83], a[4:7], a[168:171], v[80:83]
    s_and_b32 s68, s62, 1
    ds_read_b64_tr_b16 a[34:35], v4 offset:47680
    v_mfma_f32_16x16x32_bf16 v[84:87], a[0:3], a[164:167], v[84:87]
    ds_read_b64_tr_b16 a[36:37], v8 offset:19584
    v_mfma_f32_16x16x32_bf16 v[84:87], a[4:7], a[172:175], v[84:87]
    ds_read_b64_tr_b16 a[38:39], v8 offset:57024
    v_mfma_f32_16x16x32_bf16 v[88:91], a[8:11], a[160:163], v[88:91]
    ds_read_b64_tr_b16 a[40:41], v5 offset:10240
    buffer_load_dwordx4 v17, s[16:19], s72 offen offset:1024 lds
    v_mfma_f32_16x16x32_bf16 v[88:91], a[12:15], a[168:171], v[88:91]
    s_mul_i32 s73, s68, 3072
    ds_read_b64_tr_b16 a[42:43], v5 offset:47680
    v_mfma_f32_16x16x32_bf16 v[92:95], a[8:11], a[164:167], v[92:95]
    ds_read_b64_tr_b16 a[44:45], v9 offset:19584
    v_mfma_f32_16x16x32_bf16 v[92:95], a[12:15], a[172:175], v[92:95]
    s_waitcnt vmcnt(25) lgkmcnt(7)
    ds_read_b64_tr_b16 a[46:47], v9 offset:57024
    v_mfma_f32_16x16x32_bf16 v[96:99], a[16:19], a[160:163], v[96:99]
    s_barrier
    ds_read_b64_tr_b16 a[0:1], v2 offset:12288
    v_mfma_f32_16x16x32_bf16 v[96:99], a[20:23], a[168:171], v[96:99]
    s_add_u32 s73, s73, 149760
    ds_read_b64_tr_b16 a[2:3], v2 offset:49728
    v_mfma_f32_16x16x32_bf16 v[100:103], a[16:19], a[164:167], v[100:103]
    ds_read_b64_tr_b16 a[4:5], v6 offset:21632
    v_mfma_f32_16x16x32_bf16 v[100:103], a[20:23], a[172:175], v[100:103]
    s_add_u32 m0, s67, 34816
    ds_read_b64_tr_b16 a[6:7], v6 offset:59072
    v_mfma_f32_16x16x32_bf16 v[104:107], a[24:27], a[160:163], v[104:107]
    s_add_u32 s72, s85, 147712
    ds_read_b64_tr_b16 a[8:9], v3 offset:12288
    buffer_load_dwordx4 v16, s[16:19], s72 offen lds
    v_mfma_f32_16x16x32_bf16 v[104:107], a[28:31], a[168:171], v[104:107]
    s_mul_i32 s3, s68, 36864
    ds_read_b64_tr_b16 a[10:11], v3 offset:49728
    v_mfma_f32_16x16x32_bf16 v[108:111], a[24:27], a[164:167], v[108:111]
    ds_read_b64_tr_b16 a[12:13], v7 offset:21632
    v_mfma_f32_16x16x32_bf16 v[108:111], a[28:31], a[172:175], v[108:111]
    s_waitcnt lgkmcnt(7)
    ds_read_b64_tr_b16 a[14:15], v7 offset:59072
    v_mfma_f32_16x16x32_bf16 v[112:115], a[32:35], a[160:163], v[112:115]
    s_add_u32 s3, s3, s88
    ds_read_b64_tr_b16 a[16:17], v4 offset:12288
    v_mfma_f32_16x16x32_bf16 v[112:115], a[36:39], a[168:171], v[112:115]
    ds_read_b64_tr_b16 a[18:19], v4 offset:49728
    v_mfma_f32_16x16x32_bf16 v[116:119], a[32:35], a[164:167], v[116:119]
    ds_read_b64_tr_b16 a[20:21], v8 offset:21632
    v_mfma_f32_16x16x32_bf16 v[116:119], a[36:39], a[172:175], v[116:119]
    ds_read_b64_tr_b16 a[22:23], v8 offset:59072
    v_mfma_f32_16x16x32_bf16 v[120:123], a[40:43], a[160:163], v[120:123]
    s_add_u32 s3, s3, 589824
    ds_read_b64_tr_b16 a[24:25], v5 offset:12288
    buffer_load_dwordx4 v17, s[16:19], s72 offen offset:1024 lds
    v_mfma_f32_16x16x32_bf16 v[120:123], a[44:47], a[168:171], v[120:123]
    ds_read_b64_tr_b16 a[26:27], v5 offset:49728
    v_mfma_f32_16x16x32_bf16 v[124:127], a[40:43], a[164:167], v[124:127]
    ds_read_b64_tr_b16 a[28:29], v9 offset:21632
    v_mfma_f32_16x16x32_bf16 v[124:127], a[44:47], a[172:175], v[124:127]
    s_waitcnt lgkmcnt(7)
    ds_read_b64_tr_b16 a[30:31], v9 offset:59072
    v_mfma_f32_16x16x32_bf16 v[32:35], a[0:3], a[176:179], v[32:35]
    ds_read_b64_tr_b16 a[32:33], v2 offset:14336
    v_mfma_f32_16x16x32_bf16 v[32:35], a[4:7], a[184:187], v[32:35]
    s_add_u32 m0, s67, 0
    ds_read_b64_tr_b16 a[34:35], v2 offset:51776
    v_mfma_f32_16x16x32_bf16 v[36:39], a[0:3], a[180:183], v[36:39]
    s_add_u32 s72, s84, 221184
    ds_read_b64_tr_b16 a[36:37], v6 offset:23680
    buffer_load_dwordx4 v16, s[16:19], s72 offen lds
    v_mfma_f32_16x16x32_bf16 v[36:39], a[4:7], a[188:191], v[36:39]
    ds_read_b64_tr_b16 a[38:39], v6 offset:61120
    v_mfma_f32_16x16x32_bf16 v[40:43], a[8:11], a[176:179], v[40:43]
    ds_read_b64_tr_b16 a[40:41], v3 offset:14336
    v_mfma_f32_16x16x32_bf16 v[40:43], a[12:15], a[184:187], v[40:43]
    ds_read_b64_tr_b16 a[42:43], v3 offset:51776
    v_mfma_f32_16x16x32_bf16 v[44:47], a[8:11], a[180:183], v[44:47]
L_pad_m2_2:
    s_cbranch_execz L_walk_ret
    ds_read_b64_tr_b16 a[44:45], v7 offset:23680
    buffer_load_dword v21, v20, s[20:23], 0 offen sc1
    v_mfma_f32_16x16x32_bf16 v[44:47], a[12:15], a[188:191], v[44:47]
    s_waitcnt lgkmcnt(7)
    ds_read_b64_tr_b16 a[46:47], v7 offset:61120
    v_mfma_f32_16x16x32_bf16 v[48:51], a[16:19], a[176:179], v[48:51]
    ds_read_b64_tr_b16 a[0:1], v4 offset:14336
    v_mfma_f32_16x16x32_bf16 v[48:51], a[20:23], a[184:187], v[48:51]
    ds_read_b64_tr_b16 a[2:3], v4 offset:51776
    v_mfma_f32_16x16x32_bf16 v[52:55], a[16:19], a[180:183], v[52:55]
    ds_read_b64_tr_b16 a[4:5], v8 offset:23680
    buffer_load_dwordx4 v17, s[16:19], s72 offen offset:1024 lds
    v_mfma_f32_16x16x32_bf16 v[52:55], a[20:23], a[188:191], v[52:55]
    ds_read_b64_tr_b16 a[6:7], v8 offset:61120
    v_mfma_f32_16x16x32_bf16 v[56:59], a[24:27], a[176:179], v[56:59]
    ds_read_b64_tr_b16 a[8:9], v5 offset:14336
    v_mfma_f32_16x16x32_bf16 v[56:59], a[28:31], a[184:187], v[56:59]
    ds_read_b64_tr_b16 a[10:11], v5 offset:51776
    v_mfma_f32_16x16x32_bf16 v[60:63], a[24:27], a[180:183], v[60:63]
    ds_read_b64_tr_b16 a[12:13], v9 offset:23680
    v_mfma_f32_16x16x32_bf16 v[60:63], a[28:31], a[188:191], v[60:63]
    s_waitcnt lgkmcnt(7)
    ds_read_b64_tr_b16 a[14:15], v9 offset:61120
    v_mfma_f32_16x16x32_bf16 v[64:67], a[32:35], a[176:179], v[64:67]
    s_add_u32 s70, s77, 12288
    ds_read_b64_tr_b16 a[16:17], v2 offset:16384
    buffer_load_dwordx4 a[64:67], v18, s[20:23], s70 offen offset:0 sc1
    v_mfma_f32_16x16x32_bf16 v[64:67], a[36:39], a[184:187], v[64:67]
    ds_read_b64_tr_b16 a[18:19], v2 offset:53824
    v_mfma_f32_16x16x32_bf16 v[68:71], a[32:35], a[180:183], v[68:71]
    s_add_u32 m0, s67, 2048
    ds_read_b64_tr_b16 a[20:21], v6 offset:25728
    v_mfma_f32_16x16x32_bf16 v[68:71], a[36:39], a[188:191], v[68:71]
    s_add_u32 s72, s84, 221312
    ds_read_b64_tr_b16 a[22:23], v6 offset:63168
    buffer_load_dwordx4 v16, s[16:19], s72 offen lds
    v_mfma_f32_16x16x32_bf16 v[72:75], a[40:43], a[176:179], v[72:75]
    ds_read_b64_tr_b16 a[24:25], v3 offset:16384
    v_mfma_f32_16x16x32_bf16 v[72:75], a[44:47], a[184:187], v[72:75]
    ds_read_b64_tr_b16 a[26:27], v3 offset:53824
    v_mfma_f32_16x16x32_bf16 v[76:79], a[40:43], a[180:183], v[76:79]
    ds_read_b64_tr_b16 a[28:29], v7 offset:25728
    v_mfma_f32_16x16x32_bf16 v[76:79], a[44:47], a[188:191], v[76:79]
    s_waitcnt lgkmcnt(7)
    ds_read_b64_tr_b16 a[30:31], v7 offset:63168
    v_mfma_f32_16x16x32_bf16 v[80:83], a[0:3], a[176:179], v[80:83]
    ds_read_b64_tr_b16 a[32:33], v4 offset:16384
    buffer_load_dwordx4 a[68:71], v18, s[20:23], s70 offen offset:1024 sc1
    v_mfma_f32_16x16x32_bf16 v[80:83], a[4:7], a[184:187], v[80:83]
    ds_read_b64_tr_b16 a[34:35], v4 offset:53824
    v_mfma_f32_16x16x32_bf16 v[84:87], a[0:3], a[180:183], v[84:87]
    ds_read_b64_tr_b16 a[36:37], v8 offset:25728
    v_mfma_f32_16x16x32_bf16 v[84:87], a[4:7], a[188:191], v[84:87]
    ds_read_b64_tr_b16 a[38:39], v8 offset:63168
    v_mfma_f32_16x16x32_bf16 v[88:91], a[8:11], a[176:179], v[88:91]
    ds_read_b64_tr_b16 a[40:41], v5 offset:16384
    buffer_load_dwordx4 v17, s[16:19], s72 offen offset:1024 lds
    v_mfma_f32_16x16x32_bf16 v[88:91], a[12:15], a[184:187], v[88:91]
    ds_read_b64_tr_b16 a[42:43], v5 offset:53824
    v_mfma_f32_16x16x32_bf16 v[92:95], a[8:11], a[180:183], v[92:95]
    ds_read_b64_tr_b16 a[44:45], v9 offset:25728
    v_mfma_f32_16x16x32_bf16 v[92:95], a[12:15], a[188:191], v[92:95]
    s_waitcnt vmcnt(24) lgkmcnt(7)
    ds_read_b64_tr_b16 a[46:47], v9 offset:63168
    v_mfma_f32_16x16x32_bf16 v[96:99], a[16:19], a[176:179], v[96:99]
    s_barrier
    ds_read_b64_tr_b16 a[0:1], v2 offset:18432
    v_mfma_f32_16x16x32_bf16 v[96:99], a[20:23], a[184:187], v[96:99]
    ds_read_b64_tr_b16 a[2:3], v2 offset:55872
    buffer_load_dwordx4 a[72:75], v18, s[20:23], s70 offen offset:2048 sc1
    v_mfma_f32_16x16x32_bf16 v[100:103], a[16:19], a[180:183], v[100:103]
    ds_read_b64_tr_b16 a[4:5], v6 offset:27776
    v_mfma_f32_16x16x32_bf16 v[100:103], a[20:23], a[188:191], v[100:103]
    ds_read_b64_tr_b16 a[6:7], v6 offset:65216
    v_mfma_f32_16x16x32_bf16 v[104:107], a[24:27], a[176:179], v[104:107]
    s_add_u32 m0, s67, 4096
    ds_read_b64_tr_b16 a[8:9], v3 offset:18432
    v_mfma_f32_16x16x32_bf16 v[104:107], a[28:31], a[184:187], v[104:107]
    s_add_u32 s72, s84, 221440
    ds_read_b64_tr_b16 a[10:11], v3 offset:55872
    buffer_load_dwordx4 v16, s[16:19], s72 offen lds
    v_mfma_f32_16x16x32_bf16 v[108:111], a[24:27], a[180:183], v[108:111]
    ds_read_b64_tr_b16 a[12:13], v7 offset:27776
    v_mfma_f32_16x16x32_bf16 v[108:111], a[28:31], a[188:191], v[108:111]
    s_waitcnt lgkmcnt(7)
    ds_read_b64_tr_b16 a[14:15], v7 offset:65216
    v_mfma_f32_16x16x32_bf16 v[112:115], a[32:35], a[176:179], v[112:115]
    ds_read_b64_tr_b16 a[16:17], v4 offset:18432
    v_mfma_f32_16x16x32_bf16 v[112:115], a[36:39], a[184:187], v[112:115]
    ds_read_b64_tr_b16 a[18:19], v4 offset:55872
    buffer_load_dwordx4 a[76:79], v18, s[20:23], s70 offen offset:3072 sc1
    v_mfma_f32_16x16x32_bf16 v[116:119], a[32:35], a[180:183], v[116:119]
    ds_read_b64_tr_b16 a[20:21], v8 offset:27776
    v_mfma_f32_16x16x32_bf16 v[116:119], a[36:39], a[188:191], v[116:119]
    ds_read_b64_tr_b16 a[22:23], v8 offset:65216
    v_mfma_f32_16x16x32_bf16 v[120:123], a[40:43], a[176:179], v[120:123]
    ds_read_b64_tr_b16 a[24:25], v5 offset:18432
    v_mfma_f32_16x16x32_bf16 v[120:123], a[44:47], a[184:187], v[120:123]
    ds_read_b64_tr_b16 a[26:27], v5 offset:55872
    buffer_load_dwordx4 v17, s[16:19], s72 offen offset:1024 lds
    v_mfma_f32_16x16x32_bf16 v[124:127], a[40:43], a[180:183], v[124:127]
    ds_read_b64_tr_b16 a[28:29], v9 offset:27776
    v_mfma_f32_16x16x32_bf16 v[124:127], a[44:47], a[188:191], v[124:127]
    s_waitcnt lgkmcnt(7)
    ds_read_b64_tr_b16 a[30:31], v9 offset:65216
    v_mfma_f32_16x16x32_bf16 v[32:35], a[0:3], a[192:195], v[32:35]
    ds_read_b64_tr_b16 a[32:33], v2 offset:20480
    v_lshlrev_b32 v26, 16, v128
    v_mfma_f32_16x16x32_bf16 v[32:35], a[4:7], a[200:203], v[32:35]
    s_add_u32 m0, s67, 6144
    ds_read_b64_tr_b16 a[34:35], v2 offset:57920
    v_mfma_f32_16x16x32_bf16 v[36:39], a[0:3], a[196:199], v[36:39]
    s_add_u32 s72, s85, 221184
    ds_read_b64_tr_b16 a[36:37], v6 offset:29824
    buffer_load_dwordx4 v16, s[16:19], s72 offen lds
    v_mfma_f32_16x16x32_bf16 v[36:39], a[4:7], a[204:207], v[36:39]
    ds_read_b64_tr_b16 a[38:39], v10 offset:1728
    v_and_b32 v27, 0xffff0000, v128
    v_mfma_f32_16x16x32_bf16 v[40:43], a[8:11], a[192:195], v[40:43]
    ds_read_b64_tr_b16 a[40:41], v3 offset:20480
    v_mfma_f32_16x16x32_bf16 v[40:43], a[12:15], a[200:203], v[40:43]
    ds_read_b64_tr_b16 a[42:43], v3 offset:57920
    v_accvgpr_read_b32 v28, a244
    v_mfma_f32_16x16x32_bf16 v[44:47], a[8:11], a[196:199], v[44:47]
    ds_read_b64_tr_b16 a[44:45], v7 offset:29824
    s_add_u32 s71, s66, 3
    s_waitcnt vmcnt(10)
    v_subrev_u32 v21, s71, v21
    v_cmp_gt_u32 vcc, 8, v21
    s_nop 0
    s_cmp_eq_u64 vcc, exec
    s_cbranch_scc0 L_slow_7
L_back_8:
    v_mfma_f32_16x16x32_bf16 v[44:47], a[12:15], a[204:207], v[44:47]
    s_waitcnt lgkmcnt(7)
    ds_read_b64_tr_b16 a[46:47], v11 offset:1728
    v_mfma_f32_16x16x32_bf16 v[48:51], a[16:19], a[192:195], v[48:51]
    s_add_u32 s70, s76, 16384
    ds_read_b64_tr_b16 a[0:1], v4 offset:20480
    buffer_load_dwordx4 a[80:83], v18, s[20:23], s70 offen offset:0 sc1
    v_mfma_f32_16x16x32_bf16 v[48:51], a[20:23], a[200:203], v[48:51]
    ds_read_b64_tr_b16 a[2:3], v4 offset:57920
    v_lshlrev_b32 v142, 16, v28
    v_mfma_f32_16x16x32_bf16 v[52:55], a[16:19], a[196:199], v[52:55]
    ds_read_b64_tr_b16 a[4:5], v8 offset:29824
    v_and_b32 v143, 0xffff0000, v28
    v_mfma_f32_16x16x32_bf16 v[52:55], a[20:23], a[204:207], v[52:55]
    ds_read_b64_tr_b16 a[6:7], v12 offset:1728
    v_mfma_f32_16x16x32_bf16 v[56:59], a[24:27], a[192:195], v[56:59]
    ds_read_b64_tr_b16 a[8:9], v5 offset:20480
    buffer_load_dwordx4 v17, s[16:19], s72 offen offset:1024 lds
    v_mfma_f32_16x16x32_bf16 v[56:59], a[28:31], a[200:203], v[56:59]
    ds_read_b64_tr_b16 a[10:11], v5 offset:57920
    v_add_f32 v142, v142, v26
    v_mfma_f32_16x16x32_bf16 v[60:63], a[24:27], a[196:199], v[60:63]
    ds_read_b64_tr_b16 a[12:13], v9 offset:29824
    v_mfma_f32_16x16x32_bf16 v[60:63], a[28:31], a[204:207], v[60:63]
    s_waitcnt lgkmcnt(7)
    ds_read_b64_tr_b16 a[14:15], v13 offset:1728
    v_mfma_f32_16x16x32_bf16 v[64:67], a[32:35], a[192:195], v[64:67]
    ds_read_b64_tr_b16 a[16:17], v2 offset:22528
    buffer_load_dwordx4 a[84:87], v18, s[20:23], s70 offen offset:1024 sc1
    v_mfma_f32_16x16x32_bf16 v[64:67], a[36:39], a[200:203], v[64:67]
    ds_read_b64_tr_b16 a[18:19], v2 offset:59968
    v_add_f32 v143, v143, v27
    v_mfma_f32_16x16x32_bf16 v[68:71], a[32:35], a[196:199], v[68:71]
    ds_read_b64_tr_b16 a[20:21], v6 offset:31872
    v_accvgpr_read_b32 v28, a246
    v_mfma_f32_16x16x32_bf16 v[68:71], a[36:39], a[204:207], v[68:71]
    ds_read_b64_tr_b16 a[22:23], v10 offset:3776
    v_mfma_f32_16x16x32_bf16 v[72:75], a[40:43], a[192:195], v[72:75]
    s_add_u32 m0, s67, 8192
    ds_read_b64_tr_b16 a[24:25], v3 offset:22528
    v_mfma_f32_16x16x32_bf16 v[72:75], a[44:47], a[200:203], v[72:75]
    s_add_u32 s72, s85, 221312
    ds_read_b64_tr_b16 a[26:27], v3 offset:59968
    buffer_load_dwordx4 v16, s[16:19], s72 offen lds
    v_mfma_f32_16x16x32_bf16 v[76:79], a[40:43], a[196:199], v[76:79]
    ds_read_b64_tr_b16 a[28:29], v7 offset:31872
    v_lshlrev_b32 v146, 16, v28
    v_mfma_f32_16x16x32_bf16 v[76:79], a[44:47], a[204:207], v[76:79]
    s_waitcnt lgkmcnt(7)
    ds_read_b64_tr_b16 a[30:31], v11 offset:3776
    v_mfma_f32_16x16x32_bf16 v[80:83], a[0:3], a[192:195], v[80:83]
    ds_read_b64_tr_b16 a[32:33], v4 offset:22528
    v_and_b32 v147, 0xffff0000, v28
    v_mfma_f32_16x16x32_bf16 v[80:83], a[4:7], a[200:203], v[80:83]
    ds_read_b64_tr_b16 a[34:35], v4 offset:59968
    v_mfma_f32_16x16x32_bf16 v[84:87], a[0:3], a[196:199], v[84:87]
    ds_read_b64_tr_b16 a[36:37], v8 offset:31872
    buffer_load_dwordx4 v17, s[16:19], s72 offen offset:1024 lds
    v_mfma_f32_16x16x32_bf16 v[84:87], a[4:7], a[204:207], v[84:87]
    ds_read_b64_tr_b16 a[38:39], v12 offset:3776
    v_add_f32 v146, v146, v26
    v_mfma_f32_16x16x32_bf16 v[88:91], a[8:11], a[192:195], v[88:91]
    ds_read_b64_tr_b16 a[40:41], v5 offset:22528
    v_mfma_f32_16x16x32_bf16 v[88:91], a[12:15], a[200:203], v[88:91]
    ds_read_b64_tr_b16 a[42:43], v5 offset:59968
    v_add_f32 v147, v147, v27
    v_mfma_f32_16x16x32_bf16 v[92:95], a[8:11], a[196:199], v[92:95]
    ds_read_b64_tr_b16 a[44:45], v9 offset:31872
    v_mfma_f32_16x16x32_bf16 v[92:95], a[12:15], a[204:207], v[92:95]
    s_waitcnt lgkmcnt(7)
    ds_read_b64_tr_b16 a[46:47], v13 offset:3776
    buffer_load_dwordx4 a[88:91], v18, s[20:23], s70 offen offset:2048 sc1
    v_mfma_f32_16x16x32_bf16 v[96:99], a[16:19], a[192:195], v[96:99]
    s_barrier
    ds_read_b64_tr_b16 a[0:1], v2 offset:24576
    v_mfma_f32_16x16x32_bf16 v[96:99], a[20:23], a[200:203], v[96:99]
    ds_read_b64_tr_b16 a[2:3], v2 offset:62016
    v_lshlrev_b32 v26, 16, v129
    v_mfma_f32_16x16x32_bf16 v[100:103], a[16:19], a[196:199], v[100:103]
    ds_read_b64_tr_b16 a[4:5], v6 offset:33920
    v_and_b32 v27, 0xffff0000, v129
    v_mfma_f32_16x16x32_bf16 v[100:103], a[20:23], a[204:207], v[100:103]
    s_add_u32 m0, s67, 10240
    ds_read_b64_tr_b16 a[6:7], v10 offset:5824
    v_mfma_f32_16x16x32_bf16 v[104:107], a[24:27], a[192:195], v[104:107]
    s_add_u32 s72, s85, 221440
    ds_read_b64_tr_b16 a[8:9], v3 offset:24576
    buffer_load_dwordx4 v16, s[16:19], s72 offen lds
    v_mfma_f32_16x16x32_bf16 v[104:107], a[28:31], a[200:203], v[104:107]
    ds_read_b64_tr_b16 a[10:11], v3 offset:62016
    v_accvgpr_read_b32 v28, a245
    v_mfma_f32_16x16x32_bf16 v[108:111], a[24:27], a[196:199], v[108:111]
    ds_read_b64_tr_b16 a[12:13], v7 offset:33920
    v_mfma_f32_16x16x32_bf16 v[108:111], a[28:31], a[204:207], v[108:111]
    s_waitcnt lgkmcnt(7)
    ds_read_b64_tr_b16 a[14:15], v11 offset:5824
    v_mfma_f32_16x16x32_bf16 v[112:115], a[32:35], a[192:195], v[112:115]
    ds_read_b64_tr_b16 a[16:17], v4 offset:24576
    buffer_load_dwordx4 a[92:95], v18, s[20:23], s70 offen offset:3072 sc1
    v_mfma_f32_16x16x32_bf16 v[112:115], a[36:39], a[200:203], v[112:115]
    ds_read_b64_tr_b16 a[18:19], v4 offset:62016
    v_lshlrev_b32 v144, 16, v28
    v_mfma_f32_16x16x32_bf16 v[116:119], a[32:35], a[196:199], v[116:119]
    ds_read_b64_tr_b16 a[20:21], v8 offset:33920
    v_and_b32 v145, 0xffff0000, v28
    v_mfma_f32_16x16x32_bf16 v[116:119], a[36:39], a[204:207], v[116:119]
    ds_read_b64_tr_b16 a[22:23], v12 offset:5824
    v_mfma_f32_16x16x32_bf16 v[120:123], a[40:43], a[192:195], v[120:123]
    ds_read_b64_tr_b16 a[24:25], v5 offset:24576
    v_mfma_f32_16x16x32_bf16 v[120:123], a[44:47], a[200:203], v[120:123]
    ds_read_b64_tr_b16 a[26:27], v5 offset:62016
    buffer_load_dwordx4 v17, s[16:19], s72 offen offset:1024 lds
    v_mfma_f32_16x16x32_bf16 v[124:127], a[40:43], a[196:199], v[124:127]
    ds_read_b64_tr_b16 a[28:29], v9 offset:33920
    v_add_f32 v144, v144, v26
    v_mfma_f32_16x16x32_bf16 v[124:127], a[44:47], a[204:207], v[124:127]
    s_waitcnt lgkmcnt(7)
    ds_read_b64_tr_b16 a[30:31], v13 offset:5824
    v_mfma_f32_16x16x32_bf16 v[32:35], a[0:3], a[208:211], v[32:35]
    ds_read_b64_tr_b16 a[32:33], v2 offset:26624
    v_add_f32 v145, v145, v27
    v_mfma_f32_16x16x32_bf16 v[32:35], a[4:7], a[216:219], v[32:35]
    s_add_u32 m0, s67, 12288
    ds_read_b64_tr_b16 a[34:35], v2 offset:64064
    v_mfma_f32_16x16x32_bf16 v[36:39], a[0:3], a[212:215], v[36:39]
    s_add_u32 s72, s84, 294912
    ds_read_b64_tr_b16 a[36:37], v6 offset:35968
    buffer_load_dwordx4 v16, s[16:19], s72 offen lds
    v_mfma_f32_16x16x32_bf16 v[36:39], a[4:7], a[220:223], v[36:39]
    ds_read_b64_tr_b16 a[38:39], v10 offset:7872
    v_accvgpr_read_b32 v28, a247
    v_mfma_f32_16x16x32_bf16 v[40:43], a[8:11], a[208:211], v[40:43]
    ds_read_b64_tr_b16 a[40:41], v3 offset:26624
    v_mfma_f32_16x16x32_bf16 v[40:43], a[12:15], a[216:219], v[40:43]
    ds_read_b64_tr_b16 a[42:43], v3 offset:64064
    v_lshlrev_b32 v148, 16, v28
    v_mfma_f32_16x16x32_bf16 v[44:47], a[8:11], a[212:215], v[44:47]
    ds_read_b64_tr_b16 a[44:45], v7 offset:35968
    v_mfma_f32_16x16x32_bf16 v[44:47], a[12:15], a[220:223], v[44:47]
    s_waitcnt lgkmcnt(7)
    ds_read_b64_tr_b16 a[46:47], v11 offset:7872
    v_mfma_f32_16x16x32_bf16 v[48:51], a[16:19], a[208:211], v[48:51]
    s_add_u32 s70, s77, 16384
    ds_read_b64_tr_b16 a[0:1], v4 offset:26624
    buffer_load_dwordx4 a[96:99], v18, s[20:23], s70 offen offset:0 sc1
    v_mfma_f32_16x16x32_bf16 v[48:51], a[20:23], a[216:219], v[48:51]
    ds_read_b64_tr_b16 a[2:3], v4 offset:64064
    v_and_b32 v149, 0xffff0000, v28
    v_mfma_f32_16x16x32_bf16 v[52:55], a[16:19], a[212:215], v[52:55]
    ds_read_b64_tr_b16 a[4:5], v8 offset:35968
    v_add_f32 v148, v148, v26
    v_mfma_f32_16x16x32_bf16 v[52:55], a[20:23], a[220:223], v[52:55]
    ds_read_b64_tr_b16 a[6:7], v12 offset:7872
    v_mfma_f32_16x16x32_bf16 v[56:59], a[24:27], a[208:211], v[56:59]
    ds_read_b64_tr_b16 a[8:9], v5 offset:26624
    buffer_load_dwordx4 v17, s[16:19], s72 offen offset:1024 lds
    v_mfma_f32_16x16x32_bf16 v[56:59], a[28:31], a[216:219], v[56:59]
    ds_read_b64_tr_b16 a[10:11], v5 offset:64064
    v_add_f32 v149, v149, v27
    v_mfma_f32_16x16x32_bf16 v[60:63], a[24:27], a[212:215], v[60:63]
    ds_read_b64_tr_b16 a[12:13], v9 offset:35968
    v_mfma_f32_16x16x32_bf16 v[60:63], a[28:31], a[220:223], v[60:63]
    s_waitcnt lgkmcnt(7)
    ds_read_b64_tr_b16 a[14:15], v13 offset:7872
    v_mfma_f32_16x16x32_bf16 v[64:67], a[32:35], a[208:211], v[64:67]
    ds_read_b64_tr_b16 a[16:17], v2 offset:28672
    buffer_load_dwordx4 a[100:103], v18, s[20:23], s70 offen offset:1024 sc1
    v_mfma_f32_16x16x32_bf16 v[64:67], a[36:39], a[216:219], v[64:67]
    ds_read_b64_tr_b16 a[18:19], v6 offset:576
    v_lshlrev_b32 v26, 16, v130
    v_mfma_f32_16x16x32_bf16 v[68:71], a[32:35], a[212:215], v[68:71]
    ds_read_b64_tr_b16 a[20:21], v6 offset:38016
    v_and_b32 v27, 0xffff0000, v130
    v_mfma_f32_16x16x32_bf16 v[68:71], a[36:39], a[220:223], v[68:71]
    ds_read_b64_tr_b16 a[22:23], v10 offset:9920
    v_mfma_f32_16x16x32_bf16 v[72:75], a[40:43], a[208:211], v[72:75]
    s_add_u32 m0, s67, 14336
    ds_read_b64_tr_b16 a[24:25], v3 offset:28672
    v_mfma_f32_16x16x32_bf16 v[72:75], a[44:47], a[216:219], v[72:75]
    s_add_u32 s72, s84, 295040
    ds_read_b64_tr_b16 a[26:27], v7 offset:576
    buffer_load_dwordx4 v16, s[16:19], s72 offen lds
    v_mfma_f32_16x16x32_bf16 v[76:79], a[40:43], a[212:215], v[76:79]
    ds_read_b64_tr_b16 a[28:29], v7 offset:38016
    v_accvgpr_read_b32 v28, a248
    v_mfma_f32_16x16x32_bf16 v[76:79], a[44:47], a[220:223], v[76:79]
    s_waitcnt lgkmcnt(7)
    ds_read_b64_tr_b16 a[30:31], v11 offset:9920
    v_mfma_f32_16x16x32_bf16 v[80:83], a[0:3], a[208:211], v[80:83]
    ds_read_b64_tr_b16 a[32:33], v4 offset:28672
    v_lshlrev_b32 v150, 16, v28
    v_mfma_f32_16x16x32_bf16 v[80:83], a[4:7], a[216:219], v[80:83]
    ds_read_b64_tr_b16 a[34:35], v8 offset:576
    v_mfma_f32_16x16x32_bf16 v[84:87], a[0:3], a[212:215], v[84:87]
    ds_read_b64_tr_b16 a[36:37], v8 offset:38016
    buffer_load_dwordx4 v17, s[16:19], s72 offen offset:1024 lds
    v_mfma_f32_16x16x32_bf16 v[84:87], a[4:7], a[220:223], v[84:87]
    ds_read_b64_tr_b16 a[38:39], v12 offset:9920
    v_and_b32 v151, 0xffff0000, v28
    v_mfma_f32_16x16x32_bf16 v[88:91], a[8:11], a[208:211], v[88:91]
    ds_read_b64_tr_b16 a[40:41], v5 offset:28672
    v_mfma_f32_16x16x32_bf16 v[88:91], a[12:15], a[216:219], v[88:91]
    ds_read_b64_tr_b16 a[42:43], v9 offset:576
    v_add_f32 v150, v150, v26
    v_mfma_f32_16x16x32_bf16 v[92:95], a[8:11], a[212:215], v[92:95]
    ds_read_b64_tr_b16 a[44:45], v9 offset:38016
    v_mfma_f32_16x16x32_bf16 v[92:95], a[12:15], a[220:223], v[92:95]
    s_waitcnt lgkmcnt(7)
    ds_read_b64_tr_b16 a[46:47], v13 offset:9920
    buffer_load_dwordx4 a[104:107], v18, s[20:23], s70 offen offset:2048 sc1
    v_mfma_f32_16x16x32_bf16 v[96:99], a[16:19], a[208:211], v[96:99]
    s_barrier
    ds_read_b64_tr_b16 a[0:1], v2 offset:30720
    v_mfma_f32_16x16x32_bf16 v[96:99], a[20:23], a[216:219], v[96:99]
    ds_read_b64_tr_b16 a[2:3], v6 offset:2624
    v_add_f32 v151, v151, v27
    v_mfma_f32_16x16x32_bf16 v[100:103], a[16:19], a[212:215], v[100:103]
    ds_read_b64_tr_b16 a[4:5], v6 offset:40064
    v_accvgpr_read_b32 v28, a250
    v_mfma_f32_16x16x32_bf16 v[100:103], a[20:23], a[220:223], v[100:103]
    s_add_u32 m0, s67, 16384
    ds_read_b64_tr_b16 a[6:7], v10 offset:11968
    v_mfma_f32_16x16x32_bf16 v[104:107], a[24:27], a[208:211], v[104:107]
    s_add_u32 s72, s84, 295168
    ds_read_b64_tr_b16 a[8:9], v3 offset:30720
    buffer_load_dwordx4 v16, s[16:19], s72 offen lds
    v_mfma_f32_16x16x32_bf16 v[104:107], a[28:31], a[216:219], v[104:107]
    ds_read_b64_tr_b16 a[10:11], v7 offset:2624
    v_lshlrev_b32 v154, 16, v28
    v_mfma_f32_16x16x32_bf16 v[108:111], a[24:27], a[212:215], v[108:111]
    ds_read_b64_tr_b16 a[12:13], v7 offset:40064
    v_mfma_f32_16x16x32_bf16 v[108:111], a[28:31], a[220:223], v[108:111]
    s_waitcnt lgkmcnt(7)
    ds_read_b64_tr_b16 a[14:15], v11 offset:11968
    v_mfma_f32_16x16x32_bf16 v[112:115], a[32:35], a[208:211], v[112:115]
    ds_read_b64_tr_b16 a[16:17], v4 offset:30720
    buffer_load_dwordx4 a[108:111], v18, s[20:23], s70 offen offset:3072 sc1
    v_mfma_f32_16x16x32_bf16 v[112:115], a[36:39], a[216:219], v[112:115]
    ds_read_b64_tr_b16 a[18:19], v8 offset:2624
    v_and_b32 v155, 0xffff0000, v28
    v_mfma_f32_16x16x32_bf16 v[116:119], a[32:35], a[212:215], v[116:119]
    ds_read_b64_tr_b16 a[20:21], v8 offset:40064
    v_add_f32 v154, v154, v26
    v_mfma_f32_16x16x32_bf16 v[116:119], a[36:39], a[220:223], v[116:119]
    ds_read_b64_tr_b16 a[22:23], v12 offset:11968
    v_mfma_f32_16x16x32_bf16 v[120:123], a[40:43], a[208:211], v[120:123]
    ds_read_b64_tr_b16 a[24:25], v5 offset:30720
    v_mfma_f32_16x16x32_bf16 v[120:123], a[44:47], a[216:219], v[120:123]
    ds_read_b64_tr_b16 a[26:27], v9 offset:2624
    buffer_load_dwordx4 v17, s[16:19], s72 offen offset:1024 lds
    v_mfma_f32_16x16x32_bf16 v[124:127], a[40:43], a[212:215], v[124:127]
    ds_read_b64_tr_b16 a[28:29], v9 offset:40064
    v_add_f32 v155, v155, v27
    v_mfma_f32_16x16x32_bf16 v[124:127], a[44:47], a[220:223], v[124:127]
    s_waitcnt lgkmcnt(7)
    ds_read_b64_tr_b16 a[30:31], v13 offset:11968
    v_mfma_f32_16x16x32_bf16 v[32:35], a[0:3], a[224:227], v[32:35]
    ds_read_b64_tr_b16 a[32:33], v2 offset:32768
    v_lshlrev_b32 v26, 16, v131
    v_mfma_f32_16x16x32_bf16 v[32:35], a[4:7], a[232:235], v[32:35]
    s_add_u32 m0, s67, 18432
    ds_read_b64_tr_b16 a[34:35], v6 offset:4672
    v_mfma_f32_16x16x32_bf16 v[36:39], a[0:3], a[228:231], v[36:39]
    s_add_u32 s72, s85, 294912
    ds_read_b64_tr_b16 a[36:37], v6 offset:42112
    buffer_load_dwordx4 v16, s[16:19], s72 offen lds
    v_mfma_f32_16x16x32_bf16 v[36:39], a[4:7], a[236:239], v[36:39]
    ds_read_b64_tr_b16 a[38:39], v10 offset:14016
    v_and_b32 v27, 0xffff0000, v131
    v_mfma_f32_16x16x32_bf16 v[40:43], a[8:11], a[224:227], v[40:43]
    ds_read_b64_tr_b16 a[40:41], v3 offset:32768
    v_mfma_f32_16x16x32_bf16 v[40:43], a[12:15], a[232:235], v[40:43]
    ds_read_b64_tr_b16 a[42:43], v7 offset:4672
    v_accvgpr_read_b32 v28, a249
    v_mfma_f32_16x16x32_bf16 v[44:47], a[8:11], a[228:231], v[44:47]
    ds_read_b64_tr_b16 a[44:45], v7 offset:42112
    v_mfma_f32_16x16x32_bf16 v[44:47], a[12:15], a[236:239], v[44:47]
    s_waitcnt lgkmcnt(7)
    ds_read_b64_tr_b16 a[46:47], v11 offset:14016
    v_mfma_f32_16x16x32_bf16 v[48:51], a[16:19], a[224:227], v[48:51]
    s_add_u32 s70, s76, 20480
    ds_read_b64_tr_b16 a[0:1], v4 offset:32768
    buffer_load_dwordx4 a[112:115], v18, s[20:23], s70 offen offset:0 sc1
    v_mfma_f32_16x16x32_bf16 v[48:51], a[20:23], a[232:235], v[48:51]
    ds_read_b64_tr_b16 a[2:3], v8 offset:4672
    v_lshlrev_b32 v152, 16, v28
    v_mfma_f32_16x16x32_bf16 v[52:55], a[16:19], a[228:231], v[52:55]
    ds_read_b64_tr_b16 a[4:5], v8 offset:42112
    v_and_b32 v153, 0xffff0000, v28
    v_mfma_f32_16x16x32_bf16 v[52:55], a[20:23], a[236:239], v[52:55]
    ds_read_b64_tr_b16 a[6:7], v12 offset:14016
    v_mfma_f32_16x16x32_bf16 v[56:59], a[24:27], a[224:227], v[56:59]
    ds_read_b64_tr_b16 a[8:9], v5 offset:32768
    buffer_load_dwordx4 v17, s[16:19], s72 offen offset:1024 lds
    v_mfma_f32_16x16x32_bf16 v[56:59], a[28:31], a[232:235], v[56:59]
    ds_read_b64_tr_b16 a[10:11], v9 offset:4672
    v_add_f32 v152, v152, v26
    v_mfma_f32_16x16x32_bf16 v[60:63], a[24:27], a[228:231], v[60:63]
    ds_read_b64_tr_b16 a[12:13], v9 offset:42112
    v_mfma_f32_16x16x32_bf16 v[60:63], a[28:31], a[236:239], v[60:63]
    s_waitcnt lgkmcnt(7)
    ds_read_b64_tr_b16 a[14:15], v13 offset:14016
    v_mfma_f32_16x16x32_bf16 v[64:67], a[32:35], a[224:227], v[64:67]
    ds_read_b64_tr_b16 a[16:17], v2 offset:34816
    buffer_load_dwordx4 a[116:119], v18, s[20:23], s70 offen offset:1024 sc1
    v_mfma_f32_16x16x32_bf16 v[64:67], a[36:39], a[232:235], v[64:67]
    ds_read_b64_tr_b16 a[18:19], v6 offset:6720
    v_add_f32 v153, v153, v27
    v_mfma_f32_16x16x32_bf16 v[68:71], a[32:35], a[228:231], v[68:71]
    ds_read_b64_tr_b16 a[20:21], v6 offset:44160
    v_accvgpr_read_b32 v28, a251
    v_mfma_f32_16x16x32_bf16 v[68:71], a[36:39], a[236:239], v[68:71]
    ds_read_b64_tr_b16 a[22:23], v10 offset:16064
    v_mfma_f32_16x16x32_bf16 v[72:75], a[40:43], a[224:227], v[72:75]
    s_add_u32 m0, s67, 20480
    ds_read_b64_tr_b16 a[24:25], v3 offset:34816
    v_mfma_f32_16x16x32_bf16 v[72:75], a[44:47], a[232:235], v[72:75]
    s_add_u32 s72, s85, 295040
    ds_read_b64_tr_b16 a[26:27], v7 offset:6720
    buffer_load_dwordx4 v16, s[16:19], s72 offen lds
    v_mfma_f32_16x16x32_bf16 v[76:79], a[40:43], a[228:231], v[76:79]
    ds_read_b64_tr_b16 a[28:29], v7 offset:44160
    v_lshlrev_b32 v156, 16, v28
    v_mfma_f32_16x16x32_bf16 v[76:79], a[44:47], a[236:239], v[76:79]
    s_waitcnt lgkmcnt(7)
    ds_read_b64_tr_b16 a[30:31], v11 offset:16064
    v_mfma_f32_16x16x32_bf16 v[80:83], a[0:3], a[224:227], v[80:83]
    ds_read_b64_tr_b16 a[32:33], v4 offset:34816
    v_and_b32 v157, 0xffff0000, v28
    v_mfma_f32_16x16x32_bf16 v[80:83], a[4:7], a[232:235], v[80:83]
    ds_read_b64_tr_b16 a[34:35], v8 offset:6720
    v_mfma_f32_16x16x32_bf16 v[84:87], a[0:3], a[228:231], v[84:87]
    ds_read_b64_tr_b16 a[36:37], v8 offset:44160
    buffer_load_dwordx4 v17, s[16:19], s72 offen offset:1024 lds
    v_mfma_f32_16x16x32_bf16 v[84:87], a[4:7], a[236:239], v[84:87]
    ds_read_b64_tr_b16 a[38:39], v12 offset:16064
    v_add_f32 v156, v156, v26
    v_mfma_f32_16x16x32_bf16 v[88:91], a[8:11], a[224:227], v[88:91]
    ds_read_b64_tr_b16 a[40:41], v5 offset:34816
    v_mfma_f32_16x16x32_bf16 v[88:91], a[12:15], a[232:235], v[88:91]
    ds_read_b64_tr_b16 a[42:43], v9 offset:6720
    v_add_f32 v157, v157, v27
    v_mfma_f32_16x16x32_bf16 v[92:95], a[8:11], a[228:231], v[92:95]
    ds_read_b64_tr_b16 a[44:45], v9 offset:44160
    v_mfma_f32_16x16x32_bf16 v[92:95], a[12:15], a[236:239], v[92:95]
    s_waitcnt vmcnt(26) lgkmcnt(7)
    ds_read_b64_tr_b16 a[46:47], v13 offset:16064
    buffer_load_dwordx4 a[120:123], v18, s[20:23], s70 offen offset:2048 sc1
    v_mfma_f32_16x16x32_bf16 v[96:99], a[16:19], a[224:227], v[96:99]
    s_barrier
    ds_read_b64_tr_b16 a[0:1], v2 offset:0
    v_mfma_f32_16x16x32_bf16 v[96:99], a[20:23], a[232:235], v[96:99]
    ds_read_b64_tr_b16 a[2:3], v2 offset:37440
    v_lshlrev_b32 v26, 16, v132
    v_mfma_f32_16x16x32_bf16 v[100:103], a[16:19], a[228:231], v[100:103]
    ds_read_b64_tr_b16 a[4:5], v6 offset:9344
    v_and_b32 v27, 0xffff0000, v132
    v_mfma_f32_16x16x32_bf16 v[100:103], a[20:23], a[236:239], v[100:103]
    s_add_u32 m0, s67, 22528
    ds_read_b64_tr_b16 a[6:7], v6 offset:46784
    v_mfma_f32_16x16x32_bf16 v[104:107], a[24:27], a[224:227], v[104:107]
    s_add_u32 s72, s85, 295168
    ds_read_b64_tr_b16 a[8:9], v3 offset:0
    buffer_load_dwordx4 v16, s[16:19], s72 offen lds
    v_mfma_f32_16x16x32_bf16 v[104:107], a[28:31], a[232:235], v[104:107]
    ds_read_b64_tr_b16 a[10:11], v3 offset:37440
    v_accvgpr_read_b32 v28, a252
    v_mfma_f32_16x16x32_bf16 v[108:111], a[24:27], a[228:231], v[108:111]
    ds_read_b64_tr_b16 a[12:13], v7 offset:9344
    v_mfma_f32_16x16x32_bf16 v[108:111], a[28:31], a[236:239], v[108:111]
    s_waitcnt lgkmcnt(7)
    ds_read_b64_tr_b16 a[14:15], v7 offset:46784
    v_mfma_f32_16x16x32_bf16 v[112:115], a[32:35], a[224:227], v[112:115]
    ds_read_b64_tr_b16 a[16:17], v4 offset:0
    buffer_load_dwordx4 a[124:127], v18, s[20:23], s70 offen offset:3072 sc1
    v_mfma_f32_16x16x32_bf16 v[112:115], a[36:39], a[232:235], v[112:115]
    ds_read_b64_tr_b16 a[18:19], v4 offset:37440
    v_lshlrev_b32 v158, 16, v28
    v_mfma_f32_16x16x32_bf16 v[116:119], a[32:35], a[228:231], v[116:119]
    ds_read_b64_tr_b16 a[20:21], v8 offset:9344
    v_and_b32 v159, 0xffff0000, v28
    v_mfma_f32_16x16x32_bf16 v[116:119], a[36:39], a[236:239], v[116:119]
    ds_read_b64_tr_b16 a[22:23], v8 offset:46784
    v_mfma_f32_16x16x32_bf16 v[120:123], a[40:43], a[224:227], v[120:123]
    ds_read_b64_tr_b16 a[24:25], v5 offset:0
    v_mfma_f32_16x16x32_bf16 v[120:123], a[44:47], a[232:235], v[120:123]
    ds_read_b64_tr_b16 a[26:27], v5 offset:37440
    buffer_load_dwordx4 v17, s[16:19], s72 offen offset:1024 lds
    v_mfma_f32_16x16x32_bf16 v[124:127], a[40:43], a[228:231], v[124:127]
    ds_read_b64_tr_b16 a[28:29], v9 offset:9344
    v_add_f32 v158, v158, v26
    v_mfma_f32_16x16x32_bf16 v[124:127], a[44:47], a[236:239], v[124:127]
    s_waitcnt lgkmcnt(7)
    ds_read_b64_tr_b16 a[30:31], v9 offset:46784
    v_mfma_f32_16x16x32_bf16 v[32:35], a[0:3], a[48:51], v[32:35]
    ds_read_b64_tr_b16 a[32:33], v2 offset:2048
    v_add_f32 v159, v159, v27
    v_mfma_f32_16x16x32_bf16 v[32:35], a[4:7], a[56:59], v[32:35]
    s_add_u32 m0, s67, 24576
    ds_read_b64_tr_b16 a[34:35], v2 offset:39488
    v_mfma_f32_16x16x32_bf16 v[36:39], a[0:3], a[52:55], v[36:39]
    s_add_u32 s72, s84, 368640
    ds_read_b64_tr_b16 a[36:37], v6 offset:11392
    buffer_load_dwordx4 v16, s[16:19], s72 offen lds
    v_mfma_f32_16x16x32_bf16 v[36:39], a[4:7], a[60:63], v[36:39]
    ds_read_b64_tr_b16 a[38:39], v6 offset:48832
    v_accvgpr_read_b32 v28, a254
    v_mfma_f32_16x16x32_bf16 v[40:43], a[8:11], a[48:51], v[40:43]
    ds_read_b64_tr_b16 a[40:41], v3 offset:2048
    v_mfma_f32_16x16x32_bf16 v[40:43], a[12:15], a[56:59], v[40:43]
    ds_read_b64_tr_b16 a[42:43], v3 offset:39488
    v_lshlrev_b32 v162, 16, v28
    v_mfma_f32_16x16x32_bf16 v[44:47], a[8:11], a[52:55], v[44:47]
    ds_read_b64_tr_b16 a[44:45], v7 offset:11392
L_pad_m0_3:
    s_cbranch_execz L_walk_ret
    v_mfma_f32_16x16x32_bf16 v[44:47], a[12:15], a[60:63], v[44:47]
    s_waitcnt lgkmcnt(7)
    ds_read_b64_tr_b16 a[46:47], v7 offset:48832
    v_mfma_f32_16x16x32_bf16 v[48:51], a[16:19], a[48:51], v[48:51]
    s_add_u32 s70, s77, 20480
    ds_read_b64_tr_b16 a[0:1], v4 offset:2048
    buffer_load_dwordx4 a[128:131], v18, s[20:23], s70 offen offset:0 sc1
    v_mfma_f32_16x16x32_bf16 v[48:51], a[20:23], a[56:59], v[48:51]
    ds_read_b64_tr_b16 a[2:3], v4 offset:39488
    v_and_b32 v163, 0xffff0000, v28
    v_mfma_f32_16x16x32_bf16 v[52:55], a[16:19], a[52:55], v[52:55]
    ds_read_b64_tr_b16 a[4:5], v8 offset:11392
    v_add_f32 v162, v162, v26
    v_mfma_f32_16x16x32_bf16 v[52:55], a[20:23], a[60:63], v[52:55]
    ds_read_b64_tr_b16 a[6:7], v8 offset:48832
    v_mfma_f32_16x16x32_bf16 v[56:59], a[24:27], a[48:51], v[56:59]
    ds_read_b64_tr_b16 a[8:9], v5 offset:2048
    buffer_load_dwordx4 v17, s[16:19], s72 offen offset:1024 lds
    v_mfma_f32_16x16x32_bf16 v[56:59], a[28:31], a[56:59], v[56:59]
    ds_read_b64_tr_b16 a[10:11], v5 offset:39488
    v_add_f32 v163, v163, v27
    v_mfma_f32_16x16x32_bf16 v[60:63], a[24:27], a[52:55], v[60:63]
    ds_read_b64_tr_b16 a[12:13], v9 offset:11392
    v_mfma_f32_16x16x32_bf16 v[60:63], a[28:31], a[60:63], v[60:63]
    s_waitcnt lgkmcnt(7)
    ds_read_b64_tr_b16 a[14:15], v9 offset:48832
    v_mfma_f32_16x16x32_bf16 v[64:67], a[32:35], a[48:51], v[64:67]
    ds_read_b64_tr_b16 a[16:17], v2 offset:4096
    buffer_load_dwordx4 a[132:135], v18, s[20:23], s70 offen offset:1024 sc1
    v_mfma_f32_16x16x32_bf16 v[64:67], a[36:39], a[56:59], v[64:67]
    ds_read_b64_tr_b16 a[18:19], v2 offset:41536
    v_lshlrev_b32 v26, 16, v133
    v_mfma_f32_16x16x32_bf16 v[68:71], a[32:35], a[52:55], v[68:71]
    ds_read_b64_tr_b16 a[20:21], v6 offset:13440
    v_and_b32 v27, 0xffff0000, v133
    v_mfma_f32_16x16x32_bf16 v[68:71], a[36:39], a[60:63], v[68:71]
    ds_read_b64_tr_b16 a[22:23], v6 offset:50880
    v_mfma_f32_16x16x32_bf16 v[72:75], a[40:43], a[48:51], v[72:75]
    s_add_u32 m0, s67, 26624
    ds_read_b64_tr_b16 a[24:25], v3 offset:4096
    v_mfma_f32_16x16x32_bf16 v[72:75], a[44:47], a[56:59], v[72:75]
    s_add_u32 s72, s84, 368768
    ds_read_b64_tr_b16 a[26:27], v3 offset:41536
    buffer_load_dwordx4 v16, s[16:19], s72 offen lds
    v_mfma_f32_16x16x32_bf16 v[76:79], a[40:43], a[52:55], v[76:79]
    ds_read_b64_tr_b16 a[28:29], v7 offset:13440
    v_accvgpr_read_b32 v28, a253
    v_mfma_f32_16x16x32_bf16 v[76:79], a[44:47], a[60:63], v[76:79]
    s_waitcnt lgkmcnt(7)
    ds_read_b64_tr_b16 a[30:31], v7 offset:50880
    v_mfma_f32_16x16x32_bf16 v[80:83], a[0:3], a[48:51], v[80:83]
    ds_read_b64_tr_b16 a[32:33], v4 offset:4096
    v_lshlrev_b32 v160, 16, v28
    v_mfma_f32_16x16x32_bf16 v[80:83], a[4:7], a[56:59], v[80:83]
    ds_read_b64_tr_b16 a[34:35], v4 offset:41536
    v_mfma_f32_16x16x32_bf16 v[84:87], a[0:3], a[52:55], v[84:87]
    ds_read_b64_tr_b16 a[36:37], v8 offset:13440
    buffer_load_dwordx4 v17, s[16:19], s72 offen offset:1024 lds
    v_mfma_f32_16x16x32_bf16 v[84:87], a[4:7], a[60:63], v[84:87]
    ds_read_b64_tr_b16 a[38:39], v8 offset:50880
    v_and_b32 v161, 0xffff0000, v28
    v_mfma_f32_16x16x32_bf16 v[88:91], a[8:11], a[48:51], v[88:91]
    ds_read_b64_tr_b16 a[40:41], v5 offset:4096
    v_mfma_f32_16x16x32_bf16 v[88:91], a[12:15], a[56:59], v[88:91]
    ds_read_b64_tr_b16 a[42:43], v5 offset:41536
    v_add_f32 v160, v160, v26
    v_mfma_f32_16x16x32_bf16 v[92:95], a[8:11], a[52:55], v[92:95]
    ds_read_b64_tr_b16 a[44:45], v9 offset:13440
    v_mfma_f32_16x16x32_bf16 v[92:95], a[12:15], a[60:63], v[92:95]
    s_waitcnt vmcnt(26) lgkmcnt(7)
    ds_read_b64_tr_b16 a[46:47], v9 offset:50880
    buffer_load_dwordx4 a[136:139], v18, s[20:23], s70 offen offset:2048 sc1
    v_mfma_f32_16x16x32_bf16 v[96:99], a[16:19], a[48:51], v[96:99]
    s_barrier
    ds_read_b64_tr_b16 a[0:1], v2 offset:6144
    v_mfma_f32_16x16x32_bf16 v[96:99], a[20:23], a[56:59], v[96:99]
    ds_read_b64_tr_b16 a[2:3], v2 offset:43584
    v_add_f32 v161, v161, v27
    v_mfma_f32_16x16x32_bf16 v[100:103], a[16:19], a[52:55], v[100:103]
    ds_read_b64_tr_b16 a[4:5], v6 offset:15488
    v_accvgpr_read_b32 v28, a255
    v_mfma_f32_16x16x32_bf16 v[100:103], a[20:23], a[60:63], v[100:103]
    s_add_u32 m0, s67, 28672
    ds_read_b64_tr_b16 a[6:7], v6 offset:52928
    v_mfma_f32_16x16x32_bf16 v[104:107], a[24:27], a[48:51], v[104:107]
    s_add_u32 s72, s84, 368896
    ds_read_b64_tr_b16 a[8:9], v3 offset:6144
    buffer_load_dwordx4 v16, s[16:19], s72 offen lds
    v_mfma_f32_16x16x32_bf16 v[104:107], a[28:31], a[56:59], v[104:107]
    ds_read_b64_tr_b16 a[10:11], v3 offset:43584
    v_lshlrev_b32 v164, 16, v28
    v_mfma_f32_16x16x32_bf16 v[108:111], a[24:27], a[52:55], v[108:111]
    ds_read_b64_tr_b16 a[12:13], v7 offset:15488
    v_mfma_f32_16x16x32_bf16 v[108:111], a[28:31], a[60:63], v[108:111]
    s_waitcnt lgkmcnt(7)
    ds_read_b64_tr_b16 a[14:15], v7 offset:52928
    v_mfma_f32_16x16x32_bf16 v[112:115], a[32:35], a[48:51], v[112:115]
    ds_read_b64_tr_b16 a[16:17], v4 offset:6144
    buffer_load_dwordx4 a[140:143], v18, s[20:23], s70 offen offset:3072 sc1
    v_mfma_f32_16x16x32_bf16 v[112:115], a[36:39], a[56:59], v[112:115]
    ds_read_b64_tr_b16 a[18:19], v4 offset:43584
    v_and_b32 v165, 0xffff0000, v28
    v_mfma_f32_16x16x32_bf16 v[116:119], a[32:35], a[52:55], v[116:119]
    ds_read_b64_tr_b16 a[20:21], v8 offset:15488
    v_add_f32 v164, v164, v26
    v_mfma_f32_16x16x32_bf16 v[116:119], a[36:39], a[60:63], v[116:119]
    ds_read_b64_tr_b16 a[22:23], v8 offset:52928
    v_mfma_f32_16x16x32_bf16 v[120:123], a[40:43], a[48:51], v[120:123]
    ds_read_b64_tr_b16 a[24:25], v5 offset:6144
    v_mfma_f32_16x16x32_bf16 v[120:123], a[44:47], a[56:59], v[120:123]
    ds_read_b64_tr_b16 a[26:27], v5 offset:43584
    buffer_load_dwordx4 v17, s[16:19], s72 offen offset:1024 lds
    v_mfma_f32_16x16x32_bf16 v[124:127], a[40:43], a[52:55], v[124:127]
    ds_read_b64_tr_b16 a[28:29], v9 offset:15488
    v_add_f32 v165, v165, v27
    v_mfma_f32_16x16x32_bf16 v[124:127], a[44:47], a[60:63], v[124:127]
    s_waitcnt lgkmcnt(7)
    ds_read_b64_tr_b16 a[30:31], v9 offset:52928
    v_mfma_f32_16x16x32_bf16 v[32:35], a[0:3], a[64:67], v[32:35]
    ds_read_b64_tr_b16 a[32:33], v2 offset:8192
    v_mfma_f32_16x16x32_bf16 v[32:35], a[4:7], a[72:75], v[32:35]
    s_add_u32 m0, s67, 30720
    ds_read_b64_tr_b16 a[34:35], v2 offset:45632
    v_mfma_f32_16x16x32_bf16 v[36:39], a[0:3], a[68:71], v[36:39]
    s_add_u32 s72, s85, 368640
    ds_read_b64_tr_b16 a[36:37], v6 offset:17536
    buffer_load_dwordx4 v16, s[16:19], s72 offen lds
    v_mfma_f32_16x16x32_bf16 v[36:39], a[4:7], a[76:79], v[36:39]
    ds_read_b64_tr_b16 a[38:39], v6 offset:54976
    v_mfma_f32_16x16x32_bf16 v[40:43], a[8:11], a[64:67], v[40:43]
    ds_read_b64_tr_b16 a[40:41], v3 offset:8192
    v_mfma_f32_16x16x32_bf16 v[40:43], a[12:15], a[72:75], v[40:43]
    ds_read_b64_tr_b16 a[42:43], v3 offset:45632
    v_mfma_f32_16x16x32_bf16 v[44:47], a[8:11], a[68:71], v[44:47]
    ds_read_b64_tr_b16 a[44:45], v7 offset:17536
    buffer_load_dwordx4 v17, s[16:19], s72 offen offset:1024 lds
    v_mfma_f32_16x16x32_bf16 v[44:47], a[12:15], a[76:79], v[44:47]
    s_waitcnt lgkmcnt(7)
    ds_read_b64_tr_b16 a[46:47], v7 offset:54976
    v_mfma_f32_16x16x32_bf16 v[48:51], a[16:19], a[64:67], v[48:51]
    ds_read_b64_tr_b16 a[0:1], v4 offset:8192
    v_mfma_f32_16x16x32_bf16 v[48:51], a[20:23], a[72:75], v[48:51]
    s_add_u32 m0, s67, 32768
    ds_read_b64_tr_b16 a[2:3], v4 offset:45632
    v_mfma_f32_16x16x32_bf16 v[52:55], a[16:19], a[68:71], v[52:55]
    s_add_u32 s72, s85, 368768
    ds_read_b64_tr_b16 a[4:5], v8 offset:17536
    buffer_load_dwordx4 v16, s[16:19], s72 offen lds
    v_mfma_f32_16x16x32_bf16 v[52:55], a[20:23], a[76:79], v[52:55]
    ds_read_b64_tr_b16 a[6:7], v8 offset:54976
    v_mfma_f32_16x16x32_bf16 v[56:59], a[24:27], a[64:67], v[56:59]
    ds_read_b64_tr_b16 a[8:9], v5 offset:8192
    v_mfma_f32_16x16x32_bf16 v[56:59], a[28:31], a[72:75], v[56:59]
    ds_read_b64_tr_b16 a[10:11], v5 offset:45632
    v_mfma_f32_16x16x32_bf16 v[60:63], a[24:27], a[68:71], v[60:63]
    ds_read_b64_tr_b16 a[12:13], v9 offset:17536
    buffer_load_dwordx4 v17, s[16:19], s72 offen offset:1024 lds
    v_mfma_f32_16x16x32_bf16 v[60:63], a[28:31], a[76:79], v[60:63]
    s_waitcnt lgkmcnt(7)
    ds_read_b64_tr_b16 a[14:15], v9 offset:54976
    v_mfma_f32_16x16x32_bf16 v[64:67], a[32:35], a[64:67], v[64:67]
    ds_read_b64_tr_b16 a[16:17], v2 offset:10240
    v_mfma_f32_16x16x32_bf16 v[64:67], a[36:39], a[72:75], v[64:67]
    ds_read_b64_tr_b16 a[18:19], v2 offset:47680
    v_mfma_f32_16x16x32_bf16 v[68:71], a[32:35], a[68:71], v[68:71]
    s_add_u32 m0, s67, 34816
    ds_read_b64_tr_b16 a[20:21], v6 offset:19584
    v_mfma_f32_16x16x32_bf16 v[68:71], a[36:39], a[76:79], v[68:71]
    s_add_u32 s72, s85, 368896
    ds_read_b64_tr_b16 a[22:23], v6 offset:57024
    buffer_load_dwordx4 v16, s[16:19], s72 offen lds
    v_mfma_f32_16x16x32_bf16 v[72:75], a[40:43], a[64:67], v[72:75]
    ds_read_b64_tr_b16 a[24:25], v3 offset:10240
    v_mfma_f32_16x16x32_bf16 v[72:75], a[44:47], a[72:75], v[72:75]
    ds_read_b64_tr_b16 a[26:27], v3 offset:47680
    v_mfma_f32_16x16x32_bf16 v[76:79], a[40:43], a[68:71], v[76:79]
    ds_read_b64_tr_b16 a[28:29], v7 offset:19584
    v_mfma_f32_16x16x32_bf16 v[76:79], a[44:47], a[76:79], v[76:79]
    s_waitcnt lgkmcnt(7)
    ds_read_b64_tr_b16 a[30:31], v7 offset:57024
    buffer_load_dwordx4 v17, s[16:19], s72 offen offset:1024 lds
    s_cmp_eq_u32 s63, 1
    s_cbranch_scc1 L_tail_11
    s_cmp_eq_u32 s63, 2
    s_cbranch_scc1 L_tail_12
    s_cmp_eq_u32 s63, 3
    s_cbranch_scc1 L_tail_13
L_tail_10:
    s_nop 3
    v_mfma_f32_16x16x32_bf16 v[80:83], a[0:3], a[64:67], v[80:83]
    ds_read_b64_tr_b16 a[32:33], v4 offset:10240
    v_mfma_f32_16x16x32_bf16 v[80:83], a[4:7], a[72:75], v[80:83]
    ds_read_b64_tr_b16 a[34:35], v4 offset:47680
    v_mfma_f32_16x16x32_bf16 v[84:87], a[0:3], a[68:71], v[84:87]
    s_mov_b32 m0, s73
    ds_read_b64_tr_b16 a[36:37], v8 offset:19584
    v_mfma_f32_16x16x32_bf16 v[84:87], a[4:7], a[76:79], v[84:87]
    s_mov_b32 s72, s3
    ds_read_b64_tr_b16 a[38:39], v8 offset:57024
    buffer_load_dwordx4 v14, s[4:7], s72 offen offset:0 lds
    v_mfma_f32_16x16x32_bf16 v[88:91], a[8:11], a[64:67], v[88:91]
    ds_read_b64_tr_b16 a[40:41], v5 offset:10240
    v_mfma_f32_16x16x32_bf16 v[88:91], a[12:15], a[72:75], v[88:91]
    ds_read_b64_tr_b16 a[42:43], v5 offset:47680
    v_mfma_f32_16x16x32_bf16 v[92:95], a[8:11], a[68:71], v[92:95]
    ds_read_b64_tr_b16 a[44:45], v9 offset:19584
    v_mfma_f32_16x16x32_bf16 v[92:95], a[12:15], a[76:79], v[92:95]
    s_waitcnt vmcnt(17) lgkmcnt(7)
    ds_read_b64_tr_b16 a[46:47], v9 offset:57024
    buffer_load_dwordx4 v15, s[4:7], s72 offen offset:1024 lds
    v_mfma_f32_16x16x32_bf16 v[96:99], a[16:19], a[64:67], v[96:99]
    s_barrier
    ds_read_b64_tr_b16 a[0:1], v5 offset:12288
    v_mfma_f32_16x16x32_bf16 v[96:99], a[20:23], a[72:75], v[96:99]
    ds_read_b64_tr_b16 a[2:3], v5 offset:49728
    v_mfma_f32_16x16x32_bf16 v[100:103], a[16:19], a[68:71], v[100:103]
    ds_read_b64_tr_b16 a[4:5], v9 offset:21632
    v_mfma_f32_16x16x32_bf16 v[100:103], a[20:23], a[76:79], v[100:103]
    ds_read_b64_tr_b16 a[6:7], v9 offset:59072
    buffer_load_dwordx4 v19, s[4:7], s72 offen offset:2048 lds
    v_mfma_f32_16x16x32_bf16 v[104:107], a[24:27], a[64:67], v[104:107]
    ds_read_b64_tr_b16 a[8:9], v2 offset:14336
    v_mfma_f32_16x16x32_bf16 v[104:107], a[28:31], a[72:75], v[104:107]
    ds_read_b64_tr_b16 a[10:11], v2 offset:51776
    v_mfma_f32_16x16x32_bf16 v[108:111], a[24:27], a[68:71], v[108:111]
    ds_read_b64_tr_b16 a[12:13], v6 offset:23680
    v_mfma_f32_16x16x32_bf16 v[108:111], a[28:31], a[76:79], v[108:111]
    s_waitcnt lgkmcnt(7)
    ds_read_b64_tr_b16 a[14:15], v6 offset:61120
    v_mfma_f32_16x16x32_bf16 v[112:115], a[32:35], a[64:67], v[112:115]
    ds_read_b64_tr_b16 a[16:17], v3 offset:14336
    v_mfma_f32_16x16x32_bf16 v[112:115], a[36:39], a[72:75], v[112:115]
    ds_read_b64_tr_b16 a[18:19], v3 offset:51776
    v_mfma_f32_16x16x32_bf16 v[116:119], a[32:35], a[68:71], v[116:119]
    ds_read_b64_tr_b16 a[20:21], v7 offset:23680
    v_mfma_f32_16x16x32_bf16 v[116:119], a[36:39], a[76:79], v[116:119]
    ds_read_b64_tr_b16 a[22:23], v7 offset:61120
    v_mfma_f32_16x16x32_bf16 v[120:123], a[40:43], a[64:67], v[120:123]
    ds_read_b64_tr_b16 a[24:25], v5 offset:18432
    v_mfma_f32_16x16x32_bf16 v[120:123], a[44:47], a[72:75], v[120:123]
    ds_read_b64_tr_b16 a[26:27], v5 offset:55872
    v_mfma_f32_16x16x32_bf16 v[124:127], a[40:43], a[68:71], v[124:127]
    ds_read_b64_tr_b16 a[28:29], v9 offset:27776
    v_mfma_f32_16x16x32_bf16 v[124:127], a[44:47], a[76:79], v[124:127]
    s_waitcnt lgkmcnt(7)
    ds_read_b64_tr_b16 a[30:31], v9 offset:65216
    v_mfma_f32_16x16x32_bf16 v[56:59], a[0:3], a[80:83], v[56:59]
    ds_read_b64_tr_b16 a[32:33], v2 offset:20480
    v_mfma_f32_16x16x32_bf16 v[56:59], a[4:7], a[88:91], v[56:59]
    s_add_u32 m0, s67, 0
    ds_read_b64_tr_b16 a[34:35], v2 offset:57920
    v_mfma_f32_16x16x32_bf16 v[60:63], a[0:3], a[84:87], v[60:63]
    s_add_u32 s72, s83, 0
    ds_read_b64_tr_b16 a[36:37], v6 offset:29824
    buffer_load_dwordx4 v14, s[4:7], s72 offen offset:0 lds
    v_mfma_f32_16x16x32_bf16 v[60:63], a[4:7], a[92:95], v[60:63]
    ds_read_b64_tr_b16 a[38:39], v10 offset:1728
    v_mfma_f32_16x16x32_bf16 v[64:67], a[8:11], a[80:83], v[64:67]
    ds_read_b64_tr_b16 a[40:41], v3 offset:20480
    v_mfma_f32_16x16x32_bf16 v[64:67], a[12:15], a[88:91], v[64:67]
    ds_read_b64_tr_b16 a[42:43], v3 offset:57920
    v_mfma_f32_16x16x32_bf16 v[68:71], a[8:11], a[84:87], v[68:71]
    ds_read_b64_tr_b16 a[44:45], v7 offset:29824
    buffer_load_dwordx4 v15, s[4:7], s72 offen offset:1024 lds
    v_mfma_f32_16x16x32_bf16 v[68:71], a[12:15], a[92:95], v[68:71]
    s_waitcnt vmcnt(5) lgkmcnt(7)
    ds_read_b64_tr_b16 a[46:47], v11 offset:1728
    v_mfma_f32_16x16x32_bf16 v[72:75], a[16:19], a[80:83], v[72:75]
    s_barrier
    ds_read_b64_tr_b16 a[0:1], v5 offset:24576
    v_mfma_f32_16x16x32_bf16 v[72:75], a[20:23], a[88:91], v[72:75]
    ds_read_b64_tr_b16 a[2:3], v5 offset:62016
    v_mfma_f32_16x16x32_bf16 v[76:79], a[16:19], a[84:87], v[76:79]
    ds_read_b64_tr_b16 a[4:5], v9 offset:33920
    buffer_load_dwordx4 v19, s[4:7], s72 offen offset:2048 lds
    v_mfma_f32_16x16x32_bf16 v[76:79], a[20:23], a[92:95], v[76:79]
    ds_read_b64_tr_b16 a[6:7], v13 offset:5824
    v_mfma_f32_16x16x32_bf16 v[56:59], a[24:27], a[96:99], v[56:59]
    ds_read_b64_tr_b16 a[8:9], v2 offset:26624
    v_mfma_f32_16x16x32_bf16 v[56:59], a[28:31], a[104:107], v[56:59]
    s_add_u32 m0, s67, 3072
    ds_read_b64_tr_b16 a[10:11], v2 offset:64064
    v_mfma_f32_16x16x32_bf16 v[60:63], a[24:27], a[100:103], v[60:63]
    s_add_u32 s72, s83, 36864
    ds_read_b64_tr_b16 a[12:13], v6 offset:35968
    buffer_load_dwordx4 v14, s[4:7], s72 offen offset:0 lds
    v_mfma_f32_16x16x32_bf16 v[60:63], a[28:31], a[108:111], v[60:63]
    s_waitcnt lgkmcnt(7)
    ds_read_b64_tr_b16 a[14:15], v10 offset:7872
    v_mfma_f32_16x16x32_bf16 v[64:67], a[32:35], a[96:99], v[64:67]
    ds_read_b64_tr_b16 a[16:17], v3 offset:26624
    v_mfma_f32_16x16x32_bf16 v[64:67], a[36:39], a[104:107], v[64:67]
    ds_read_b64_tr_b16 a[18:19], v3 offset:64064
    v_mfma_f32_16x16x32_bf16 v[68:71], a[32:35], a[100:103], v[68:71]
    ds_read_b64_tr_b16 a[20:21], v7 offset:35968
    buffer_load_dwordx4 v15, s[4:7], s72 offen offset:1024 lds
    v_mfma_f32_16x16x32_bf16 v[68:71], a[36:39], a[108:111], v[68:71]
    ds_read_b64_tr_b16 a[22:23], v11 offset:7872
    v_mfma_f32_16x16x32_bf16 v[72:75], a[40:43], a[96:99], v[72:75]
    ds_read_b64_tr_b16 a[24:25], v5 offset:30720
    v_mfma_f32_16x16x32_bf16 v[72:75], a[44:47], a[104:107], v[72:75]
    ds_read_b64_tr_b16 a[26:27], v9 offset:2624
    v_mfma_f32_16x16x32_bf16 v[76:79], a[40:43], a[100:103], v[76:79]
    ds_read_b64_tr_b16 a[28:29], v9 offset:40064
    buffer_load_dwordx4 v19, s[4:7], s72 offen offset:2048 lds
    v_mfma_f32_16x16x32_bf16 v[76:79], a[44:47], a[108:111], v[76:79]
    s_waitcnt lgkmcnt(7)
    ds_read_b64_tr_b16 a[30:31], v13 offset:11968
    v_mfma_f32_16x16x32_bf16 v[56:59], a[0:3], a[112:115], v[56:59]
    ds_read_b64_tr_b16 a[32:33], v2 offset:32768
    v_mfma_f32_16x16x32_bf16 v[56:59], a[4:7], a[120:123], v[56:59]
    ds_read_b64_tr_b16 a[34:35], v6 offset:4672
    buffer_load_dword v21, v250, s[20:23], 0 offen sc1
    v_mfma_f32_16x16x32_bf16 v[60:63], a[0:3], a[116:119], v[60:63]
    ds_read_b64_tr_b16 a[36:37], v6 offset:42112
    v_mfma_f32_16x16x32_bf16 v[60:63], a[4:7], a[124:127], v[60:63]
    ds_read_b64_tr_b16 a[38:39], v10 offset:14016
    v_mfma_f32_16x16x32_bf16 v[64:67], a[8:11], a[112:115], v[64:67]
    s_add_u32 m0, s67, 6144
    ds_read_b64_tr_b16 a[40:41], v3 offset:32768
    v_mfma_f32_16x16x32_bf16 v[64:67], a[12:15], a[120:123], v[64:67]
    s_add_u32 s72, s83, 73728
    ds_read_b64_tr_b16 a[42:43], v7 offset:4672
    buffer_load_dwordx4 v14, s[4:7], s72 offen offset:0 lds
    v_mfma_f32_16x16x32_bf16 v[68:71], a[8:11], a[116:119], v[68:71]
    ds_read_b64_tr_b16 a[44:45], v7 offset:42112
    v_mfma_f32_16x16x32_bf16 v[68:71], a[12:15], a[124:127], v[68:71]
    s_waitcnt lgkmcnt(7)
    ds_read_b64_tr_b16 a[46:47], v11 offset:14016
    v_mfma_f32_16x16x32_bf16 v[72:75], a[16:19], a[112:115], v[72:75]
    ds_read_b64_tr_b16 a[0:1], v4 offset:14336
    buffer_load_dwordx4 v15, s[4:7], s72 offen offset:1024 lds
    v_mfma_f32_16x16x32_bf16 v[72:75], a[20:23], a[120:123], v[72:75]
    ds_read_b64_tr_b16 a[2:3], v4 offset:51776
    v_mfma_f32_16x16x32_bf16 v[76:79], a[16:19], a[116:119], v[76:79]
    ds_read_b64_tr_b16 a[4:5], v8 offset:23680
    v_mfma_f32_16x16x32_bf16 v[76:79], a[20:23], a[124:127], v[76:79]
    ds_read_b64_tr_b16 a[6:7], v8 offset:61120
    v_mfma_f32_16x16x32_bf16 v[56:59], a[24:27], a[128:131], v[56:59]
    ds_read_b64_tr_b16 a[8:9], v5 offset:14336
    buffer_load_dwordx4 v19, s[4:7], s72 offen offset:2048 lds
    v_mfma_f32_16x16x32_bf16 v[56:59], a[28:31], a[136:139], v[56:59]
    ds_read_b64_tr_b16 a[10:11], v5 offset:51776
    v_mfma_f32_16x16x32_bf16 v[60:63], a[24:27], a[132:135], v[60:63]
    s_add_u32 m0, s67, 9216
    ds_read_b64_tr_b16 a[12:13], v9 offset:23680
    v_mfma_f32_16x16x32_bf16 v[60:63], a[28:31], a[140:143], v[60:63]
    s_waitcnt lgkmcnt(7)
    ds_read_b64_tr_b16 a[14:15], v9 offset:61120
    v_mfma_f32_16x16x32_bf16 v[64:67], a[32:35], a[128:131], v[64:67]
    s_add_u32 s72, s83, 110592
    ds_read_b64_tr_b16 a[16:17], v2 offset:16384
    buffer_load_dwordx4 v14, s[4:7], s72 offen offset:0 lds
    v_mfma_f32_16x16x32_bf16 v[64:67], a[36:39], a[136:139], v[64:67]
    ds_read_b64_tr_b16 a[18:19], v2 offset:53824
    v_mfma_f32_16x16x32_bf16 v[68:71], a[32:35], a[132:135], v[68:71]
    ds_read_b64_tr_b16 a[20:21], v6 offset:25728
    buffer_load_dwordx4 v15, s[4:7], s72 offen offset:1024 lds
    v_mfma_f32_16x16x32_bf16 v[68:71], a[36:39], a[140:143], v[68:71]
    ds_read_b64_tr_b16 a[22:23], v6 offset:63168
    v_mfma_f32_16x16x32_bf16 v[72:75], a[40:43], a[128:131], v[72:75]
    ds_read_b64_tr_b16 a[24:25], v4 offset:20480
    v_mfma_f32_16x16x32_bf16 v[72:75], a[44:47], a[136:139], v[72:75]
    ds_read_b64_tr_b16 a[26:27], v4 offset:57920
    v_mfma_f32_16x16x32_bf16 v[76:79], a[40:43], a[132:135], v[76:79]
    ds_read_b64_tr_b16 a[28:29], v8 offset:29824
    buffer_load_dwordx4 v19, s[4:7], s72 offen offset:2048 lds
    v_mfma_f32_16x16x32_bf16 v[76:79], a[44:47], a[140:143], v[76:79]
    s_waitcnt lgkmcnt(7)
    ds_read_b64_tr_b16 a[30:31], v12 offset:1728
    v_mfma_f32_16x16x32_bf16 v[80:83], a[0:3], a[80:83], v[80:83]
    ds_read_b64_tr_b16 a[32:33], v5 offset:20480
    v_mfma_f32_16x16x32_bf16 v[80:83], a[4:7], a[88:91], v[80:83]
    ds_read_b64_tr_b16 a[34:35], v5 offset:57920
    v_mfma_f32_16x16x32_bf16 v[84:87], a[0:3], a[84:87], v[84:87]
    ds_read_b64_tr_b16 a[36:37], v9 offset:29824
    v_mfma_f32_16x16x32_bf16 v[84:87], a[4:7], a[92:95], v[84:87]
    ds_read_b64_tr_b16 a[38:39], v13 offset:1728
    v_mfma_f32_16x16x32_bf16 v[88:91], a[8:11], a[80:83], v[88:91]
    s_add_u32 s82, s79, 0
    ds_read_b64_tr_b16 a[40:41], v2 offset:22528
    v_mfma_f32_16x16x32_bf16 v[88:91], a[12:15], a[88:91], v[88:91]
    ds_read_b64_tr_b16 a[42:43], v2 offset:59968
    v_cvt_pk_bf16_f32 v56, v56, v57
    v_mfma_f32_16x16x32_bf16 v[92:95], a[8:11], a[84:87], v[92:95]
    ds_read_b64_tr_b16 a[44:45], v6 offset:31872
    v_cvt_pk_bf16_f32 v57, v58, v59
    v_mfma_f32_16x16x32_bf16 v[92:95], a[12:15], a[92:95], v[92:95]
    s_waitcnt lgkmcnt(7)
    ds_read_b64_tr_b16 a[46:47], v10 offset:3776
    v_cvt_pk_bf16_f32 v58, v60, v61
    v_mfma_f32_16x16x32_bf16 v[96:99], a[16:19], a[80:83], v[96:99]
    ds_read_b64_tr_b16 a[0:1], v4 offset:26624
    v_cvt_pk_bf16_f32 v59, v62, v63
    v_mfma_f32_16x16x32_bf16 v[96:99], a[20:23], a[88:91], v[96:99]
    ds_read_b64_tr_b16 a[2:3], v4 offset:64064
    buffer_store_dwordx4 v[56:59], v18, s[20:23], s82 offen offset:0 sc1
    v_mfma_f32_16x16x32_bf16 v[100:103], a[16:19], a[84:87], v[100:103]
    ds_read_b64_tr_b16 a[4:5], v8 offset:35968
    v_mfma_f32_16x16x32_bf16 v[100:103], a[20:23], a[92:95], v[100:103]
    ds_read_b64_tr_b16 a[6:7], v12 offset:7872
    v_mfma_f32_16x16x32_bf16 v[80:83], a[24:27], a[96:99], v[80:83]
    ds_read_b64_tr_b16 a[8:9], v5 offset:26624
    v_mfma_f32_16x16x32_bf16 v[80:83], a[28:31], a[104:107], v[80:83]
    ds_read_b64_tr_b16 a[10:11], v5 offset:64064
    v_mfma_f32_16x16x32_bf16 v[84:87], a[24:27], a[100:103], v[84:87]
    ds_read_b64_tr_b16 a[12:13], v9 offset:35968
    v_mfma_f32_16x16x32_bf16 v[84:87], a[28:31], a[108:111], v[84:87]
    s_waitcnt lgkmcnt(7)
    ds_read_b64_tr_b16 a[14:15], v13 offset:7872
    v_mfma_f32_16x16x32_bf16 v[88:91], a[32:35], a[96:99], v[88:91]
    ds_read_b64_tr_b16 a[16:17], v2 offset:28672
    v_mfma_f32_16x16x32_bf16 v[88:91], a[36:39], a[104:107], v[88:91]
    ds_read_b64_tr_b16 a[18:19], v6 offset:576
    v_mfma_f32_16x16x32_bf16 v[92:95], a[32:35], a[100:103], v[92:95]
    ds_read_b64_tr_b16 a[20:21], v6 offset:38016
    v_mfma_f32_16x16x32_bf16 v[92:95], a[36:39], a[108:111], v[92:95]
    ds_read_b64_tr_b16 a[22:23], v10 offset:9920
    v_mfma_f32_16x16x32_bf16 v[96:99], a[40:43], a[96:99], v[96:99]
    ds_read_b64_tr_b16 a[24:25], v4 offset:32768
    v_mfma_f32_16x16x32_bf16 v[96:99], a[44:47], a[104:107], v[96:99]
    ds_read_b64_tr_b16 a[26:27], v8 offset:4672
    v_cvt_pk_bf16_f32 v64, v64, v65
    v_mfma_f32_16x16x32_bf16 v[100:103], a[40:43], a[100:103], v[100:103]
    ds_read_b64_tr_b16 a[28:29], v8 offset:42112
    v_cvt_pk_bf16_f32 v65, v66, v67
    v_mfma_f32_16x16x32_bf16 v[100:103], a[44:47], a[108:111], v[100:103]
    s_waitcnt lgkmcnt(7)
    ds_read_b64_tr_b16 a[30:31], v12 offset:14016
    v_cvt_pk_bf16_f32 v66, v68, v69
    v_mfma_f32_16x16x32_bf16 v[80:83], a[0:3], a[112:115], v[80:83]
    ds_read_b64_tr_b16 a[32:33], v5 offset:32768
    v_cvt_pk_bf16_f32 v67, v70, v71
    v_mfma_f32_16x16x32_bf16 v[80:83], a[4:7], a[120:123], v[80:83]
    ds_read_b64_tr_b16 a[34:35], v9 offset:4672
    buffer_store_dwordx4 v[64:67], v18, s[20:23], s82 offen offset:1024 sc1
    v_mfma_f32_16x16x32_bf16 v[84:87], a[0:3], a[116:119], v[84:87]
    ds_read_b64_tr_b16 a[36:37], v9 offset:42112
    v_mfma_f32_16x16x32_bf16 v[84:87], a[4:7], a[124:127], v[84:87]
    ds_read_b64_tr_b16 a[38:39], v13 offset:14016
    v_mfma_f32_16x16x32_bf16 v[88:91], a[8:11], a[112:115], v[88:91]
    ds_read_b64_tr_b16 a[40:41], v2 offset:34816
    v_mfma_f32_16x16x32_bf16 v[88:91], a[12:15], a[120:123], v[88:91]
    ds_read_b64_tr_b16 a[42:43], v6 offset:6720
    v_mfma_f32_16x16x32_bf16 v[92:95], a[8:11], a[116:119], v[92:95]
    ds_read_b64_tr_b16 a[44:45], v6 offset:44160
    v_mfma_f32_16x16x32_bf16 v[92:95], a[12:15], a[124:127], v[92:95]
    s_waitcnt lgkmcnt(7)
    ds_read_b64_tr_b16 a[46:47], v10 offset:16064
    v_mfma_f32_16x16x32_bf16 v[96:99], a[16:19], a[112:115], v[96:99]
    ds_read_b64_tr_b16 a[0:1], v3 offset:16384
    v_mfma_f32_16x16x32_bf16 v[96:99], a[20:23], a[120:123], v[96:99]
    ds_read_b64_tr_b16 a[2:3], v3 offset:53824
    v_mfma_f32_16x16x32_bf16 v[100:103], a[16:19], a[116:119], v[100:103]
    ds_read_b64_tr_b16 a[4:5], v7 offset:25728
    v_mfma_f32_16x16x32_bf16 v[100:103], a[20:23], a[124:127], v[100:103]
    ds_read_b64_tr_b16 a[6:7], v7 offset:63168
    v_mfma_f32_16x16x32_bf16 v[80:83], a[24:27], a[128:131], v[80:83]
    ds_read_b64_tr_b16 a[8:9], v4 offset:16384
    v_mfma_f32_16x16x32_bf16 v[80:83], a[28:31], a[136:139], v[80:83]
    ds_read_b64_tr_b16 a[10:11], v4 offset:53824
    v_cvt_pk_bf16_f32 v72, v72, v73
    v_mfma_f32_16x16x32_bf16 v[84:87], a[24:27], a[132:135], v[84:87]
    ds_read_b64_tr_b16 a[12:13], v8 offset:25728
    v_cvt_pk_bf16_f32 v73, v74, v75
    v_mfma_f32_16x16x32_bf16 v[84:87], a[28:31], a[140:143], v[84:87]
    s_waitcnt lgkmcnt(7)
    ds_read_b64_tr_b16 a[14:15], v8 offset:63168
    v_cvt_pk_bf16_f32 v74, v76, v77
    v_mfma_f32_16x16x32_bf16 v[88:91], a[32:35], a[128:131], v[88:91]
    ds_read_b64_tr_b16 a[16:17], v5 offset:16384
    v_cvt_pk_bf16_f32 v75, v78, v79
    v_mfma_f32_16x16x32_bf16 v[88:91], a[36:39], a[136:139], v[88:91]
    ds_read_b64_tr_b16 a[18:19], v5 offset:53824
    buffer_store_dwordx4 v[72:75], v18, s[20:23], s82 offen offset:2048 sc1
    v_mfma_f32_16x16x32_bf16 v[92:95], a[32:35], a[132:135], v[92:95]
    ds_read_b64_tr_b16 a[20:21], v9 offset:25728
    v_mfma_f32_16x16x32_bf16 v[92:95], a[36:39], a[140:143], v[92:95]
    ds_read_b64_tr_b16 a[22:23], v9 offset:63168
    v_mfma_f32_16x16x32_bf16 v[96:99], a[40:43], a[128:131], v[96:99]
    ds_read_b64_tr_b16 a[24:25], v3 offset:22528
    v_mfma_f32_16x16x32_bf16 v[96:99], a[44:47], a[136:139], v[96:99]
    ds_read_b64_tr_b16 a[26:27], v3 offset:59968
    v_mfma_f32_16x16x32_bf16 v[100:103], a[40:43], a[132:135], v[100:103]
    ds_read_b64_tr_b16 a[28:29], v7 offset:31872
    v_mfma_f32_16x16x32_bf16 v[100:103], a[44:47], a[140:143], v[100:103]
    s_waitcnt lgkmcnt(7)
    ds_read_b64_tr_b16 a[30:31], v11 offset:3776
    v_mfma_f32_16x16x32_bf16 v[104:107], a[0:3], a[80:83], v[104:107]
    ds_read_b64_tr_b16 a[32:33], v4 offset:22528
    s_add_u32 s71, s66, 1
    s_waitcnt vmcnt(9)
    v_subrev_u32 v21, s71, v21
    v_cmp_gt_u32 vcc, 8, v21
    s_nop 0
    s_cmp_eq_u64 vcc, exec
    s_cbranch_scc0 L_slow_14
L_back_15:
    v_mfma_f32_16x16x32_bf16 v[104:107], a[4:7], a[88:91], v[104:107]
    s_add_u32 s70, s78, 0
    ds_read_b64_tr_b16 a[34:35], v4 offset:59968
    buffer_load_dwordx4 a[144:147], v18, s[20:23], s70 offen offset:0 sc1
    v_mfma_f32_16x16x32_bf16 v[108:111], a[0:3], a[84:87], v[108:111]
    ds_read_b64_tr_b16 a[36:37], v8 offset:31872
    v_mfma_f32_16x16x32_bf16 v[108:111], a[4:7], a[92:95], v[108:111]
    ds_read_b64_tr_b16 a[38:39], v12 offset:3776
    v_mfma_f32_16x16x32_bf16 v[112:115], a[8:11], a[80:83], v[112:115]
    ds_read_b64_tr_b16 a[40:41], v5 offset:22528
    buffer_load_dwordx4 a[148:151], v18, s[20:23], s70 offen offset:1024 sc1
    v_mfma_f32_16x16x32_bf16 v[112:115], a[12:15], a[88:91], v[112:115]
    s_add_u32 s82, s79, 3072
    ds_read_b64_tr_b16 a[42:43], v5 offset:59968
    v_cvt_pk_bf16_f32 v80, v80, v81
    v_mfma_f32_16x16x32_bf16 v[116:119], a[8:11], a[84:87], v[116:119]
    ds_read_b64_tr_b16 a[44:45], v9 offset:31872
    v_cvt_pk_bf16_f32 v81, v82, v83
    v_mfma_f32_16x16x32_bf16 v[116:119], a[12:15], a[92:95], v[116:119]
    s_waitcnt lgkmcnt(7)
    ds_read_b64_tr_b16 a[46:47], v13 offset:3776
    v_cvt_pk_bf16_f32 v82, v84, v85
    v_mfma_f32_16x16x32_bf16 v[120:123], a[16:19], a[80:83], v[120:123]
    ds_read_b64_tr_b16 a[0:1], v3 offset:28672
    v_cvt_pk_bf16_f32 v83, v86, v87
    v_mfma_f32_16x16x32_bf16 v[120:123], a[20:23], a[88:91], v[120:123]
    ds_read_b64_tr_b16 a[2:3], v7 offset:576
    buffer_store_dwordx4 v[80:83], v18, s[20:23], s82 offen offset:0 sc1
    v_mfma_f32_16x16x32_bf16 v[124:127], a[16:19], a[84:87], v[124:127]
    ds_read_b64_tr_b16 a[4:5], v7 offset:38016
    v_mfma_f32_16x16x32_bf16 v[124:127], a[20:23], a[92:95], v[124:127]
    ds_read_b64_tr_b16 a[6:7], v11 offset:9920
    buffer_load_dwordx4 a[152:155], v18, s[20:23], s70 offen offset:2048 sc1
    v_mfma_f32_16x16x32_bf16 v[104:107], a[24:27], a[96:99], v[104:107]
    ds_read_b64_tr_b16 a[8:9], v4 offset:28672
    v_mfma_f32_16x16x32_bf16 v[104:107], a[28:31], a[104:107], v[104:107]
    ds_read_b64_tr_b16 a[10:11], v8 offset:576
    v_mfma_f32_16x16x32_bf16 v[108:111], a[24:27], a[100:103], v[108:111]
    ds_read_b64_tr_b16 a[12:13], v8 offset:38016
    buffer_load_dwordx4 a[156:159], v18, s[20:23], s70 offen offset:3072 sc1
    v_mfma_f32_16x16x32_bf16 v[108:111], a[28:31], a[108:111], v[108:111]
    s_waitcnt lgkmcnt(7)
    ds_read_b64_tr_b16 a[14:15], v12 offset:9920
    v_mfma_f32_16x16x32_bf16 v[112:115], a[32:35], a[96:99], v[112:115]
L_pad_v0_0:
    s_cbranch_execz L_pad_v0_1
    ds_read_b64_tr_b16 a[16:17], v5 offset:28672
    v_mfma_f32_16x16x32_bf16 v[112:115], a[36:39], a[104:107], v[112:115]
    s_add_u32 s70, s78, 4096
    ds_read_b64_tr_b16 a[18:19], v9 offset:576
    buffer_load_dwordx4 a[160:163], v18, s[20:23], s70 offen offset:0 sc1
    v_mfma_f32_16x16x32_bf16 v[116:119], a[32:35], a[100:103], v[116:119]
    ds_read_b64_tr_b16 a[20:21], v9 offset:38016
    v_mfma_f32_16x16x32_bf16 v[116:119], a[36:39], a[108:111], v[116:119]
    ds_read_b64_tr_b16 a[22:23], v13 offset:9920
    v_mfma_f32_16x16x32_bf16 v[120:123], a[40:43], a[96:99], v[120:123]
    ds_read_b64_tr_b16 a[24:25], v3 offset:34816
    buffer_load_dwordx4 a[164:167], v18, s[20:23], s70 offen offset:1024 sc1
    v_mfma_f32_16x16x32_bf16 v[120:123], a[44:47], a[104:107], v[120:123]
    ds_read_b64_tr_b16 a[26:27], v7 offset:6720
    v_cvt_pk_bf16_f32 v88, v88, v89
    v_mfma_f32_16x16x32_bf16 v[124:127], a[40:43], a[100:103], v[124:127]
    ds_read_b64_tr_b16 a[28:29], v7 offset:44160
    v_cvt_pk_bf16_f32 v89, v90, v91
    v_mfma_f32_16x16x32_bf16 v[124:127], a[44:47], a[108:111], v[124:127]
    s_waitcnt lgkmcnt(7)
    ds_read_b64_tr_b16 a[30:31], v11 offset:16064
    v_cvt_pk_bf16_f32 v90, v92, v93
    v_mfma_f32_16x16x32_bf16 v[104:107], a[0:3], a[112:115], v[104:107]
    ds_read_b64_tr_b16 a[32:33], v4 offset:34816
    v_cvt_pk_bf16_f32 v91, v94, v95
    v_mfma_f32_16x16x32_bf16 v[104:107], a[4:7], a[120:123], v[104:107]
    ds_read_b64_tr_b16 a[34:35], v8 offset:6720
    buffer_store_dwordx4 v[88:91], v18, s[20:23], s82 offen offset:1024 sc1
    v_mfma_f32_16x16x32_bf16 v[108:111], a[0:3], a[116:119], v[108:111]
    ds_read_b64_tr_b16 a[36:37], v8 offset:44160
    v_mfma_f32_16x16x32_bf16 v[108:111], a[4:7], a[124:127], v[108:111]
    ds_read_b64_tr_b16 a[38:39], v12 offset:16064
    buffer_load_dwordx4 a[168:171], v18, s[20:23], s70 offen offset:2048 sc1
    v_mfma_f32_16x16x32_bf16 v[112:115], a[8:11], a[112:115], v[112:115]
    ds_read_b64_tr_b16 a[40:41], v5 offset:34816
    v_mfma_f32_16x16x32_bf16 v[112:115], a[12:15], a[120:123], v[112:115]
    ds_read_b64_tr_b16 a[42:43], v9 offset:6720
    v_mfma_f32_16x16x32_bf16 v[116:119], a[8:11], a[116:119], v[116:119]
    ds_read_b64_tr_b16 a[44:45], v9 offset:44160
    buffer_load_dwordx4 a[172:175], v18, s[20:23], s70 offen offset:3072 sc1
    v_mfma_f32_16x16x32_bf16 v[116:119], a[12:15], a[124:127], v[116:119]
    s_waitcnt lgkmcnt(7)
    ds_read_b64_tr_b16 a[46:47], v13 offset:16064
    v_mfma_f32_16x16x32_bf16 v[120:123], a[16:19], a[112:115], v[120:123]
    ds_read_b64_tr_b16 a[0:1], v2 offset:12288
    v_mfma_f32_16x16x32_bf16 v[120:123], a[20:23], a[120:123], v[120:123]
    s_add_u32 s70, s78, 8192
    ds_read_b64_tr_b16 a[2:3], v2 offset:49728
    buffer_load_dwordx2 a[176:177], v251, s[20:23], s70 offen offset:0 sc1
    buffer_load_dwordx2 a[178:179], v251, s[20:23], s70 offen offset:512 sc1
    v_mfma_f32_16x16x32_bf16 v[124:127], a[16:19], a[116:119], v[124:127]
    ds_read_b64_tr_b16 a[4:5], v6 offset:21632
    v_mfma_f32_16x16x32_bf16 v[124:127], a[20:23], a[124:127], v[124:127]
    ds_read_b64_tr_b16 a[6:7], v6 offset:59072
    v_mfma_f32_16x16x32_bf16 v[104:107], a[24:27], a[128:131], v[104:107]
    ds_read_b64_tr_b16 a[8:9], v3 offset:12288
    buffer_load_dwordx2 a[180:181], v251, s[20:23], s70 offen offset:1024 sc1
    buffer_load_dwordx2 a[182:183], v251, s[20:23], s70 offen offset:1536 sc1
    v_mfma_f32_16x16x32_bf16 v[104:107], a[28:31], a[136:139], v[104:107]
    ds_read_b64_tr_b16 a[10:11], v3 offset:49728
    v_cvt_pk_bf16_f32 v96, v96, v97
    v_mfma_f32_16x16x32_bf16 v[108:111], a[24:27], a[132:135], v[108:111]
    ds_read_b64_tr_b16 a[12:13], v7 offset:21632
    v_cvt_pk_bf16_f32 v97, v98, v99
    v_mfma_f32_16x16x32_bf16 v[108:111], a[28:31], a[140:143], v[108:111]
    s_waitcnt lgkmcnt(7)
    ds_read_b64_tr_b16 a[14:15], v7 offset:59072
    v_cvt_pk_bf16_f32 v98, v100, v101
    v_mfma_f32_16x16x32_bf16 v[112:115], a[32:35], a[128:131], v[112:115]
    ds_read_b64_tr_b16 a[16:17], v4 offset:12288
    v_cvt_pk_bf16_f32 v99, v102, v103
    v_mfma_f32_16x16x32_bf16 v[112:115], a[36:39], a[136:139], v[112:115]
    ds_read_b64_tr_b16 a[18:19], v4 offset:49728
    buffer_store_dwordx4 v[96:99], v18, s[20:23], s82 offen offset:2048 sc1
    v_mfma_f32_16x16x32_bf16 v[116:119], a[32:35], a[132:135], v[116:119]
    ds_read_b64_tr_b16 a[20:21], v8 offset:21632
    v_mfma_f32_16x16x32_bf16 v[116:119], a[36:39], a[140:143], v[116:119]
    ds_read_b64_tr_b16 a[22:23], v8 offset:59072
    buffer_load_dwordx4 a[184:187], v18, s[20:23], s70 offen offset:2048 sc1
    v_mfma_f32_16x16x32_bf16 v[120:123], a[40:43], a[128:131], v[120:123]
    ds_read_b64_tr_b16 a[24:25], v2 offset:18432
    v_mfma_f32_16x16x32_bf16 v[120:123], a[44:47], a[136:139], v[120:123]
    ds_read_b64_tr_b16 a[26:27], v2 offset:55872
    v_mfma_f32_16x16x32_bf16 v[124:127], a[40:43], a[132:135], v[124:127]
    ds_read_b64_tr_b16 a[28:29], v6 offset:27776
    buffer_load_dwordx4 a[188:191], v18, s[20:23], s70 offen offset:3072 sc1
    v_mfma_f32_16x16x32_bf16 v[124:127], a[44:47], a[140:143], v[124:127]
    s_waitcnt lgkmcnt(7)
    ds_read_b64_tr_b16 a[30:31], v6 offset:65216
    v_mfma_f32_16x16x32_bf16 v[32:35], a[0:3], a[80:83], v[32:35]
    s_add_u32 s82, s79, 6144
    ds_read_b64_tr_b16 a[32:33], v3 offset:18432
    v_cvt_pk_bf16_f32 v104, v104, v105
    v_mfma_f32_16x16x32_bf16 v[32:35], a[4:7], a[88:91], v[32:35]
    ds_read_b64_tr_b16 a[34:35], v3 offset:55872
    v_cvt_pk_bf16_f32 v105, v106, v107
    v_mfma_f32_16x16x32_bf16 v[36:39], a[0:3], a[84:87], v[36:39]
    ds_read_b64_tr_b16 a[36:37], v7 offset:27776
    v_cvt_pk_bf16_f32 v106, v108, v109
    v_mfma_f32_16x16x32_bf16 v[36:39], a[4:7], a[92:95], v[36:39]
    ds_read_b64_tr_b16 a[38:39], v7 offset:65216
    v_cvt_pk_bf16_f32 v107, v110, v111
    v_mfma_f32_16x16x32_bf16 v[40:43], a[8:11], a[80:83], v[40:43]
    ds_read_b64_tr_b16 a[40:41], v4 offset:18432
    buffer_store_dwordx4 v[104:107], v18, s[20:23], s82 offen offset:0 sc1
    v_mfma_f32_16x16x32_bf16 v[40:43], a[12:15], a[88:91], v[40:43]
    ds_read_b64_tr_b16 a[42:43], v4 offset:55872
    v_cvt_pk_bf16_f32 v112, v112, v113
    v_mfma_f32_16x16x32_bf16 v[44:47], a[8:11], a[84:87], v[44:47]
    ds_read_b64_tr_b16 a[44:45], v8 offset:27776
    v_cvt_pk_bf16_f32 v113, v114, v115
    v_mfma_f32_16x16x32_bf16 v[44:47], a[12:15], a[92:95], v[44:47]
    s_waitcnt lgkmcnt(7)
    ds_read_b64_tr_b16 a[46:47], v8 offset:65216
    v_cvt_pk_bf16_f32 v114, v116, v117
    v_mfma_f32_16x16x32_bf16 v[48:51], a[16:19], a[80:83], v[48:51]
    ds_read_b64_tr_b16 a[0:1], v2 offset:24576
    v_cvt_pk_bf16_f32 v115, v118, v119
    v_mfma_f32_16x16x32_bf16 v[48:51], a[20:23], a[88:91], v[48:51]
    ds_read_b64_tr_b16 a[2:3], v2 offset:62016
    buffer_store_dwordx4 v[112:115], v18, s[20:23], s82 offen offset:1024 sc1
    v_mfma_f32_16x16x32_bf16 v[52:55], a[16:19], a[84:87], v[52:55]
    ds_read_b64_tr_b16 a[4:5], v6 offset:33920
    v_cvt_pk_bf16_f32 v120, v120, v121
    v_mfma_f32_16x16x32_bf16 v[52:55], a[20:23], a[92:95], v[52:55]
    ds_read_b64_tr_b16 a[6:7], v10 offset:5824
    v_cvt_pk_bf16_f32 v121, v122, v123
    v_mfma_f32_16x16x32_bf16 v[32:35], a[24:27], a[96:99], v[32:35]
    ds_read_b64_tr_b16 a[8:9], v3 offset:24576
    v_cvt_pk_bf16_f32 v122, v124, v125
    v_mfma_f32_16x16x32_bf16 v[32:35], a[28:31], a[104:107], v[32:35]
    ds_read_b64_tr_b16 a[10:11], v3 offset:62016
    v_cvt_pk_bf16_f32 v123, v126, v127
    v_mfma_f32_16x16x32_bf16 v[36:39], a[24:27], a[100:103], v[36:39]
    ds_read_b64_tr_b16 a[12:13], v7 offset:33920
    buffer_store_dwordx4 v[120:123], v18, s[20:23], s82 offen offset:2048 sc1
    v_mfma_f32_16x16x32_bf16 v[36:39], a[28:31], a[108:111], v[36:39]
    s_waitcnt lgkmcnt(7)
    ds_read_b64_tr_b16 a[14:15], v11 offset:5824
    v_mfma_f32_16x16x32_bf16 v[40:43], a[32:35], a[96:99], v[40:43]
    s_add_u32 s70, s78, 12288
    ds_read_b64_tr_b16 a[16:17], v4 offset:24576
    buffer_load_dwordx4 a[192:195], v18, s[20:23], s70 offen offset:0 sc1
    v_mfma_f32_16x16x32_bf16 v[40:43], a[36:39], a[104:107], v[40:43]
    ds_read_b64_tr_b16 a[18:19], v4 offset:62016
    buffer_load_dwordx4 a[196:199], v18, s[20:23], s70 offen offset:1024 sc1
    v_mfma_f32_16x16x32_bf16 v[44:47], a[32:35], a[100:103], v[44:47]
    ds_read_b64_tr_b16 a[20:21], v8 offset:33920
    buffer_load_dwordx4 a[200:203], v18, s[20:23], s70 offen offset:2048 sc1
    v_mfma_f32_16x16x32_bf16 v[44:47], a[36:39], a[108:111], v[44:47]
    ds_read_b64_tr_b16 a[22:23], v12 offset:5824
    v_mfma_f32_16x16x32_bf16 v[48:51], a[40:43], a[96:99], v[48:51]
    ds_read_b64_tr_b16 a[24:25], v2 offset:30720
    buffer_load_dwordx4 a[204:207], v18, s[20:23], s70 offen offset:3072 sc1
    v_mfma_f32_16x16x32_bf16 v[48:51], a[44:47], a[104:107], v[48:51]
    ds_read_b64_tr_b16 a[26:27], v6 offset:2624
    v_mfma_f32_16x16x32_bf16 v[52:55], a[40:43], a[100:103], v[52:55]
    ds_read_b64_tr_b16 a[28:29], v6 offset:40064
    v_mfma_f32_16x16x32_bf16 v[52:55], a[44:47], a[108:111], v[52:55]
    s_waitcnt lgkmcnt(7)
    ds_read_b64_tr_b16 a[30:31], v10 offset:11968
    v_mfma_f32_16x16x32_bf16 v[32:35], a[0:3], a[112:115], v[32:35]
    s_add_u32 s70, s78, 16384
    ds_read_b64_tr_b16 a[32:33], v3 offset:30720
    buffer_load_dwordx4 a[208:211], v18, s[20:23], s70 offen offset:0 sc1
    v_mfma_f32_16x16x32_bf16 v[32:35], a[4:7], a[120:123], v[32:35]
    ds_read_b64_tr_b16 a[34:35], v7 offset:2624
    v_mfma_f32_16x16x32_bf16 v[36:39], a[0:3], a[116:119], v[36:39]
    ds_read_b64_tr_b16 a[36:37], v7 offset:40064
    v_mfma_f32_16x16x32_bf16 v[36:39], a[4:7], a[124:127], v[36:39]
    ds_read_b64_tr_b16 a[38:39], v11 offset:11968
    buffer_load_dwordx4 a[212:215], v18, s[20:23], s70 offen offset:1024 sc1
    v_mfma_f32_16x16x32_bf16 v[40:43], a[8:11], a[112:115], v[40:43]
    ds_read_b64_tr_b16 a[40:41], v4 offset:30720
    v_mfma_f32_16x16x32_bf16 v[40:43], a[12:15], a[120:123], v[40:43]
    ds_read_b64_tr_b16 a[42:43], v8 offset:2624
    v_mfma_f32_16x16x32_bf16 v[44:47], a[8:11], a[116:119], v[44:47]
    ds_read_b64_tr_b16 a[44:45], v8 offset:40064
    buffer_load_dwordx4 a[216:219], v18, s[20:23], s70 offen offset:2048 sc1
    v_mfma_f32_16x16x32_bf16 v[44:47], a[12:15], a[124:127], v[44:47]
    s_waitcnt vmcnt(30) lgkmcnt(7)
    ds_read_b64_tr_b16 a[46:47], v12 offset:11968
    v_mfma_f32_16x16x32_bf16 v[48:51], a[16:19], a[112:115], v[48:51]
    s_barrier
    ds_read_b64_tr_b16 a[0:1], v29 offset:0
    v_mfma_f32_16x16x32_bf16 v[48:51], a[20:23], a[120:123], v[48:51]
    ds_read_b64_tr_b16 a[2:3], v29 offset:1536
    buffer_load_dwordx4 a[220:223], v18, s[20:23], s70 offen offset:3072 sc1
    v_mfma_f32_16x16x32_bf16 v[52:55], a[16:19], a[116:119], v[52:55]
    ds_read_b64_tr_b16 a[4:5], v29 offset:3072
    v_mfma_f32_16x16x32_bf16 v[52:55], a[20:23], a[124:127], v[52:55]
    ds_read_b64_tr_b16 a[6:7], v29 offset:4608
    v_mfma_f32_16x16x32_bf16 v[32:35], a[24:27], a[128:131], v[32:35]
    s_add_u32 s70, s78, 20480
    ds_read_b64_tr_b16 a[8:9], v29 offset:6144
    buffer_load_dwordx4 a[224:227], v18, s[20:23], s70 offen offset:0 sc1
    v_mfma_f32_16x16x32_bf16 v[32:35], a[28:31], a[136:139], v[32:35]
    ds_read_b64_tr_b16 a[10:11], v29 offset:7680
    v_mfma_f32_16x16x32_bf16 v[36:39], a[24:27], a[132:135], v[36:39]
    ds_read_b64_tr_b16 a[12:13], v29 offset:9216
    v_mfma_f32_16x16x32_bf16 v[36:39], a[28:31], a[140:143], v[36:39]
    s_waitcnt lgkmcnt(7)
    ds_read_b64_tr_b16 a[14:15], v29 offset:10752
    v_mfma_f32_16x16x32_bf16 v[40:43], a[32:35], a[128:131], v[40:43]
    ds_read_b64_tr_b16 a[16:17], v29 offset:37440
    buffer_load_dwordx4 a[228:231], v18, s[20:23], s70 offen offset:1024 sc1
    v_mfma_f32_16x16x32_bf16 v[40:43], a[36:39], a[136:139], v[40:43]
    ds_read_b64_tr_b16 a[18:19], v29 offset:38976
    v_mfma_f32_16x16x32_bf16 v[44:47], a[32:35], a[132:135], v[44:47]
    ds_read_b64_tr_b16 a[20:21], v29 offset:40512
    v_mfma_f32_16x16x32_bf16 v[44:47], a[36:39], a[140:143], v[44:47]
    ds_read_b64_tr_b16 a[22:23], v29 offset:42048
    buffer_load_dwordx4 a[232:235], v18, s[20:23], s70 offen offset:2048 sc1
    v_mfma_f32_16x16x32_bf16 v[48:51], a[40:43], a[128:131], v[48:51]
    ds_read_b64_tr_b16 a[24:25], v29 offset:32
    v_mfma_f32_16x16x32_bf16 v[48:51], a[44:47], a[136:139], v[48:51]
    ds_read_b64_tr_b16 a[26:27], v29 offset:1568
    v_mfma_f32_16x16x32_bf16 v[52:55], a[40:43], a[132:135], v[52:55]
    ds_read_b64_tr_b16 a[28:29], v29 offset:3104
    buffer_load_dwordx4 a[236:239], v18, s[20:23], s70 offen offset:3072 sc1
    v_mfma_f32_16x16x32_bf16 v[52:55], a[44:47], a[140:143], v[52:55]
    s_waitcnt lgkmcnt(7)
    ds_read_b64_tr_b16 a[30:31], v29 offset:4640
    s_waitcnt vmcnt(31)
    v_mfma_f32_16x16x32_bf16 v[32:35], a[0:3], a[144:147], v[32:35]
    ds_read_b64_tr_b16 a[32:33], v29 offset:6176
    s_waitcnt vmcnt(28)
    v_mfma_f32_16x16x32_bf16 v[32:35], a[4:7], a[152:155], v[32:35]
    ds_read_b64_tr_b16 a[34:35], v29 offset:7712
    s_waitcnt vmcnt(12)
    s_add_u32 s71, s66, 1
    v_mov_b32 v22, s71
    buffer_store_dword v22, off, s[20:23], s93 sc1
    v_mfma_f32_16x16x32_bf16 v[36:39], a[0:3], a[148:151], v[36:39]
    ds_read_b64_tr_b16 a[36:37], v29 offset:9248
    v_mfma_f32_16x16x32_bf16 v[36:39], a[4:7], a[156:159], v[36:39]
    ds_read_b64_tr_b16 a[38:39], v29 offset:10784
    v_mfma_f32_16x16x32_bf16 v[32:35], a[8:11], a[160:163], v[32:35]
    s_add_u32 s70, s78, 24576
    ds_read_b64_tr_b16 a[40:41], v29 offset:37472
    buffer_load_dwordx4 v[202:205], v18, s[20:23], s70 offen offset:0 sc1
    v_mfma_f32_16x16x32_bf16 v[32:35], a[12:15], a[168:171], v[32:35]
    ds_read_b64_tr_b16 a[42:43], v29 offset:39008
    v_mfma_f32_16x16x32_bf16 v[36:39], a[8:11], a[164:167], v[36:39]
    ds_read_b64_tr_b16 a[44:45], v29 offset:40544
    buffer_load_dwordx4 v[206:209], v18, s[20:23], s70 offen offset:1024 sc1
    v_mfma_f32_16x16x32_bf16 v[36:39], a[12:15], a[172:175], v[36:39]
    s_waitcnt lgkmcnt(7)
    ds_read_b64_tr_b16 a[46:47], v29 offset:42080
    v_mfma_f32_16x16x32_bf16 v[32:35], a[16:19], a[176:179], v[32:35]
    ds_read_b64_tr_b16 a[0:1], v29 offset:64
    v_mfma_f32_16x16x32_bf16 v[32:35], a[20:23], a[184:187], v[32:35]
    ds_read_b64_tr_b16 a[2:3], v29 offset:1600
    buffer_load_dwordx2 v[210:211], v251, s[20:23], s70 offen offset:2048 sc1
    buffer_load_dwordx2 v[212:213], v251, s[20:23], s70 offen offset:2560 sc1
    v_mfma_f32_16x16x32_bf16 v[36:39], a[16:19], a[180:183], v[36:39]
    ds_read_b64_tr_b16 a[4:5], v29 offset:3136
    v_mfma_f32_16x16x32_bf16 v[36:39], a[20:23], a[188:191], v[36:39]
    ds_read_b64_tr_b16 a[6:7], v29 offset:4672
    v_mfma_f32_16x16x32_bf16 v[40:43], a[24:27], a[144:147], v[40:43]
    ds_read_b64_tr_b16 a[8:9], v29 offset:6208
    buffer_load_dwordx2 v[214:215], v251, s[20:23], s70 offen offset:3072 sc1
    buffer_load_dwordx2 v[216:217], v251, s[20:23], s70 offen offset:3584 sc1
    v_mfma_f32_16x16x32_bf16 v[40:43], a[28:31], a[152:155], v[40:43]
    ds_read_b64_tr_b16 a[10:11], v29 offset:7744
    v_mfma_f32_16x16x32_bf16 v[44:47], a[24:27], a[148:151], v[44:47]
    ds_read_b64_tr_b16 a[12:13], v29 offset:9280
    v_mfma_f32_16x16x32_bf16 v[44:47], a[28:31], a[156:159], v[44:47]
    s_waitcnt lgkmcnt(7)
    ds_read_b64_tr_b16 a[14:15], v29 offset:10816
    v_mfma_f32_16x16x32_bf16 v[40:43], a[32:35], a[160:163], v[40:43]
    s_add_u32 s70, s78, 28672
    ds_read_b64_tr_b16 a[16:17], v29 offset:37504
    buffer_load_dwordx4 v[218:221], v18, s[20:23], s70 offen offset:0 sc1
    v_mfma_f32_16x16x32_bf16 v[40:43], a[36:39], a[168:171], v[40:43]
    ds_read_b64_tr_b16 a[18:19], v29 offset:39040
    v_mfma_f32_16x16x32_bf16 v[44:47], a[32:35], a[164:167], v[44:47]
    ds_read_b64_tr_b16 a[20:21], v29 offset:40576
    buffer_load_dwordx4 v[222:225], v18, s[20:23], s70 offen offset:1024 sc1
    v_mfma_f32_16x16x32_bf16 v[44:47], a[36:39], a[172:175], v[44:47]
    ds_read_b64_tr_b16 a[22:23], v29 offset:42112
    v_mfma_f32_16x16x32_bf16 v[40:43], a[40:43], a[176:179], v[40:43]
    ds_read_b64_tr_b16 a[24:25], v29 offset:43584
    buffer_load_dwordx4 v[226:229], v18, s[20:23], s70 offen offset:2048 sc1
    v_mfma_f32_16x16x32_bf16 v[40:43], a[44:47], a[184:187], v[40:43]
    ds_read_b64_tr_b16 a[26:27], v29 offset:45120
    v_mfma_f32_16x16x32_bf16 v[44:47], a[40:43], a[180:183], v[44:47]
    ds_read_b64_tr_b16 a[28:29], v29 offset:46656
    v_mfma_f32_16x16x32_bf16 v[44:47], a[44:47], a[188:191], v[44:47]
    s_waitcnt lgkmcnt(7)
    ds_read_b64_tr_b16 a[30:31], v29 offset:48192
    buffer_load_dwordx4 v[230:233], v18, s[20:23], s70 offen offset:3072 sc1
    v_mfma_f32_16x16x32_bf16 v[48:51], a[0:3], a[144:147], v[48:51]
    ds_read_b64_tr_b16 a[32:33], v30 offset:9344
    v_mfma_f32_16x16x32_bf16 v[48:51], a[4:7], a[152:155], v[48:51]
    ds_read_b64_tr_b16 a[34:35], v30 offset:10880
    v_mfma_f32_16x16x32_bf16 v[52:55], a[0:3], a[148:151], v[52:55]
    s_add_u32 s70, s78, 32768
    ds_read_b64_tr_b16 a[36:37], v30 offset:12416
    buffer_load_dwordx4 v[234:237], v18, s[20:23], s70 offen offset:0 sc1
    v_mfma_f32_16x16x32_bf16 v[52:55], a[4:7], a[156:159], v[52:55]
    ds_read_b64_tr_b16 a[38:39], v30 offset:13952
    v_mfma_f32_16x16x32_bf16 v[48:51], a[8:11], a[160:163], v[48:51]
    ds_read_b64_tr_b16 a[40:41], v30 offset:15488
    v_mfma_f32_16x16x32_bf16 v[48:51], a[12:15], a[168:171], v[48:51]
    ds_read_b64_tr_b16 a[42:43], v30 offset:17024
    buffer_load_dwordx4 v[238:241], v18, s[20:23], s70 offen offset:1024 sc1
    v_mfma_f32_16x16x32_bf16 v[52:55], a[8:11], a[164:167], v[52:55]
    ds_read_b64_tr_b16 a[44:45], v30 offset:18560
    v_mfma_f32_16x16x32_bf16 v[52:55], a[12:15], a[172:175], v[52:55]
    s_waitcnt lgkmcnt(7)
    ds_read_b64_tr_b16 a[46:47], v30 offset:20096
    buffer_load_dwordx4 v[242:245], v18, s[20:23], s70 offen offset:2048 sc1
    v_mfma_f32_16x16x32_bf16 v[48:51], a[16:19], a[176:179], v[48:51]
    ds_read_b64_tr_b16 a[0:1], v29 offset:43616
    v_mfma_f32_16x16x32_bf16 v[48:51], a[20:23], a[184:187], v[48:51]
    ds_read_b64_tr_b16 a[2:3], v29 offset:45152
    v_mfma_f32_16x16x32_bf16 v[52:55], a[16:19], a[180:183], v[52:55]
    ds_read_b64_tr_b16 a[4:5], v29 offset:46688
    buffer_load_dwordx4 v[246:249], v18, s[20:23], s70 offen offset:3072 sc1
    v_mfma_f32_16x16x32_bf16 v[52:55], a[20:23], a[188:191], v[52:55]
    ds_read_b64_tr_b16 a[6:7], v29 offset:48224
    s_waitcnt vmcnt(26)
    v_mfma_f32_16x16x32_bf16 v[32:35], a[24:27], a[192:195], v[32:35]
    ds_read_b64_tr_b16 a[8:9], v30 offset:9376
    s_waitcnt vmcnt(24)
    v_mfma_f32_16x16x32_bf16 v[32:35], a[28:31], a[200:203], v[32:35]
    ds_read_b64_tr_b16 a[10:11], v30 offset:10912
    v_mfma_f32_16x16x32_bf16 v[36:39], a[24:27], a[196:199], v[36:39]
    ds_read_b64_tr_b16 a[12:13], v30 offset:12448
    s_waitcnt vmcnt(23)
    v_mfma_f32_16x16x32_bf16 v[36:39], a[28:31], a[204:207], v[36:39]
    s_waitcnt lgkmcnt(7)
    ds_read_b64_tr_b16 a[14:15], v30 offset:13984
    s_waitcnt vmcnt(22)
    v_mfma_f32_16x16x32_bf16 v[32:35], a[32:35], a[208:211], v[32:35]
    ds_read_b64_tr_b16 a[16:17], v30 offset:15520
    s_waitcnt vmcnt(20)
    v_mfma_f32_16x16x32_bf16 v[32:35], a[36:39], a[216:219], v[32:35]
    ds_read_b64_tr_b16 a[18:19], v30 offset:17056
    v_mfma_f32_16x16x32_bf16 v[36:39], a[32:35], a[212:215], v[36:39]
    ds_read_b64_tr_b16 a[20:21], v30 offset:18592
    s_waitcnt vmcnt(19)
    v_mfma_f32_16x16x32_bf16 v[36:39], a[36:39], a[220:223], v[36:39]
    ds_read_b64_tr_b16 a[22:23], v30 offset:20128
    s_waitcnt vmcnt(18)
    v_mfma_f32_16x16x32_bf16 v[32:35], a[40:43], a[224:227], v[32:35]
    ds_read_b64_tr_b16 a[24:25], v29 offset:43648
    s_waitcnt vmcnt(16)
    v_mfma_f32_16x16x32_bf16 v[32:35], a[44:47], a[232:235], v[32:35]
    ds_read_b64_tr_b16 a[26:27], v29 offset:45184
    v_mfma_f32_16x16x32_bf16 v[36:39], a[40:43], a[228:231], v[36:39]
    ds_read_b64_tr_b16 a[28:29], v29 offset:46720
    s_waitcnt vmcnt(15)
    v_mfma_f32_16x16x32_bf16 v[36:39], a[44:47], a[236:239], v[36:39]
    s_waitcnt lgkmcnt(7)
    ds_read_b64_tr_b16 a[30:31], v29 offset:48256
    v_mfma_f32_16x16x32_bf16 v[40:43], a[0:3], a[192:195], v[40:43]
    ds_read_b64_tr_b16 a[32:33], v30 offset:9408
    v_mfma_f32_16x16x32_bf16 v[40:43], a[4:7], a[200:203], v[40:43]
    ds_read_b64_tr_b16 a[34:35], v30 offset:10944
    v_mfma_f32_16x16x32_bf16 v[44:47], a[0:3], a[196:199], v[44:47]
    ds_read_b64_tr_b16 a[36:37], v30 offset:12480
    v_mfma_f32_16x16x32_bf16 v[44:47], a[4:7], a[204:207], v[44:47]
    ds_read_b64_tr_b16 a[38:39], v30 offset:14016
    v_mfma_f32_16x16x32_bf16 v[40:43], a[8:11], a[208:211], v[40:43]
    ds_read_b64_tr_b16 a[40:41], v30 offset:15552
    v_mfma_f32_16x16x32_bf16 v[40:43], a[12:15], a[216:219], v[40:43]
    ds_read_b64_tr_b16 a[42:43], v30 offset:17088
    v_mfma_f32_16x16x32_bf16 v[44:47], a[8:11], a[212:215], v[44:47]
    ds_read_b64_tr_b16 a[44:45], v30 offset:18624
    buffer_load_dword v21, v25, s[20:23], 0 offen sc1
    v_mfma_f32_16x16x32_bf16 v[44:47], a[12:15], a[220:223], v[44:47]
    s_waitcnt lgkmcnt(7)
    ds_read_b64_tr_b16 a[46:47], v30 offset:20160
    v_mfma_f32_16x16x32_bf16 v[40:43], a[16:19], a[224:227], v[40:43]
    ds_read_b64_tr_b16 a[0:1], v30 offset:46784
    v_mfma_f32_16x16x32_bf16 v[40:43], a[20:23], a[232:235], v[40:43]
    ds_read_b64_tr_b16 a[2:3], v30 offset:48320
    v_mfma_f32_16x16x32_bf16 v[44:47], a[16:19], a[228:231], v[44:47]
    ds_read_b64_tr_b16 a[4:5], v30 offset:49856
    v_mfma_f32_16x16x32_bf16 v[44:47], a[20:23], a[236:239], v[44:47]
    ds_read_b64_tr_b16 a[6:7], v30 offset:51392
    v_mfma_f32_16x16x32_bf16 v[48:51], a[24:27], a[192:195], v[48:51]
    ds_read_b64_tr_b16 a[8:9], v30 offset:52928
    v_mfma_f32_16x16x32_bf16 v[48:51], a[28:31], a[200:203], v[48:51]
    ds_read_b64_tr_b16 a[10:11], v30 offset:54464
    v_mfma_f32_16x16x32_bf16 v[52:55], a[24:27], a[196:199], v[52:55]
    ds_read_b64_tr_b16 a[12:13], v30 offset:56000
    v_mfma_f32_16x16x32_bf16 v[52:55], a[28:31], a[204:207], v[52:55]
    s_waitcnt lgkmcnt(7)
    ds_read_b64_tr_b16 a[14:15], v30 offset:57536
    v_mfma_f32_16x16x32_bf16 v[48:51], a[32:35], a[208:211], v[48:51]
    ds_read_b64_tr_b16 a[16:17], v31 offset:18688
    v_mfma_f32_16x16x32_bf16 v[48:51], a[36:39], a[216:219], v[48:51]
    ds_read_b64_tr_b16 a[18:19], v31 offset:20224
    v_mfma_f32_16x16x32_bf16 v[52:55], a[32:35], a[212:215], v[52:55]
    ds_read_b64_tr_b16 a[20:21], v31 offset:21760
    v_mfma_f32_16x16x32_bf16 v[52:55], a[36:39], a[220:223], v[52:55]
    ds_read_b64_tr_b16 a[22:23], v31 offset:23296
    v_mfma_f32_16x16x32_bf16 v[48:51], a[40:43], a[224:227], v[48:51]
    ds_read_b64_tr_b16 a[24:25], v30 offset:46816
    v_mfma_f32_16x16x32_bf16 v[48:51], a[44:47], a[232:235], v[48:51]
    ds_read_b64_tr_b16 a[26:27], v30 offset:48352
    v_mfma_f32_16x16x32_bf16 v[52:55], a[40:43], a[228:231], v[52:55]
    ds_read_b64_tr_b16 a[28:29], v30 offset:49888
    v_mfma_f32_16x16x32_bf16 v[52:55], a[44:47], a[236:239], v[52:55]
    s_waitcnt lgkmcnt(7)
    ds_read_b64_tr_b16 a[30:31], v30 offset:51424
    s_waitcnt vmcnt(14)
    v_mfma_f32_16x16x32_bf16 v[32:35], a[0:3], v[202:205], v[32:35]
    ds_read_b64_tr_b16 a[32:33], v30 offset:52960
    s_add_u32 s71, s66, 1
    s_waitcnt vmcnt(0)
    v_subrev_u32 v21, s71, v21
    v_cmp_gt_u32 vcc, 8, v21
    s_nop 0
    s_cmp_eq_u64 vcc, exec
    s_cbranch_scc0 L_slow_17
L_back_18:
    v_mfma_f32_16x16x32_bf16 v[32:35], a[4:7], v[210:213], v[32:35]
    s_add_u32 s72, s79, 1327104
    ds_read_b64_tr_b16 a[34:35], v30 offset:54496
    buffer_load_dwordx4 v[166:169], v18, s[20:23], s72 offen offset:0 sc1
    v_mfma_f32_16x16x32_bf16 v[36:39], a[0:3], v[206:209], v[36:39]
    ds_read_b64_tr_b16 a[36:37], v30 offset:56032
    v_mfma_f32_16x16x32_bf16 v[36:39], a[4:7], v[214:217], v[36:39]
    ds_read_b64_tr_b16 a[38:39], v30 offset:57568
    buffer_load_dwordx4 v[170:173], v18, s[20:23], s72 offen offset:1024 sc1
    v_mfma_f32_16x16x32_bf16 v[32:35], a[8:11], v[218:221], v[32:35]
    ds_read_b64_tr_b16 a[40:41], v31 offset:18720
    v_mfma_f32_16x16x32_bf16 v[32:35], a[12:15], v[226:229], v[32:35]
    ds_read_b64_tr_b16 a[42:43], v31 offset:20256
    buffer_load_dwordx4 v[174:177], v18, s[20:23], s72 offen offset:2048 sc1
    v_mfma_f32_16x16x32_bf16 v[36:39], a[8:11], v[222:225], v[36:39]
    ds_read_b64_tr_b16 a[44:45], v31 offset:21792
    v_mfma_f32_16x16x32_bf16 v[36:39], a[12:15], v[230:233], v[36:39]
    s_waitcnt lgkmcnt(7)
    ds_read_b64_tr_b16 a[46:47], v31 offset:23328
    v_mfma_f32_16x16x32_bf16 v[32:35], a[16:19], v[234:237], v[32:35]
    s_add_u32 s72, s79, 887808
    ds_read_b64_tr_b16 a[0:1], v30 offset:46848
    buffer_load_dwordx4 v[178:181], v18, s[20:23], s72 offen offset:0 sc1
    v_mfma_f32_16x16x32_bf16 v[32:35], a[20:23], v[242:245], v[32:35]
    ds_read_b64_tr_b16 a[2:3], v30 offset:48384
    v_mfma_f32_16x16x32_bf16 v[36:39], a[16:19], v[238:241], v[36:39]
    ds_read_b64_tr_b16 a[4:5], v30 offset:49920
    buffer_load_dwordx4 v[182:185], v18, s[20:23], s72 offen offset:1024 sc1
    v_mfma_f32_16x16x32_bf16 v[36:39], a[20:23], v[246:249], v[36:39]
    ds_read_b64_tr_b16 a[6:7], v30 offset:51456
    v_mfma_f32_16x16x32_bf16 v[40:43], a[24:27], v[202:205], v[40:43]
    ds_read_b64_tr_b16 a[8:9], v30 offset:52992
    buffer_load_dwordx4 v[186:189], v18, s[20:23], s72 offen offset:2048 sc1
    v_mfma_f32_16x16x32_bf16 v[40:43], a[28:31], v[210:213], v[40:43]
    ds_read_b64_tr_b16 a[10:11], v30 offset:54528
    v_mfma_f32_16x16x32_bf16 v[44:47], a[24:27], v[206:209], v[44:47]
    ds_read_b64_tr_b16 a[12:13], v30 offset:56064
    v_mfma_f32_16x16x32_bf16 v[44:47], a[28:31], v[214:217], v[44:47]
    s_waitcnt lgkmcnt(7)
    ds_read_b64_tr_b16 a[14:15], v30 offset:57600
    v_mfma_f32_16x16x32_bf16 v[40:43], a[32:35], v[218:221], v[40:43]
    s_add_u32 s72, s79, 448512
    ds_read_b64_tr_b16 a[16:17], v31 offset:18752
    buffer_load_dwordx4 v[190:193], v18, s[20:23], s72 offen offset:0 sc1
    v_mfma_f32_16x16x32_bf16 v[40:43], a[36:39], v[226:229], v[40:43]
    ds_read_b64_tr_b16 a[18:19], v31 offset:20288
    buffer_load_dwordx4 v[194:197], v18, s[20:23], s72 offen offset:1024 sc1
    v_mfma_f32_16x16x32_bf16 v[44:47], a[32:35], v[222:225], v[44:47]
    ds_read_b64_tr_b16 a[20:21], v31 offset:21824
    v_mfma_f32_16x16x32_bf16 v[44:47], a[36:39], v[230:233], v[44:47]
    ds_read_b64_tr_b16 a[22:23], v31 offset:23360
    buffer_load_dwordx4 v[198:201], v18, s[20:23], s72 offen offset:2048 sc1
    v_mfma_f32_16x16x32_bf16 v[40:43], a[40:43], v[234:237], v[40:43]
    v_mfma_f32_16x16x32_bf16 v[40:43], a[44:47], v[242:245], v[40:43]
    v_mfma_f32_16x16x32_bf16 v[44:47], a[40:43], v[238:241], v[44:47]
    v_mfma_f32_16x16x32_bf16 v[44:47], a[44:47], v[246:249], v[44:47]
    s_waitcnt lgkmcnt(4)
    v_mfma_f32_16x16x32_bf16 v[48:51], a[0:3], v[202:205], v[48:51]
    v_mfma_f32_16x16x32_bf16 v[48:51], a[4:7], v[210:213], v[48:51]
    v_mfma_f32_16x16x32_bf16 v[52:55], a[0:3], v[206:209], v[52:55]
    v_mfma_f32_16x16x32_bf16 v[52:55], a[4:7], v[214:217], v[52:55]
    v_mfma_f32_16x16x32_bf16 v[48:51], a[8:11], v[218:221], v[48:51]
    v_mfma_f32_16x16x32_bf16 v[48:51], a[12:15], v[226:229], v[48:51]
    v_mfma_f32_16x16x32_bf16 v[52:55], a[8:11], v[222:225], v[52:55]
    v_mfma_f32_16x16x32_bf16 v[52:55], a[12:15], v[230:233], v[52:55]
    s_waitcnt lgkmcnt(0)
    v_mfma_f32_16x16x32_bf16 v[48:51], a[16:19], v[234:237], v[48:51]
    v_mfma_f32_16x16x32_bf16 v[48:51], a[20:23], v[242:245], v[48:51]
    v_mfma_f32_16x16x32_bf16 v[52:55], a[16:19], v[238:241], v[52:55]
    v_mfma_f32_16x16x32_bf16 v[52:55], a[20:23], v[246:249], v[52:55]
    v_add_f32 v142, v142, v32
    v_add_f32 v143, v143, v33
    v_add_f32 v144, v144, v34
    v_add_f32 v145, v145, v35
    v_add_f32 v146, v146, v36
    v_add_f32 v147, v147, v37
    v_add_f32 v148, v148, v38
    v_add_f32 v149, v149, v39
    v_add_f32 v150, v150, v40
    v_add_f32 v151, v151, v41
    v_add_f32 v152, v152, v42
    v_add_f32 v153, v153, v43
    v_add_f32 v154, v154, v44
    v_add_f32 v155, v155, v45
    v_add_f32 v156, v156, v46
    v_add_f32 v157, v157, v47
    v_add_f32 v158, v158, v48
    v_add_f32 v159, v159, v49
    v_add_f32 v160, v160, v50
    v_add_f32 v161, v161, v51
    v_add_f32 v162, v162, v52
    v_add_f32 v163, v163, v53
    v_add_f32 v164, v164, v54
    v_add_f32 v165, v165, v55
    s_waitcnt vmcnt(8)
    v_mfma_f32_16x16x32_bf16 v[142:145], v[138:141], v[166:169], v[142:145]
    v_mfma_f32_16x16x32_bf16 v[146:149], v[136:139], v[166:169], v[146:149]
    s_waitcnt vmcnt(7)
    v_mfma_f32_16x16x32_bf16 v[150:153], v[138:141], v[170:173], v[150:153]
    v_mfma_f32_16x16x32_bf16 v[154:157], v[136:139], v[170:173], v[154:157]
    s_waitcnt vmcnt(6)
    v_mfma_f32_16x16x32_bf16 v[158:161], v[138:141], v[174:177], v[158:161]
    v_mfma_f32_16x16x32_bf16 v[162:165], v[136:139], v[174:177], v[162:165]
    s_waitcnt vmcnt(5)
    v_mfma_f32_16x16x32_bf16 v[142:145], v[138:141], v[178:181], v[142:145]
    v_mfma_f32_16x16x32_bf16 v[146:149], v[136:139], v[178:181], v[146:149]
    s_waitcnt vmcnt(4)
    v_mfma_f32_16x16x32_bf16 v[150:153], v[138:141], v[182:185], v[150:153]
    v_mfma_f32_16x16x32_bf16 v[154:157], v[136:139], v[182:185], v[154:157]
    s_waitcnt vmcnt(3)
    v_mfma_f32_16x16x32_bf16 v[158:161], v[138:141], v[186:189], v[158:161]
    v_mfma_f32_16x16x32_bf16 v[162:165], v[136:139], v[186:189], v[162:165]
    s_waitcnt vmcnt(2)
    v_mfma_f32_16x16x32_bf16 v[142:145], v[138:141], v[190:193], v[142:145]
    v_mfma_f32_16x16x32_bf16 v[146:149], v[136:139], v[190:193], v[146:149]
    s_waitcnt vmcnt(1)
    v_mfma_f32_16x16x32_bf16 v[150:153], v[138:141], v[194:197], v[150:153]
    v_mfma_f32_16x16x32_bf16 v[154:157], v[136:139], v[194:197], v[154:157]
    s_waitcnt vmcnt(0)
    v_mfma_f32_16x16x32_bf16 v[158:161], v[138:141], v[198:201], v[158:161]
    v_mfma_f32_16x16x32_bf16 v[162:165], v[136:139], v[198:201], v[162:165]
    s_nop 0
    v_cvt_pk_bf16_f32 v142, v142, v143
    v_cvt_pk_bf16_f32 v143, v144, v145
    buffer_store_dwordx2 v[142:143], v23, s[24:27], s89 offen offset:0 sc1
    v_cvt_pk_bf16_f32 v146, v146, v147
    v_cvt_pk_bf16_f32 v147, v148, v149
    buffer_store_dwordx2 v[146:147], v23, s[24:27], s91 offen offset:0 sc1
    v_cvt_pk_bf16_f32 v150, v150, v151
    v_cvt_pk_bf16_f32 v151, v152, v153
    buffer_store_dwordx2 v[150:151], v23, s[24:27], s89 offen offset:32 sc1
    v_cvt_pk_bf16_f32 v154, v154, v155
    v_cvt_pk_bf16_f32 v155, v156, v157
L_pad_v0_1:
    s_cbranch_execz L_walk_ret
    buffer_store_dwordx2 v[154:155], v23, s[24:27], s91 offen offset:32 sc1
    v_cvt_pk_bf16_f32 v158, v158, v159
    v_cvt_pk_bf16_f32 v159, v160, v161
    buffer_store_dwordx2 v[158:159], v23, s[24:27], s89 offen offset:64 sc1
    v_cvt_pk_bf16_f32 v162, v162, v163
    v_cvt_pk_bf16_f32 v163, v164, v165
    buffer_store_dwordx2 v[162:163], v23, s[24:27], s91 offen offset:64 sc1
    s_or_b32 s68, s65, s62
    s_cmp_lg_u32 s68, 0
    s_cbranch_scc1 L_noep_20
    s_add_u32 s71, s66, 16
    v_mov_b32 v22, s71
    buffer_store_dword v22, off, s[20:23], s96 sc1
L_noep_20:
    s_endpgm
L_tail_11:
L_pad_v1_0:
    s_cbranch_execz L_pad_v1_1
    s_nop 3
    v_mfma_f32_16x16x32_bf16 v[80:83], a[0:3], a[64:67], v[80:83]
    ds_read_b64_tr_b16 a[32:33], v4 offset:10240
    v_mfma_f32_16x16x32_bf16 v[80:83], a[4:7], a[72:75], v[80:83]
    ds_read_b64_tr_b16 a[34:35], v4 offset:47680
    v_mfma_f32_16x16x32_bf16 v[84:87], a[0:3], a[68:71], v[84:87]
    s_mov_b32 m0, s73
    ds_read_b64_tr_b16 a[36:37], v8 offset:19584
    v_mfma_f32_16x16x32_bf16 v[84:87], a[4:7], a[76:79], v[84:87]
    s_mov_b32 s72, s3
    ds_read_b64_tr_b16 a[38:39], v8 offset:57024
    buffer_load_dwordx4 v14, s[4:7], s72 offen offset:0 lds
    v_mfma_f32_16x16x32_bf16 v[88:91], a[8:11], a[64:67], v[88:91]
    ds_read_b64_tr_b16 a[40:41], v5 offset:10240
    v_mfma_f32_16x16x32_bf16 v[88:91], a[12:15], a[72:75], v[88:91]
    ds_read_b64_tr_b16 a[42:43], v5 offset:47680
    v_mfma_f32_16x16x32_bf16 v[92:95], a[8:11], a[68:71], v[92:95]
    ds_read_b64_tr_b16 a[44:45], v9 offset:19584
    v_mfma_f32_16x16x32_bf16 v[92:95], a[12:15], a[76:79], v[92:95]
    s_waitcnt vmcnt(17) lgkmcnt(7)
    ds_read_b64_tr_b16 a[46:47], v9 offset:57024
    buffer_load_dwordx4 v15, s[4:7], s72 offen offset:1024 lds
    v_mfma_f32_16x16x32_bf16 v[96:99], a[16:19], a[64:67], v[96:99]
    s_barrier
    ds_read_b64_tr_b16 a[0:1], v4 offset:14336
    v_mfma_f32_16x16x32_bf16 v[96:99], a[20:23], a[72:75], v[96:99]
    ds_read_b64_tr_b16 a[2:3], v4 offset:51776
    v_mfma_f32_16x16x32_bf16 v[100:103], a[16:19], a[68:71], v[100:103]
    ds_read_b64_tr_b16 a[4:5], v8 offset:23680
    v_mfma_f32_16x16x32_bf16 v[100:103], a[20:23], a[76:79], v[100:103]
    ds_read_b64_tr_b16 a[6:7], v8 offset:61120
    buffer_load_dwordx4 v19, s[4:7], s72 offen offset:2048 lds
    v_mfma_f32_16x16x32_bf16 v[104:107], a[24:27], a[64:67], v[104:107]
    ds_read_b64_tr_b16 a[8:9], v5 offset:14336
    v_mfma_f32_16x16x32_bf16 v[104:107], a[28:31], a[72:75], v[104:107]
    ds_read_b64_tr_b16 a[10:11], v5 offset:51776
    v_mfma_f32_16x16x32_bf16 v[108:111], a[24:27], a[68:71], v[108:111]
    ds_read_b64_tr_b16 a[12:13], v9 offset:23680
    v_mfma_f32_16x16x32_bf16 v[108:111], a[28:31], a[76:79], v[108:111]
    s_waitcnt lgkmcnt(7)
    ds_read_b64_tr_b16 a[14:15], v9 offset:61120
    v_mfma_f32_16x16x32_bf16 v[112:115], a[32:35], a[64:67], v[112:115]
    ds_read_b64_tr_b16 a[16:17], v2 offset:16384
    v_mfma_f32_16x16x32_bf16 v[112:115], a[36:39], a[72:75], v[112:115]
    ds_read_b64_tr_b16 a[18:19], v2 offset:53824
    v_mfma_f32_16x16x32_bf16 v[116:119], a[32:35], a[68:71], v[116:119]
    ds_read_b64_tr_b16 a[20:21], v6 offset:25728
    v_mfma_f32_16x16x32_bf16 v[116:119], a[36:39], a[76:79], v[116:119]
    ds_read_b64_tr_b16 a[22:23], v6 offset:63168
    v_mfma_f32_16x16x32_bf16 v[120:123], a[40:43], a[64:67], v[120:123]
    ds_read_b64_tr_b16 a[24:25], v4 offset:20480
    v_mfma_f32_16x16x32_bf16 v[120:123], a[44:47], a[72:75], v[120:123]
    ds_read_b64_tr_b16 a[26:27], v4 offset:57920
    v_mfma_f32_16x16x32_bf16 v[124:127], a[40:43], a[68:71], v[124:127]
    ds_read_b64_tr_b16 a[28:29], v8 offset:29824
    v_mfma_f32_16x16x32_bf16 v[124:127], a[44:47], a[76:79], v[124:127]
    s_waitcnt lgkmcnt(7)
    ds_read_b64_tr_b16 a[30:31], v12 offset:1728
    v_mfma_f32_16x16x32_bf16 v[80:83], a[0:3], a[80:83], v[80:83]
    ds_read_b64_tr_b16 a[32:33], v5 offset:20480
    v_mfma_f32_16x16x32_bf16 v[80:83], a[4:7], a[88:91], v[80:83]
    s_add_u32 m0, s67, 0
    ds_read_b64_tr_b16 a[34:35], v5 offset:57920
    v_mfma_f32_16x16x32_bf16 v[84:87], a[0:3], a[84:87], v[84:87]
    s_add_u32 s72, s83, 0
    ds_read_b64_tr_b16 a[36:37], v9 offset:29824
    buffer_load_dwordx4 v14, s[4:7], s72 offen offset:0 lds
    v_mfma_f32_16x16x32_bf16 v[84:87], a[4:7], a[92:95], v[84:87]
    ds_read_b64_tr_b16 a[38:39], v13 offset:1728
    v_mfma_f32_16x16x32_bf16 v[88:91], a[8:11], a[80:83], v[88:91]
    ds_read_b64_tr_b16 a[40:41], v2 offset:22528
    v_mfma_f32_16x16x32_bf16 v[88:91], a[12:15], a[88:91], v[88:91]
    ds_read_b64_tr_b16 a[42:43], v2 offset:59968
    v_mfma_f32_16x16x32_bf16 v[92:95], a[8:11], a[84:87], v[92:95]
    ds_read_b64_tr_b16 a[44:45], v6 offset:31872
    buffer_load_dwordx4 v15, s[4:7], s72 offen offset:1024 lds
    v_mfma_f32_16x16x32_bf16 v[92:95], a[12:15], a[92:95], v[92:95]
    s_waitcnt vmcnt(5) lgkmcnt(7)
    ds_read_b64_tr_b16 a[46:47], v10 offset:3776
    v_mfma_f32_16x16x32_bf16 v[96:99], a[16:19], a[80:83], v[96:99]
    s_barrier
    ds_read_b64_tr_b16 a[0:1], v4 offset:26624
    v_mfma_f32_16x16x32_bf16 v[96:99], a[20:23], a[88:91], v[96:99]
    ds_read_b64_tr_b16 a[2:3], v4 offset:64064
    v_mfma_f32_16x16x32_bf16 v[100:103], a[16:19], a[84:87], v[100:103]
    ds_read_b64_tr_b16 a[4:5], v8 offset:35968
    buffer_load_dwordx4 v19, s[4:7], s72 offen offset:2048 lds
    v_mfma_f32_16x16x32_bf16 v[100:103], a[20:23], a[92:95], v[100:103]
    ds_read_b64_tr_b16 a[6:7], v12 offset:7872
    v_mfma_f32_16x16x32_bf16 v[80:83], a[24:27], a[96:99], v[80:83]
    ds_read_b64_tr_b16 a[8:9], v5 offset:26624
    v_mfma_f32_16x16x32_bf16 v[80:83], a[28:31], a[104:107], v[80:83]
    s_add_u32 m0, s67, 3072
    ds_read_b64_tr_b16 a[10:11], v5 offset:64064
    v_mfma_f32_16x16x32_bf16 v[84:87], a[24:27], a[100:103], v[84:87]
    s_add_u32 s72, s83, 36864
    ds_read_b64_tr_b16 a[12:13], v9 offset:35968
    buffer_load_dwordx4 v14, s[4:7], s72 offen offset:0 lds
    v_mfma_f32_16x16x32_bf16 v[84:87], a[28:31], a[108:111], v[84:87]
    s_waitcnt lgkmcnt(7)
    ds_read_b64_tr_b16 a[14:15], v13 offset:7872
    v_mfma_f32_16x16x32_bf16 v[88:91], a[32:35], a[96:99], v[88:91]
    ds_read_b64_tr_b16 a[16:17], v2 offset:28672
    v_mfma_f32_16x16x32_bf16 v[88:91], a[36:39], a[104:107], v[88:91]
    ds_read_b64_tr_b16 a[18:19], v6 offset:576
    v_mfma_f32_16x16x32_bf16 v[92:95], a[32:35], a[100:103], v[92:95]
    ds_read_b64_tr_b16 a[20:21], v6 offset:38016
    buffer_load_dwordx4 v15, s[4:7], s72 offen offset:1024 lds
    v_mfma_f32_16x16x32_bf16 v[92:95], a[36:39], a[108:111], v[92:95]
    ds_read_b64_tr_b16 a[22:23], v10 offset:9920
    v_mfma_f32_16x16x32_bf16 v[96:99], a[40:43], a[96:99], v[96:99]
    ds_read_b64_tr_b16 a[24:25], v4 offset:32768
    v_mfma_f32_16x16x32_bf16 v[96:99], a[44:47], a[104:107], v[96:99]
    ds_read_b64_tr_b16 a[26:27], v8 offset:4672
    v_mfma_f32_16x16x32_bf16 v[100:103], a[40:43], a[100:103], v[100:103]
    ds_read_b64_tr_b16 a[28:29], v8 offset:42112
    buffer_load_dwordx4 v19, s[4:7], s72 offen offset:2048 lds
    v_mfma_f32_16x16x32_bf16 v[100:103], a[44:47], a[108:111], v[100:103]
    s_waitcnt lgkmcnt(7)
    ds_read_b64_tr_b16 a[30:31], v12 offset:14016
    v_mfma_f32_16x16x32_bf16 v[80:83], a[0:3], a[112:115], v[80:83]
    ds_read_b64_tr_b16 a[32:33], v5 offset:32768
    v_mfma_f32_16x16x32_bf16 v[80:83], a[4:7], a[120:123], v[80:83]
    ds_read_b64_tr_b16 a[34:35], v9 offset:4672
    buffer_load_dword v21, v250, s[20:23], 0 offen sc1
    v_mfma_f32_16x16x32_bf16 v[84:87], a[0:3], a[116:119], v[84:87]
    ds_read_b64_tr_b16 a[36:37], v9 offset:42112
    v_mfma_f32_16x16x32_bf16 v[84:87], a[4:7], a[124:127], v[84:87]
    ds_read_b64_tr_b16 a[38:39], v13 offset:14016
    v_mfma_f32_16x16x32_bf16 v[88:91], a[8:11], a[112:115], v[88:91]
    s_add_u32 m0, s67, 6144
    ds_read_b64_tr_b16 a[40:41], v2 offset:34816
    v_mfma_f32_16x16x32_bf16 v[88:91], a[12:15], a[120:123], v[88:91]
    s_add_u32 s72, s83, 73728
    ds_read_b64_tr_b16 a[42:43], v6 offset:6720
    buffer_load_dwordx4 v14, s[4:7], s72 offen offset:0 lds
    v_mfma_f32_16x16x32_bf16 v[92:95], a[8:11], a[116:119], v[92:95]
    ds_read_b64_tr_b16 a[44:45], v6 offset:44160
    v_mfma_f32_16x16x32_bf16 v[92:95], a[12:15], a[124:127], v[92:95]
    s_waitcnt lgkmcnt(7)
    ds_read_b64_tr_b16 a[46:47], v10 offset:16064
    v_mfma_f32_16x16x32_bf16 v[96:99], a[16:19], a[112:115], v[96:99]
    ds_read_b64_tr_b16 a[0:1], v3 offset:16384
    buffer_load_dwordx4 v15, s[4:7], s72 offen offset:1024 lds
    v_mfma_f32_16x16x32_bf16 v[96:99], a[20:23], a[120:123], v[96:99]
    ds_read_b64_tr_b16 a[2:3], v3 offset:53824
    v_mfma_f32_16x16x32_bf16 v[100:103], a[16:19], a[116:119], v[100:103]
    ds_read_b64_tr_b16 a[4:5], v7 offset:25728
    v_mfma_f32_16x16x32_bf16 v[100:103], a[20:23], a[124:127], v[100:103]
    ds_read_b64_tr_b16 a[6:7], v7 offset:63168
    v_mfma_f32_16x16x32_bf16 v[80:83], a[24:27], a[128:131], v[80:83]
    ds_read_b64_tr_b16 a[8:9], v4 offset:16384
    buffer_load_dwordx4 v19, s[4:7], s72 offen offset:2048 lds
    v_mfma_f32_16x16x32_bf16 v[80:83], a[28:31], a[136:139], v[80:83]
    ds_read_b64_tr_b16 a[10:11], v4 offset:53824
    v_mfma_f32_16x16x32_bf16 v[84:87], a[24:27], a[132:135], v[84:87]
    s_add_u32 m0, s67, 9216
    ds_read_b64_tr_b16 a[12:13], v8 offset:25728
    v_mfma_f32_16x16x32_bf16 v[84:87], a[28:31], a[140:143], v[84:87]
    s_waitcnt lgkmcnt(7)
    ds_read_b64_tr_b16 a[14:15], v8 offset:63168
    v_mfma_f32_16x16x32_bf16 v[88:91], a[32:35], a[128:131], v[88:91]
    s_add_u32 s72, s83, 110592
    ds_read_b64_tr_b16 a[16:17], v5 offset:16384
    buffer_load_dwordx4 v14, s[4:7], s72 offen offset:0 lds
    v_mfma_f32_16x16x32_bf16 v[88:91], a[36:39], a[136:139], v[88:91]
    ds_read_b64_tr_b16 a[18:19], v5 offset:53824
    v_mfma_f32_16x16x32_bf16 v[92:95], a[32:35], a[132:135], v[92:95]
    ds_read_b64_tr_b16 a[20:21], v9 offset:25728
    buffer_load_dwordx4 v15, s[4:7], s72 offen offset:1024 lds
    v_mfma_f32_16x16x32_bf16 v[92:95], a[36:39], a[140:143], v[92:95]
    ds_read_b64_tr_b16 a[22:23], v9 offset:63168
    v_mfma_f32_16x16x32_bf16 v[96:99], a[40:43], a[128:131], v[96:99]
    ds_read_b64_tr_b16 a[24:25], v3 offset:22528
    v_mfma_f32_16x16x32_bf16 v[96:99], a[44:47], a[136:139], v[96:99]
    ds_read_b64_tr_b16 a[26:27], v3 offset:59968
    v_mfma_f32_16x16x32_bf16 v[100:103], a[40:43], a[132:135], v[100:103]
    ds_read_b64_tr_b16 a[28:29], v7 offset:31872
    buffer_load_dwordx4 v19, s[4:7], s72 offen offset:2048 lds
    v_mfma_f32_16x16x32_bf16 v[100:103], a[44:47], a[140:143], v[100:103]
    s_waitcnt lgkmcnt(7)
    ds_read_b64_tr_b16 a[30:31], v11 offset:3776
    v_mfma_f32_16x16x32_bf16 v[104:107], a[0:3], a[80:83], v[104:107]
    ds_read_b64_tr_b16 a[32:33], v4 offset:22528
    v_mfma_f32_16x16x32_bf16 v[104:107], a[4:7], a[88:91], v[104:107]
    ds_read_b64_tr_b16 a[34:35], v4 offset:59968
    v_mfma_f32_16x16x32_bf16 v[108:111], a[0:3], a[84:87], v[108:111]
    ds_read_b64_tr_b16 a[36:37], v8 offset:31872
    v_mfma_f32_16x16x32_bf16 v[108:111], a[4:7], a[92:95], v[108:111]
    ds_read_b64_tr_b16 a[38:39], v12 offset:3776
    v_mfma_f32_16x16x32_bf16 v[112:115], a[8:11], a[80:83], v[112:115]
    s_add_u32 s82, s79, 442368
    ds_read_b64_tr_b16 a[40:41], v5 offset:22528
    v_mfma_f32_16x16x32_bf16 v[112:115], a[12:15], a[88:91], v[112:115]
    ds_read_b64_tr_b16 a[42:43], v5 offset:59968
    v_cvt_pk_bf16_f32 v80, v80, v81
    v_mfma_f32_16x16x32_bf16 v[116:119], a[8:11], a[84:87], v[116:119]
    ds_read_b64_tr_b16 a[44:45], v9 offset:31872
    v_cvt_pk_bf16_f32 v81, v82, v83
    v_mfma_f32_16x16x32_bf16 v[116:119], a[12:15], a[92:95], v[116:119]
    s_waitcnt lgkmcnt(7)
    ds_read_b64_tr_b16 a[46:47], v13 offset:3776
    v_cvt_pk_bf16_f32 v82, v84, v85
    v_mfma_f32_16x16x32_bf16 v[120:123], a[16:19], a[80:83], v[120:123]
    ds_read_b64_tr_b16 a[0:1], v3 offset:28672
    v_cvt_pk_bf16_f32 v83, v86, v87
    v_mfma_f32_16x16x32_bf16 v[120:123], a[20:23], a[88:91], v[120:123]
    ds_read_b64_tr_b16 a[2:3], v7 offset:576
    buffer_store_dwordx4 v[80:83], v18, s[20:23], s82 offen offset:0 sc1
    v_mfma_f32_16x16x32_bf16 v[124:127], a[16:19], a[84:87], v[124:127]
    ds_read_b64_tr_b16 a[4:5], v7 offset:38016
    v_mfma_f32_16x16x32_bf16 v[124:127], a[20:23], a[92:95], v[124:127]
    ds_read_b64_tr_b16 a[6:7], v11 offset:9920
    v_mfma_f32_16x16x32_bf16 v[104:107], a[24:27], a[96:99], v[104:107]
    ds_read_b64_tr_b16 a[8:9], v4 offset:28672
    v_mfma_f32_16x16x32_bf16 v[104:107], a[28:31], a[104:107], v[104:107]
    ds_read_b64_tr_b16 a[10:11], v8 offset:576
    v_mfma_f32_16x16x32_bf16 v[108:111], a[24:27], a[100:103], v[108:111]
    ds_read_b64_tr_b16 a[12:13], v8 offset:38016
    v_mfma_f32_16x16x32_bf16 v[108:111], a[28:31], a[108:111], v[108:111]
    s_waitcnt lgkmcnt(7)
    ds_read_b64_tr_b16 a[14:15], v12 offset:9920
    v_mfma_f32_16x16x32_bf16 v[112:115], a[32:35], a[96:99], v[112:115]
    ds_read_b64_tr_b16 a[16:17], v5 offset:28672
    v_mfma_f32_16x16x32_bf16 v[112:115], a[36:39], a[104:107], v[112:115]
    ds_read_b64_tr_b16 a[18:19], v9 offset:576
    v_mfma_f32_16x16x32_bf16 v[116:119], a[32:35], a[100:103], v[116:119]
    ds_read_b64_tr_b16 a[20:21], v9 offset:38016
    v_mfma_f32_16x16x32_bf16 v[116:119], a[36:39], a[108:111], v[116:119]
    ds_read_b64_tr_b16 a[22:23], v13 offset:9920
    v_mfma_f32_16x16x32_bf16 v[120:123], a[40:43], a[96:99], v[120:123]
    ds_read_b64_tr_b16 a[24:25], v3 offset:34816
    v_mfma_f32_16x16x32_bf16 v[120:123], a[44:47], a[104:107], v[120:123]
    ds_read_b64_tr_b16 a[26:27], v7 offset:6720
    v_cvt_pk_bf16_f32 v88, v88, v89
    v_mfma_f32_16x16x32_bf16 v[124:127], a[40:43], a[100:103], v[124:127]
    ds_read_b64_tr_b16 a[28:29], v7 offset:44160
    v_cvt_pk_bf16_f32 v89, v90, v91
    v_mfma_f32_16x16x32_bf16 v[124:127], a[44:47], a[108:111], v[124:127]
    s_waitcnt lgkmcnt(7)
    ds_read_b64_tr_b16 a[30:31], v11 offset:16064
    v_cvt_pk_bf16_f32 v90, v92, v93
    v_mfma_f32_16x16x32_bf16 v[104:107], a[0:3], a[112:115], v[104:107]
    ds_read_b64_tr_b16 a[32:33], v4 offset:34816
    v_cvt_pk_bf16_f32 v91, v94, v95
    v_mfma_f32_16x16x32_bf16 v[104:107], a[4:7], a[120:123], v[104:107]
    ds_read_b64_tr_b16 a[34:35], v8 offset:6720
    buffer_store_dwordx4 v[88:91], v18, s[20:23], s82 offen offset:1024 sc1
    v_mfma_f32_16x16x32_bf16 v[108:111], a[0:3], a[116:119], v[108:111]
    ds_read_b64_tr_b16 a[36:37], v8 offset:44160
    v_mfma_f32_16x16x32_bf16 v[108:111], a[4:7], a[124:127], v[108:111]
    ds_read_b64_tr_b16 a[38:39], v12 offset:16064
    v_mfma_f32_16x16x32_bf16 v[112:115], a[8:11], a[112:115], v[112:115]
    ds_read_b64_tr_b16 a[40:41], v5 offset:34816
    v_mfma_f32_16x16x32_bf16 v[112:115], a[12:15], a[120:123], v[112:115]
    ds_read_b64_tr_b16 a[42:43], v9 offset:6720
    v_mfma_f32_16x16x32_bf16 v[116:119], a[8:11], a[116:119], v[116:119]
    ds_read_b64_tr_b16 a[44:45], v9 offset:44160
    v_mfma_f32_16x16x32_bf16 v[116:119], a[12:15], a[124:127], v[116:119]
    s_waitcnt lgkmcnt(7)
    ds_read_b64_tr_b16 a[46:47], v13 offset:16064
    v_mfma_f32_16x16x32_bf16 v[120:123], a[16:19], a[112:115], v[120:123]
    ds_read_b64_tr_b16 a[0:1], v2 offset:12288
    v_mfma_f32_16x16x32_bf16 v[120:123], a[20:23], a[120:123], v[120:123]
    ds_read_b64_tr_b16 a[2:3], v2 offset:49728
    v_mfma_f32_16x16x32_bf16 v[124:127], a[16:19], a[116:119], v[124:127]
    ds_read_b64_tr_b16 a[4:5], v6 offset:21632
    v_mfma_f32_16x16x32_bf16 v[124:127], a[20:23], a[124:127], v[124:127]
    ds_read_b64_tr_b16 a[6:7], v6 offset:59072
    v_mfma_f32_16x16x32_bf16 v[104:107], a[24:27], a[128:131], v[104:107]
    ds_read_b64_tr_b16 a[8:9], v3 offset:12288
    v_mfma_f32_16x16x32_bf16 v[104:107], a[28:31], a[136:139], v[104:107]
    ds_read_b64_tr_b16 a[10:11], v3 offset:49728
    v_cvt_pk_bf16_f32 v96, v96, v97
    v_mfma_f32_16x16x32_bf16 v[108:111], a[24:27], a[132:135], v[108:111]
    ds_read_b64_tr_b16 a[12:13], v7 offset:21632
    v_cvt_pk_bf16_f32 v97, v98, v99
    v_mfma_f32_16x16x32_bf16 v[108:111], a[28:31], a[140:143], v[108:111]
    s_waitcnt lgkmcnt(7)
    ds_read_b64_tr_b16 a[14:15], v7 offset:59072
    v_cvt_pk_bf16_f32 v98, v100, v101
    v_mfma_f32_16x16x32_bf16 v[112:115], a[32:35], a[128:131], v[112:115]
    ds_read_b64_tr_b16 a[16:17], v4 offset:12288
    v_cvt_pk_bf16_f32 v99, v102, v103
    v_mfma_f32_16x16x32_bf16 v[112:115], a[36:39], a[136:139], v[112:115]
    ds_read_b64_tr_b16 a[18:19], v4 offset:49728
    buffer_store_dwordx4 v[96:99], v18, s[20:23], s82 offen offset:2048 sc1
    v_mfma_f32_16x16x32_bf16 v[116:119], a[32:35], a[132:135], v[116:119]
    ds_read_b64_tr_b16 a[20:21], v8 offset:21632
    v_mfma_f32_16x16x32_bf16 v[116:119], a[36:39], a[140:143], v[116:119]
    ds_read_b64_tr_b16 a[22:23], v8 offset:59072
    v_mfma_f32_16x16x32_bf16 v[120:123], a[40:43], a[128:131], v[120:123]
    ds_read_b64_tr_b16 a[24:25], v2 offset:18432
    v_mfma_f32_16x16x32_bf16 v[120:123], a[44:47], a[136:139], v[120:123]
    ds_read_b64_tr_b16 a[26:27], v2 offset:55872
    v_mfma_f32_16x16x32_bf16 v[124:127], a[40:43], a[132:135], v[124:127]
    ds_read_b64_tr_b16 a[28:29], v6 offset:27776
    v_mfma_f32_16x16x32_bf16 v[124:127], a[44:47], a[140:143], v[124:127]
    s_waitcnt lgkmcnt(7)
    ds_read_b64_tr_b16 a[30:31], v6 offset:65216
    v_mfma_f32_16x16x32_bf16 v[32:35], a[0:3], a[80:83], v[32:35]
    ds_read_b64_tr_b16 a[32:33], v3 offset:18432
    s_add_u32 s71, s66, 1
    s_waitcnt vmcnt(9)
    v_subrev_u32 v21, s71, v21
    v_cmp_gt_u32 vcc, 8, v21
    s_nop 0
    s_cmp_eq_u64 vcc, exec
    s_cbranch_scc0 L_slow_21
L_back_22:
    v_mfma_f32_16x16x32_bf16 v[32:35], a[4:7], a[88:91], v[32:35]
    s_add_u32 s70, s78, 0
    ds_read_b64_tr_b16 a[34:35], v3 offset:55872
    buffer_load_dwordx4 a[144:147], v18, s[20:23], s70 offen offset:0 sc1
    v_mfma_f32_16x16x32_bf16 v[36:39], a[0:3], a[84:87], v[36:39]
    ds_read_b64_tr_b16 a[36:37], v7 offset:27776
    v_mfma_f32_16x16x32_bf16 v[36:39], a[4:7], a[92:95], v[36:39]
    ds_read_b64_tr_b16 a[38:39], v7 offset:65216
    v_mfma_f32_16x16x32_bf16 v[40:43], a[8:11], a[80:83], v[40:43]
    ds_read_b64_tr_b16 a[40:41], v4 offset:18432
    buffer_load_dwordx4 a[148:151], v18, s[20:23], s70 offen offset:1024 sc1
    v_mfma_f32_16x16x32_bf16 v[40:43], a[12:15], a[88:91], v[40:43]
    s_add_u32 s82, s79, 445440
    ds_read_b64_tr_b16 a[42:43], v4 offset:55872
    v_cvt_pk_bf16_f32 v104, v104, v105
    v_mfma_f32_16x16x32_bf16 v[44:47], a[8:11], a[84:87], v[44:47]
    ds_read_b64_tr_b16 a[44:45], v8 offset:27776
    v_cvt_pk_bf16_f32 v105, v106, v107
    v_mfma_f32_16x16x32_bf16 v[44:47], a[12:15], a[92:95], v[44:47]
    s_waitcnt lgkmcnt(7)
    ds_read_b64_tr_b16 a[46:47], v8 offset:65216
    v_cvt_pk_bf16_f32 v106, v108, v109
    v_mfma_f32_16x16x32_bf16 v[48:51], a[16:19], a[80:83], v[48:51]
    ds_read_b64_tr_b16 a[0:1], v2 offset:24576
    v_cvt_pk_bf16_f32 v107, v110, v111
    v_mfma_f32_16x16x32_bf16 v[48:51], a[20:23], a[88:91], v[48:51]
    ds_read_b64_tr_b16 a[2:3], v2 offset:62016
    buffer_store_dwordx4 v[104:107], v18, s[20:23], s82 offen offset:0 sc1
    v_mfma_f32_16x16x32_bf16 v[52:55], a[16:19], a[84:87], v[52:55]
    ds_read_b64_tr_b16 a[4:5], v6 offset:33920
    v_mfma_f32_16x16x32_bf16 v[52:55], a[20:23], a[92:95], v[52:55]
    ds_read_b64_tr_b16 a[6:7], v10 offset:5824
    buffer_load_dwordx4 a[152:155], v18, s[20:23], s70 offen offset:2048 sc1
    v_mfma_f32_16x16x32_bf16 v[32:35], a[24:27], a[96:99], v[32:35]
    ds_read_b64_tr_b16 a[8:9], v3 offset:24576
    v_mfma_f32_16x16x32_bf16 v[32:35], a[28:31], a[104:107], v[32:35]
    ds_read_b64_tr_b16 a[10:11], v3 offset:62016
    v_mfma_f32_16x16x32_bf16 v[36:39], a[24:27], a[100:103], v[36:39]
    ds_read_b64_tr_b16 a[12:13], v7 offset:33920
    buffer_load_dwordx4 a[156:159], v18, s[20:23], s70 offen offset:3072 sc1
    v_mfma_f32_16x16x32_bf16 v[36:39], a[28:31], a[108:111], v[36:39]
    s_waitcnt lgkmcnt(7)
    ds_read_b64_tr_b16 a[14:15], v11 offset:5824
    v_mfma_f32_16x16x32_bf16 v[40:43], a[32:35], a[96:99], v[40:43]
    ds_read_b64_tr_b16 a[16:17], v4 offset:24576
    v_mfma_f32_16x16x32_bf16 v[40:43], a[36:39], a[104:107], v[40:43]
    s_add_u32 s70, s78, 4096
    ds_read_b64_tr_b16 a[18:19], v4 offset:62016
    buffer_load_dwordx4 a[160:163], v18, s[20:23], s70 offen offset:0 sc1
    v_mfma_f32_16x16x32_bf16 v[44:47], a[32:35], a[100:103], v[44:47]
    ds_read_b64_tr_b16 a[20:21], v8 offset:33920
    v_mfma_f32_16x16x32_bf16 v[44:47], a[36:39], a[108:111], v[44:47]
    ds_read_b64_tr_b16 a[22:23], v12 offset:5824
    v_mfma_f32_16x16x32_bf16 v[48:51], a[40:43], a[96:99], v[48:51]
    ds_read_b64_tr_b16 a[24:25], v2 offset:30720
    buffer_load_dwordx4 a[164:167], v18, s[20:23], s70 offen offset:1024 sc1
    v_mfma_f32_16x16x32_bf16 v[48:51], a[44:47], a[104:107], v[48:51]
    ds_read_b64_tr_b16 a[26:27], v6 offset:2624
    v_cvt_pk_bf16_f32 v112, v112, v113
    v_mfma_f32_16x16x32_bf16 v[52:55], a[40:43], a[100:103], v[52:55]
    ds_read_b64_tr_b16 a[28:29], v6 offset:40064
    v_cvt_pk_bf16_f32 v113, v114, v115
    v_mfma_f32_16x16x32_bf16 v[52:55], a[44:47], a[108:111], v[52:55]
    s_waitcnt lgkmcnt(7)
    ds_read_b64_tr_b16 a[30:31], v10 offset:11968
    v_cvt_pk_bf16_f32 v114, v116, v117
    v_mfma_f32_16x16x32_bf16 v[32:35], a[0:3], a[112:115], v[32:35]
    ds_read_b64_tr_b16 a[32:33], v3 offset:30720
    v_cvt_pk_bf16_f32 v115, v118, v119
    v_mfma_f32_16x16x32_bf16 v[32:35], a[4:7], a[120:123], v[32:35]
    ds_read_b64_tr_b16 a[34:35], v7 offset:2624
    buffer_store_dwordx4 v[112:115], v18, s[20:23], s82 offen offset:1024 sc1
    v_mfma_f32_16x16x32_bf16 v[36:39], a[0:3], a[116:119], v[36:39]
    ds_read_b64_tr_b16 a[36:37], v7 offset:40064
    v_mfma_f32_16x16x32_bf16 v[36:39], a[4:7], a[124:127], v[36:39]
    ds_read_b64_tr_b16 a[38:39], v11 offset:11968
    buffer_load_dwordx4 a[168:171], v18, s[20:23], s70 offen offset:2048 sc1
    v_mfma_f32_16x16x32_bf16 v[40:43], a[8:11], a[112:115], v[40:43]
    ds_read_b64_tr_b16 a[40:41], v4 offset:30720
    v_mfma_f32_16x16x32_bf16 v[40:43], a[12:15], a[120:123], v[40:43]
    ds_read_b64_tr_b16 a[42:43], v8 offset:2624
    v_mfma_f32_16x16x32_bf16 v[44:47], a[8:11], a[116:119], v[44:47]
    ds_read_b64_tr_b16 a[44:45], v8 offset:40064
    buffer_load_dwordx4 a[172:175], v18, s[20:23], s70 offen offset:3072 sc1
    v_mfma_f32_16x16x32_bf16 v[44:47], a[12:15], a[124:127], v[44:47]
    s_waitcnt lgkmcnt(7)
    ds_read_b64_tr_b16 a[46:47], v12 offset:11968
    v_mfma_f32_16x16x32_bf16 v[48:51], a[16:19], a[112:115], v[48:51]
    ds_read_b64_tr_b16 a[0:1], v5 offset:12288
    v_mfma_f32_16x16x32_bf16 v[48:51], a[20:23], a[120:123], v[48:51]
    s_add_u32 s70, s78, 8192
    ds_read_b64_tr_b16 a[2:3], v5 offset:49728
    buffer_load_dwordx2 a[176:177], v251, s[20:23], s70 offen offset:0 sc1
    buffer_load_dwordx2 a[178:179], v251, s[20:23], s70 offen offset:512 sc1
    v_mfma_f32_16x16x32_bf16 v[52:55], a[16:19], a[116:119], v[52:55]
    ds_read_b64_tr_b16 a[4:5], v9 offset:21632
    v_mfma_f32_16x16x32_bf16 v[52:55], a[20:23], a[124:127], v[52:55]
    ds_read_b64_tr_b16 a[6:7], v9 offset:59072
    v_mfma_f32_16x16x32_bf16 v[32:35], a[24:27], a[128:131], v[32:35]
    ds_read_b64_tr_b16 a[8:9], v2 offset:14336
    buffer_load_dwordx2 a[180:181], v251, s[20:23], s70 offen offset:1024 sc1
    buffer_load_dwordx2 a[182:183], v251, s[20:23], s70 offen offset:1536 sc1
    v_mfma_f32_16x16x32_bf16 v[32:35], a[28:31], a[136:139], v[32:35]
    ds_read_b64_tr_b16 a[10:11], v2 offset:51776
    v_cvt_pk_bf16_f32 v120, v120, v121
    v_mfma_f32_16x16x32_bf16 v[36:39], a[24:27], a[132:135], v[36:39]
    ds_read_b64_tr_b16 a[12:13], v6 offset:23680
    v_cvt_pk_bf16_f32 v121, v122, v123
    v_mfma_f32_16x16x32_bf16 v[36:39], a[28:31], a[140:143], v[36:39]
    s_waitcnt lgkmcnt(7)
    ds_read_b64_tr_b16 a[14:15], v6 offset:61120
    v_cvt_pk_bf16_f32 v122, v124, v125
    v_mfma_f32_16x16x32_bf16 v[40:43], a[32:35], a[128:131], v[40:43]
    ds_read_b64_tr_b16 a[16:17], v3 offset:14336
    v_cvt_pk_bf16_f32 v123, v126, v127
    v_mfma_f32_16x16x32_bf16 v[40:43], a[36:39], a[136:139], v[40:43]
    ds_read_b64_tr_b16 a[18:19], v3 offset:51776
    buffer_store_dwordx4 v[120:123], v18, s[20:23], s82 offen offset:2048 sc1
    v_mfma_f32_16x16x32_bf16 v[44:47], a[32:35], a[132:135], v[44:47]
    ds_read_b64_tr_b16 a[20:21], v7 offset:23680
    v_mfma_f32_16x16x32_bf16 v[44:47], a[36:39], a[140:143], v[44:47]
    ds_read_b64_tr_b16 a[22:23], v7 offset:61120
    buffer_load_dwordx4 a[184:187], v18, s[20:23], s70 offen offset:2048 sc1
    v_mfma_f32_16x16x32_bf16 v[48:51], a[40:43], a[128:131], v[48:51]
    ds_read_b64_tr_b16 a[24:25], v5 offset:18432
    v_mfma_f32_16x16x32_bf16 v[48:51], a[44:47], a[136:139], v[48:51]
    ds_read_b64_tr_b16 a[26:27], v5 offset:55872
    v_mfma_f32_16x16x32_bf16 v[52:55], a[40:43], a[132:135], v[52:55]
    ds_read_b64_tr_b16 a[28:29], v9 offset:27776
    buffer_load_dwordx4 a[188:191], v18, s[20:23], s70 offen offset:3072 sc1
    v_mfma_f32_16x16x32_bf16 v[52:55], a[44:47], a[140:143], v[52:55]
    s_waitcnt lgkmcnt(7)
    ds_read_b64_tr_b16 a[30:31], v9 offset:65216
    v_mfma_f32_16x16x32_bf16 v[56:59], a[0:3], a[80:83], v[56:59]
    s_add_u32 s82, s79, 448512
    ds_read_b64_tr_b16 a[32:33], v2 offset:20480
    v_cvt_pk_bf16_f32 v32, v32, v33
    v_mfma_f32_16x16x32_bf16 v[56:59], a[4:7], a[88:91], v[56:59]
    ds_read_b64_tr_b16 a[34:35], v2 offset:57920
    v_cvt_pk_bf16_f32 v33, v34, v35
    v_mfma_f32_16x16x32_bf16 v[60:63], a[0:3], a[84:87], v[60:63]
    ds_read_b64_tr_b16 a[36:37], v6 offset:29824
    v_cvt_pk_bf16_f32 v34, v36, v37
    v_mfma_f32_16x16x32_bf16 v[60:63], a[4:7], a[92:95], v[60:63]
    ds_read_b64_tr_b16 a[38:39], v10 offset:1728
    v_cvt_pk_bf16_f32 v35, v38, v39
    v_mfma_f32_16x16x32_bf16 v[64:67], a[8:11], a[80:83], v[64:67]
    ds_read_b64_tr_b16 a[40:41], v3 offset:20480
    buffer_store_dwordx4 v[32:35], v18, s[20:23], s82 offen offset:0 sc1
    v_mfma_f32_16x16x32_bf16 v[64:67], a[12:15], a[88:91], v[64:67]
    ds_read_b64_tr_b16 a[42:43], v3 offset:57920
    v_cvt_pk_bf16_f32 v40, v40, v41
    v_mfma_f32_16x16x32_bf16 v[68:71], a[8:11], a[84:87], v[68:71]
    ds_read_b64_tr_b16 a[44:45], v7 offset:29824
    v_cvt_pk_bf16_f32 v41, v42, v43
    v_mfma_f32_16x16x32_bf16 v[68:71], a[12:15], a[92:95], v[68:71]
    s_waitcnt lgkmcnt(7)
    ds_read_b64_tr_b16 a[46:47], v11 offset:1728
    v_cvt_pk_bf16_f32 v42, v44, v45
    v_mfma_f32_16x16x32_bf16 v[72:75], a[16:19], a[80:83], v[72:75]
    ds_read_b64_tr_b16 a[0:1], v5 offset:24576
    v_cvt_pk_bf16_f32 v43, v46, v47
    v_mfma_f32_16x16x32_bf16 v[72:75], a[20:23], a[88:91], v[72:75]
    ds_read_b64_tr_b16 a[2:3], v5 offset:62016
    buffer_store_dwordx4 v[40:43], v18, s[20:23], s82 offen offset:1024 sc1
    v_mfma_f32_16x16x32_bf16 v[76:79], a[16:19], a[84:87], v[76:79]
    ds_read_b64_tr_b16 a[4:5], v9 offset:33920
    v_cvt_pk_bf16_f32 v48, v48, v49
    v_mfma_f32_16x16x32_bf16 v[76:79], a[20:23], a[92:95], v[76:79]
    ds_read_b64_tr_b16 a[6:7], v13 offset:5824
    v_cvt_pk_bf16_f32 v49, v50, v51
    v_mfma_f32_16x16x32_bf16 v[56:59], a[24:27], a[96:99], v[56:59]
    ds_read_b64_tr_b16 a[8:9], v2 offset:26624
    v_cvt_pk_bf16_f32 v50, v52, v53
    v_mfma_f32_16x16x32_bf16 v[56:59], a[28:31], a[104:107], v[56:59]
    ds_read_b64_tr_b16 a[10:11], v2 offset:64064
    v_cvt_pk_bf16_f32 v51, v54, v55
    v_mfma_f32_16x16x32_bf16 v[60:63], a[24:27], a[100:103], v[60:63]
    ds_read_b64_tr_b16 a[12:13], v6 offset:35968
    buffer_store_dwordx4 v[48:51], v18, s[20:23], s82 offen offset:2048 sc1
    v_mfma_f32_16x16x32_bf16 v[60:63], a[28:31], a[108:111], v[60:63]
    s_waitcnt lgkmcnt(7)
    ds_read_b64_tr_b16 a[14:15], v10 offset:7872
    v_mfma_f32_16x16x32_bf16 v[64:67], a[32:35], a[96:99], v[64:67]
    s_add_u32 s70, s78, 12288
    ds_read_b64_tr_b16 a[16:17], v3 offset:26624
    buffer_load_dwordx4 a[192:195], v18, s[20:23], s70 offen offset:0 sc1
    v_mfma_f32_16x16x32_bf16 v[64:67], a[36:39], a[104:107], v[64:67]
    ds_read_b64_tr_b16 a[18:19], v3 offset:64064
    buffer_load_dwordx4 a[196:199], v18, s[20:23], s70 offen offset:1024 sc1
    v_mfma_f32_16x16x32_bf16 v[68:71], a[32:35], a[100:103], v[68:71]
    ds_read_b64_tr_b16 a[20:21], v7 offset:35968
    buffer_load_dwordx4 a[200:203], v18, s[20:23], s70 offen offset:2048 sc1
    v_mfma_f32_16x16x32_bf16 v[68:71], a[36:39], a[108:111], v[68:71]
    ds_read_b64_tr_b16 a[22:23], v11 offset:7872
    v_mfma_f32_16x16x32_bf16 v[72:75], a[40:43], a[96:99], v[72:75]
    ds_read_b64_tr_b16 a[24:25], v5 offset:30720
    buffer_load_dwordx4 a[204:207], v18, s[20:23], s70 offen offset:3072 sc1
    v_mfma_f32_16x16x32_bf16 v[72:75], a[44:47], a[104:107], v[72:75]
    ds_read_b64_tr_b16 a[26:27], v9 offset:2624
    v_mfma_f32_16x16x32_bf16 v[76:79], a[40:43], a[100:103], v[76:79]
    ds_read_b64_tr_b16 a[28:29], v9 offset:40064
    v_mfma_f32_16x16x32_bf16 v[76:79], a[44:47], a[108:111], v[76:79]
    s_waitcnt lgkmcnt(7)
    ds_read_b64_tr_b16 a[30:31], v13 offset:11968
    v_mfma_f32_16x16x32_bf16 v[56:59], a[0:3], a[112:115], v[56:59]
    s_add_u32 s70, s78, 16384
    ds_read_b64_tr_b16 a[32:33], v2 offset:32768
    buffer_load_dwordx4 a[208:211], v18, s[20:23], s70 offen offset:0 sc1
    v_mfma_f32_16x16x32_bf16 v[56:59], a[4:7], a[120:123], v[56:59]
L_pad_v1_1:
    s_cbranch_execz L_walk_ret
    ds_read_b64_tr_b16 a[34:35], v6 offset:4672
    v_mfma_f32_16x16x32_bf16 v[60:63], a[0:3], a[116:119], v[60:63]
    ds_read_b64_tr_b16 a[36:37], v6 offset:42112
    v_mfma_f32_16x16x32_bf16 v[60:63], a[4:7], a[124:127], v[60:63]
    ds_read_b64_tr_b16 a[38:39], v10 offset:14016
    buffer_load_dwordx4 a[212:215], v18, s[20:23], s70 offen offset:1024 sc1
    v_mfma_f32_16x16x32_bf16 v[64:67], a[8:11], a[112:115], v[64:67]
    ds_read_b64_tr_b16 a[40:41], v3 offset:32768
    v_mfma_f32_16x16x32_bf16 v[64:67], a[12:15], a[120:123], v[64:67]
    ds_read_b64_tr_b16 a[42:43], v7 offset:4672
    v_mfma_f32_16x16x32_bf16 v[68:71], a[8:11], a[116:119], v[68:71]
    ds_read_b64_tr_b16 a[44:45], v7 offset:42112
    buffer_load_dwordx4 a[216:219], v18, s[20:23], s70 offen offset:2048 sc1
    v_mfma_f32_16x16x32_bf16 v[68:71], a[12:15], a[124:127], v[68:71]
    s_waitcnt vmcnt(30) lgkmcnt(7)
    ds_read_b64_tr_b16 a[46:47], v11 offset:14016
    v_mfma_f32_16x16x32_bf16 v[72:75], a[16:19], a[112:115], v[72:75]
    s_barrier
    ds_read_b64_tr_b16 a[0:1], v29 offset:0
    v_mfma_f32_16x16x32_bf16 v[72:75], a[20:23], a[120:123], v[72:75]
    ds_read_b64_tr_b16 a[2:3], v29 offset:1536
    buffer_load_dwordx4 a[220:223], v18, s[20:23], s70 offen offset:3072 sc1
    v_mfma_f32_16x16x32_bf16 v[76:79], a[16:19], a[116:119], v[76:79]
    ds_read_b64_tr_b16 a[4:5], v29 offset:3072
    v_mfma_f32_16x16x32_bf16 v[76:79], a[20:23], a[124:127], v[76:79]
    ds_read_b64_tr_b16 a[6:7], v29 offset:4608
    v_mfma_f32_16x16x32_bf16 v[56:59], a[24:27], a[128:131], v[56:59]
    s_add_u32 s70, s78, 20480
    ds_read_b64_tr_b16 a[8:9], v29 offset:6144
    buffer_load_dwordx4 a[224:227], v18, s[20:23], s70 offen offset:0 sc1
    v_mfma_f32_16x16x32_bf16 v[56:59], a[28:31], a[136:139], v[56:59]
    ds_read_b64_tr_b16 a[10:11], v29 offset:7680
    v_mfma_f32_16x16x32_bf16 v[60:63], a[24:27], a[132:135], v[60:63]
    ds_read_b64_tr_b16 a[12:13], v29 offset:9216
    v_mfma_f32_16x16x32_bf16 v[60:63], a[28:31], a[140:143], v[60:63]
    s_waitcnt lgkmcnt(7)
    ds_read_b64_tr_b16 a[14:15], v29 offset:10752
    v_mfma_f32_16x16x32_bf16 v[64:67], a[32:35], a[128:131], v[64:67]
    ds_read_b64_tr_b16 a[16:17], v29 offset:37440
    buffer_load_dwordx4 a[228:231], v18, s[20:23], s70 offen offset:1024 sc1
    v_mfma_f32_16x16x32_bf16 v[64:67], a[36:39], a[136:139], v[64:67]
    ds_read_b64_tr_b16 a[18:19], v29 offset:38976
    v_mfma_f32_16x16x32_bf16 v[68:71], a[32:35], a[132:135], v[68:71]
    ds_read_b64_tr_b16 a[20:21], v29 offset:40512
    v_mfma_f32_16x16x32_bf16 v[68:71], a[36:39], a[140:143], v[68:71]
    ds_read_b64_tr_b16 a[22:23], v29 offset:42048
    buffer_load_dwordx4 a[232:235], v18, s[20:23], s70 offen offset:2048 sc1
    v_mfma_f32_16x16x32_bf16 v[72:75], a[40:43], a[128:131], v[72:75]
    ds_read_b64_tr_b16 a[24:25], v29 offset:32
    v_mfma_f32_16x16x32_bf16 v[72:75], a[44:47], a[136:139], v[72:75]
    ds_read_b64_tr_b16 a[26:27], v29 offset:1568
    v_mfma_f32_16x16x32_bf16 v[76:79], a[40:43], a[132:135], v[76:79]
    ds_read_b64_tr_b16 a[28:29], v29 offset:3104
    buffer_load_dwordx4 a[236:239], v18, s[20:23], s70 offen offset:3072 sc1
    v_mfma_f32_16x16x32_bf16 v[76:79], a[44:47], a[140:143], v[76:79]
    s_waitcnt lgkmcnt(7)
    ds_read_b64_tr_b16 a[30:31], v29 offset:4640
    s_waitcnt vmcnt(31)
    v_mfma_f32_16x16x32_bf16 v[56:59], a[0:3], a[144:147], v[56:59]
    ds_read_b64_tr_b16 a[32:33], v29 offset:6176
    s_waitcnt vmcnt(28)
    v_mfma_f32_16x16x32_bf16 v[56:59], a[4:7], a[152:155], v[56:59]
    ds_read_b64_tr_b16 a[34:35], v29 offset:7712
    s_waitcnt vmcnt(12)
    s_add_u32 s71, s66, 1
    v_mov_b32 v22, s71
    buffer_store_dword v22, off, s[20:23], s93 sc1
    v_mfma_f32_16x16x32_bf16 v[60:63], a[0:3], a[148:151], v[60:63]
    ds_read_b64_tr_b16 a[36:37], v29 offset:9248
    v_mfma_f32_16x16x32_bf16 v[60:63], a[4:7], a[156:159], v[60:63]
    ds_read_b64_tr_b16 a[38:39], v29 offset:10784
    v_mfma_f32_16x16x32_bf16 v[56:59], a[8:11], a[160:163], v[56:59]
    s_add_u32 s70, s78, 24576
    ds_read_b64_tr_b16 a[40:41], v29 offset:37472
    buffer_load_dwordx4 v[202:205], v18, s[20:23], s70 offen offset:0 sc1
    v_mfma_f32_16x16x32_bf16 v[56:59], a[12:15], a[168:171], v[56:59]
    ds_read_b64_tr_b16 a[42:43], v29 offset:39008
    v_mfma_f32_16x16x32_bf16 v[60:63], a[8:11], a[164:167], v[60:63]
    ds_read_b64_tr_b16 a[44:45], v29 offset:40544
    buffer_load_dwordx4 v[206:209], v18, s[20:23], s70 offen offset:1024 sc1
    v_mfma_f32_16x16x32_bf16 v[60:63], a[12:15], a[172:175], v[60:63]
    s_waitcnt lgkmcnt(7)
    ds_read_b64_tr_b16 a[46:47], v29 offset:42080
    v_mfma_f32_16x16x32_bf16 v[56:59], a[16:19], a[176:179], v[56:59]
    ds_read_b64_tr_b16 a[0:1], v29 offset:64
    v_mfma_f32_16x16x32_bf16 v[56:59], a[20:23], a[184:187], v[56:59]
    ds_read_b64_tr_b16 a[2:3], v29 offset:1600
    buffer_load_dwordx2 v[210:211], v251, s[20:23], s70 offen offset:2048 sc1
    buffer_load_dwordx2 v[212:213], v251, s[20:23], s70 offen offset:2560 sc1
    v_mfma_f32_16x16x32_bf16 v[60:63], a[16:19], a[180:183], v[60:63]
    ds_read_b64_tr_b16 a[4:5], v29 offset:3136
    v_mfma_f32_16x16x32_bf16 v[60:63], a[20:23], a[188:191], v[60:63]
    ds_read_b64_tr_b16 a[6:7], v29 offset:4672
    v_mfma_f32_16x16x32_bf16 v[64:67], a[24:27], a[144:147], v[64:67]
    ds_read_b64_tr_b16 a[8:9], v29 offset:6208
    buffer_load_dwordx2 v[214:215], v251, s[20:23], s70 offen offset:3072 sc1
    buffer_load_dwordx2 v[216:217], v251, s[20:23], s70 offen offset:3584 sc1
    v_mfma_f32_16x16x32_bf16 v[64:67], a[28:31], a[152:155], v[64:67]
    ds_read_b64_tr_b16 a[10:11], v29 offset:7744
    v_mfma_f32_16x16x32_bf16 v[68:71], a[24:27], a[148:151], v[68:71]
    ds_read_b64_tr_b16 a[12:13], v29 offset:9280
    v_mfma_f32_16x16x32_bf16 v[68:71], a[28:31], a[156:159], v[68:71]
    s_waitcnt lgkmcnt(7)
    ds_read_b64_tr_b16 a[14:15], v29 offset:10816
    v_mfma_f32_16x16x32_bf16 v[64:67], a[32:35], a[160:163], v[64:67]
    s_add_u32 s70, s78, 28672
    ds_read_b64_tr_b16 a[16:17], v29 offset:37504
    buffer_load_dwordx4 v[218:221], v18, s[20:23], s70 offen offset:0 sc1
    v_mfma_f32_16x16x32_bf16 v[64:67], a[36:39], a[168:171], v[64:67]
    ds_read_b64_tr_b16 a[18:19], v29 offset:39040
    v_mfma_f32_16x16x32_bf16 v[68:71], a[32:35], a[164:167], v[68:71]
    ds_read_b64_tr_b16 a[20:21], v29 offset:40576
    buffer_load_dwordx4 v[222:225], v18, s[20:23], s70 offen offset:1024 sc1
    v_mfma_f32_16x16x32_bf16 v[68:71], a[36:39], a[172:175], v[68:71]
    ds_read_b64_tr_b16 a[22:23], v29 offset:42112
    v_mfma_f32_16x16x32_bf16 v[64:67], a[40:43], a[176:179], v[64:67]
    ds_read_b64_tr_b16 a[24:25], v29 offset:43584
    buffer_load_dwordx4 v[226:229], v18, s[20:23], s70 offen offset:2048 sc1
    v_mfma_f32_16x16x32_bf16 v[64:67], a[44:47], a[184:187], v[64:67]
    ds_read_b64_tr_b16 a[26:27], v29 offset:45120
    v_mfma_f32_16x16x32_bf16 v[68:71], a[40:43], a[180:183], v[68:71]
    ds_read_b64_tr_b16 a[28:29], v29 offset:46656
    v_mfma_f32_16x16x32_bf16 v[68:71], a[44:47], a[188:191], v[68:71]
    s_waitcnt lgkmcnt(7)
    ds_read_b64_tr_b16 a[30:31], v29 offset:48192
    buffer_load_dwordx4 v[230:233], v18, s[20:23], s70 offen offset:3072 sc1
    v_mfma_f32_16x16x32_bf16 v[72:75], a[0:3], a[144:147], v[72:75]
    ds_read_b64_tr_b16 a[32:33], v30 offset:9344
    v_mfma_f32_16x16x32_bf16 v[72:75], a[4:7], a[152:155], v[72:75]
    ds_read_b64_tr_b16 a[34:35], v30 offset:10880
    v_mfma_f32_16x16x32_bf16 v[76:79], a[0:3], a[148:151], v[76:79]
    s_add_u32 s70, s78, 32768
    ds_read_b64_tr_b16 a[36:37], v30 offset:12416
    buffer_load_dwordx4 v[234:237], v18, s[20:23], s70 offen offset:0 sc1
    v_mfma_f32_16x16x32_bf16 v[76:79], a[4:7], a[156:159], v[76:79]
    ds_read_b64_tr_b16 a[38:39], v30 offset:13952
    v_mfma_f32_16x16x32_bf16 v[72:75], a[8:11], a[160:163], v[72:75]
    ds_read_b64_tr_b16 a[40:41], v30 offset:15488
    v_mfma_f32_16x16x32_bf16 v[72:75], a[12:15], a[168:171], v[72:75]
    ds_read_b64_tr_b16 a[42:43], v30 offset:17024
    buffer_load_dwordx4 v[238:241], v18, s[20:23], s70 offen offset:1024 sc1
    v_mfma_f32_16x16x32_bf16 v[76:79], a[8:11], a[164:167], v[76:79]
    ds_read_b64_tr_b16 a[44:45], v30 offset:18560
    v_mfma_f32_16x16x32_bf16 v[76:79], a[12:15], a[172:175], v[76:79]
    s_waitcnt lgkmcnt(7)
    ds_read_b64_tr_b16 a[46:47], v30 offset:20096
    buffer_load_dwordx4 v[242:245], v18, s[20:23], s70 offen offset:2048 sc1
    v_mfma_f32_16x16x32_bf16 v[72:75], a[16:19], a[176:179], v[72:75]
    ds_read_b64_tr_b16 a[0:1], v29 offset:43616
    v_mfma_f32_16x16x32_bf16 v[72:75], a[20:23], a[184:187], v[72:75]
    ds_read_b64_tr_b16 a[2:3], v29 offset:45152
    v_mfma_f32_16x16x32_bf16 v[76:79], a[16:19], a[180:183], v[76:79]
    ds_read_b64_tr_b16 a[4:5], v29 offset:46688
    buffer_load_dwordx4 v[246:249], v18, s[20:23], s70 offen offset:3072 sc1
    v_mfma_f32_16x16x32_bf16 v[76:79], a[20:23], a[188:191], v[76:79]
    ds_read_b64_tr_b16 a[6:7], v29 offset:48224
    s_waitcnt vmcnt(26)
    v_mfma_f32_16x16x32_bf16 v[56:59], a[24:27], a[192:195], v[56:59]
    ds_read_b64_tr_b16 a[8:9], v30 offset:9376
    s_waitcnt vmcnt(24)
    v_mfma_f32_16x16x32_bf16 v[56:59], a[28:31], a[200:203], v[56:59]
    ds_read_b64_tr_b16 a[10:11], v30 offset:10912
    v_mfma_f32_16x16x32_bf16 v[60:63], a[24:27], a[196:199], v[60:63]
    ds_read_b64_tr_b16 a[12:13], v30 offset:12448
    s_waitcnt vmcnt(23)
    v_mfma_f32_16x16x32_bf16 v[60:63], a[28:31], a[204:207], v[60:63]
    s_waitcnt lgkmcnt(7)
    ds_read_b64_tr_b16 a[14:15], v30 offset:13984
    s_waitcnt vmcnt(22)
    v_mfma_f32_16x16x32_bf16 v[56:59], a[32:35], a[208:211], v[56:59]
    ds_read_b64_tr_b16 a[16:17], v30 offset:15520
    s_waitcnt vmcnt(20)
    v_mfma_f32_16x16x32_bf16 v[56:59], a[36:39], a[216:219], v[56:59]
    ds_read_b64_tr_b16 a[18:19], v30 offset:17056
    v_mfma_f32_16x16x32_bf16 v[60:63], a[32:35], a[212:215], v[60:63]
    ds_read_b64_tr_b16 a[20:21], v30 offset:18592
    s_waitcnt vmcnt(19)
    v_mfma_f32_16x16x32_bf16 v[60:63], a[36:39], a[220:223], v[60:63]
    ds_read_b64_tr_b16 a[22:23], v30 offset:20128
    s_waitcnt vmcnt(18)
    v_mfma_f32_16x16x32_bf16 v[56:59], a[40:43], a[224:227], v[56:59]
    ds_read_b64_tr_b16 a[24:25], v29 offset:43648
    s_waitcnt vmcnt(16)
    v_mfma_f32_16x16x32_bf16 v[56:59], a[44:47], a[232:235], v[56:59]
    ds_read_b64_tr_b16 a[26:27], v29 offset:45184
    v_mfma_f32_16x16x32_bf16 v[60:63], a[40:43], a[228:231], v[60:63]
    ds_read_b64_tr_b16 a[28:29], v29 offset:46720
    s_waitcnt vmcnt(15)
    v_mfma_f32_16x16x32_bf16 v[60:63], a[44:47], a[236:239], v[60:63]
    s_waitcnt lgkmcnt(7)
    ds_read_b64_tr_b16 a[30:31], v29 offset:48256
    v_mfma_f32_16x16x32_bf16 v[64:67], a[0:3], a[192:195], v[64:67]
    ds_read_b64_tr_b16 a[32:33], v30 offset:9408
    v_mfma_f32_16x16x32_bf16 v[64:67], a[4:7], a[200:203], v[64:67]
    ds_read_b64_tr_b16 a[34:35], v30 offset:10944
    v_mfma_f32_16x16x32_bf16 v[68:71], a[0:3], a[196:199], v[68:71]
    ds_read_b64_tr_b16 a[36:37], v30 offset:12480
    v_mfma_f32_16x16x32_bf16 v[68:71], a[4:7], a[204:207], v[68:71]
    ds_read_b64_tr_b16 a[38:39], v30 offset:14016
    v_mfma_f32_16x16x32_bf16 v[64:67], a[8:11], a[208:211], v[64:67]
    ds_read_b64_tr_b16 a[40:41], v30 offset:15552
    v_mfma_f32_16x16x32_bf16 v[64:67], a[12:15], a[216:219], v[64:67]
    ds_read_b64_tr_b16 a[42:43], v30 offset:17088
    v_mfma_f32_16x16x32_bf16 v[68:71], a[8:11], a[212:215], v[68:71]
    ds_read_b64_tr_b16 a[44:45], v30 offset:18624
    buffer_load_dword v21, v25, s[20:23], 0 offen sc1
    v_mfma_f32_16x16x32_bf16 v[68:71], a[12:15], a[220:223], v[68:71]
    s_waitcnt lgkmcnt(7)
    ds_read_b64_tr_b16 a[46:47], v30 offset:20160
    v_mfma_f32_16x16x32_bf16 v[64:67], a[16:19], a[224:227], v[64:67]
    ds_read_b64_tr_b16 a[0:1], v30 offset:46784
    v_mfma_f32_16x16x32_bf16 v[64:67], a[20:23], a[232:235], v[64:67]
    ds_read_b64_tr_b16 a[2:3], v30 offset:48320
    v_mfma_f32_16x16x32_bf16 v[68:71], a[16:19], a[228:231], v[68:71]
    ds_read_b64_tr_b16 a[4:5], v30 offset:49856
    v_mfma_f32_16x16x32_bf16 v[68:71], a[20:23], a[236:239], v[68:71]
    ds_read_b64_tr_b16 a[6:7], v30 offset:51392
    v_mfma_f32_16x16x32_bf16 v[72:75], a[24:27], a[192:195], v[72:75]
    ds_read_b64_tr_b16 a[8:9], v30 offset:52928
    v_mfma_f32_16x16x32_bf16 v[72:75], a[28:31], a[200:203], v[72:75]
    ds_read_b64_tr_b16 a[10:11], v30 offset:54464
    v_mfma_f32_16x16x32_bf16 v[76:79], a[24:27], a[196:199], v[76:79]
    ds_read_b64_tr_b16 a[12:13], v30 offset:56000
    v_mfma_f32_16x16x32_bf16 v[76:79], a[28:31], a[204:207], v[76:79]
    s_waitcnt lgkmcnt(7)
    ds_read_b64_tr_b16 a[14:15], v30 offset:57536
    v_mfma_f32_16x16x32_bf16 v[72:75], a[32:35], a[208:211], v[72:75]
    ds_read_b64_tr_b16 a[16:17], v31 offset:18688
    v_mfma_f32_16x16x32_bf16 v[72:75], a[36:39], a[216:219], v[72:75]
    ds_read_b64_tr_b16 a[18:19], v31 offset:20224
    v_mfma_f32_16x16x32_bf16 v[76:79], a[32:35], a[212:215], v[76:79]
    ds_read_b64_tr_b16 a[20:21], v31 offset:21760
    v_mfma_f32_16x16x32_bf16 v[76:79], a[36:39], a[220:223], v[76:79]
    ds_read_b64_tr_b16 a[22:23], v31 offset:23296
    v_mfma_f32_16x16x32_bf16 v[72:75], a[40:43], a[224:227], v[72:75]
    ds_read_b64_tr_b16 a[24:25], v30 offset:46816
    v_mfma_f32_16x16x32_bf16 v[72:75], a[44:47], a[232:235], v[72:75]
    ds_read_b64_tr_b16 a[26:27], v30 offset:48352
    v_mfma_f32_16x16x32_bf16 v[76:79], a[40:43], a[228:231], v[76:79]
    ds_read_b64_tr_b16 a[28:29], v30 offset:49888
    v_mfma_f32_16x16x32_bf16 v[76:79], a[44:47], a[236:239], v[76:79]
    s_waitcnt lgkmcnt(7)
    ds_read_b64_tr_b16 a[30:31], v30 offset:51424
    s_waitcnt vmcnt(14)
    v_mfma_f32_16x16x32_bf16 v[56:59], a[0:3], v[202:205], v[56:59]
    ds_read_b64_tr_b16 a[32:33], v30 offset:52960
    s_add_u32 s71, s66, 1
    s_waitcnt vmcnt(0)
    v_subrev_u32 v21, s71, v21
    v_cmp_gt_u32 vcc, 8, v21
    s_nop 0
    s_cmp_eq_u64 vcc, exec
    s_cbranch_scc0 L_slow_24
L_back_25:
    v_mfma_f32_16x16x32_bf16 v[56:59], a[4:7], v[210:213], v[56:59]
    s_add_u32 s72, s79, 0
    ds_read_b64_tr_b16 a[34:35], v30 offset:54496
    buffer_load_dwordx4 v[166:169], v18, s[20:23], s72 offen offset:0 sc1
    v_mfma_f32_16x16x32_bf16 v[60:63], a[0:3], v[206:209], v[60:63]
    ds_read_b64_tr_b16 a[36:37], v30 offset:56032
    v_mfma_f32_16x16x32_bf16 v[60:63], a[4:7], v[214:217], v[60:63]
    ds_read_b64_tr_b16 a[38:39], v30 offset:57568
    buffer_load_dwordx4 v[170:173], v18, s[20:23], s72 offen offset:1024 sc1
    v_mfma_f32_16x16x32_bf16 v[56:59], a[8:11], v[218:221], v[56:59]
    ds_read_b64_tr_b16 a[40:41], v31 offset:18720
    v_mfma_f32_16x16x32_bf16 v[56:59], a[12:15], v[226:229], v[56:59]
    ds_read_b64_tr_b16 a[42:43], v31 offset:20256
    buffer_load_dwordx4 v[174:177], v18, s[20:23], s72 offen offset:2048 sc1
    v_mfma_f32_16x16x32_bf16 v[60:63], a[8:11], v[222:225], v[60:63]
    ds_read_b64_tr_b16 a[44:45], v31 offset:21792
    v_mfma_f32_16x16x32_bf16 v[60:63], a[12:15], v[230:233], v[60:63]
    s_waitcnt lgkmcnt(7)
    ds_read_b64_tr_b16 a[46:47], v31 offset:23328
    v_mfma_f32_16x16x32_bf16 v[56:59], a[16:19], v[234:237], v[56:59]
    s_add_u32 s72, s79, 1330176
    ds_read_b64_tr_b16 a[0:1], v30 offset:46848
    buffer_load_dwordx4 v[178:181], v18, s[20:23], s72 offen offset:0 sc1
    v_mfma_f32_16x16x32_bf16 v[56:59], a[20:23], v[242:245], v[56:59]
    ds_read_b64_tr_b16 a[2:3], v30 offset:48384
    v_mfma_f32_16x16x32_bf16 v[60:63], a[16:19], v[238:241], v[60:63]
    ds_read_b64_tr_b16 a[4:5], v30 offset:49920
    buffer_load_dwordx4 v[182:185], v18, s[20:23], s72 offen offset:1024 sc1
    v_mfma_f32_16x16x32_bf16 v[60:63], a[20:23], v[246:249], v[60:63]
    ds_read_b64_tr_b16 a[6:7], v30 offset:51456
    v_mfma_f32_16x16x32_bf16 v[64:67], a[24:27], v[202:205], v[64:67]
    ds_read_b64_tr_b16 a[8:9], v30 offset:52992
    buffer_load_dwordx4 v[186:189], v18, s[20:23], s72 offen offset:2048 sc1
    v_mfma_f32_16x16x32_bf16 v[64:67], a[28:31], v[210:213], v[64:67]
    ds_read_b64_tr_b16 a[10:11], v30 offset:54528
    v_mfma_f32_16x16x32_bf16 v[68:71], a[24:27], v[206:209], v[68:71]
    ds_read_b64_tr_b16 a[12:13], v30 offset:56064
    v_mfma_f32_16x16x32_bf16 v[68:71], a[28:31], v[214:217], v[68:71]
    s_waitcnt lgkmcnt(7)
    ds_read_b64_tr_b16 a[14:15], v30 offset:57600
    v_mfma_f32_16x16x32_bf16 v[64:67], a[32:35], v[218:221], v[64:67]
    s_add_u32 s72, s79, 890880
    ds_read_b64_tr_b16 a[16:17], v31 offset:18752
    buffer_load_dwordx4 v[190:193], v18, s[20:23], s72 offen offset:0 sc1
    v_mfma_f32_16x16x32_bf16 v[64:67], a[36:39], v[226:229], v[64:67]
    ds_read_b64_tr_b16 a[18:19], v31 offset:20288
    buffer_load_dwordx4 v[194:197], v18, s[20:23], s72 offen offset:1024 sc1
    v_mfma_f32_16x16x32_bf16 v[68:71], a[32:35], v[222:225], v[68:71]
    ds_read_b64_tr_b16 a[20:21], v31 offset:21824
    v_mfma_f32_16x16x32_bf16 v[68:71], a[36:39], v[230:233], v[68:71]
    ds_read_b64_tr_b16 a[22:23], v31 offset:23360
    buffer_load_dwordx4 v[198:201], v18, s[20:23], s72 offen offset:2048 sc1
    v_mfma_f32_16x16x32_bf16 v[64:67], a[40:43], v[234:237], v[64:67]
    v_mfma_f32_16x16x32_bf16 v[64:67], a[44:47], v[242:245], v[64:67]
    v_mfma_f32_16x16x32_bf16 v[68:71], a[40:43], v[238:241], v[68:71]
    v_mfma_f32_16x16x32_bf16 v[68:71], a[44:47], v[246:249], v[68:71]
    s_waitcnt lgkmcnt(4)
    v_mfma_f32_16x16x32_bf16 v[72:75], a[0:3], v[202:205], v[72:75]
    v_mfma_f32_16x16x32_bf16 v[72:75], a[4:7], v[210:213], v[72:75]
    v_mfma_f32_16x16x32_bf16 v[76:79], a[0:3], v[206:209], v[76:79]
    v_mfma_f32_16x16x32_bf16 v[76:79], a[4:7], v[214:217], v[76:79]
    v_mfma_f32_16x16x32_bf16 v[72:75], a[8:11], v[218:221], v[72:75]
    v_mfma_f32_16x16x32_bf16 v[72:75], a[12:15], v[226:229], v[72:75]
    v_mfma_f32_16x16x32_bf16 v[76:79], a[8:11], v[222:225], v[76:79]
    v_mfma_f32_16x16x32_bf16 v[76:79], a[12:15], v[230:233], v[76:79]
    s_waitcnt lgkmcnt(0)
    v_mfma_f32_16x16x32_bf16 v[72:75], a[16:19], v[234:237], v[72:75]
    v_mfma_f32_16x16x32_bf16 v[72:75], a[20:23], v[242:245], v[72:75]
    v_mfma_f32_16x16x32_bf16 v[76:79], a[16:19], v[238:241], v[76:79]
    v_mfma_f32_16x16x32_bf16 v[76:79], a[20:23], v[246:249], v[76:79]
    v_add_f32 v142, v142, v56
    v_add_f32 v143, v143, v57
    v_add_f32 v144, v144, v58
    v_add_f32 v145, v145, v59
    v_add_f32 v146, v146, v60
    v_add_f32 v147, v147, v61
    v_add_f32 v148, v148, v62
    v_add_f32 v149, v149, v63
    v_add_f32 v150, v150, v64
    v_add_f32 v151, v151, v65
    v_add_f32 v152, v152, v66
    v_add_f32 v153, v153, v67
    v_add_f32 v154, v154, v68
    v_add_f32 v155, v155, v69
    v_add_f32 v156, v156, v70
    v_add_f32 v157, v157, v71
    v_add_f32 v158, v158, v72
    v_add_f32 v159, v159, v73
    v_add_f32 v160, v160, v74
    v_add_f32 v161, v161, v75
    v_add_f32 v162, v162, v76
    v_add_f32 v163, v163, v77
    v_add_f32 v164, v164, v78
    v_add_f32 v165, v165, v79
    s_waitcnt vmcnt(8)
    v_mfma_f32_16x16x32_bf16 v[142:145], v[138:141], v[166:169], v[142:145]
    v_mfma_f32_16x16x32_bf16 v[146:149], v[136:139], v[166:169], v[146:149]
    s_waitcnt vmcnt(7)
    v_mfma_f32_16x16x32_bf16 v[150:153], v[138:141], v[170:173], v[150:153]
    v_mfma_f32_16x16x32_bf16 v[154:157], v[136:139], v[170:173], v[154:157]
    s_waitcnt vmcnt(6)
    v_mfma_f32_16x16x32_bf16 v[158:161], v[138:141], v[174:177], v[158:161]
    v_mfma_f32_16x16x32_bf16 v[162:165], v[136:139], v[174:177], v[162:165]
    s_waitcnt vmcnt(5)
    v_mfma_f32_16x16x32_bf16 v[142:145], v[138:141], v[178:181], v[142:145]
    v_mfma_f32_16x16x32_bf16 v[146:149], v[136:139], v[178:181], v[146:149]
    s_waitcnt vmcnt(4)
    v_mfma_f32_16x16x32_bf16 v[150:153], v[138:141], v[182:185], v[150:153]
    v_mfma_f32_16x16x32_bf16 v[154:157], v[136:139], v[182:185], v[154:157]
    s_waitcnt vmcnt(3)
    v_mfma_f32_16x16x32_bf16 v[158:161], v[138:141], v[186:189], v[158:161]
    v_mfma_f32_16x16x32_bf16 v[162:165], v[136:139], v[186:189], v[162:165]
    s_waitcnt vmcnt(2)
    v_mfma_f32_16x16x32_bf16 v[142:145], v[138:141], v[190:193], v[142:145]
    v_mfma_f32_16x16x32_bf16 v[146:149], v[136:139], v[190:193], v[146:149]
    s_waitcnt vmcnt(1)
    v_mfma_f32_16x16x32_bf16 v[150:153], v[138:141], v[194:197], v[150:153]
    v_mfma_f32_16x16x32_bf16 v[154:157], v[136:139], v[194:197], v[154:157]
    s_waitcnt vmcnt(0)
    v_mfma_f32_16x16x32_bf16 v[158:161], v[138:141], v[198:201], v[158:161]
    v_mfma_f32_16x16x32_bf16 v[162:165], v[136:139], v[198:201], v[162:165]
    s_nop 0
    v_cvt_pk_bf16_f32 v142, v142, v143
    v_cvt_pk_bf16_f32 v143, v144, v145
    buffer_store_dwordx2 v[142:143], v23, s[24:27], s89 offen offset:0 sc1
    v_cvt_pk_bf16_f32 v146, v146, v147
    v_cvt_pk_bf16_f32 v147, v148, v149
    buffer_store_dwordx2 v[146:147], v23, s[24:27], s91 offen offset:0 sc1
    v_cvt_pk_bf16_f32 v150, v150, v151
    v_cvt_pk_bf16_f32 v151, v152, v153
    buffer_store_dwordx2 v[150:151], v23, s[24:27], s89 offen offset:32 sc1
    v_cvt_pk_bf16_f32 v154, v154, v155
    v_cvt_pk_bf16_f32 v155, v156, v157
    buffer_store_dwordx2 v[154:155], v23, s[24:27], s91 offen offset:32 sc1
    v_cvt_pk_bf16_f32 v158, v158, v159
    v_cvt_pk_bf16_f32 v159, v160, v161
    buffer_store_dwordx2 v[158:159], v23, s[24:27], s89 offen offset:64 sc1
    v_cvt_pk_bf16_f32 v162, v162, v163
    v_cvt_pk_bf16_f32 v163, v164, v165
    buffer_store_dwordx2 v[162:163], v23, s[24:27], s91 offen offset:64 sc1
    s_endpgm
L_tail_12:
L_pad_v2_0:
    s_cbranch_execz L_pad_v2_1
    s_nop 3
    v_mfma_f32_16x16x32_bf16 v[80:83], a[0:3], a[64:67], v[80:83]
    ds_read_b64_tr_b16 a[32:33], v4 offset:10240
    v_mfma_f32_16x16x32_bf16 v[80:83], a[4:7], a[72:75], v[80:83]
    ds_read_b64_tr_b16 a[34:35], v4 offset:47680
    v_mfma_f32_16x16x32_bf16 v[84:87], a[0:3], a[68:71], v[84:87]
    s_mov_b32 m0, s73
    ds_read_b64_tr_b16 a[36:37], v8 offset:19584
    v_mfma_f32_16x16x32_bf16 v[84:87], a[4:7], a[76:79], v[84:87]
    s_mov_b32 s72, s3
    ds_read_b64_tr_b16 a[38:39], v8 offset:57024
    buffer_load_dwordx4 v14, s[4:7], s72 offen offset:0 lds
    v_mfma_f32_16x16x32_bf16 v[88:91], a[8:11], a[64:67], v[88:91]
    ds_read_b64_tr_b16 a[40:41], v5 offset:10240
    v_mfma_f32_16x16x32_bf16 v[88:91], a[12:15], a[72:75], v[88:91]
    ds_read_b64_tr_b16 a[42:43], v5 offset:47680
    v_mfma_f32_16x16x32_bf16 v[92:95], a[8:11], a[68:71], v[92:95]
    ds_read_b64_tr_b16 a[44:45], v9 offset:19584
    v_mfma_f32_16x16x32_bf16 v[92:95], a[12:15], a[76:79], v[92:95]
    s_waitcnt vmcnt(17) lgkmcnt(7)
    ds_read_b64_tr_b16 a[46:47], v9 offset:57024
    buffer_load_dwordx4 v15, s[4:7], s72 offen offset:1024 lds
    v_mfma_f32_16x16x32_bf16 v[96:99], a[16:19], a[64:67], v[96:99]
    s_barrier
    ds_read_b64_tr_b16 a[0:1], v3 offset:16384
    v_mfma_f32_16x16x32_bf16 v[96:99], a[20:23], a[72:75], v[96:99]
    ds_read_b64_tr_b16 a[2:3], v3 offset:53824
    v_mfma_f32_16x16x32_bf16 v[100:103], a[16:19], a[68:71], v[100:103]
    ds_read_b64_tr_b16 a[4:5], v7 offset:25728
    v_mfma_f32_16x16x32_bf16 v[100:103], a[20:23], a[76:79], v[100:103]
    ds_read_b64_tr_b16 a[6:7], v7 offset:63168
    buffer_load_dwordx4 v19, s[4:7], s72 offen offset:2048 lds
    v_mfma_f32_16x16x32_bf16 v[104:107], a[24:27], a[64:67], v[104:107]
    ds_read_b64_tr_b16 a[8:9], v4 offset:16384
    v_mfma_f32_16x16x32_bf16 v[104:107], a[28:31], a[72:75], v[104:107]
    ds_read_b64_tr_b16 a[10:11], v4 offset:53824
    v_mfma_f32_16x16x32_bf16 v[108:111], a[24:27], a[68:71], v[108:111]
    ds_read_b64_tr_b16 a[12:13], v8 offset:25728
    v_mfma_f32_16x16x32_bf16 v[108:111], a[28:31], a[76:79], v[108:111]
    s_waitcnt lgkmcnt(7)
    ds_read_b64_tr_b16 a[14:15], v8 offset:63168
    v_mfma_f32_16x16x32_bf16 v[112:115], a[32:35], a[64:67], v[112:115]
    ds_read_b64_tr_b16 a[16:17], v5 offset:16384
    v_mfma_f32_16x16x32_bf16 v[112:115], a[36:39], a[72:75], v[112:115]
    ds_read_b64_tr_b16 a[18:19], v5 offset:53824
    v_mfma_f32_16x16x32_bf16 v[116:119], a[32:35], a[68:71], v[116:119]
    ds_read_b64_tr_b16 a[20:21], v9 offset:25728
    v_mfma_f32_16x16x32_bf16 v[116:119], a[36:39], a[76:79], v[116:119]
    ds_read_b64_tr_b16 a[22:23], v9 offset:63168
    v_mfma_f32_16x16x32_bf16 v[120:123], a[40:43], a[64:67], v[120:123]
    ds_read_b64_tr_b16 a[24:25], v3 offset:22528
    v_mfma_f32_16x16x32_bf16 v[120:123], a[44:47], a[72:75], v[120:123]
    ds_read_b64_tr_b16 a[26:27], v3 offset:59968
    v_mfma_f32_16x16x32_bf16 v[124:127], a[40:43], a[68:71], v[124:127]
    ds_read_b64_tr_b16 a[28:29], v7 offset:31872
    v_mfma_f32_16x16x32_bf16 v[124:127], a[44:47], a[76:79], v[124:127]
    s_waitcnt lgkmcnt(7)
    ds_read_b64_tr_b16 a[30:31], v11 offset:3776
    v_mfma_f32_16x16x32_bf16 v[104:107], a[0:3], a[80:83], v[104:107]
    ds_read_b64_tr_b16 a[32:33], v4 offset:22528
    v_mfma_f32_16x16x32_bf16 v[104:107], a[4:7], a[88:91], v[104:107]
    s_add_u32 m0, s67, 0
    ds_read_b64_tr_b16 a[34:35], v4 offset:59968
    v_mfma_f32_16x16x32_bf16 v[108:111], a[0:3], a[84:87], v[108:111]
    s_add_u32 s72, s83, 0
    ds_read_b64_tr_b16 a[36:37], v8 offset:31872
    buffer_load_dwordx4 v14, s[4:7], s72 offen offset:0 lds
    v_mfma_f32_16x16x32_bf16 v[108:111], a[4:7], a[92:95], v[108:111]
    ds_read_b64_tr_b16 a[38:39], v12 offset:3776
    v_mfma_f32_16x16x32_bf16 v[112:115], a[8:11], a[80:83], v[112:115]
    ds_read_b64_tr_b16 a[40:41], v5 offset:22528
    v_mfma_f32_16x16x32_bf16 v[112:115], a[12:15], a[88:91], v[112:115]
    ds_read_b64_tr_b16 a[42:43], v5 offset:59968
    v_mfma_f32_16x16x32_bf16 v[116:119], a[8:11], a[84:87], v[116:119]
    ds_read_b64_tr_b16 a[44:45], v9 offset:31872
    buffer_load_dwordx4 v15, s[4:7], s72 offen offset:1024 lds
    v_mfma_f32_16x16x32_bf16 v[116:119], a[12:15], a[92:95], v[116:119]
    s_waitcnt vmcnt(5) lgkmcnt(7)
    ds_read_b64_tr_b16 a[46:47], v13 offset:3776
    v_mfma_f32_16x16x32_bf16 v[120:123], a[16:19], a[80:83], v[120:123]
    s_barrier
    ds_read_b64_tr_b16 a[0:1], v3 offset:28672
    v_mfma_f32_16x16x32_bf16 v[120:123], a[20:23], a[88:91], v[120:123]
    ds_read_b64_tr_b16 a[2:3], v7 offset:576
    v_mfma_f32_16x16x32_bf16 v[124:127], a[16:19], a[84:87], v[124:127]
    ds_read_b64_tr_b16 a[4:5], v7 offset:38016
    buffer_load_dwordx4 v19, s[4:7], s72 offen offset:2048 lds
    v_mfma_f32_16x16x32_bf16 v[124:127], a[20:23], a[92:95], v[124:127]
    ds_read_b64_tr_b16 a[6:7], v11 offset:9920
    v_mfma_f32_16x16x32_bf16 v[104:107], a[24:27], a[96:99], v[104:107]
    ds_read_b64_tr_b16 a[8:9], v4 offset:28672
    v_mfma_f32_16x16x32_bf16 v[104:107], a[28:31], a[104:107], v[104:107]
    s_add_u32 m0, s67, 3072
    ds_read_b64_tr_b16 a[10:11], v8 offset:576
    v_mfma_f32_16x16x32_bf16 v[108:111], a[24:27], a[100:103], v[108:111]
    s_add_u32 s72, s83, 36864
    ds_read_b64_tr_b16 a[12:13], v8 offset:38016
    buffer_load_dwordx4 v14, s[4:7], s72 offen offset:0 lds
    v_mfma_f32_16x16x32_bf16 v[108:111], a[28:31], a[108:111], v[108:111]
    s_waitcnt lgkmcnt(7)
    ds_read_b64_tr_b16 a[14:15], v12 offset:9920
    v_mfma_f32_16x16x32_bf16 v[112:115], a[32:35], a[96:99], v[112:115]
    ds_read_b64_tr_b16 a[16:17], v5 offset:28672
    v_mfma_f32_16x16x32_bf16 v[112:115], a[36:39], a[104:107], v[112:115]
    ds_read_b64_tr_b16 a[18:19], v9 offset:576
    v_mfma_f32_16x16x32_bf16 v[116:119], a[32:35], a[100:103], v[116:119]
    ds_read_b64_tr_b16 a[20:21], v9 offset:38016
    buffer_load_dwordx4 v15, s[4:7], s72 offen offset:1024 lds
    v_mfma_f32_16x16x32_bf16 v[116:119], a[36:39], a[108:111], v[116:119]
    ds_read_b64_tr_b16 a[22:23], v13 offset:9920
    v_mfma_f32_16x16x32_bf16 v[120:123], a[40:43], a[96:99], v[120:123]
    ds_read_b64_tr_b16 a[24:25], v3 offset:34816
    v_mfma_f32_16x16x32_bf16 v[120:123], a[44:47], a[104:107], v[120:123]
    ds_read_b64_tr_b16 a[26:27], v7 offset:6720
    v_mfma_f32_16x16x32_bf16 v[124:127], a[40:43], a[100:103], v[124:127]
    ds_read_b64_tr_b16 a[28:29], v7 offset:44160
    buffer_load_dwordx4 v19, s[4:7], s72 offen offset:2048 lds
    v_mfma_f32_16x16x32_bf16 v[124:127], a[44:47], a[108:111], v[124:127]
    s_waitcnt lgkmcnt(7)
    ds_read_b64_tr_b16 a[30:31], v11 offset:16064
    v_mfma_f32_16x16x32_bf16 v[104:107], a[0:3], a[112:115], v[104:107]
    ds_read_b64_tr_b16 a[32:33], v4 offset:34816
    v_mfma_f32_16x16x32_bf16 v[104:107], a[4:7], a[120:123], v[104:107]
    ds_read_b64_tr_b16 a[34:35], v8 offset:6720
    buffer_load_dword v21, v250, s[20:23], 0 offen sc1
    v_mfma_f32_16x16x32_bf16 v[108:111], a[0:3], a[116:119], v[108:111]
    ds_read_b64_tr_b16 a[36:37], v8 offset:44160
    v_mfma_f32_16x16x32_bf16 v[108:111], a[4:7], a[124:127], v[108:111]
    ds_read_b64_tr_b16 a[38:39], v12 offset:16064
    v_mfma_f32_16x16x32_bf16 v[112:115], a[8:11], a[112:115], v[112:115]
    s_add_u32 m0, s67, 6144
    ds_read_b64_tr_b16 a[40:41], v5 offset:34816
    v_mfma_f32_16x16x32_bf16 v[112:115], a[12:15], a[120:123], v[112:115]
    s_add_u32 s72, s83, 73728
    ds_read_b64_tr_b16 a[42:43], v9 offset:6720
    buffer_load_dwordx4 v14, s[4:7], s72 offen offset:0 lds
    v_mfma_f32_16x16x32_bf16 v[116:119], a[8:11], a[116:119], v[116:119]
    ds_read_b64_tr_b16 a[44:45], v9 offset:44160
    v_mfma_f32_16x16x32_bf16 v[116:119], a[12:15], a[124:127], v[116:119]
    s_waitcnt lgkmcnt(7)
    ds_read_b64_tr_b16 a[46:47], v13 offset:16064
    v_mfma_f32_16x16x32_bf16 v[120:123], a[16:19], a[112:115], v[120:123]
    ds_read_b64_tr_b16 a[0:1], v2 offset:12288
    buffer_load_dwordx4 v15, s[4:7], s72 offen offset:1024 lds
    v_mfma_f32_16x16x32_bf16 v[120:123], a[20:23], a[120:123], v[120:123]
    ds_read_b64_tr_b16 a[2:3], v2 offset:49728
    v_mfma_f32_16x16x32_bf16 v[124:127], a[16:19], a[116:119], v[124:127]
    ds_read_b64_tr_b16 a[4:5], v6 offset:21632
    v_mfma_f32_16x16x32_bf16 v[124:127], a[20:23], a[124:127], v[124:127]
    ds_read_b64_tr_b16 a[6:7], v6 offset:59072
    v_mfma_f32_16x16x32_bf16 v[104:107], a[24:27], a[128:131], v[104:107]
    ds_read_b64_tr_b16 a[8:9], v3 offset:12288
    buffer_load_dwordx4 v19, s[4:7], s72 offen offset:2048 lds
    v_mfma_f32_16x16x32_bf16 v[104:107], a[28:31], a[136:139], v[104:107]
    ds_read_b64_tr_b16 a[10:11], v3 offset:49728
    v_mfma_f32_16x16x32_bf16 v[108:111], a[24:27], a[132:135], v[108:111]
    s_add_u32 m0, s67, 9216
    ds_read_b64_tr_b16 a[12:13], v7 offset:21632
    v_mfma_f32_16x16x32_bf16 v[108:111], a[28:31], a[140:143], v[108:111]
    s_waitcnt lgkmcnt(7)
    ds_read_b64_tr_b16 a[14:15], v7 offset:59072
    v_mfma_f32_16x16x32_bf16 v[112:115], a[32:35], a[128:131], v[112:115]
L_pad_v2_1:
    s_cbranch_execz L_pad_v2_2
    s_add_u32 s72, s83, 110592
    ds_read_b64_tr_b16 a[16:17], v4 offset:12288
    buffer_load_dwordx4 v14, s[4:7], s72 offen offset:0 lds
    v_mfma_f32_16x16x32_bf16 v[112:115], a[36:39], a[136:139], v[112:115]
    ds_read_b64_tr_b16 a[18:19], v4 offset:49728
    v_mfma_f32_16x16x32_bf16 v[116:119], a[32:35], a[132:135], v[116:119]
    ds_read_b64_tr_b16 a[20:21], v8 offset:21632
    buffer_load_dwordx4 v15, s[4:7], s72 offen offset:1024 lds
    v_mfma_f32_16x16x32_bf16 v[116:119], a[36:39], a[140:143], v[116:119]
    ds_read_b64_tr_b16 a[22:23], v8 offset:59072
    v_mfma_f32_16x16x32_bf16 v[120:123], a[40:43], a[128:131], v[120:123]
    ds_read_b64_tr_b16 a[24:25], v2 offset:18432
    v_mfma_f32_16x16x32_bf16 v[120:123], a[44:47], a[136:139], v[120:123]
    ds_read_b64_tr_b16 a[26:27], v2 offset:55872
    v_mfma_f32_16x16x32_bf16 v[124:127], a[40:43], a[132:135], v[124:127]
    ds_read_b64_tr_b16 a[28:29], v6 offset:27776
    buffer_load_dwordx4 v19, s[4:7], s72 offen offset:2048 lds
    v_mfma_f32_16x16x32_bf16 v[124:127], a[44:47], a[140:143], v[124:127]
    s_waitcnt lgkmcnt(7)
    ds_read_b64_tr_b16 a[30:31], v6 offset:65216
    v_mfma_f32_16x16x32_bf16 v[32:35], a[0:3], a[80:83], v[32:35]
    ds_read_b64_tr_b16 a[32:33], v3 offset:18432
    v_mfma_f32_16x16x32_bf16 v[32:35], a[4:7], a[88:91], v[32:35]
    ds_read_b64_tr_b16 a[34:35], v3 offset:55872
    v_mfma_f32_16x16x32_bf16 v[36:39], a[0:3], a[84:87], v[36:39]
    ds_read_b64_tr_b16 a[36:37], v7 offset:27776
    v_mfma_f32_16x16x32_bf16 v[36:39], a[4:7], a[92:95], v[36:39]
    ds_read_b64_tr_b16 a[38:39], v7 offset:65216
    v_mfma_f32_16x16x32_bf16 v[40:43], a[8:11], a[80:83], v[40:43]
    s_add_u32 s82, s79, 884736
    ds_read_b64_tr_b16 a[40:41], v4 offset:18432
    v_mfma_f32_16x16x32_bf16 v[40:43], a[12:15], a[88:91], v[40:43]
    ds_read_b64_tr_b16 a[42:43], v4 offset:55872
    v_cvt_pk_bf16_f32 v104, v104, v105
    v_mfma_f32_16x16x32_bf16 v[44:47], a[8:11], a[84:87], v[44:47]
    ds_read_b64_tr_b16 a[44:45], v8 offset:27776
    v_cvt_pk_bf16_f32 v105, v106, v107
    v_mfma_f32_16x16x32_bf16 v[44:47], a[12:15], a[92:95], v[44:47]
    s_waitcnt lgkmcnt(7)
    ds_read_b64_tr_b16 a[46:47], v8 offset:65216
    v_cvt_pk_bf16_f32 v106, v108, v109
    v_mfma_f32_16x16x32_bf16 v[48:51], a[16:19], a[80:83], v[48:51]
    ds_read_b64_tr_b16 a[0:1], v2 offset:24576
    v_cvt_pk_bf16_f32 v107, v110, v111
    v_mfma_f32_16x16x32_bf16 v[48:51], a[20:23], a[88:91], v[48:51]
    ds_read_b64_tr_b16 a[2:3], v2 offset:62016
    buffer_store_dwordx4 v[104:107], v18, s[20:23], s82 offen offset:0 sc1
    v_mfma_f32_16x16x32_bf16 v[52:55], a[16:19], a[84:87], v[52:55]
    ds_read_b64_tr_b16 a[4:5], v6 offset:33920
    v_mfma_f32_16x16x32_bf16 v[52:55], a[20:23], a[92:95], v[52:55]
    ds_read_b64_tr_b16 a[6:7], v10 offset:5824
    v_mfma_f32_16x16x32_bf16 v[32:35], a[24:27], a[96:99], v[32:35]
    ds_read_b64_tr_b16 a[8:9], v3 offset:24576
    v_mfma_f32_16x16x32_bf16 v[32:35], a[28:31], a[104:107], v[32:35]
    ds_read_b64_tr_b16 a[10:11], v3 offset:62016
    v_mfma_f32_16x16x32_bf16 v[36:39], a[24:27], a[100:103], v[36:39]
    ds_read_b64_tr_b16 a[12:13], v7 offset:33920
    v_mfma_f32_16x16x32_bf16 v[36:39], a[28:31], a[108:111], v[36:39]
    s_waitcnt lgkmcnt(7)
    ds_read_b64_tr_b16 a[14:15], v11 offset:5824
    v_mfma_f32_16x16x32_bf16 v[40:43], a[32:35], a[96:99], v[40:43]
    ds_read_b64_tr_b16 a[16:17], v4 offset:24576
    v_mfma_f32_16x16x32_bf16 v[40:43], a[36:39], a[104:107], v[40:43]
    ds_read_b64_tr_b16 a[18:19], v4 offset:62016
    v_mfma_f32_16x16x32_bf16 v[44:47], a[32:35], a[100:103], v[44:47]
    ds_read_b64_tr_b16 a[20:21], v8 offset:33920
    v_mfma_f32_16x16x32_bf16 v[44:47], a[36:39], a[108:111], v[44:47]
    ds_read_b64_tr_b16 a[22:23], v12 offset:5824
    v_mfma_f32_16x16x32_bf16 v[48:51], a[40:43], a[96:99], v[48:51]
    ds_read_b64_tr_b16 a[24:25], v2 offset:30720
    v_mfma_f32_16x16x32_bf16 v[48:51], a[44:47], a[104:107], v[48:51]
    ds_read_b64_tr_b16 a[26:27], v6 offset:2624
    v_cvt_pk_bf16_f32 v112, v112, v113
    v_mfma_f32_16x16x32_bf16 v[52:55], a[40:43], a[100:103], v[52:55]
    ds_read_b64_tr_b16 a[28:29], v6 offset:40064
    v_cvt_pk_bf16_f32 v113, v114, v115
    v_mfma_f32_16x16x32_bf16 v[52:55], a[44:47], a[108:111], v[52:55]
    s_waitcnt lgkmcnt(7)
    ds_read_b64_tr_b16 a[30:31], v10 offset:11968
    v_cvt_pk_bf16_f32 v114, v116, v117
    v_mfma_f32_16x16x32_bf16 v[32:35], a[0:3], a[112:115], v[32:35]
    ds_read_b64_tr_b16 a[32:33], v3 offset:30720
    v_cvt_pk_bf16_f32 v115, v118, v119
    v_mfma_f32_16x16x32_bf16 v[32:35], a[4:7], a[120:123], v[32:35]
    ds_read_b64_tr_b16 a[34:35], v7 offset:2624
    buffer_store_dwordx4 v[112:115], v18, s[20:23], s82 offen offset:1024 sc1
    v_mfma_f32_16x16x32_bf16 v[36:39], a[0:3], a[116:119], v[36:39]
    ds_read_b64_tr_b16 a[36:37], v7 offset:40064
    v_mfma_f32_16x16x32_bf16 v[36:39], a[4:7], a[124:127], v[36:39]
    ds_read_b64_tr_b16 a[38:39], v11 offset:11968
    v_mfma_f32_16x16x32_bf16 v[40:43], a[8:11], a[112:115], v[40:43]
    ds_read_b64_tr_b16 a[40:41], v4 offset:30720
    v_mfma_f32_16x16x32_bf16 v[40:43], a[12:15], a[120:123], v[40:43]
    ds_read_b64_tr_b16 a[42:43], v8 offset:2624
    v_mfma_f32_16x16x32_bf16 v[44:47], a[8:11], a[116:119], v[44:47]
    ds_read_b64_tr_b16 a[44:45], v8 offset:40064
    v_mfma_f32_16x16x32_bf16 v[44:47], a[12:15], a[124:127], v[44:47]
    s_waitcnt lgkmcnt(7)
    ds_read_b64_tr_b16 a[46:47], v12 offset:11968
    v_mfma_f32_16x16x32_bf16 v[48:51], a[16:19], a[112:115], v[48:51]
    ds_read_b64_tr_b16 a[0:1], v5 offset:12288
    v_mfma_f32_16x16x32_bf16 v[48:51], a[20:23], a[120:123], v[48:51]
    ds_read_b64_tr_b16 a[2:3], v5 offset:49728
    v_mfma_f32_16x16x32_bf16 v[52:55], a[16:19], a[116:119], v[52:55]
    ds_read_b64_tr_b16 a[4:5], v9 offset:21632
    v_mfma_f32_16x16x32_bf16 v[52:55], a[20:23], a[124:127], v[52:55]
    ds_read_b64_tr_b16 a[6:7], v9 offset:59072
    v_mfma_f32_16x16x32_bf16 v[32:35], a[24:27], a[128:131], v[32:35]
    ds_read_b64_tr_b16 a[8:9], v2 offset:14336
    v_mfma_f32_16x16x32_bf16 v[32:35], a[28:31], a[136:139], v[32:35]
    ds_read_b64_tr_b16 a[10:11], v2 offset:51776
    v_cvt_pk_bf16_f32 v120, v120, v121
    v_mfma_f32_16x16x32_bf16 v[36:39], a[24:27], a[132:135], v[36:39]
    ds_read_b64_tr_b16 a[12:13], v6 offset:23680
    v_cvt_pk_bf16_f32 v121, v122, v123
    v_mfma_f32_16x16x32_bf16 v[36:39], a[28:31], a[140:143], v[36:39]
    s_waitcnt lgkmcnt(7)
    ds_read_b64_tr_b16 a[14:15], v6 offset:61120
    v_cvt_pk_bf16_f32 v122, v124, v125
    v_mfma_f32_16x16x32_bf16 v[40:43], a[32:35], a[128:131], v[40:43]
    ds_read_b64_tr_b16 a[16:17], v3 offset:14336
    v_cvt_pk_bf16_f32 v123, v126, v127
    v_mfma_f32_16x16x32_bf16 v[40:43], a[36:39], a[136:139], v[40:43]
    ds_read_b64_tr_b16 a[18:19], v3 offset:51776
    buffer_store_dwordx4 v[120:123], v18, s[20:23], s82 offen offset:2048 sc1
    v_mfma_f32_16x16x32_bf16 v[44:47], a[32:35], a[132:135], v[44:47]
    ds_read_b64_tr_b16 a[20:21], v7 offset:23680
    v_mfma_f32_16x16x32_bf16 v[44:47], a[36:39], a[140:143], v[44:47]
    ds_read_b64_tr_b16 a[22:23], v7 offset:61120
    v_mfma_f32_16x16x32_bf16 v[48:51], a[40:43], a[128:131], v[48:51]
    ds_read_b64_tr_b16 a[24:25], v5 offset:18432
    v_mfma_f32_16x16x32_bf16 v[48:51], a[44:47], a[136:139], v[48:51]
    ds_read_b64_tr_b16 a[26:27], v5 offset:55872
    v_mfma_f32_16x16x32_bf16 v[52:55], a[40:43], a[132:135], v[52:55]
    ds_read_b64_tr_b16 a[28:29], v9 offset:27776
    v_mfma_f32_16x16x32_bf16 v[52:55], a[44:47], a[140:143], v[52:55]
    s_waitcnt lgkmcnt(7)
    ds_read_b64_tr_b16 a[30:31], v9 offset:65216
    v_mfma_f32_16x16x32_bf16 v[56:59], a[0:3], a[80:83], v[56:59]
    ds_read_b64_tr_b16 a[32:33], v2 offset:20480
    s_add_u32 s71, s66, 1
    s_waitcnt vmcnt(9)
    v_subrev_u32 v21, s71, v21
    v_cmp_gt_u32 vcc, 8, v21
    s_nop 0
    s_cmp_eq_u64 vcc, exec
    s_cbranch_scc0 L_slow_27
L_back_28:
    v_mfma_f32_16x16x32_bf16 v[56:59], a[4:7], a[88:91], v[56:59]
    s_add_u32 s70, s78, 0
    ds_read_b64_tr_b16 a[34:35], v2 offset:57920
    buffer_load_dwordx4 a[144:147], v18, s[20:23], s70 offen offset:0 sc1
    v_mfma_f32_16x16x32_bf16 v[60:63], a[0:3], a[84:87], v[60:63]
    ds_read_b64_tr_b16 a[36:37], v6 offset:29824
    v_mfma_f32_16x16x32_bf16 v[60:63], a[4:7], a[92:95], v[60:63]
    ds_read_b64_tr_b16 a[38:39], v10 offset:1728
    v_mfma_f32_16x16x32_bf16 v[64:67], a[8:11], a[80:83], v[64:67]
    ds_read_b64_tr_b16 a[40:41], v3 offset:20480
    buffer_load_dwordx4 a[148:151], v18, s[20:23], s70 offen offset:1024 sc1
    v_mfma_f32_16x16x32_bf16 v[64:67], a[12:15], a[88:91], v[64:67]
    s_add_u32 s82, s79, 887808
    ds_read_b64_tr_b16 a[42:43], v3 offset:57920
    v_cvt_pk_bf16_f32 v32, v32, v33
    v_mfma_f32_16x16x32_bf16 v[68:71], a[8:11], a[84:87], v[68:71]
    ds_read_b64_tr_b16 a[44:45], v7 offset:29824
    v_cvt_pk_bf16_f32 v33, v34, v35
    v_mfma_f32_16x16x32_bf16 v[68:71], a[12:15], a[92:95], v[68:71]
    s_waitcnt lgkmcnt(7)
    ds_read_b64_tr_b16 a[46:47], v11 offset:1728
    v_cvt_pk_bf16_f32 v34, v36, v37
    v_mfma_f32_16x16x32_bf16 v[72:75], a[16:19], a[80:83], v[72:75]
    ds_read_b64_tr_b16 a[0:1], v5 offset:24576
    v_cvt_pk_bf16_f32 v35, v38, v39
    v_mfma_f32_16x16x32_bf16 v[72:75], a[20:23], a[88:91], v[72:75]
    ds_read_b64_tr_b16 a[2:3], v5 offset:62016
    buffer_store_dwordx4 v[32:35], v18, s[20:23], s82 offen offset:0 sc1
    v_mfma_f32_16x16x32_bf16 v[76:79], a[16:19], a[84:87], v[76:79]
    ds_read_b64_tr_b16 a[4:5], v9 offset:33920
    v_mfma_f32_16x16x32_bf16 v[76:79], a[20:23], a[92:95], v[76:79]
    ds_read_b64_tr_b16 a[6:7], v13 offset:5824
    buffer_load_dwordx4 a[152:155], v18, s[20:23], s70 offen offset:2048 sc1
    v_mfma_f32_16x16x32_bf16 v[56:59], a[24:27], a[96:99], v[56:59]
    ds_read_b64_tr_b16 a[8:9], v2 offset:26624
    v_mfma_f32_16x16x32_bf16 v[56:59], a[28:31], a[104:107], v[56:59]
    ds_read_b64_tr_b16 a[10:11], v2 offset:64064
    v_mfma_f32_16x16x32_bf16 v[60:63], a[24:27], a[100:103], v[60:63]
    ds_read_b64_tr_b16 a[12:13], v6 offset:35968
    buffer_load_dwordx4 a[156:159], v18, s[20:23], s70 offen offset:3072 sc1
    v_mfma_f32_16x16x32_bf16 v[60:63], a[28:31], a[108:111], v[60:63]
    s_waitcnt lgkmcnt(7)
    ds_read_b64_tr_b16 a[14:15], v10 offset:7872
    v_mfma_f32_16x16x32_bf16 v[64:67], a[32:35], a[96:99], v[64:67]
    ds_read_b64_tr_b16 a[16:17], v3 offset:26624
    v_mfma_f32_16x16x32_bf16 v[64:67], a[36:39], a[104:107], v[64:67]
    s_add_u32 s70, s78, 4096
    ds_read_b64_tr_b16 a[18:19], v3 offset:64064
    buffer_load_dwordx4 a[160:163], v18, s[20:23], s70 offen offset:0 sc1
    v_mfma_f32_16x16x32_bf16 v[68:71], a[32:35], a[100:103], v[68:71]
    ds_read_b64_tr_b16 a[20:21], v7 offset:35968
    v_mfma_f32_16x16x32_bf16 v[68:71], a[36:39], a[108:111], v[68:71]
    ds_read_b64_tr_b16 a[22:23], v11 offset:7872
    v_mfma_f32_16x16x32_bf16 v[72:75], a[40:43], a[96:99], v[72:75]
    ds_read_b64_tr_b16 a[24:25], v5 offset:30720
    buffer_load_dwordx4 a[164:167], v18, s[20:23], s70 offen offset:1024 sc1
    v_mfma_f32_16x16x32_bf16 v[72:75], a[44:47], a[104:107], v[72:75]
    ds_read_b64_tr_b16 a[26:27], v9 offset:2624
    v_cvt_pk_bf16_f32 v40, v40, v41
    v_mfma_f32_16x16x32_bf16 v[76:79], a[40:43], a[100:103], v[76:79]
    ds_read_b64_tr_b16 a[28:29], v9 offset:40064
    v_cvt_pk_bf16_f32 v41, v42, v43
    v_mfma_f32_16x16x32_bf16 v[76:79], a[44:47], a[108:111], v[76:79]
    s_waitcnt lgkmcnt(7)
    ds_read_b64_tr_b16 a[30:31], v13 offset:11968
    v_cvt_pk_bf16_f32 v42, v44, v45
    v_mfma_f32_16x16x32_bf16 v[56:59], a[0:3], a[112:115], v[56:59]
    ds_read_b64_tr_b16 a[32:33], v2 offset:32768
    v_cvt_pk_bf16_f32 v43, v46, v47
    v_mfma_f32_16x16x32_bf16 v[56:59], a[4:7], a[120:123], v[56:59]
    ds_read_b64_tr_b16 a[34:35], v6 offset:4672
    buffer_store_dwordx4 v[40:43], v18, s[20:23], s82 offen offset:1024 sc1
    v_mfma_f32_16x16x32_bf16 v[60:63], a[0:3], a[116:119], v[60:63]
    ds_read_b64_tr_b16 a[36:37], v6 offset:42112
    v_mfma_f32_16x16x32_bf16 v[60:63], a[4:7], a[124:127], v[60:63]
    ds_read_b64_tr_b16 a[38:39], v10 offset:14016
    buffer_load_dwordx4 a[168:171], v18, s[20:23], s70 offen offset:2048 sc1
    v_mfma_f32_16x16x32_bf16 v[64:67], a[8:11], a[112:115], v[64:67]
    ds_read_b64_tr_b16 a[40:41], v3 offset:32768
    v_mfma_f32_16x16x32_bf16 v[64:67], a[12:15], a[120:123], v[64:67]
    ds_read_b64_tr_b16 a[42:43], v7 offset:4672
    v_mfma_f32_16x16x32_bf16 v[68:71], a[8:11], a[116:119], v[68:71]
    ds_read_b64_tr_b16 a[44:45], v7 offset:42112
    buffer_load_dwordx4 a[172:175], v18, s[20:23], s70 offen offset:3072 sc1
    v_mfma_f32_16x16x32_bf16 v[68:71], a[12:15], a[124:127], v[68:71]
    s_waitcnt lgkmcnt(7)
    ds_read_b64_tr_b16 a[46:47], v11 offset:14016
    v_mfma_f32_16x16x32_bf16 v[72:75], a[16:19], a[112:115], v[72:75]
    ds_read_b64_tr_b16 a[0:1], v4 offset:14336
    v_mfma_f32_16x16x32_bf16 v[72:75], a[20:23], a[120:123], v[72:75]
    s_add_u32 s70, s78, 8192
    ds_read_b64_tr_b16 a[2:3], v4 offset:51776
    buffer_load_dwordx2 a[176:177], v251, s[20:23], s70 offen offset:0 sc1
    buffer_load_dwordx2 a[178:179], v251, s[20:23], s70 offen offset:512 sc1
    v_mfma_f32_16x16x32_bf16 v[76:79], a[16:19], a[116:119], v[76:79]
    ds_read_b64_tr_b16 a[4:5], v8 offset:23680
    v_mfma_f32_16x16x32_bf16 v[76:79], a[20:23], a[124:127], v[76:79]
    ds_read_b64_tr_b16 a[6:7], v8 offset:61120
    v_mfma_f32_16x16x32_bf16 v[56:59], a[24:27], a[128:131], v[56:59]
    ds_read_b64_tr_b16 a[8:9], v5 offset:14336
    buffer_load_dwordx2 a[180:181], v251, s[20:23], s70 offen offset:1024 sc1
    buffer_load_dwordx2 a[182:183], v251, s[20:23], s70 offen offset:1536 sc1
    v_mfma_f32_16x16x32_bf16 v[56:59], a[28:31], a[136:139], v[56:59]
    ds_read_b64_tr_b16 a[10:11], v5 offset:51776
    v_cvt_pk_bf16_f32 v48, v48, v49
    v_mfma_f32_16x16x32_bf16 v[60:63], a[24:27], a[132:135], v[60:63]
    ds_read_b64_tr_b16 a[12:13], v9 offset:23680
    v_cvt_pk_bf16_f32 v49, v50, v51
    v_mfma_f32_16x16x32_bf16 v[60:63], a[28:31], a[140:143], v[60:63]
    s_waitcnt lgkmcnt(7)
    ds_read_b64_tr_b16 a[14:15], v9 offset:61120
    v_cvt_pk_bf16_f32 v50, v52, v53
    v_mfma_f32_16x16x32_bf16 v[64:67], a[32:35], a[128:131], v[64:67]
    ds_read_b64_tr_b16 a[16:17], v2 offset:16384
    v_cvt_pk_bf16_f32 v51, v54, v55
    v_mfma_f32_16x16x32_bf16 v[64:67], a[36:39], a[136:139], v[64:67]
    ds_read_b64_tr_b16 a[18:19], v2 offset:53824
    buffer_store_dwordx4 v[48:51], v18, s[20:23], s82 offen offset:2048 sc1
    v_mfma_f32_16x16x32_bf16 v[68:71], a[32:35], a[132:135], v[68:71]
    ds_read_b64_tr_b16 a[20:21], v6 offset:25728
    v_mfma_f32_16x16x32_bf16 v[68:71], a[36:39], a[140:143], v[68:71]
    ds_read_b64_tr_b16 a[22:23], v6 offset:63168
    buffer_load_dwordx4 a[184:187], v18, s[20:23], s70 offen offset:2048 sc1
    v_mfma_f32_16x16x32_bf16 v[72:75], a[40:43], a[128:131], v[72:75]
    ds_read_b64_tr_b16 a[24:25], v4 offset:20480
    v_mfma_f32_16x16x32_bf16 v[72:75], a[44:47], a[136:139], v[72:75]
    ds_read_b64_tr_b16 a[26:27], v4 offset:57920
    v_mfma_f32_16x16x32_bf16 v[76:79], a[40:43], a[132:135], v[76:79]
    ds_read_b64_tr_b16 a[28:29], v8 offset:29824
    buffer_load_dwordx4 a[188:191], v18, s[20:23], s70 offen offset:3072 sc1
    v_mfma_f32_16x16x32_bf16 v[76:79], a[44:47], a[140:143], v[76:79]
    s_waitcnt lgkmcnt(7)
    ds_read_b64_tr_b16 a[30:31], v12 offset:1728
    v_mfma_f32_16x16x32_bf16 v[80:83], a[0:3], a[80:83], v[80:83]
    s_add_u32 s82, s79, 890880
    ds_read_b64_tr_b16 a[32:33], v5 offset:20480
    v_cvt_pk_bf16_f32 v56, v56, v57
    v_mfma_f32_16x16x32_bf16 v[80:83], a[4:7], a[88:91], v[80:83]
    ds_read_b64_tr_b16 a[34:35], v5 offset:57920
    v_cvt_pk_bf16_f32 v57, v58, v59
    v_mfma_f32_16x16x32_bf16 v[84:87], a[0:3], a[84:87], v[84:87]
    ds_read_b64_tr_b16 a[36:37], v9 offset:29824
    v_cvt_pk_bf16_f32 v58, v60, v61
    v_mfma_f32_16x16x32_bf16 v[84:87], a[4:7], a[92:95], v[84:87]
    ds_read_b64_tr_b16 a[38:39], v13 offset:1728
    v_cvt_pk_bf16_f32 v59, v62, v63
    v_mfma_f32_16x16x32_bf16 v[88:91], a[8:11], a[80:83], v[88:91]
    ds_read_b64_tr_b16 a[40:41], v2 offset:22528
    buffer_store_dwordx4 v[56:59], v18, s[20:23], s82 offen offset:0 sc1
    v_mfma_f32_16x16x32_bf16 v[88:91], a[12:15], a[88:91], v[88:91]
    ds_read_b64_tr_b16 a[42:43], v2 offset:59968
    v_cvt_pk_bf16_f32 v64, v64, v65
    v_mfma_f32_16x16x32_bf16 v[92:95], a[8:11], a[84:87], v[92:95]
    ds_read_b64_tr_b16 a[44:45], v6 offset:31872
    v_cvt_pk_bf16_f32 v65, v66, v67
    v_mfma_f32_16x16x32_bf16 v[92:95], a[12:15], a[92:95], v[92:95]
    s_waitcnt lgkmcnt(7)
    ds_read_b64_tr_b16 a[46:47], v10 offset:3776
    v_cvt_pk_bf16_f32 v66, v68, v69
    v_mfma_f32_16x16x32_bf16 v[96:99], a[16:19], a[80:83], v[96:99]
    ds_read_b64_tr_b16 a[0:1], v4 offset:26624
    v_cvt_pk_bf16_f32 v67, v70, v71
    v_mfma_f32_16x16x32_bf16 v[96:99], a[20:23], a[88:91], v[96:99]
    ds_read_b64_tr_b16 a[2:3], v4 offset:64064
    buffer_store_dwordx4 v[64:67], v18, s[20:23], s82 offen offset:1024 sc1
    v_mfma_f32_16x16x32_bf16 v[100:103], a[16:19], a[84:87], v[100:103]
    ds_read_b64_tr_b16 a[4:5], v8 offset:35968
    v_cvt_pk_bf16_f32 v72, v72, v73
    v_mfma_f32_16x16x32_bf16 v[100:103], a[20:23], a[92:95], v[100:103]
    ds_read_b64_tr_b16 a[6:7], v12 offset:7872
    v_cvt_pk_bf16_f32 v73, v74, v75
    v_mfma_f32_16x16x32_bf16 v[80:83], a[24:27], a[96:99], v[80:83]
    ds_read_b64_tr_b16 a[8:9], v5 offset:26624
    v_cvt_pk_bf16_f32 v74, v76, v77
    v_mfma_f32_16x16x32_bf16 v[80:83], a[28:31], a[104:107], v[80:83]
    ds_read_b64_tr_b16 a[10:11], v5 offset:64064
    v_cvt_pk_bf16_f32 v75, v78, v79
    v_mfma_f32_16x16x32_bf16 v[84:87], a[24:27], a[100:103], v[84:87]
    ds_read_b64_tr_b16 a[12:13], v9 offset:35968
    buffer_store_dwordx4 v[72:75], v18, s[20:23], s82 offen offset:2048 sc1
    v_mfma_f32_16x16x32_bf16 v[84:87], a[28:31], a[108:111], v[84:87]
    s_waitcnt lgkmcnt(7)
    ds_read_b64_tr_b16 a[14:15], v13 offset:7872
    v_mfma_f32_16x16x32_bf16 v[88:91], a[32:35], a[96:99], v[88:91]
    s_add_u32 s70, s78, 12288
    ds_read_b64_tr_b16 a[16:17], v2 offset:28672
    buffer_load_dwordx4 a[192:195], v18, s[20:23], s70 offen offset:0 sc1
    v_mfma_f32_16x16x32_bf16 v[88:91], a[36:39], a[104:107], v[88:91]
    ds_read_b64_tr_b16 a[18:19], v6 offset:576
    buffer_load_dwordx4 a[196:199], v18, s[20:23], s70 offen offset:1024 sc1
    v_mfma_f32_16x16x32_bf16 v[92:95], a[32:35], a[100:103], v[92:95]
    ds_read_b64_tr_b16 a[20:21], v6 offset:38016
    buffer_load_dwordx4 a[200:203], v18, s[20:23], s70 offen offset:2048 sc1
    v_mfma_f32_16x16x32_bf16 v[92:95], a[36:39], a[108:111], v[92:95]
    ds_read_b64_tr_b16 a[22:23], v10 offset:9920
    v_mfma_f32_16x16x32_bf16 v[96:99], a[40:43], a[96:99], v[96:99]
    ds_read_b64_tr_b16 a[24:25], v4 offset:32768
    buffer_load_dwordx4 a[204:207], v18, s[20:23], s70 offen offset:3072 sc1
    v_mfma_f32_16x16x32_bf16 v[96:99], a[44:47], a[104:107], v[96:99]
    ds_read_b64_tr_b16 a[26:27], v8 offset:4672
    v_mfma_f32_16x16x32_bf16 v[100:103], a[40:43], a[100:103], v[100:103]
    ds_read_b64_tr_b16 a[28:29], v8 offset:42112
    v_mfma_f32_16x16x32_bf16 v[100:103], a[44:47], a[108:111], v[100:103]
    s_waitcnt lgkmcnt(7)
    ds_read_b64_tr_b16 a[30:31], v12 offset:14016
    v_mfma_f32_16x16x32_bf16 v[80:83], a[0:3], a[112:115], v[80:83]
    s_add_u32 s70, s78, 16384
    ds_read_b64_tr_b16 a[32:33], v5 offset:32768
    buffer_load_dwordx4 a[208:211], v18, s[20:23], s70 offen offset:0 sc1
    v_mfma_f32_16x16x32_bf16 v[80:83], a[4:7], a[120:123], v[80:83]
    ds_read_b64_tr_b16 a[34:35], v9 offset:4672
    v_mfma_f32_16x16x32_bf16 v[84:87], a[0:3], a[116:119], v[84:87]
    ds_read_b64_tr_b16 a[36:37], v9 offset:42112
    v_mfma_f32_16x16x32_bf16 v[84:87], a[4:7], a[124:127], v[84:87]
    ds_read_b64_tr_b16 a[38:39], v13 offset:14016
    buffer_load_dwordx4 a[212:215], v18, s[20:23], s70 offen offset:1024 sc1
    v_mfma_f32_16x16x32_bf16 v[88:91], a[8:11], a[112:115], v[88:91]
    ds_read_b64_tr_b16 a[40:41], v2 offset:34816
    v_mfma_f32_16x16x32_bf16 v[88:91], a[12:15], a[120:123], v[88:91]
    ds_read_b64_tr_b16 a[42:43], v6 offset:6720
    v_mfma_f32_16x16x32_bf16 v[92:95], a[8:11], a[116:119], v[92:95]
    ds_read_b64_tr_b16 a[44:45], v6 offset:44160
    buffer_load_dwordx4 a[216:219], v18, s[20:23], s70 offen offset:2048 sc1
    v_mfma_f32_16x16x32_bf16 v[92:95], a[12:15], a[124:127], v[92:95]
    s_waitcnt vmcnt(30) lgkmcnt(7)
    ds_read_b64_tr_b16 a[46:47], v10 offset:16064
    v_mfma_f32_16x16x32_bf16 v[96:99], a[16:19], a[112:115], v[96:99]
    s_barrier
    ds_read_b64_tr_b16 a[0:1], v29 offset:0
    v_mfma_f32_16x16x32_bf16 v[96:99], a[20:23], a[120:123], v[96:99]
    ds_read_b64_tr_b16 a[2:3], v29 offset:1536
    buffer_load_dwordx4 a[220:223], v18, s[20:23], s70 offen offset:3072 sc1
    v_mfma_f32_16x16x32_bf16 v[100:103], a[16:19], a[116:119], v[100:103]
    ds_read_b64_tr_b16 a[4:5], v29 offset:3072
    v_mfma_f32_16x16x32_bf16 v[100:103], a[20:23], a[124:127], v[100:103]
    ds_read_b64_tr_b16 a[6:7], v29 offset:4608
    v_mfma_f32_16x16x32_bf16 v[80:83], a[24:27], a[128:131], v[80:83]
    s_add_u32 s70, s78, 20480
    ds_read_b64_tr_b16 a[8:9], v29 offset:6144
    buffer_load_dwordx4 a[224:227], v18, s[20:23], s70 offen offset:0 sc1
    v_mfma_f32_16x16x32_bf16 v[80:83], a[28:31], a[136:139], v[80:83]
    ds_read_b64_tr_b16 a[10:11], v29 offset:7680
    v_mfma_f32_16x16x32_bf16 v[84:87], a[24:27], a[132:135], v[84:87]
    ds_read_b64_tr_b16 a[12:13], v29 offset:9216
    v_mfma_f32_16x16x32_bf16 v[84:87], a[28:31], a[140:143], v[84:87]
    s_waitcnt lgkmcnt(7)
    ds_read_b64_tr_b16 a[14:15], v29 offset:10752
    v_mfma_f32_16x16x32_bf16 v[88:91], a[32:35], a[128:131], v[88:91]
    ds_read_b64_tr_b16 a[16:17], v29 offset:37440
    buffer_load_dwordx4 a[228:231], v18, s[20:23], s70 offen offset:1024 sc1
    v_mfma_f32_16x16x32_bf16 v[88:91], a[36:39], a[136:139], v[88:91]
    ds_read_b64_tr_b16 a[18:19], v29 offset:38976
    v_mfma_f32_16x16x32_bf16 v[92:95], a[32:35], a[132:135], v[92:95]
    ds_read_b64_tr_b16 a[20:21], v29 offset:40512
    v_mfma_f32_16x16x32_bf16 v[92:95], a[36:39], a[140:143], v[92:95]
    ds_read_b64_tr_b16 a[22:23], v29 offset:42048
    buffer_load_dwordx4 a[232:235], v18, s[20:23], s70 offen offset:2048 sc1
    v_mfma_f32_16x16x32_bf16 v[96:99], a[40:43], a[128:131], v[96:99]
    ds_read_b64_tr_b16 a[24:25], v29 offset:32
    v_mfma_f32_16x16x32_bf16 v[96:99], a[44:47], a[136:139], v[96:99]
    ds_read_b64_tr_b16 a[26:27], v29 offset:1568
    v_mfma_f32_16x16x32_bf16 v[100:103], a[40:43], a[132:135], v[100:103]
    ds_read_b64_tr_b16 a[28:29], v29 offset:3104
    buffer_load_dwordx4 a[236:239], v18, s[20:23], s70 offen offset:3072 sc1
    v_mfma_f32_16x16x32_bf16 v[100:103], a[44:47], a[140:143], v[100:103]
    s_waitcnt lgkmcnt(7)
    ds_read_b64_tr_b16 a[30:31], v29 offset:4640
    s_waitcnt vmcnt(31)
    v_mfma_f32_16x16x32_bf16 v[80:83], a[0:3], a[144:147], v[80:83]
    ds_read_b64_tr_b16 a[32:33], v29 offset:6176
    s_waitcnt vmcnt(28)
    v_mfma_f32_16x16x32_bf16 v[80:83], a[4:7], a[152:155], v[80:83]
    ds_read_b64_tr_b16 a[34:35], v29 offset:7712
    s_waitcnt vmcnt(12)
    s_add_u32 s71, s66, 1
    v_mov_b32 v22, s71
    buffer_store_dword v22, off, s[20:23], s93 sc1
    v_mfma_f32_16x16x32_bf16 v[84:87], a[0:3], a[148:151], v[84:87]
    ds_read_b64_tr_b16 a[36:37], v29 offset:9248
    v_mfma_f32_16x16x32_bf16 v[84:87], a[4:7], a[156:159], v[84:87]
    ds_read_b64_tr_b16 a[38:39], v29 offset:10784
    v_mfma_f32_16x16x32_bf16 v[80:83], a[8:11], a[160:163], v[80:83]
    s_add_u32 s70, s78, 24576
    ds_read_b64_tr_b16 a[40:41], v29 offset:37472
    buffer_load_dwordx4 v[202:205], v18, s[20:23], s70 offen offset:0 sc1
    v_mfma_f32_16x16x32_bf16 v[80:83], a[12:15], a[168:171], v[80:83]
    ds_read_b64_tr_b16 a[42:43], v29 offset:39008
    v_mfma_f32_16x16x32_bf16 v[84:87], a[8:11], a[164:167], v[84:87]
    ds_read_b64_tr_b16 a[44:45], v29 offset:40544
    buffer_load_dwordx4 v[206:209], v18, s[20:23], s70 offen offset:1024 sc1
    v_mfma_f32_16x16x32_bf16 v[84:87], a[12:15], a[172:175], v[84:87]
    s_waitcnt lgkmcnt(7)
    ds_read_b64_tr_b16 a[46:47], v29 offset:42080
    v_mfma_f32_16x16x32_bf16 v[80:83], a[16:19], a[176:179], v[80:83]
    ds_read_b64_tr_b16 a[0:1], v29 offset:64
    v_mfma_f32_16x16x32_bf16 v[80:83], a[20:23], a[184:187], v[80:83]
    ds_read_b64_tr_b16 a[2:3], v29 offset:1600
    buffer_load_dwordx2 v[210:211], v251, s[20:23], s70 offen offset:2048 sc1
    buffer_load_dwordx2 v[212:213], v251, s[20:23], s70 offen offset:2560 sc1
    v_mfma_f32_16x16x32_bf16 v[84:87], a[16:19], a[180:183], v[84:87]
    ds_read_b64_tr_b16 a[4:5], v29 offset:3136
    v_mfma_f32_16x16x32_bf16 v[84:87], a[20:23], a[188:191], v[84:87]
    ds_read_b64_tr_b16 a[6:7], v29 offset:4672
    v_mfma_f32_16x16x32_bf16 v[88:91], a[24:27], a[144:147], v[88:91]
    ds_read_b64_tr_b16 a[8:9], v29 offset:6208
    buffer_load_dwordx2 v[214:215], v251, s[20:23], s70 offen offset:3072 sc1
    buffer_load_dwordx2 v[216:217], v251, s[20:23], s70 offen offset:3584 sc1
    v_mfma_f32_16x16x32_bf16 v[88:91], a[28:31], a[152:155], v[88:91]
    ds_read_b64_tr_b16 a[10:11], v29 offset:7744
    v_mfma_f32_16x16x32_bf16 v[92:95], a[24:27], a[148:151], v[92:95]
    ds_read_b64_tr_b16 a[12:13], v29 offset:9280
    v_mfma_f32_16x16x32_bf16 v[92:95], a[28:31], a[156:159], v[92:95]
    s_waitcnt lgkmcnt(7)
    ds_read_b64_tr_b16 a[14:15], v29 offset:10816
    v_mfma_f32_16x16x32_bf16 v[88:91], a[32:35], a[160:163], v[88:91]
    s_add_u32 s70, s78, 28672
    ds_read_b64_tr_b16 a[16:17], v29 offset:37504
    buffer_load_dwordx4 v[218:221], v18, s[20:23], s70 offen offset:0 sc1
    v_mfma_f32_16x16x32_bf16 v[88:91], a[36:39], a[168:171], v[88:91]
    ds_read_b64_tr_b16 a[18:19], v29 offset:39040
    v_mfma_f32_16x16x32_bf16 v[92:95], a[32:35], a[164:167], v[92:95]
    ds_read_b64_tr_b16 a[20:21], v29 offset:40576
    buffer_load_dwordx4 v[222:225], v18, s[20:23], s70 offen offset:1024 sc1
    v_mfma_f32_16x16x32_bf16 v[92:95], a[36:39], a[172:175], v[92:95]
    ds_read_b64_tr_b16 a[22:23], v29 offset:42112
    v_mfma_f32_16x16x32_bf16 v[88:91], a[40:43], a[176:179], v[88:91]
    ds_read_b64_tr_b16 a[24:25], v29 offset:43584
    buffer_load_dwordx4 v[226:229], v18, s[20:23], s70 offen offset:2048 sc1
    v_mfma_f32_16x16x32_bf16 v[88:91], a[44:47], a[184:187], v[88:91]
    ds_read_b64_tr_b16 a[26:27], v29 offset:45120
    v_mfma_f32_16x16x32_bf16 v[92:95], a[40:43], a[180:183], v[92:95]
    ds_read_b64_tr_b16 a[28:29], v29 offset:46656
    v_mfma_f32_16x16x32_bf16 v[92:95], a[44:47], a[188:191], v[92:95]
    s_waitcnt lgkmcnt(7)
    ds_read_b64_tr_b16 a[30:31], v29 offset:48192
    buffer_load_dwordx4 v[230:233], v18, s[20:23], s70 offen offset:3072 sc1
    v_mfma_f32_16x16x32_bf16 v[96:99], a[0:3], a[144:147], v[96:99]
    ds_read_b64_tr_b16 a[32:33], v30 offset:9344
    v_mfma_f32_16x16x32_bf16 v[96:99], a[4:7], a[152:155], v[96:99]
    ds_read_b64_tr_b16 a[34:35], v30 offset:10880
    v_mfma_f32_16x16x32_bf16 v[100:103], a[0:3], a[148:151], v[100:103]
    s_add_u32 s70, s78, 32768
    ds_read_b64_tr_b16 a[36:37], v30 offset:12416
    buffer_load_dwordx4 v[234:237], v18, s[20:23], s70 offen offset:0 sc1
    v_mfma_f32_16x16x32_bf16 v[100:103], a[4:7], a[156:159], v[100:103]
    ds_read_b64_tr_b16 a[38:39], v30 offset:13952
    v_mfma_f32_16x16x32_bf16 v[96:99], a[8:11], a[160:163], v[96:99]
    ds_read_b64_tr_b16 a[40:41], v30 offset:15488
    v_mfma_f32_16x16x32_bf16 v[96:99], a[12:15], a[168:171], v[96:99]
    ds_read_b64_tr_b16 a[42:43], v30 offset:17024
    buffer_load_dwordx4 v[238:241], v18, s[20:23], s70 offen offset:1024 sc1
    v_mfma_f32_16x16x32_bf16 v[100:103], a[8:11], a[164:167], v[100:103]
    ds_read_b64_tr_b16 a[44:45], v30 offset:18560
    v_mfma_f32_16x16x32_bf16 v[100:103], a[12:15], a[172:175], v[100:103]
    s_waitcnt lgkmcnt(7)
    ds_read_b64_tr_b16 a[46:47], v30 offset:20096
    buffer_load_dwordx4 v[242:245], v18, s[20:23], s70 offen offset:2048 sc1
    v_mfma_f32_16x16x32_bf16 v[96:99], a[16:19], a[176:179], v[96:99]
    ds_read_b64_tr_b16 a[0:1], v29 offset:43616
    v_mfma_f32_16x16x32_bf16 v[96:99], a[20:23], a[184:187], v[96:99]
    ds_read_b64_tr_b16 a[2:3], v29 offset:45152
    v_mfma_f32_16x16x32_bf16 v[100:103], a[16:19], a[180:183], v[100:103]
    ds_read_b64_tr_b16 a[4:5], v29 offset:46688
    buffer_load_dwordx4 v[246:249], v18, s[20:23], s70 offen offset:3072 sc1
    v_mfma_f32_16x16x32_bf16 v[100:103], a[20:23], a[188:191], v[100:103]
    ds_read_b64_tr_b16 a[6:7], v29 offset:48224
    s_waitcnt vmcnt(26)
    v_mfma_f32_16x16x32_bf16 v[80:83], a[24:27], a[192:195], v[80:83]
    ds_read_b64_tr_b16 a[8:9], v30 offset:9376
    s_waitcnt vmcnt(24)
    v_mfma_f32_16x16x32_bf16 v[80:83], a[28:31], a[200:203], v[80:83]
    ds_read_b64_tr_b16 a[10:11], v30 offset:10912
    v_mfma_f32_16x16x32_bf16 v[84:87], a[24:27], a[196:199], v[84:87]
    ds_read_b64_tr_b16 a[12:13], v30 offset:12448
    s_waitcnt vmcnt(23)
    v_mfma_f32_16x16x32_bf16 v[84:87], a[28:31], a[204:207], v[84:87]
    s_waitcnt lgkmcnt(7)
    ds_read_b64_tr_b16 a[14:15], v30 offset:13984
    s_waitcnt vmcnt(22)
    v_mfma_f32_16x16x32_bf16 v[80:83], a[32:35], a[208:211], v[80:83]
    ds_read_b64_tr_b16 a[16:17], v30 offset:15520
    s_waitcnt vmcnt(20)
    v_mfma_f32_16x16x32_bf16 v[80:83], a[36:39], a[216:219], v[80:83]
    ds_read_b64_tr_b16 a[18:19], v30 offset:17056
    v_mfma_f32_16x16x32_bf16 v[84:87], a[32:35], a[212:215], v[84:87]
    ds_read_b64_tr_b16 a[20:21], v30 offset:18592
L_pad_v2_2:
    s_cbranch_execz L_walk_ret
    s_waitcnt vmcnt(19)
    v_mfma_f32_16x16x32_bf16 v[84:87], a[36:39], a[220:223], v[84:87]
    ds_read_b64_tr_b16 a[22:23], v30 offset:20128
    s_waitcnt vmcnt(18)
    v_mfma_f32_16x16x32_bf16 v[80:83], a[40:43], a[224:227], v[80:83]
    ds_read_b64_tr_b16 a[24:25], v29 offset:43648
    s_waitcnt vmcnt(16)
    v_mfma_f32_16x16x32_bf16 v[80:83], a[44:47], a[232:235], v[80:83]
    ds_read_b64_tr_b16 a[26:27], v29 offset:45184
    v_mfma_f32_16x16x32_bf16 v[84:87], a[40:43], a[228:231], v[84:87]
    ds_read_b64_tr_b16 a[28:29], v29 offset:46720
    s_waitcnt vmcnt(15)
    v_mfma_f32_16x16x32_bf16 v[84:87], a[44:47], a[236:239], v[84:87]
    s_waitcnt lgkmcnt(7)
    ds_read_b64_tr_b16 a[30:31], v29 offset:48256
    v_mfma_f32_16x16x32_bf16 v[88:91], a[0:3], a[192:195], v[88:91]
    ds_read_b64_tr_b16 a[32:33], v30 offset:9408
    v_mfma_f32_16x16x32_bf16 v[88:91], a[4:7], a[200:203], v[88:91]
    ds_read_b64_tr_b16 a[34:35], v30 offset:10944
    v_mfma_f32_16x16x32_bf16 v[92:95], a[0:3], a[196:199], v[92:95]
    ds_read_b64_tr_b16 a[36:37], v30 offset:12480
    v_mfma_f32_16x16x32_bf16 v[92:95], a[4:7], a[204:207], v[92:95]
    ds_read_b64_tr_b16 a[38:39], v30 offset:14016
    v_mfma_f32_16x16x32_bf16 v[88:91], a[8:11], a[208:211], v[88:91]
    ds_read_b64_tr_b16 a[40:41], v30 offset:15552
    v_mfma_f32_16x16x32_bf16 v[88:91], a[12:15], a[216:219], v[88:91]
    ds_read_b64_tr_b16 a[42:43], v30 offset:17088
    v_mfma_f32_16x16x32_bf16 v[92:95], a[8:11], a[212:215], v[92:95]
    ds_read_b64_tr_b16 a[44:45], v30 offset:18624
    buffer_load_dword v21, v25, s[20:23], 0 offen sc1
    v_mfma_f32_16x16x32_bf16 v[92:95], a[12:15], a[220:223], v[92:95]
    s_waitcnt lgkmcnt(7)
    ds_read_b64_tr_b16 a[46:47], v30 offset:20160
    v_mfma_f32_16x16x32_bf16 v[88:91], a[16:19], a[224:227], v[88:91]
    ds_read_b64_tr_b16 a[0:1], v30 offset:46784
    v_mfma_f32_16x16x32_bf16 v[88:91], a[20:23], a[232:235], v[88:91]
    ds_read_b64_tr_b16 a[2:3], v30 offset:48320
    v_mfma_f32_16x16x32_bf16 v[92:95], a[16:19], a[228:231], v[92:95]
    ds_read_b64_tr_b16 a[4:5], v30 offset:49856
    v_mfma_f32_16x16x32_bf16 v[92:95], a[20:23], a[236:239], v[92:95]
    ds_read_b64_tr_b16 a[6:7], v30 offset:51392
    v_mfma_f32_16x16x32_bf16 v[96:99], a[24:27], a[192:195], v[96:99]
    ds_read_b64_tr_b16 a[8:9], v30 offset:52928
    v_mfma_f32_16x16x32_bf16 v[96:99], a[28:31], a[200:203], v[96:99]
    ds_read_b64_tr_b16 a[10:11], v30 offset:54464
    v_mfma_f32_16x16x32_bf16 v[100:103], a[24:27], a[196:199], v[100:103]
    ds_read_b64_tr_b16 a[12:13], v30 offset:56000
    v_mfma_f32_16x16x32_bf16 v[100:103], a[28:31], a[204:207], v[100:103]
    s_waitcnt lgkmcnt(7)
    ds_read_b64_tr_b16 a[14:15], v30 offset:57536
    v_mfma_f32_16x16x32_bf16 v[96:99], a[32:35], a[208:211], v[96:99]
    ds_read_b64_tr_b16 a[16:17], v31 offset:18688
    v_mfma_f32_16x16x32_bf16 v[96:99], a[36:39], a[216:219], v[96:99]
    ds_read_b64_tr_b16 a[18:19], v31 offset:20224
    v_mfma_f32_16x16x32_bf16 v[100:103], a[32:35], a[212:215], v[100:103]
    ds_read_b64_tr_b16 a[20:21], v31 offset:21760
    v_mfma_f32_16x16x32_bf16 v[100:103], a[36:39], a[220:223], v[100:103]
    ds_read_b64_tr_b16 a[22:23], v31 offset:23296
    v_mfma_f32_16x16x32_bf16 v[96:99], a[40:43], a[224:227], v[96:99]
    ds_read_b64_tr_b16 a[24:25], v30 offset:46816
    v_mfma_f32_16x16x32_bf16 v[96:99], a[44:47], a[232:235], v[96:99]
    ds_read_b64_tr_b16 a[26:27], v30 offset:48352
    v_mfma_f32_16x16x32_bf16 v[100:103], a[40:43], a[228:231], v[100:103]
    ds_read_b64_tr_b16 a[28:29], v30 offset:49888
    v_mfma_f32_16x16x32_bf16 v[100:103], a[44:47], a[236:239], v[100:103]
    s_waitcnt lgkmcnt(7)
    ds_read_b64_tr_b16 a[30:31], v30 offset:51424
    s_waitcnt vmcnt(14)
    v_mfma_f32_16x16x32_bf16 v[80:83], a[0:3], v[202:205], v[80:83]
    ds_read_b64_tr_b16 a[32:33], v30 offset:52960
    s_add_u32 s71, s66, 1
    s_waitcnt vmcnt(0)
    v_subrev_u32 v21, s71, v21
    v_cmp_gt_u32 vcc, 8, v21
    s_nop 0
    s_cmp_eq_u64 vcc, exec
    s_cbranch_scc0 L_slow_30
L_back_31:
    v_mfma_f32_16x16x32_bf16 v[80:83], a[4:7], v[210:213], v[80:83]
    s_add_u32 s72, s79, 442368
    ds_read_b64_tr_b16 a[34:35], v30 offset:54496
    buffer_load_dwordx4 v[166:169], v18, s[20:23], s72 offen offset:0 sc1
    v_mfma_f32_16x16x32_bf16 v[84:87], a[0:3], v[206:209], v[84:87]
    ds_read_b64_tr_b16 a[36:37], v30 offset:56032
    v_mfma_f32_16x16x32_bf16 v[84:87], a[4:7], v[214:217], v[84:87]
    ds_read_b64_tr_b16 a[38:39], v30 offset:57568
    buffer_load_dwordx4 v[170:173], v18, s[20:23], s72 offen offset:1024 sc1
    v_mfma_f32_16x16x32_bf16 v[80:83], a[8:11], v[218:221], v[80:83]
    ds_read_b64_tr_b16 a[40:41], v31 offset:18720
    v_mfma_f32_16x16x32_bf16 v[80:83], a[12:15], v[226:229], v[80:83]
    ds_read_b64_tr_b16 a[42:43], v31 offset:20256
    buffer_load_dwordx4 v[174:177], v18, s[20:23], s72 offen offset:2048 sc1
    v_mfma_f32_16x16x32_bf16 v[84:87], a[8:11], v[222:225], v[84:87]
    ds_read_b64_tr_b16 a[44:45], v31 offset:21792
    v_mfma_f32_16x16x32_bf16 v[84:87], a[12:15], v[230:233], v[84:87]
    s_waitcnt lgkmcnt(7)
    ds_read_b64_tr_b16 a[46:47], v31 offset:23328
    v_mfma_f32_16x16x32_bf16 v[80:83], a[16:19], v[234:237], v[80:83]
    s_add_u32 s72, s79, 3072
    ds_read_b64_tr_b16 a[0:1], v30 offset:46848
    buffer_load_dwordx4 v[178:181], v18, s[20:23], s72 offen offset:0 sc1
    v_mfma_f32_16x16x32_bf16 v[80:83], a[20:23], v[242:245], v[80:83]
    ds_read_b64_tr_b16 a[2:3], v30 offset:48384
    v_mfma_f32_16x16x32_bf16 v[84:87], a[16:19], v[238:241], v[84:87]
    ds_read_b64_tr_b16 a[4:5], v30 offset:49920
    buffer_load_dwordx4 v[182:185], v18, s[20:23], s72 offen offset:1024 sc1
    v_mfma_f32_16x16x32_bf16 v[84:87], a[20:23], v[246:249], v[84:87]
    ds_read_b64_tr_b16 a[6:7], v30 offset:51456
    v_mfma_f32_16x16x32_bf16 v[88:91], a[24:27], v[202:205], v[88:91]
    ds_read_b64_tr_b16 a[8:9], v30 offset:52992
    buffer_load_dwordx4 v[186:189], v18, s[20:23], s72 offen offset:2048 sc1
    v_mfma_f32_16x16x32_bf16 v[88:91], a[28:31], v[210:213], v[88:91]
    ds_read_b64_tr_b16 a[10:11], v30 offset:54528
    v_mfma_f32_16x16x32_bf16 v[92:95], a[24:27], v[206:209], v[92:95]
    ds_read_b64_tr_b16 a[12:13], v30 offset:56064
    v_mfma_f32_16x16x32_bf16 v[92:95], a[28:31], v[214:217], v[92:95]
    s_waitcnt lgkmcnt(7)
    ds_read_b64_tr_b16 a[14:15], v30 offset:57600
    v_mfma_f32_16x16x32_bf16 v[88:91], a[32:35], v[218:221], v[88:91]
    s_add_u32 s72, s79, 1333248
    ds_read_b64_tr_b16 a[16:17], v31 offset:18752
    buffer_load_dwordx4 v[190:193], v18, s[20:23], s72 offen offset:0 sc1
    v_mfma_f32_16x16x32_bf16 v[88:91], a[36:39], v[226:229], v[88:91]
    ds_read_b64_tr_b16 a[18:19], v31 offset:20288
    buffer_load_dwordx4 v[194:197], v18, s[20:23], s72 offen offset:1024 sc1
    v_mfma_f32_16x16x32_bf16 v[92:95], a[32:35], v[222:225], v[92:95]
    ds_read_b64_tr_b16 a[20:21], v31 offset:21824
    v_mfma_f32_16x16x32_bf16 v[92:95], a[36:39], v[230:233], v[92:95]
    ds_read_b64_tr_b16 a[22:23], v31 offset:23360
    buffer_load_dwordx4 v[198:201], v18, s[20:23], s72 offen offset:2048 sc1
    v_mfma_f32_16x16x32_bf16 v[88:91], a[40:43], v[234:237], v[88:91]
    v_mfma_f32_16x16x32_bf16 v[88:91], a[44:47], v[242:245], v[88:91]
    v_mfma_f32_16x16x32_bf16 v[92:95], a[40:43], v[238:241], v[92:95]
    v_mfma_f32_16x16x32_bf16 v[92:95], a[44:47], v[246:249], v[92:95]
    s_waitcnt lgkmcnt(4)
    v_mfma_f32_16x16x32_bf16 v[96:99], a[0:3], v[202:205], v[96:99]
    v_mfma_f32_16x16x32_bf16 v[96:99], a[4:7], v[210:213], v[96:99]
    v_mfma_f32_16x16x32_bf16 v[100:103], a[0:3], v[206:209], v[100:103]
    v_mfma_f32_16x16x32_bf16 v[100:103], a[4:7], v[214:217], v[100:103]
    v_mfma_f32_16x16x32_bf16 v[96:99], a[8:11], v[218:221], v[96:99]
    v_mfma_f32_16x16x32_bf16 v[96:99], a[12:15], v[226:229], v[96:99]
    v_mfma_f32_16x16x32_bf16 v[100:103], a[8:11], v[222:225], v[100:103]
    v_mfma_f32_16x16x32_bf16 v[100:103], a[12:15], v[230:233], v[100:103]
    s_waitcnt lgkmcnt(0)
    v_mfma_f32_16x16x32_bf16 v[96:99], a[16:19], v[234:237], v[96:99]
    v_mfma_f32_16x16x32_bf16 v[96:99], a[20:23], v[242:245], v[96:99]
    v_mfma_f32_16x16x32_bf16 v[100:103], a[16:19], v[238:241], v[100:103]
    v_mfma_f32_16x16x32_bf16 v[100:103], a[20:23], v[246:249], v[100:103]
    v_add_f32 v142, v142, v80
    v_add_f32 v143, v143, v81
    v_add_f32 v144, v144, v82
    v_add_f32 v145, v145, v83
    v_add_f32 v146, v146, v84
    v_add_f32 v147, v147, v85
    v_add_f32 v148, v148, v86
    v_add_f32 v149, v149, v87
    v_add_f32 v150, v150, v88
    v_add_f32 v151, v151, v89
    v_add_f32 v152, v152, v90
    v_add_f32 v153, v153, v91
    v_add_f32 v154, v154, v92
    v_add_f32 v155, v155, v93
    v_add_f32 v156, v156, v94
    v_add_f32 v157, v157, v95
    v_add_f32 v158, v158, v96
    v_add_f32 v159, v159, v97
    v_add_f32 v160, v160, v98
    v_add_f32 v161, v161, v99
    v_add_f32 v162, v162, v100
    v_add_f32 v163, v163, v101
    v_add_f32 v164, v164, v102
    v_add_f32 v165, v165, v103
    s_waitcnt vmcnt(8)
    v_mfma_f32_16x16x32_bf16 v[142:145], v[138:141], v[166:169], v[142:145]
    v_mfma_f32_16x16x32_bf16 v[146:149], v[136:139], v[166:169], v[146:149]
    s_waitcnt vmcnt(7)
    v_mfma_f32_16x16x32_bf16 v[150:153], v[138:141], v[170:173], v[150:153]
    v_mfma_f32_16x16x32_bf16 v[154:157], v[136:139], v[170:173], v[154:157]
    s_waitcnt vmcnt(6)
    v_mfma_f32_16x16x32_bf16 v[158:161], v[138:141], v[174:177], v[158:161]
    v_mfma_f32_16x16x32_bf16 v[162:165], v[136:139], v[174:177], v[162:165]
    s_waitcnt vmcnt(5)
    v_mfma_f32_16x16x32_bf16 v[142:145], v[138:141], v[178:181], v[142:145]
    v_mfma_f32_16x16x32_bf16 v[146:149], v[136:139], v[178:181], v[146:149]
    s_waitcnt vmcnt(4)
    v_mfma_f32_16x16x32_bf16 v[150:153], v[138:141], v[182:185], v[150:153]
    v_mfma_f32_16x16x32_bf16 v[154:157], v[136:139], v[182:185], v[154:157]
    s_waitcnt vmcnt(3)
    v_mfma_f32_16x16x32_bf16 v[158:161], v[138:141], v[186:189], v[158:161]
    v_mfma_f32_16x16x32_bf16 v[162:165], v[136:139], v[186:189], v[162:165]
    s_waitcnt vmcnt(2)
    v_mfma_f32_16x16x32_bf16 v[142:145], v[138:141], v[190:193], v[142:145]
    v_mfma_f32_16x16x32_bf16 v[146:149], v[136:139], v[190:193], v[146:149]
    s_waitcnt vmcnt(1)
    v_mfma_f32_16x16x32_bf16 v[150:153], v[138:141], v[194:197], v[150:153]
    v_mfma_f32_16x16x32_bf16 v[154:157], v[136:139], v[194:197], v[154:157]
    s_waitcnt vmcnt(0)
    v_mfma_f32_16x16x32_bf16 v[158:161], v[138:141], v[198:201], v[158:161]
    v_mfma_f32_16x16x32_bf16 v[162:165], v[136:139], v[198:201], v[162:165]
    s_nop 0
    v_cvt_pk_bf16_f32 v142, v142, v143
    v_cvt_pk_bf16_f32 v143, v144, v145
    buffer_store_dwordx2 v[142:143], v23, s[24:27], s89 offen offset:0 sc1
    v_cvt_pk_bf16_f32 v146, v146, v147
    v_cvt_pk_bf16_f32 v147, v148, v149
    buffer_store_dwordx2 v[146:147], v23, s[24:27], s91 offen offset:0 sc1
    v_cvt_pk_bf16_f32 v150, v150, v151
    v_cvt_pk_bf16_f32 v151, v152, v153
    buffer_store_dwordx2 v[150:151], v23, s[24:27], s89 offen offset:32 sc1
    v_cvt_pk_bf16_f32 v154, v154, v155
    v_cvt_pk_bf16_f32 v155, v156, v157
    buffer_store_dwordx2 v[154:155], v23, s[24:27], s91 offen offset:32 sc1
    v_cvt_pk_bf16_f32 v158, v158, v159
    v_cvt_pk_bf16_f32 v159, v160, v161
    buffer_store_dwordx2 v[158:159], v23, s[24:27], s89 offen offset:64 sc1
    v_cvt_pk_bf16_f32 v162, v162, v163
    v_cvt_pk_bf16_f32 v163, v164, v165
    buffer_store_dwordx2 v[162:163], v23, s[24:27], s91 offen offset:64 sc1
    s_endpgm
L_tail_13:
L_pad_v3_0:
    s_cbranch_execz L_pad_v3_1
    s_nop 3
    v_mfma_f32_16x16x32_bf16 v[80:83], a[0:3], a[64:67], v[80:83]
    ds_read_b64_tr_b16 a[32:33], v4 offset:10240
    v_mfma_f32_16x16x32_bf16 v[80:83], a[4:7], a[72:75], v[80:83]
    ds_read_b64_tr_b16 a[34:35], v4 offset:47680
    v_mfma_f32_16x16x32_bf16 v[84:87], a[0:3], a[68:71], v[84:87]
    s_mov_b32 m0, s73
    ds_read_b64_tr_b16 a[36:37], v8 offset:19584
    v_mfma_f32_16x16x32_bf16 v[84:87], a[4:7], a[76:79], v[84:87]
    s_mov_b32 s72, s3
    ds_read_b64_tr_b16 a[38:39], v8 offset:57024
    buffer_load_dwordx4 v14, s[4:7], s72 offen offset:0 lds
    v_mfma_f32_16x16x32_bf16 v[88:91], a[8:11], a[64:67], v[88:91]
    ds_read_b64_tr_b16 a[40:41], v5 offset:10240
    v_mfma_f32_16x16x32_bf16 v[88:91], a[12:15], a[72:75], v[88:91]
    ds_read_b64_tr_b16 a[42:43], v5 offset:47680
    v_mfma_f32_16x16x32_bf16 v[92:95], a[8:11], a[68:71], v[92:95]
    ds_read_b64_tr_b16 a[44:45], v9 offset:19584
    v_mfma_f32_16x16x32_bf16 v[92:95], a[12:15], a[76:79], v[92:95]
    s_waitcnt vmcnt(17) lgkmcnt(7)
    ds_read_b64_tr_b16 a[46:47], v9 offset:57024
    buffer_load_dwordx4 v15, s[4:7], s72 offen offset:1024 lds
    v_mfma_f32_16x16x32_bf16 v[96:99], a[16:19], a[64:67], v[96:99]
    s_barrier
    ds_read_b64_tr_b16 a[0:1], v2 offset:12288
    v_mfma_f32_16x16x32_bf16 v[96:99], a[20:23], a[72:75], v[96:99]
    ds_read_b64_tr_b16 a[2:3], v2 offset:49728
    v_mfma_f32_16x16x32_bf16 v[100:103], a[16:19], a[68:71], v[100:103]
    ds_read_b64_tr_b16 a[4:5], v6 offset:21632
    v_mfma_f32_16x16x32_bf16 v[100:103], a[20:23], a[76:79], v[100:103]
    ds_read_b64_tr_b16 a[6:7], v6 offset:59072
    buffer_load_dwordx4 v19, s[4:7], s72 offen offset:2048 lds
    v_mfma_f32_16x16x32_bf16 v[104:107], a[24:27], a[64:67], v[104:107]
    ds_read_b64_tr_b16 a[8:9], v3 offset:12288
    v_mfma_f32_16x16x32_bf16 v[104:107], a[28:31], a[72:75], v[104:107]
    ds_read_b64_tr_b16 a[10:11], v3 offset:49728
    v_mfma_f32_16x16x32_bf16 v[108:111], a[24:27], a[68:71], v[108:111]
    ds_read_b64_tr_b16 a[12:13], v7 offset:21632
    v_mfma_f32_16x16x32_bf16 v[108:111], a[28:31], a[76:79], v[108:111]
    s_waitcnt lgkmcnt(7)
    ds_read_b64_tr_b16 a[14:15], v7 offset:59072
    v_mfma_f32_16x16x32_bf16 v[112:115], a[32:35], a[64:67], v[112:115]
    ds_read_b64_tr_b16 a[16:17], v4 offset:12288
    v_mfma_f32_16x16x32_bf16 v[112:115], a[36:39], a[72:75], v[112:115]
    ds_read_b64_tr_b16 a[18:19], v4 offset:49728
    v_mfma_f32_16x16x32_bf16 v[116:119], a[32:35], a[68:71], v[116:119]
    ds_read_b64_tr_b16 a[20:21], v8 offset:21632
    v_mfma_f32_16x16x32_bf16 v[116:119], a[36:39], a[76:79], v[116:119]
    ds_read_b64_tr_b16 a[22:23], v8 offset:59072
    v_mfma_f32_16x16x32_bf16 v[120:123], a[40:43], a[64:67], v[120:123]
    ds_read_b64_tr_b16 a[24:25], v2 offset:18432
    v_mfma_f32_16x16x32_bf16 v[120:123], a[44:47], a[72:75], v[120:123]
    ds_read_b64_tr_b16 a[26:27], v2 offset:55872
    v_mfma_f32_16x16x32_bf16 v[124:127], a[40:43], a[68:71], v[124:127]
    ds_read_b64_tr_b16 a[28:29], v6 offset:27776
    v_mfma_f32_16x16x32_bf16 v[124:127], a[44:47], a[76:79], v[124:127]
    s_waitcnt lgkmcnt(7)
    ds_read_b64_tr_b16 a[30:31], v6 offset:65216
    v_mfma_f32_16x16x32_bf16 v[32:35], a[0:3], a[80:83], v[32:35]
    ds_read_b64_tr_b16 a[32:33], v3 offset:18432
    v_mfma_f32_16x16x32_bf16 v[32:35], a[4:7], a[88:91], v[32:35]
    s_add_u32 m0, s67, 0
    ds_read_b64_tr_b16 a[34:35], v3 offset:55872
    v_mfma_f32_16x16x32_bf16 v[36:39], a[0:3], a[84:87], v[36:39]
    s_add_u32 s72, s83, 0
    ds_read_b64_tr_b16 a[36:37], v7 offset:27776
    buffer_load_dwordx4 v14, s[4:7], s72 offen offset:0 lds
    v_mfma_f32_16x16x32_bf16 v[36:39], a[4:7], a[92:95], v[36:39]
    ds_read_b64_tr_b16 a[38:39], v7 offset:65216
    v_mfma_f32_16x16x32_bf16 v[40:43], a[8:11], a[80:83], v[40:43]
    ds_read_b64_tr_b16 a[40:41], v4 offset:18432
    v_mfma_f32_16x16x32_bf16 v[40:43], a[12:15], a[88:91], v[40:43]
    ds_read_b64_tr_b16 a[42:43], v4 offset:55872
    v_mfma_f32_16x16x32_bf16 v[44:47], a[8:11], a[84:87], v[44:47]
    ds_read_b64_tr_b16 a[44:45], v8 offset:27776
    buffer_load_dwordx4 v15, s[4:7], s72 offen offset:1024 lds
    v_mfma_f32_16x16x32_bf16 v[44:47], a[12:15], a[92:95], v[44:47]
    s_waitcnt vmcnt(5) lgkmcnt(7)
    ds_read_b64_tr_b16 a[46:47], v8 offset:65216
    v_mfma_f32_16x16x32_bf16 v[48:51], a[16:19], a[80:83], v[48:51]
    s_barrier
    ds_read_b64_tr_b16 a[0:1], v2 offset:24576
    v_mfma_f32_16x16x32_bf16 v[48:51], a[20:23], a[88:91], v[48:51]
    ds_read_b64_tr_b16 a[2:3], v2 offset:62016
    v_mfma_f32_16x16x32_bf16 v[52:55], a[16:19], a[84:87], v[52:55]
    ds_read_b64_tr_b16 a[4:5], v6 offset:33920
    buffer_load_dwordx4 v19, s[4:7], s72 offen offset:2048 lds
    v_mfma_f32_16x16x32_bf16 v[52:55], a[20:23], a[92:95], v[52:55]
    ds_read_b64_tr_b16 a[6:7], v10 offset:5824
    v_mfma_f32_16x16x32_bf16 v[32:35], a[24:27], a[96:99], v[32:35]
    ds_read_b64_tr_b16 a[8:9], v3 offset:24576
    v_mfma_f32_16x16x32_bf16 v[32:35], a[28:31], a[104:107], v[32:35]
    s_add_u32 m0, s67, 3072
    ds_read_b64_tr_b16 a[10:11], v3 offset:62016
    v_mfma_f32_16x16x32_bf16 v[36:39], a[24:27], a[100:103], v[36:39]
    s_add_u32 s72, s83, 36864
    ds_read_b64_tr_b16 a[12:13], v7 offset:33920
    buffer_load_dwordx4 v14, s[4:7], s72 offen offset:0 lds
    v_mfma_f32_16x16x32_bf16 v[36:39], a[28:31], a[108:111], v[36:39]
    s_waitcnt lgkmcnt(7)
    ds_read_b64_tr_b16 a[14:15], v11 offset:5824
    v_mfma_f32_16x16x32_bf16 v[40:43], a[32:35], a[96:99], v[40:43]
    ds_read_b64_tr_b16 a[16:17], v4 offset:24576
    v_mfma_f32_16x16x32_bf16 v[40:43], a[36:39], a[104:107], v[40:43]
    ds_read_b64_tr_b16 a[18:19], v4 offset:62016
    v_mfma_f32_16x16x32_bf16 v[44:47], a[32:35], a[100:103], v[44:47]
    ds_read_b64_tr_b16 a[20:21], v8 offset:33920
    buffer_load_dwordx4 v15, s[4:7], s72 offen offset:1024 lds
    v_mfma_f32_16x16x32_bf16 v[44:47], a[36:39], a[108:111], v[44:47]
    ds_read_b64_tr_b16 a[22:23], v12 offset:5824
    v_mfma_f32_16x16x32_bf16 v[48:51], a[40:43], a[96:99], v[48:51]
    ds_read_b64_tr_b16 a[24:25], v2 offset:30720
    v_mfma_f32_16x16x32_bf16 v[48:51], a[44:47], a[104:107], v[48:51]
    ds_read_b64_tr_b16 a[26:27], v6 offset:2624
    v_mfma_f32_16x16x32_bf16 v[52:55], a[40:43], a[100:103], v[52:55]
    ds_read_b64_tr_b16 a[28:29], v6 offset:40064
    buffer_load_dwordx4 v19, s[4:7], s72 offen offset:2048 lds
    v_mfma_f32_16x16x32_bf16 v[52:55], a[44:47], a[108:111], v[52:55]
    s_waitcnt lgkmcnt(7)
    ds_read_b64_tr_b16 a[30:31], v10 offset:11968
    v_mfma_f32_16x16x32_bf16 v[32:35], a[0:3], a[112:115], v[32:35]
    ds_read_b64_tr_b16 a[32:33], v3 offset:30720
    v_mfma_f32_16x16x32_bf16 v[32:35], a[4:7], a[120:123], v[32:35]
    ds_read_b64_tr_b16 a[34:35], v7 offset:2624
    buffer_load_dword v21, v250, s[20:23], 0 offen sc1
    v_mfma_f32_16x16x32_bf16 v[36:39], a[0:3], a[116:119], v[36:39]
    ds_read_b64_tr_b16 a[36:37], v7 offset:40064
    v_mfma_f32_16x16x32_bf16 v[36:39], a[4:7], a[124:127], v[36:39]
    ds_read_b64_tr_b16 a[38:39], v11 offset:11968
    v_mfma_f32_16x16x32_bf16 v[40:43], a[8:11], a[112:115], v[40:43]
    s_add_u32 m0, s67, 6144
    ds_read_b64_tr_b16 a[40:41], v4 offset:30720
    v_mfma_f32_16x16x32_bf16 v[40:43], a[12:15], a[120:123], v[40:43]
    s_add_u32 s72, s83, 73728
    ds_read_b64_tr_b16 a[42:43], v8 offset:2624
    buffer_load_dwordx4 v14, s[4:7], s72 offen offset:0 lds
    v_mfma_f32_16x16x32_bf16 v[44:47], a[8:11], a[116:119], v[44:47]
    ds_read_b64_tr_b16 a[44:45], v8 offset:40064
    v_mfma_f32_16x16x32_bf16 v[44:47], a[12:15], a[124:127], v[44:47]
    s_waitcnt lgkmcnt(7)
    ds_read_b64_tr_b16 a[46:47], v12 offset:11968
    v_mfma_f32_16x16x32_bf16 v[48:51], a[16:19], a[112:115], v[48:51]
    ds_read_b64_tr_b16 a[0:1], v5 offset:12288
    buffer_load_dwordx4 v15, s[4:7], s72 offen offset:1024 lds
    v_mfma_f32_16x16x32_bf16 v[48:51], a[20:23], a[120:123], v[48:51]
    ds_read_b64_tr_b16 a[2:3], v5 offset:49728
    v_mfma_f32_16x16x32_bf16 v[52:55], a[16:19], a[116:119], v[52:55]
    ds_read_b64_tr_b16 a[4:5], v9 offset:21632
    v_mfma_f32_16x16x32_bf16 v[52:55], a[20:23], a[124:127], v[52:55]
    ds_read_b64_tr_b16 a[6:7], v9 offset:59072
    v_mfma_f32_16x16x32_bf16 v[32:35], a[24:27], a[128:131], v[32:35]
    ds_read_b64_tr_b16 a[8:9], v2 offset:14336
    buffer_load_dwordx4 v19, s[4:7], s72 offen offset:2048 lds
    v_mfma_f32_16x16x32_bf16 v[32:35], a[28:31], a[136:139], v[32:35]
    ds_read_b64_tr_b16 a[10:11], v2 offset:51776
    v_mfma_f32_16x16x32_bf16 v[36:39], a[24:27], a[132:135], v[36:39]
    s_add_u32 m0, s67, 9216
    ds_read_b64_tr_b16 a[12:13], v6 offset:23680
    v_mfma_f32_16x16x32_bf16 v[36:39], a[28:31], a[140:143], v[36:39]
    s_waitcnt lgkmcnt(7)
    ds_read_b64_tr_b16 a[14:15], v6 offset:61120
    v_mfma_f32_16x16x32_bf16 v[40:43], a[32:35], a[128:131], v[40:43]
    s_add_u32 s72, s83, 110592
    ds_read_b64_tr_b16 a[16:17], v3 offset:14336
    buffer_load_dwordx4 v14, s[4:7], s72 offen offset:0 lds
    v_mfma_f32_16x16x32_bf16 v[40:43], a[36:39], a[136:139], v[40:43]
    ds_read_b64_tr_b16 a[18:19], v3 offset:51776
    v_mfma_f32_16x16x32_bf16 v[44:47], a[32:35], a[132:135], v[44:47]
    ds_read_b64_tr_b16 a[20:21], v7 offset:23680
    buffer_load_dwordx4 v15, s[4:7], s72 offen offset:1024 lds
    v_mfma_f32_16x16x32_bf16 v[44:47], a[36:39], a[140:143], v[44:47]
    ds_read_b64_tr_b16 a[22:23], v7 offset:61120
    v_mfma_f32_16x16x32_bf16 v[48:51], a[40:43], a[128:131], v[48:51]
    ds_read_b64_tr_b16 a[24:25], v5 offset:18432
    v_mfma_f32_16x16x32_bf16 v[48:51], a[44:47], a[136:139], v[48:51]
    ds_read_b64_tr_b16 a[26:27], v5 offset:55872
    v_mfma_f32_16x16x32_bf16 v[52:55], a[40:43], a[132:135], v[52:55]
    ds_read_b64_tr_b16 a[28:29], v9 offset:27776
    buffer_load_dwordx4 v19, s[4:7], s72 offen offset:2048 lds
    v_mfma_f32_16x16x32_bf16 v[52:55], a[44:47], a[140:143], v[52:55]
    s_waitcnt lgkmcnt(7)
    ds_read_b64_tr_b16 a[30:31], v9 offset:65216
    v_mfma_f32_16x16x32_bf16 v[56:59], a[0:3], a[80:83], v[56:59]
    ds_read_b64_tr_b16 a[32:33], v2 offset:20480
    v_mfma_f32_16x16x32_bf16 v[56:59], a[4:7], a[88:91], v[56:59]
    ds_read_b64_tr_b16 a[34:35], v2 offset:57920
    v_mfma_f32_16x16x32_bf16 v[60:63], a[0:3], a[84:87], v[60:63]
    ds_read_b64_tr_b16 a[36:37], v6 offset:29824
    v_mfma_f32_16x16x32_bf16 v[60:63], a[4:7], a[92:95], v[60:63]
    ds_read_b64_tr_b16 a[38:39], v10 offset:1728
    v_mfma_f32_16x16x32_bf16 v[64:67], a[8:11], a[80:83], v[64:67]
    s_add_u32 s82, s79, 1327104
    ds_read_b64_tr_b16 a[40:41], v3 offset:20480
    v_mfma_f32_16x16x32_bf16 v[64:67], a[12:15], a[88:91], v[64:67]
    ds_read_b64_tr_b16 a[42:43], v3 offset:57920
    v_cvt_pk_bf16_f32 v32, v32, v33
    v_mfma_f32_16x16x32_bf16 v[68:71], a[8:11], a[84:87], v[68:71]
    ds_read_b64_tr_b16 a[44:45], v7 offset:29824
    v_cvt_pk_bf16_f32 v33, v34, v35
    v_mfma_f32_16x16x32_bf16 v[68:71], a[12:15], a[92:95], v[68:71]
    s_waitcnt lgkmcnt(7)
    ds_read_b64_tr_b16 a[46:47], v11 offset:1728
    v_cvt_pk_bf16_f32 v34, v36, v37
    v_mfma_f32_16x16x32_bf16 v[72:75], a[16:19], a[80:83], v[72:75]
    ds_read_b64_tr_b16 a[0:1], v5 offset:24576
    v_cvt_pk_bf16_f32 v35, v38, v39
    v_mfma_f32_16x16x32_bf16 v[72:75], a[20:23], a[88:91], v[72:75]
    ds_read_b64_tr_b16 a[2:3], v5 offset:62016
    buffer_store_dwordx4 v[32:35], v18, s[20:23], s82 offen offset:0 sc1
    v_mfma_f32_16x16x32_bf16 v[76:79], a[16:19], a[84:87], v[76:79]
    ds_read_b64_tr_b16 a[4:5], v9 offset:33920
    v_mfma_f32_16x16x32_bf16 v[76:79], a[20:23], a[92:95], v[76:79]
    ds_read_b64_tr_b16 a[6:7], v13 offset:5824
    v_mfma_f32_16x16x32_bf16 v[56:59], a[24:27], a[96:99], v[56:59]
    ds_read_b64_tr_b16 a[8:9], v2 offset:26624
    v_mfma_f32_16x16x32_bf16 v[56:59], a[28:31], a[104:107], v[56:59]
    ds_read_b64_tr_b16 a[10:11], v2 offset:64064
    v_mfma_f32_16x16x32_bf16 v[60:63], a[24:27], a[100:103], v[60:63]
    ds_read_b64_tr_b16 a[12:13], v6 offset:35968
    v_mfma_f32_16x16x32_bf16 v[60:63], a[28:31], a[108:111], v[60:63]
    s_waitcnt lgkmcnt(7)
    ds_read_b64_tr_b16 a[14:15], v10 offset:7872
    v_mfma_f32_16x16x32_bf16 v[64:67], a[32:35], a[96:99], v[64:67]
    ds_read_b64_tr_b16 a[16:17], v3 offset:26624
    v_mfma_f32_16x16x32_bf16 v[64:67], a[36:39], a[104:107], v[64:67]
    ds_read_b64_tr_b16 a[18:19], v3 offset:64064
    v_mfma_f32_16x16x32_bf16 v[68:71], a[32:35], a[100:103], v[68:71]
    ds_read_b64_tr_b16 a[20:21], v7 offset:35968
    v_mfma_f32_16x16x32_bf16 v[68:71], a[36:39], a[108:111], v[68:71]
    ds_read_b64_tr_b16 a[22:23], v11 offset:7872
    v_mfma_f32_16x16x32_bf16 v[72:75], a[40:43], a[96:99], v[72:75]
    ds_read_b64_tr_b16 a[24:25], v5 offset:30720
    v_mfma_f32_16x16x32_bf16 v[72:75], a[44:47], a[104:107], v[72:75]
    ds_read_b64_tr_b16 a[26:27], v9 offset:2624
    v_cvt_pk_bf16_f32 v40, v40, v41
    v_mfma_f32_16x16x32_bf16 v[76:79], a[40:43], a[100:103], v[76:79]
    ds_read_b64_tr_b16 a[28:29], v9 offset:40064
    v_cvt_pk_bf16_f32 v41, v42, v43
    v_mfma_f32_16x16x32_bf16 v[76:79], a[44:47], a[108:111], v[76:79]
    s_waitcnt lgkmcnt(7)
    ds_read_b64_tr_b16 a[30:31], v13 offset:11968
    v_cvt_pk_bf16_f32 v42, v44, v45
    v_mfma_f32_16x16x32_bf16 v[56:59], a[0:3], a[112:115], v[56:59]
    ds_read_b64_tr_b16 a[32:33], v2 offset:32768
    v_cvt_pk_bf16_f32 v43, v46, v47
    v_mfma_f32_16x16x32_bf16 v[56:59], a[4:7], a[120:123], v[56:59]
    ds_read_b64_tr_b16 a[34:35], v6 offset:4672
    buffer_store_dwordx4 v[40:43], v18, s[20:23], s82 offen offset:1024 sc1
    v_mfma_f32_16x16x32_bf16 v[60:63], a[0:3], a[116:119], v[60:63]
    ds_read_b64_tr_b16 a[36:37], v6 offset:42112
    v_mfma_f32_16x16x32_bf16 v[60:63], a[4:7], a[124:127], v[60:63]
    ds_read_b64_tr_b16 a[38:39], v10 offset:14016
    v_mfma_f32_16x16x32_bf16 v[64:67], a[8:11], a[112:115], v[64:67]
    ds_read_b64_tr_b16 a[40:41], v3 offset:32768
    v_mfma_f32_16x16x32_bf16 v[64:67], a[12:15], a[120:123], v[64:67]
    ds_read_b64_tr_b16 a[42:43], v7 offset:4672
    v_mfma_f32_16x16x32_bf16 v[68:71], a[8:11], a[116:119], v[68:71]
    ds_read_b64_tr_b16 a[44:45], v7 offset:42112
    v_mfma_f32_16x16x32_bf16 v[68:71], a[12:15], a[124:127], v[68:71]
    s_waitcnt lgkmcnt(7)
    ds_read_b64_tr_b16 a[46:47], v11 offset:14016
    v_mfma_f32_16x16x32_bf16 v[72:75], a[16:19], a[112:115], v[72:75]
    ds_read_b64_tr_b16 a[0:1], v4 offset:14336
    v_mfma_f32_16x16x32_bf16 v[72:75], a[20:23], a[120:123], v[72:75]
    ds_read_b64_tr_b16 a[2:3], v4 offset:51776
    v_mfma_f32_16x16x32_bf16 v[76:79], a[16:19], a[116:119], v[76:79]
    ds_read_b64_tr_b16 a[4:5], v8 offset:23680
    v_mfma_f32_16x16x32_bf16 v[76:79], a[20:23], a[124:127], v[76:79]
    ds_read_b64_tr_b16 a[6:7], v8 offset:61120
    v_mfma_f32_16x16x32_bf16 v[56:59], a[24:27], a[128:131], v[56:59]
    ds_read_b64_tr_b16 a[8:9], v5 offset:14336
    v_mfma_f32_16x16x32_bf16 v[56:59], a[28:31], a[136:139], v[56:59]
    ds_read_b64_tr_b16 a[10:11], v5 offset:51776
    v_cvt_pk_bf16_f32 v48, v48, v49
    v_mfma_f32_16x16x32_bf16 v[60:63], a[24:27], a[132:135], v[60:63]
    ds_read_b64_tr_b16 a[12:13], v9 offset:23680
    v_cvt_pk_bf16_f32 v49, v50, v51
    v_mfma_f32_16x16x32_bf16 v[60:63], a[28:31], a[140:143], v[60:63]
    s_waitcnt lgkmcnt(7)
    ds_read_b64_tr_b16 a[14:15], v9 offset:61120
    v_cvt_pk_bf16_f32 v50, v52, v53
    v_mfma_f32_16x16x32_bf16 v[64:67], a[32:35], a[128:131], v[64:67]
    ds_read_b64_tr_b16 a[16:17], v2 offset:16384
    v_cvt_pk_bf16_f32 v51, v54, v55
    v_mfma_f32_16x16x32_bf16 v[64:67], a[36:39], a[136:139], v[64:67]
    ds_read_b64_tr_b16 a[18:19], v2 offset:53824
    buffer_store_dwordx4 v[48:51], v18, s[20:23], s82 offen offset:2048 sc1
    v_mfma_f32_16x16x32_bf16 v[68:71], a[32:35], a[132:135], v[68:71]
    ds_read_b64_tr_b16 a[20:21], v6 offset:25728
    v_mfma_f32_16x16x32_bf16 v[68:71], a[36:39], a[140:143], v[68:71]
    ds_read_b64_tr_b16 a[22:23], v6 offset:63168
    v_mfma_f32_16x16x32_bf16 v[72:75], a[40:43], a[128:131], v[72:75]
    ds_read_b64_tr_b16 a[24:25], v4 offset:20480
    v_mfma_f32_16x16x32_bf16 v[72:75], a[44:47], a[136:139], v[72:75]
    ds_read_b64_tr_b16 a[26:27], v4 offset:57920
    v_mfma_f32_16x16x32_bf16 v[76:79], a[40:43], a[132:135], v[76:79]
    ds_read_b64_tr_b16 a[28:29], v8 offset:29824
    v_mfma_f32_16x16x32_bf16 v[76:79], a[44:47], a[140:143], v[76:79]
    s_waitcnt lgkmcnt(7)
    ds_read_b64_tr_b16 a[30:31], v12 offset:1728
    v_mfma_f32_16x16x32_bf16 v[80:83], a[0:3], a[80:83], v[80:83]
    ds_read_b64_tr_b16 a[32:33], v5 offset:20480
    s_add_u32 s71, s66, 1
    s_waitcnt vmcnt(9)
    v_subrev_u32 v21, s71, v21
    v_cmp_gt_u32 vcc, 8, v21
    s_nop 0
    s_cmp_eq_u64 vcc, exec
    s_cbranch_scc0 L_slow_33
L_back_34:
    v_mfma_f32_16x16x32_bf16 v[80:83], a[4:7], a[88:91], v[80:83]
    s_add_u32 s70, s78, 0
    ds_read_b64_tr_b16 a[34:35], v5 offset:57920
    buffer_load_dwordx4 a[144:147], v18, s[20:23], s70 offen offset:0 sc1
    v_mfma_f32_16x16x32_bf16 v[84:87], a[0:3], a[84:87], v[84:87]
    ds_read_b64_tr_b16 a[36:37], v9 offset:29824
    v_mfma_f32_16x16x32_bf16 v[84:87], a[4:7], a[92:95], v[84:87]
    ds_read_b64_tr_b16 a[38:39], v13 offset:1728
    v_mfma_f32_16x16x32_bf16 v[88:91], a[8:11], a[80:83], v[88:91]
    ds_read_b64_tr_b16 a[40:41], v2 offset:22528
    buffer_load_dwordx4 a[148:151], v18, s[20:23], s70 offen offset:1024 sc1
    v_mfma_f32_16x16x32_bf16 v[88:91], a[12:15], a[88:91], v[88:91]
    s_add_u32 s82, s79, 1330176
    ds_read_b64_tr_b16 a[42:43], v2 offset:59968
    v_cvt_pk_bf16_f32 v56, v56, v57
    v_mfma_f32_16x16x32_bf16 v[92:95], a[8:11], a[84:87], v[92:95]
    ds_read_b64_tr_b16 a[44:45], v6 offset:31872
    v_cvt_pk_bf16_f32 v57, v58, v59
    v_mfma_f32_16x16x32_bf16 v[92:95], a[12:15], a[92:95], v[92:95]
    s_waitcnt lgkmcnt(7)
    ds_read_b64_tr_b16 a[46:47], v10 offset:3776
    v_cvt_pk_bf16_f32 v58, v60, v61
    v_mfma_f32_16x16x32_bf16 v[96:99], a[16:19], a[80:83], v[96:99]
    ds_read_b64_tr_b16 a[0:1], v4 offset:26624
    v_cvt_pk_bf16_f32 v59, v62, v63
    v_mfma_f32_16x16x32_bf16 v[96:99], a[20:23], a[88:91], v[96:99]
    ds_read_b64_tr_b16 a[2:3], v4 offset:64064
L_pad_v3_1:
    s_cbranch_execz L_pad_v3_2
    buffer_store_dwordx4 v[56:59], v18, s[20:23], s82 offen offset:0 sc1
    v_mfma_f32_16x16x32_bf16 v[100:103], a[16:19], a[84:87], v[100:103]
    ds_read_b64_tr_b16 a[4:5], v8 offset:35968
    v_mfma_f32_16x16x32_bf16 v[100:103], a[20:23], a[92:95], v[100:103]
    ds_read_b64_tr_b16 a[6:7], v12 offset:7872
    buffer_load_dwordx4 a[152:155], v18, s[20:23], s70 offen offset:2048 sc1
    v_mfma_f32_16x16x32_bf16 v[80:83], a[24:27], a[96:99], v[80:83]
    ds_read_b64_tr_b16 a[8:9], v5 offset:26624
    v_mfma_f32_16x16x32_bf16 v[80:83], a[28:31], a[104:107], v[80:83]
    ds_read_b64_tr_b16 a[10:11], v5 offset:64064
    v_mfma_f32_16x16x32_bf16 v[84:87], a[24:27], a[100:103], v[84:87]
    ds_read_b64_tr_b16 a[12:13], v9 offset:35968
    buffer_load_dwordx4 a[156:159], v18, s[20:23], s70 offen offset:3072 sc1
    v_mfma_f32_16x16x32_bf16 v[84:87], a[28:31], a[108:111], v[84:87]
    s_waitcnt lgkmcnt(7)
    ds_read_b64_tr_b16 a[14:15], v13 offset:7872
    v_mfma_f32_16x16x32_bf16 v[88:91], a[32:35], a[96:99], v[88:91]
    ds_read_b64_tr_b16 a[16:17], v2 offset:28672
    v_mfma_f32_16x16x32_bf16 v[88:91], a[36:39], a[104:107], v[88:91]
    s_add_u32 s70, s78, 4096
    ds_read_b64_tr_b16 a[18:19], v6 offset:576
    buffer_load_dwordx4 a[160:163], v18, s[20:23], s70 offen offset:0 sc1
    v_mfma_f32_16x16x32_bf16 v[92:95], a[32:35], a[100:103], v[92:95]
    ds_read_b64_tr_b16 a[20:21], v6 offset:38016
    v_mfma_f32_16x16x32_bf16 v[92:95], a[36:39], a[108:111], v[92:95]
    ds_read_b64_tr_b16 a[22:23], v10 offset:9920
    v_mfma_f32_16x16x32_bf16 v[96:99], a[40:43], a[96:99], v[96:99]
    ds_read_b64_tr_b16 a[24:25], v4 offset:32768
    buffer_load_dwordx4 a[164:167], v18, s[20:23], s70 offen offset:1024 sc1
    v_mfma_f32_16x16x32_bf16 v[96:99], a[44:47], a[104:107], v[96:99]
    ds_read_b64_tr_b16 a[26:27], v8 offset:4672
    v_cvt_pk_bf16_f32 v64, v64, v65
    v_mfma_f32_16x16x32_bf16 v[100:103], a[40:43], a[100:103], v[100:103]
    ds_read_b64_tr_b16 a[28:29], v8 offset:42112
    v_cvt_pk_bf16_f32 v65, v66, v67
    v_mfma_f32_16x16x32_bf16 v[100:103], a[44:47], a[108:111], v[100:103]
    s_waitcnt lgkmcnt(7)
    ds_read_b64_tr_b16 a[30:31], v12 offset:14016
    v_cvt_pk_bf16_f32 v66, v68, v69
    v_mfma_f32_16x16x32_bf16 v[80:83], a[0:3], a[112:115], v[80:83]
    ds_read_b64_tr_b16 a[32:33], v5 offset:32768
    v_cvt_pk_bf16_f32 v67, v70, v71
    v_mfma_f32_16x16x32_bf16 v[80:83], a[4:7], a[120:123], v[80:83]
    ds_read_b64_tr_b16 a[34:35], v9 offset:4672
    buffer_store_dwordx4 v[64:67], v18, s[20:23], s82 offen offset:1024 sc1
    v_mfma_f32_16x16x32_bf16 v[84:87], a[0:3], a[116:119], v[84:87]
    ds_read_b64_tr_b16 a[36:37], v9 offset:42112
    v_mfma_f32_16x16x32_bf16 v[84:87], a[4:7], a[124:127], v[84:87]
    ds_read_b64_tr_b16 a[38:39], v13 offset:14016
    buffer_load_dwordx4 a[168:171], v18, s[20:23], s70 offen offset:2048 sc1
    v_mfma_f32_16x16x32_bf16 v[88:91], a[8:11], a[112:115], v[88:91]
    ds_read_b64_tr_b16 a[40:41], v2 offset:34816
    v_mfma_f32_16x16x32_bf16 v[88:91], a[12:15], a[120:123], v[88:91]
    ds_read_b64_tr_b16 a[42:43], v6 offset:6720
    v_mfma_f32_16x16x32_bf16 v[92:95], a[8:11], a[116:119], v[92:95]
    ds_read_b64_tr_b16 a[44:45], v6 offset:44160
    buffer_load_dwordx4 a[172:175], v18, s[20:23], s70 offen offset:3072 sc1
    v_mfma_f32_16x16x32_bf16 v[92:95], a[12:15], a[124:127], v[92:95]
    s_waitcnt lgkmcnt(7)
    ds_read_b64_tr_b16 a[46:47], v10 offset:16064
    v_mfma_f32_16x16x32_bf16 v[96:99], a[16:19], a[112:115], v[96:99]
    ds_read_b64_tr_b16 a[0:1], v3 offset:16384
    v_mfma_f32_16x16x32_bf16 v[96:99], a[20:23], a[120:123], v[96:99]
    s_add_u32 s70, s78, 8192
    ds_read_b64_tr_b16 a[2:3], v3 offset:53824
    buffer_load_dwordx2 a[176:177], v251, s[20:23], s70 offen offset:0 sc1
    buffer_load_dwordx2 a[178:179], v251, s[20:23], s70 offen offset:512 sc1
    v_mfma_f32_16x16x32_bf16 v[100:103], a[16:19], a[116:119], v[100:103]
    ds_read_b64_tr_b16 a[4:5], v7 offset:25728
    v_mfma_f32_16x16x32_bf16 v[100:103], a[20:23], a[124:127], v[100:103]
    ds_read_b64_tr_b16 a[6:7], v7 offset:63168
    v_mfma_f32_16x16x32_bf16 v[80:83], a[24:27], a[128:131], v[80:83]
    ds_read_b64_tr_b16 a[8:9], v4 offset:16384
    buffer_load_dwordx2 a[180:181], v251, s[20:23], s70 offen offset:1024 sc1
    buffer_load_dwordx2 a[182:183], v251, s[20:23], s70 offen offset:1536 sc1
    v_mfma_f32_16x16x32_bf16 v[80:83], a[28:31], a[136:139], v[80:83]
    ds_read_b64_tr_b16 a[10:11], v4 offset:53824
    v_cvt_pk_bf16_f32 v72, v72, v73
    v_mfma_f32_16x16x32_bf16 v[84:87], a[24:27], a[132:135], v[84:87]
    ds_read_b64_tr_b16 a[12:13], v8 offset:25728
    v_cvt_pk_bf16_f32 v73, v74, v75
    v_mfma_f32_16x16x32_bf16 v[84:87], a[28:31], a[140:143], v[84:87]
    s_waitcnt lgkmcnt(7)
    ds_read_b64_tr_b16 a[14:15], v8 offset:63168
    v_cvt_pk_bf16_f32 v74, v76, v77
    v_mfma_f32_16x16x32_bf16 v[88:91], a[32:35], a[128:131], v[88:91]
    ds_read_b64_tr_b16 a[16:17], v5 offset:16384
    v_cvt_pk_bf16_f32 v75, v78, v79
    v_mfma_f32_16x16x32_bf16 v[88:91], a[36:39], a[136:139], v[88:91]
    ds_read_b64_tr_b16 a[18:19], v5 offset:53824
    buffer_store_dwordx4 v[72:75], v18, s[20:23], s82 offen offset:2048 sc1
    v_mfma_f32_16x16x32_bf16 v[92:95], a[32:35], a[132:135], v[92:95]
    ds_read_b64_tr_b16 a[20:21], v9 offset:25728
    v_mfma_f32_16x16x32_bf16 v[92:95], a[36:39], a[140:143], v[92:95]
    ds_read_b64_tr_b16 a[22:23], v9 offset:63168
    buffer_load_dwordx4 a[184:187], v18, s[20:23], s70 offen offset:2048 sc1
    v_mfma_f32_16x16x32_bf16 v[96:99], a[40:43], a[128:131], v[96:99]
    ds_read_b64_tr_b16 a[24:25], v3 offset:22528
    v_mfma_f32_16x16x32_bf16 v[96:99], a[44:47], a[136:139], v[96:99]
    ds_read_b64_tr_b16 a[26:27], v3 offset:59968
    v_mfma_f32_16x16x32_bf16 v[100:103], a[40:43], a[132:135], v[100:103]
    ds_read_b64_tr_b16 a[28:29], v7 offset:31872
    buffer_load_dwordx4 a[188:191], v18, s[20:23], s70 offen offset:3072 sc1
    v_mfma_f32_16x16x32_bf16 v[100:103], a[44:47], a[140:143], v[100:103]
    s_waitcnt lgkmcnt(7)
    ds_read_b64_tr_b16 a[30:31], v11 offset:3776
    v_mfma_f32_16x16x32_bf16 v[104:107], a[0:3], a[80:83], v[104:107]
    s_add_u32 s82, s79, 1333248
    ds_read_b64_tr_b16 a[32:33], v4 offset:22528
    v_cvt_pk_bf16_f32 v80, v80, v81
    v_mfma_f32_16x16x32_bf16 v[104:107], a[4:7], a[88:91], v[104:107]
    ds_read_b64_tr_b16 a[34:35], v4 offset:59968
    v_cvt_pk_bf16_f32 v81, v82, v83
    v_mfma_f32_16x16x32_bf16 v[108:111], a[0:3], a[84:87], v[108:111]
    ds_read_b64_tr_b16 a[36:37], v8 offset:31872
    v_cvt_pk_bf16_f32 v82, v84, v85
    v_mfma_f32_16x16x32_bf16 v[108:111], a[4:7], a[92:95], v[108:111]
    ds_read_b64_tr_b16 a[38:39], v12 offset:3776
    v_cvt_pk_bf16_f32 v83, v86, v87
    v_mfma_f32_16x16x32_bf16 v[112:115], a[8:11], a[80:83], v[112:115]
    ds_read_b64_tr_b16 a[40:41], v5 offset:22528
    buffer_store_dwordx4 v[80:83], v18, s[20:23], s82 offen offset:0 sc1
    v_mfma_f32_16x16x32_bf16 v[112:115], a[12:15], a[88:91], v[112:115]
    ds_read_b64_tr_b16 a[42:43], v5 offset:59968
    v_cvt_pk_bf16_f32 v88, v88, v89
    v_mfma_f32_16x16x32_bf16 v[116:119], a[8:11], a[84:87], v[116:119]
    ds_read_b64_tr_b16 a[44:45], v9 offset:31872
    v_cvt_pk_bf16_f32 v89, v90, v91
    v_mfma_f32_16x16x32_bf16 v[116:119], a[12:15], a[92:95], v[116:119]
    s_waitcnt lgkmcnt(7)
    ds_read_b64_tr_b16 a[46:47], v13 offset:3776
    v_cvt_pk_bf16_f32 v90, v92, v93
    v_mfma_f32_16x16x32_bf16 v[120:123], a[16:19], a[80:83], v[120:123]
    ds_read_b64_tr_b16 a[0:1], v3 offset:28672
    v_cvt_pk_bf16_f32 v91, v94, v95
    v_mfma_f32_16x16x32_bf16 v[120:123], a[20:23], a[88:91], v[120:123]
    ds_read_b64_tr_b16 a[2:3], v7 offset:576
    buffer_store_dwordx4 v[88:91], v18, s[20:23], s82 offen offset:1024 sc1
    v_mfma_f32_16x16x32_bf16 v[124:127], a[16:19], a[84:87], v[124:127]
    ds_read_b64_tr_b16 a[4:5], v7 offset:38016
    v_cvt_pk_bf16_f32 v96, v96, v97
    v_mfma_f32_16x16x32_bf16 v[124:127], a[20:23], a[92:95], v[124:127]
    ds_read_b64_tr_b16 a[6:7], v11 offset:9920
    v_cvt_pk_bf16_f32 v97, v98, v99
    v_mfma_f32_16x16x32_bf16 v[104:107], a[24:27], a[96:99], v[104:107]
    ds_read_b64_tr_b16 a[8:9], v4 offset:28672
    v_cvt_pk_bf16_f32 v98, v100, v101
    v_mfma_f32_16x16x32_bf16 v[104:107], a[28:31], a[104:107], v[104:107]
    ds_read_b64_tr_b16 a[10:11], v8 offset:576
    v_cvt_pk_bf16_f32 v99, v102, v103
    v_mfma_f32_16x16x32_bf16 v[108:111], a[24:27], a[100:103], v[108:111]
    ds_read_b64_tr_b16 a[12:13], v8 offset:38016
    buffer_store_dwordx4 v[96:99], v18, s[20:23], s82 offen offset:2048 sc1
    v_mfma_f32_16x16x32_bf16 v[108:111], a[28:31], a[108:111], v[108:111]
    s_waitcnt lgkmcnt(7)
    ds_read_b64_tr_b16 a[14:15], v12 offset:9920
    v_mfma_f32_16x16x32_bf16 v[112:115], a[32:35], a[96:99], v[112:115]
    s_add_u32 s70, s78, 12288
    ds_read_b64_tr_b16 a[16:17], v5 offset:28672
    buffer_load_dwordx4 a[192:195], v18, s[20:23], s70 offen offset:0 sc1
    v_mfma_f32_16x16x32_bf16 v[112:115], a[36:39], a[104:107], v[112:115]
    ds_read_b64_tr_b16 a[18:19], v9 offset:576
    buffer_load_dwordx4 a[196:199], v18, s[20:23], s70 offen offset:1024 sc1
    v_mfma_f32_16x16x32_bf16 v[116:119], a[32:35], a[100:103], v[116:119]
    ds_read_b64_tr_b16 a[20:21], v9 offset:38016
    buffer_load_dwordx4 a[200:203], v18, s[20:23], s70 offen offset:2048 sc1
    v_mfma_f32_16x16x32_bf16 v[116:119], a[36:39], a[108:111], v[116:119]
    ds_read_b64_tr_b16 a[22:23], v13 offset:9920
    v_mfma_f32_16x16x32_bf16 v[120:123], a[40:43], a[96:99], v[120:123]
    ds_read_b64_tr_b16 a[24:25], v3 offset:34816
    buffer_load_dwordx4 a[204:207], v18, s[20:23], s70 offen offset:3072 sc1
    v_mfma_f32_16x16x32_bf16 v[120:123], a[44:47], a[104:107], v[120:123]
    ds_read_b64_tr_b16 a[26:27], v7 offset:6720
    v_mfma_f32_16x16x32_bf16 v[124:127], a[40:43], a[100:103], v[124:127]
    ds_read_b64_tr_b16 a[28:29], v7 offset:44160
    v_mfma_f32_16x16x32_bf16 v[124:127], a[44:47], a[108:111], v[124:127]
    s_waitcnt lgkmcnt(7)
    ds_read_b64_tr_b16 a[30:31], v11 offset:16064
    v_mfma_f32_16x16x32_bf16 v[104:107], a[0:3], a[112:115], v[104:107]
    s_add_u32 s70, s78, 16384
    ds_read_b64_tr_b16 a[32:33], v4 offset:34816
    buffer_load_dwordx4 a[208:211], v18, s[20:23], s70 offen offset:0 sc1
    v_mfma_f32_16x16x32_bf16 v[104:107], a[4:7], a[120:123], v[104:107]
    ds_read_b64_tr_b16 a[34:35], v8 offset:6720
    v_mfma_f32_16x16x32_bf16 v[108:111], a[0:3], a[116:119], v[108:111]
    ds_read_b64_tr_b16 a[36:37], v8 offset:44160
    v_mfma_f32_16x16x32_bf16 v[108:111], a[4:7], a[124:127], v[108:111]
    ds_read_b64_tr_b16 a[38:39], v12 offset:16064
    buffer_load_dwordx4 a[212:215], v18, s[20:23], s70 offen offset:1024 sc1
    v_mfma_f32_16x16x32_bf16 v[112:115], a[8:11], a[112:115], v[112:115]
    ds_read_b64_tr_b16 a[40:41], v5 offset:34816
    v_mfma_f32_16x16x32_bf16 v[112:115], a[12:15], a[120:123], v[112:115]
    ds_read_b64_tr_b16 a[42:43], v9 offset:6720
    v_mfma_f32_16x16x32_bf16 v[116:119], a[8:11], a[116:119], v[116:119]
    ds_read_b64_tr_b16 a[44:45], v9 offset:44160
    buffer_load_dwordx4 a[216:219], v18, s[20:23], s70 offen offset:2048 sc1
    v_mfma_f32_16x16x32_bf16 v[116:119], a[12:15], a[124:127], v[116:119]
    s_waitcnt vmcnt(30) lgkmcnt(7)
    ds_read_b64_tr_b16 a[46:47], v13 offset:16064
    v_mfma_f32_16x16x32_bf16 v[120:123], a[16:19], a[112:115], v[120:123]
    s_barrier
    ds_read_b64_tr_b16 a[0:1], v29 offset:0
    v_mfma_f32_16x16x32_bf16 v[120:123], a[20:23], a[120:123], v[120:123]
    ds_read_b64_tr_b16 a[2:3], v29 offset:1536
    buffer_load_dwordx4 a[220:223], v18, s[20:23], s70 offen offset:3072 sc1
    v_mfma_f32_16x16x32_bf16 v[124:127], a[16:19], a[116:119], v[124:127]
    ds_read_b64_tr_b16 a[4:5], v29 offset:3072
    v_mfma_f32_16x16x32_bf16 v[124:127], a[20:23], a[124:127], v[124:127]
    ds_read_b64_tr_b16 a[6:7], v29 offset:4608
    v_mfma_f32_16x16x32_bf16 v[104:107], a[24:27], a[128:131], v[104:107]
    s_add_u32 s70, s78, 20480
    ds_read_b64_tr_b16 a[8:9], v29 offset:6144
    buffer_load_dwordx4 a[224:227], v18, s[20:23], s70 offen offset:0 sc1
    v_mfma_f32_16x16x32_bf16 v[104:107], a[28:31], a[136:139], v[104:107]
    ds_read_b64_tr_b16 a[10:11], v29 offset:7680
    v_mfma_f32_16x16x32_bf16 v[108:111], a[24:27], a[132:135], v[108:111]
    ds_read_b64_tr_b16 a[12:13], v29 offset:9216
    v_mfma_f32_16x16x32_bf16 v[108:111], a[28:31], a[140:143], v[108:111]
    s_waitcnt lgkmcnt(7)
    ds_read_b64_tr_b16 a[14:15], v29 offset:10752
    v_mfma_f32_16x16x32_bf16 v[112:115], a[32:35], a[128:131], v[112:115]
    ds_read_b64_tr_b16 a[16:17], v29 offset:37440
    buffer_load_dwordx4 a[228:231], v18, s[20:23], s70 offen offset:1024 sc1
    v_mfma_f32_16x16x32_bf16 v[112:115], a[36:39], a[136:139], v[112:115]
    ds_read_b64_tr_b16 a[18:19], v29 offset:38976
    v_mfma_f32_16x16x32_bf16 v[116:119], a[32:35], a[132:135], v[116:119]
    ds_read_b64_tr_b16 a[20:21], v29 offset:40512
    v_mfma_f32_16x16x32_bf16 v[116:119], a[36:39], a[140:143], v[116:119]
    ds_read_b64_tr_b16 a[22:23], v29 offset:42048
    buffer_load_dwordx4 a[232:235], v18, s[20:23], s70 offen offset:2048 sc1
    v_mfma_f32_16x16x32_bf16 v[120:123], a[40:43], a[128:131], v[120:123]
    ds_read_b64_tr_b16 a[24:25], v29 offset:32
    v_mfma_f32_16x16x32_bf16 v[120:123], a[44:47], a[136:139], v[120:123]
    ds_read_b64_tr_b16 a[26:27], v29 offset:1568
    v_mfma_f32_16x16x32_bf16 v[124:127], a[40:43], a[132:135], v[124:127]
    ds_read_b64_tr_b16 a[28:29], v29 offset:3104
    buffer_load_dwordx4 a[236:239], v18, s[20:23], s70 offen offset:3072 sc1
    v_mfma_f32_16x16x32_bf16 v[124:127], a[44:47], a[140:143], v[124:127]
    s_waitcnt lgkmcnt(7)
    ds_read_b64_tr_b16 a[30:31], v29 offset:4640
    s_waitcnt vmcnt(31)
    v_mfma_f32_16x16x32_bf16 v[104:107], a[0:3], a[144:147], v[104:107]
    ds_read_b64_tr_b16 a[32:33], v29 offset:6176
    s_waitcnt vmcnt(28)
    v_mfma_f32_16x16x32_bf16 v[104:107], a[4:7], a[152:155], v[104:107]
    ds_read_b64_tr_b16 a[34:35], v29 offset:7712
    s_waitcnt vmcnt(12)
    s_add_u32 s71, s66, 1
    v_mov_b32 v22, s71
    buffer_store_dword v22, off, s[20:23], s93 sc1
    v_mfma_f32_16x16x32_bf16 v[108:111], a[0:3], a[148:151], v[108:111]
    ds_read_b64_tr_b16 a[36:37], v29 offset:9248
    v_mfma_f32_16x16x32_bf16 v[108:111], a[4:7], a[156:159], v[108:111]
    ds_read_b64_tr_b16 a[38:39], v29 offset:10784
    v_mfma_f32_16x16x32_bf16 v[104:107], a[8:11], a[160:163], v[104:107]
    s_add_u32 s70, s78, 24576
    ds_read_b64_tr_b16 a[40:41], v29 offset:37472
    buffer_load_dwordx4 v[202:205], v18, s[20:23], s70 offen offset:0 sc1
    v_mfma_f32_16x16x32_bf16 v[104:107], a[12:15], a[168:171], v[104:107]
    ds_read_b64_tr_b16 a[42:43], v29 offset:39008
    v_mfma_f32_16x16x32_bf16 v[108:111], a[8:11], a[164:167], v[108:111]
    ds_read_b64_tr_b16 a[44:45], v29 offset:40544
    buffer_load_dwordx4 v[206:209], v18, s[20:23], s70 offen offset:1024 sc1
    v_mfma_f32_16x16x32_bf16 v[108:111], a[12:15], a[172:175], v[108:111]
    s_waitcnt lgkmcnt(7)
    ds_read_b64_tr_b16 a[46:47], v29 offset:42080
    v_mfma_f32_16x16x32_bf16 v[104:107], a[16:19], a[176:179], v[104:107]
    ds_read_b64_tr_b16 a[0:1], v29 offset:64
    v_mfma_f32_16x16x32_bf16 v[104:107], a[20:23], a[184:187], v[104:107]
    ds_read_b64_tr_b16 a[2:3], v29 offset:1600
    buffer_load_dwordx2 v[210:211], v251, s[20:23], s70 offen offset:2048 sc1
    buffer_load_dwordx2 v[212:213], v251, s[20:23], s70 offen offset:2560 sc1
    v_mfma_f32_16x16x32_bf16 v[108:111], a[16:19], a[180:183], v[108:111]
    ds_read_b64_tr_b16 a[4:5], v29 offset:3136
    v_mfma_f32_16x16x32_bf16 v[108:111], a[20:23], a[188:191], v[108:111]
    ds_read_b64_tr_b16 a[6:7], v29 offset:4672
    v_mfma_f32_16x16x32_bf16 v[112:115], a[24:27], a[144:147], v[112:115]
    ds_read_b64_tr_b16 a[8:9], v29 offset:6208
    buffer_load_dwordx2 v[214:215], v251, s[20:23], s70 offen offset:3072 sc1
    buffer_load_dwordx2 v[216:217], v251, s[20:23], s70 offen offset:3584 sc1
    v_mfma_f32_16x16x32_bf16 v[112:115], a[28:31], a[152:155], v[112:115]
    ds_read_b64_tr_b16 a[10:11], v29 offset:7744
    v_mfma_f32_16x16x32_bf16 v[116:119], a[24:27], a[148:151], v[116:119]
    ds_read_b64_tr_b16 a[12:13], v29 offset:9280
    v_mfma_f32_16x16x32_bf16 v[116:119], a[28:31], a[156:159], v[116:119]
    s_waitcnt lgkmcnt(7)
    ds_read_b64_tr_b16 a[14:15], v29 offset:10816
    v_mfma_f32_16x16x32_bf16 v[112:115], a[32:35], a[160:163], v[112:115]
    s_add_u32 s70, s78, 28672
    ds_read_b64_tr_b16 a[16:17], v29 offset:37504
    buffer_load_dwordx4 v[218:221], v18, s[20:23], s70 offen offset:0 sc1
    v_mfma_f32_16x16x32_bf16 v[112:115], a[36:39], a[168:171], v[112:115]
    ds_read_b64_tr_b16 a[18:19], v29 offset:39040
    v_mfma_f32_16x16x32_bf16 v[116:119], a[32:35], a[164:167], v[116:119]
    ds_read_b64_tr_b16 a[20:21], v29 offset:40576
    buffer_load_dwordx4 v[222:225], v18, s[20:23], s70 offen offset:1024 sc1
    v_mfma_f32_16x16x32_bf16 v[116:119], a[36:39], a[172:175], v[116:119]
    ds_read_b64_tr_b16 a[22:23], v29 offset:42112
    v_mfma_f32_16x16x32_bf16 v[112:115], a[40:43], a[176:179], v[112:115]
    ds_read_b64_tr_b16 a[24:25], v29 offset:43584
    buffer_load_dwordx4 v[226:229], v18, s[20:23], s70 offen offset:2048 sc1
    v_mfma_f32_16x16x32_bf16 v[112:115], a[44:47], a[184:187], v[112:115]
    ds_read_b64_tr_b16 a[26:27], v29 offset:45120
    v_mfma_f32_16x16x32_bf16 v[116:119], a[40:43], a[180:183], v[116:119]
    ds_read_b64_tr_b16 a[28:29], v29 offset:46656
    v_mfma_f32_16x16x32_bf16 v[116:119], a[44:47], a[188:191], v[116:119]
    s_waitcnt lgkmcnt(7)
    ds_read_b64_tr_b16 a[30:31], v29 offset:48192
    buffer_load_dwordx4 v[230:233], v18, s[20:23], s70 offen offset:3072 sc1
    v_mfma_f32_16x16x32_bf16 v[120:123], a[0:3], a[144:147], v[120:123]
    ds_read_b64_tr_b16 a[32:33], v30 offset:9344
    v_mfma_f32_16x16x32_bf16 v[120:123], a[4:7], a[152:155], v[120:123]
    ds_read_b64_tr_b16 a[34:35], v30 offset:10880
    v_mfma_f32_16x16x32_bf16 v[124:127], a[0:3], a[148:151], v[124:127]
    s_add_u32 s70, s78, 32768
    ds_read_b64_tr_b16 a[36:37], v30 offset:12416
    buffer_load_dwordx4 v[234:237], v18, s[20:23], s70 offen offset:0 sc1
    v_mfma_f32_16x16x32_bf16 v[124:127], a[4:7], a[156:159], v[124:127]
    ds_read_b64_tr_b16 a[38:39], v30 offset:13952
    v_mfma_f32_16x16x32_bf16 v[120:123], a[8:11], a[160:163], v[120:123]
    ds_read_b64_tr_b16 a[40:41], v30 offset:15488
    v_mfma_f32_16x16x32_bf16 v[120:123], a[12:15], a[168:171], v[120:123]
    ds_read_b64_tr_b16 a[42:43], v30 offset:17024
    buffer_load_dwordx4 v[238:241], v18, s[20:23], s70 offen offset:1024 sc1
    v_mfma_f32_16x16x32_bf16 v[124:127], a[8:11], a[164:167], v[124:127]
    ds_read_b64_tr_b16 a[44:45], v30 offset:18560
    v_mfma_f32_16x16x32_bf16 v[124:127], a[12:15], a[172:175], v[124:127]
    s_waitcnt lgkmcnt(7)
    ds_read_b64_tr_b16 a[46:47], v30 offset:20096
    buffer_load_dwordx4 v[242:245], v18, s[20:23], s70 offen offset:2048 sc1
    v_mfma_f32_16x16x32_bf16 v[120:123], a[16:19], a[176:179], v[120:123]
    ds_read_b64_tr_b16 a[0:1], v29 offset:43616
    v_mfma_f32_16x16x32_bf16 v[120:123], a[20:23], a[184:187], v[120:123]
    ds_read_b64_tr_b16 a[2:3], v29 offset:45152
    v_mfma_f32_16x16x32_bf16 v[124:127], a[16:19], a[180:183], v[124:127]
    ds_read_b64_tr_b16 a[4:5], v29 offset:46688
    buffer_load_dwordx4 v[246:249], v18, s[20:23], s70 offen offset:3072 sc1
    v_mfma_f32_16x16x32_bf16 v[124:127], a[20:23], a[188:191], v[124:127]
    ds_read_b64_tr_b16 a[6:7], v29 offset:48224
    s_waitcnt vmcnt(26)
    v_mfma_f32_16x16x32_bf16 v[104:107], a[24:27], a[192:195], v[104:107]
    ds_read_b64_tr_b16 a[8:9], v30 offset:9376
    s_waitcnt vmcnt(24)
    v_mfma_f32_16x16x32_bf16 v[104:107], a[28:31], a[200:203], v[104:107]
    ds_read_b64_tr_b16 a[10:11], v30 offset:10912
    v_mfma_f32_16x16x32_bf16 v[108:111], a[24:27], a[196:199], v[108:111]
    ds_read_b64_tr_b16 a[12:13], v30 offset:12448
    s_waitcnt vmcnt(23)
    v_mfma_f32_16x16x32_bf16 v[108:111], a[28:31], a[204:207], v[108:111]
    s_waitcnt lgkmcnt(7)
    ds_read_b64_tr_b16 a[14:15], v30 offset:13984
    s_waitcnt vmcnt(22)
    v_mfma_f32_16x16x32_bf16 v[104:107], a[32:35], a[208:211], v[104:107]
    ds_read_b64_tr_b16 a[16:17], v30 offset:15520
    s_waitcnt vmcnt(20)
    v_mfma_f32_16x16x32_bf16 v[104:107], a[36:39], a[216:219], v[104:107]
    ds_read_b64_tr_b16 a[18:19], v30 offset:17056
    v_mfma_f32_16x16x32_bf16 v[108:111], a[32:35], a[212:215], v[108:111]
    ds_read_b64_tr_b16 a[20:21], v30 offset:18592
    s_waitcnt vmcnt(19)
    v_mfma_f32_16x16x32_bf16 v[108:111], a[36:39], a[220:223], v[108:111]
    ds_read_b64_tr_b16 a[22:23], v30 offset:20128
    s_waitcnt vmcnt(18)
    v_mfma_f32_16x16x32_bf16 v[104:107], a[40:43], a[224:227], v[104:107]
    ds_read_b64_tr_b16 a[24:25], v29 offset:43648
    s_waitcnt vmcnt(16)
    v_mfma_f32_16x16x32_bf16 v[104:107], a[44:47], a[232:235], v[104:107]
    ds_read_b64_tr_b16 a[26:27], v29 offset:45184
    v_mfma_f32_16x16x32_bf16 v[108:111], a[40:43], a[228:231], v[108:111]
    ds_read_b64_tr_b16 a[28:29], v29 offset:46720
    s_waitcnt vmcnt(15)
    v_mfma_f32_16x16x32_bf16 v[108:111], a[44:47], a[236:239], v[108:111]
    s_waitcnt lgkmcnt(7)
    ds_read_b64_tr_b16 a[30:31], v29 offset:48256
    v_mfma_f32_16x16x32_bf16 v[112:115], a[0:3], a[192:195], v[112:115]
    ds_read_b64_tr_b16 a[32:33], v30 offset:9408
    v_mfma_f32_16x16x32_bf16 v[112:115], a[4:7], a[200:203], v[112:115]
    ds_read_b64_tr_b16 a[34:35], v30 offset:10944
    v_mfma_f32_16x16x32_bf16 v[116:119], a[0:3], a[196:199], v[116:119]
    ds_read_b64_tr_b16 a[36:37], v30 offset:12480
    v_mfma_f32_16x16x32_bf16 v[116:119], a[4:7], a[204:207], v[116:119]
    ds_read_b64_tr_b16 a[38:39], v30 offset:14016
    v_mfma_f32_16x16x32_bf16 v[112:115], a[8:11], a[208:211], v[112:115]
    ds_read_b64_tr_b16 a[40:41], v30 offset:15552
    v_mfma_f32_16x16x32_bf16 v[112:115], a[12:15], a[216:219], v[112:115]
    ds_read_b64_tr_b16 a[42:43], v30 offset:17088
    v_mfma_f32_16x16x32_bf16 v[116:119], a[8:11], a[212:215], v[116:119]
    ds_read_b64_tr_b16 a[44:45], v30 offset:18624
    buffer_load_dword v21, v25, s[20:23], 0 offen sc1
    v_mfma_f32_16x16x32_bf16 v[116:119], a[12:15], a[220:223], v[116:119]
    s_waitcnt lgkmcnt(7)
    ds_read_b64_tr_b16 a[46:47], v30 offset:20160
    v_mfma_f32_16x16x32_bf16 v[112:115], a[16:19], a[224:227], v[112:115]
    ds_read_b64_tr_b16 a[0:1], v30 offset:46784
    v_mfma_f32_16x16x32_bf16 v[112:115], a[20:23], a[232:235], v[112:115]
    ds_read_b64_tr_b16 a[2:3], v30 offset:48320
    v_mfma_f32_16x16x32_bf16 v[116:119], a[16:19], a[228:231], v[116:119]
    ds_read_b64_tr_b16 a[4:5], v30 offset:49856
    v_mfma_f32_16x16x32_bf16 v[116:119], a[20:23], a[236:239], v[116:119]
    ds_read_b64_tr_b16 a[6:7], v30 offset:51392
    v_mfma_f32_16x16x32_bf16 v[120:123], a[24:27], a[192:195], v[120:123]
    ds_read_b64_tr_b16 a[8:9], v30 offset:52928
    v_mfma_f32_16x16x32_bf16 v[120:123], a[28:31], a[200:203], v[120:123]
    ds_read_b64_tr_b16 a[10:11], v30 offset:54464
    v_mfma_f32_16x16x32_bf16 v[124:127], a[24:27], a[196:199], v[124:127]
    ds_read_b64_tr_b16 a[12:13], v30 offset:56000
    v_mfma_f32_16x16x32_bf16 v[124:127], a[28:31], a[204:207], v[124:127]
    s_waitcnt lgkmcnt(7)
    ds_read_b64_tr_b16 a[14:15], v30 offset:57536
    v_mfma_f32_16x16x32_bf16 v[120:123], a[32:35], a[208:211], v[120:123]
    ds_read_b64_tr_b16 a[16:17], v31 offset:18688
    v_mfma_f32_16x16x32_bf16 v[120:123], a[36:39], a[216:219], v[120:123]
    ds_read_b64_tr_b16 a[18:19], v31 offset:20224
    v_mfma_f32_16x16x32_bf16 v[124:127], a[32:35], a[212:215], v[124:127]
    ds_read_b64_tr_b16 a[20:21], v31 offset:21760
    v_mfma_f32_16x16x32_bf16 v[124:127], a[36:39], a[220:223], v[124:127]
    ds_read_b64_tr_b16 a[22:23], v31 offset:23296
    v_mfma_f32_16x16x32_bf16 v[120:123], a[40:43], a[224:227], v[120:123]
    ds_read_b64_tr_b16 a[24:25], v30 offset:46816
    v_mfma_f32_16x16x32_bf16 v[120:123], a[44:47], a[232:235], v[120:123]
    ds_read_b64_tr_b16 a[26:27], v30 offset:48352
    v_mfma_f32_16x16x32_bf16 v[124:127], a[40:43], a[228:231], v[124:127]
    ds_read_b64_tr_b16 a[28:29], v30 offset:49888
    v_mfma_f32_16x16x32_bf16 v[124:127], a[44:47], a[236:239], v[124:127]
    s_waitcnt lgkmcnt(7)
    ds_read_b64_tr_b16 a[30:31], v30 offset:51424
    s_waitcnt vmcnt(14)
    v_mfma_f32_16x16x32_bf16 v[104:107], a[0:3], v[202:205], v[104:107]
    ds_read_b64_tr_b16 a[32:33], v30 offset:52960
    s_add_u32 s71, s66, 1
    s_waitcnt vmcnt(0)
    v_subrev_u32 v21, s71, v21
    v_cmp_gt_u32 vcc, 8, v21
    s_nop 0
    s_cmp_eq_u64 vcc, exec
    s_cbranch_scc0 L_slow_36
L_back_37:
    v_mfma_f32_16x16x32_bf16 v[104:107], a[4:7], v[210:213], v[104:107]
    s_add_u32 s72, s79, 884736
    ds_read_b64_tr_b16 a[34:35], v30 offset:54496
    buffer_load_dwordx4 v[166:169], v18, s[20:23], s72 offen offset:0 sc1
    v_mfma_f32_16x16x32_bf16 v[108:111], a[0:3], v[206:209], v[108:111]
    ds_read_b64_tr_b16 a[36:37], v30 offset:56032
    v_mfma_f32_16x16x32_bf16 v[108:111], a[4:7], v[214:217], v[108:111]
    ds_read_b64_tr_b16 a[38:39], v30 offset:57568
    buffer_load_dwordx4 v[170:173], v18, s[20:23], s72 offen offset:1024 sc1
    v_mfma_f32_16x16x32_bf16 v[104:107], a[8:11], v[218:221], v[104:107]
    ds_read_b64_tr_b16 a[40:41], v31 offset:18720
    v_mfma_f32_16x16x32_bf16 v[104:107], a[12:15], v[226:229], v[104:107]
    ds_read_b64_tr_b16 a[42:43], v31 offset:20256
    buffer_load_dwordx4 v[174:177], v18, s[20:23], s72 offen offset:2048 sc1
    v_mfma_f32_16x16x32_bf16 v[108:111], a[8:11], v[222:225], v[108:111]
    ds_read_b64_tr_b16 a[44:45], v31 offset:21792
    v_mfma_f32_16x16x32_bf16 v[108:111], a[12:15], v[230:233], v[108:111]
    s_waitcnt lgkmcnt(7)
    ds_read_b64_tr_b16 a[46:47], v31 offset:23328
    v_mfma_f32_16x16x32_bf16 v[104:107], a[16:19], v[234:237], v[104:107]
    s_add_u32 s72, s79, 445440
    ds_read_b64_tr_b16 a[0:1], v30 offset:46848
    buffer_load_dwordx4 v[178:181], v18, s[20:23], s72 offen offset:0 sc1
    v_mfma_f32_16x16x32_bf16 v[104:107], a[20:23], v[242:245], v[104:107]
    ds_read_b64_tr_b16 a[2:3], v30 offset:48384
    v_mfma_f32_16x16x32_bf16 v[108:111], a[16:19], v[238:241], v[108:111]
    ds_read_b64_tr_b16 a[4:5], v30 offset:49920
    buffer_load_dwordx4 v[182:185], v18, s[20:23], s72 offen offset:1024 sc1
    v_mfma_f32_16x16x32_bf16 v[108:111], a[20:23], v[246:249], v[108:111]
    ds_read_b64_tr_b16 a[6:7], v30 offset:51456
    v_mfma_f32_16x16x32_bf16 v[112:115], a[24:27], v[202:205], v[112:115]
    ds_read_b64_tr_b16 a[8:9], v30 offset:52992
    buffer_load_dwordx4 v[186:189], v18, s[20:23], s72 offen offset:2048 sc1
    v_mfma_f32_16x16x32_bf16 v[112:115], a[28:31], v[210:213], v[112:115]
    ds_read_b64_tr_b16 a[10:11], v30 offset:54528
    v_mfma_f32_16x16x32_bf16 v[116:119], a[24:27], v[206:209], v[116:119]
    ds_read_b64_tr_b16 a[12:13], v30 offset:56064
    v_mfma_f32_16x16x32_bf16 v[116:119], a[28:31], v[214:217], v[116:119]
    s_waitcnt lgkmcnt(7)
    ds_read_b64_tr_b16 a[14:15], v30 offset:57600
    v_mfma_f32_16x16x32_bf16 v[112:115], a[32:35], v[218:221], v[112:115]
    s_add_u32 s72, s79, 6144
    ds_read_b64_tr_b16 a[16:17], v31 offset:18752
    buffer_load_dwordx4 v[190:193], v18, s[20:23], s72 offen offset:0 sc1
    v_mfma_f32_16x16x32_bf16 v[112:115], a[36:39], v[226:229], v[112:115]
    ds_read_b64_tr_b16 a[18:19], v31 offset:20288
    buffer_load_dwordx4 v[194:197], v18, s[20:23], s72 offen offset:1024 sc1
    v_mfma_f32_16x16x32_bf16 v[116:119], a[32:35], v[222:225], v[116:119]
    ds_read_b64_tr_b16 a[20:21], v31 offset:21824
    v_mfma_f32_16x16x32_bf16 v[116:119], a[36:39], v[230:233], v[116:119]
    ds_read_b64_tr_b16 a[22:23], v31 offset:23360
    buffer_load_dwordx4 v[198:201], v18, s[20:23], s72 offen offset:2048 sc1
    v_mfma_f32_16x16x32_bf16 v[112:115], a[40:43], v[234:237], v[112:115]
    v_mfma_f32_16x16x32_bf16 v[112:115], a[44:47], v[242:245], v[112:115]
    v_mfma_f32_16x16x32_bf16 v[116:119], a[40:43], v[238:241], v[116:119]
    v_mfma_f32_16x16x32_bf16 v[116:119], a[44:47], v[246:249], v[116:119]
    s_waitcnt lgkmcnt(4)
    v_mfma_f32_16x16x32_bf16 v[120:123], a[0:3], v[202:205], v[120:123]
    v_mfma_f32_16x16x32_bf16 v[120:123], a[4:7], v[210:213], v[120:123]
    v_mfma_f32_16x16x32_bf16 v[124:127], a[0:3], v[206:209], v[124:127]
    v_mfma_f32_16x16x32_bf16 v[124:127], a[4:7], v[214:217], v[124:127]
    v_mfma_f32_16x16x32_bf16 v[120:123], a[8:11], v[218:221], v[120:123]
    v_mfma_f32_16x16x32_bf16 v[120:123], a[12:15], v[226:229], v[120:123]
    v_mfma_f32_16x16x32_bf16 v[124:127], a[8:11], v[222:225], v[124:127]
    v_mfma_f32_16x16x32_bf16 v[124:127], a[12:15], v[230:233], v[124:127]
    s_waitcnt lgkmcnt(0)
    v_mfma_f32_16x16x32_bf16 v[120:123], a[16:19], v[234:237], v[120:123]
    v_mfma_f32_16x16x32_bf16 v[120:123], a[20:23], v[242:245], v[120:123]
    v_mfma_f32_16x16x32_bf16 v[124:127], a[16:19], v[238:241], v[124:127]
    v_mfma_f32_16x16x32_bf16 v[124:127], a[20:23], v[246:249], v[124:127]
    v_add_f32 v142, v142, v104
    v_add_f32 v143, v143, v105
    v_add_f32 v144, v144, v106
    v_add_f32 v145, v145, v107
    v_add_f32 v146, v146, v108
    v_add_f32 v147, v147, v109
    v_add_f32 v148, v148, v110
    v_add_f32 v149, v149, v111
    v_add_f32 v150, v150, v112
    v_add_f32 v151, v151, v113
    v_add_f32 v152, v152, v114
    v_add_f32 v153, v153, v115
    v_add_f32 v154, v154, v116
    v_add_f32 v155, v155, v117
    v_add_f32 v156, v156, v118
    v_add_f32 v157, v157, v119
    v_add_f32 v158, v158, v120
    v_add_f32 v159, v159, v121
    v_add_f32 v160, v160, v122
    v_add_f32 v161, v161, v123
    v_add_f32 v162, v162, v124
    v_add_f32 v163, v163, v125
    v_add_f32 v164, v164, v126
    v_add_f32 v165, v165, v127
    s_waitcnt vmcnt(8)
    v_mfma_f32_16x16x32_bf16 v[142:145], v[138:141], v[166:169], v[142:145]
    v_mfma_f32_16x16x32_bf16 v[146:149], v[136:139], v[166:169], v[146:149]
    s_waitcnt vmcnt(7)
    v_mfma_f32_16x16x32_bf16 v[150:153], v[138:141], v[170:173], v[150:153]
    v_mfma_f32_16x16x32_bf16 v[154:157], v[136:139], v[170:173], v[154:157]
    s_waitcnt vmcnt(6)
    v_mfma_f32_16x16x32_bf16 v[158:161], v[138:141], v[174:177], v[158:161]
    v_mfma_f32_16x16x32_bf16 v[162:165], v[136:139], v[174:177], v[162:165]
    s_waitcnt vmcnt(5)
    v_mfma_f32_16x16x32_bf16 v[142:145], v[138:141], v[178:181], v[142:145]
    v_mfma_f32_16x16x32_bf16 v[146:149], v[136:139], v[178:181], v[146:149]
    s_waitcnt vmcnt(4)
    v_mfma_f32_16x16x32_bf16 v[150:153], v[138:141], v[182:185], v[150:153]
    v_mfma_f32_16x16x32_bf16 v[154:157], v[136:139], v[182:185], v[154:157]
    s_waitcnt vmcnt(3)
    v_mfma_f32_16x16x32_bf16 v[158:161], v[138:141], v[186:189], v[158:161]
    v_mfma_f32_16x16x32_bf16 v[162:165], v[136:139], v[186:189], v[162:165]
    s_waitcnt vmcnt(2)
    v_mfma_f32_16x16x32_bf16 v[142:145], v[138:141], v[190:193], v[142:145]
    v_mfma_f32_16x16x32_bf16 v[146:149], v[136:139], v[190:193], v[146:149]
L_pad_v3_2:
    s_cbranch_execz L_walk_ret
    s_waitcnt vmcnt(1)
    v_mfma_f32_16x16x32_bf16 v[150:153], v[138:141], v[194:197], v[150:153]
    v_mfma_f32_16x16x32_bf16 v[154:157], v[136:139], v[194:197], v[154:157]
    s_waitcnt vmcnt(0)
    v_mfma_f32_16x16x32_bf16 v[158:161], v[138:141], v[198:201], v[158:161]
    v_mfma_f32_16x16x32_bf16 v[162:165], v[136:139], v[198:201], v[162:165]
    s_nop 0
    v_cvt_pk_bf16_f32 v142, v142, v143
    v_cvt_pk_bf16_f32 v143, v144, v145
    buffer_store_dwordx2 v[142:143], v23, s[24:27], s89 offen offset:0 sc1
    v_cvt_pk_bf16_f32 v146, v146, v147
    v_cvt_pk_bf16_f32 v147, v148, v149
    buffer_store_dwordx2 v[146:147], v23, s[24:27], s91 offen offset:0 sc1
    v_cvt_pk_bf16_f32 v150, v150, v151
    v_cvt_pk_bf16_f32 v151, v152, v153
    buffer_store_dwordx2 v[150:151], v23, s[24:27], s89 offen offset:32 sc1
    v_cvt_pk_bf16_f32 v154, v154, v155
    v_cvt_pk_bf16_f32 v155, v156, v157
    buffer_store_dwordx2 v[154:155], v23, s[24:27], s91 offen offset:32 sc1
    v_cvt_pk_bf16_f32 v158, v158, v159
    v_cvt_pk_bf16_f32 v159, v160, v161
    buffer_store_dwordx2 v[158:159], v23, s[24:27], s89 offen offset:64 sc1
    v_cvt_pk_bf16_f32 v162, v162, v163
    v_cvt_pk_bf16_f32 v163, v164, v165
    buffer_store_dwordx2 v[162:163], v23, s[24:27], s91 offen offset:64 sc1
    s_endpgm
L_slow_1:
    s_mov_b32 s80, 40000
L_spin_3:
    buffer_load_dword v21, v20, s[20:23], 0 offen sc1
    s_waitcnt vmcnt(0)
    s_add_u32 s71, s66, 1
    v_subrev_u32 v21, s71, v21
    v_cmp_gt_u32 vcc, 8, v21
    s_nop 1
    s_cmp_eq_u64 vcc, exec
    s_cbranch_scc1 L_back_2
    s_sub_u32 s80, s80, 1
    s_cmp_lg_u32 s80, 0
    s_cbranch_scc1 L_spin_3
    s_branch L_back_2
L_slow_4:
    s_mov_b32 s80, 40000
L_spin_6:
    buffer_load_dword v21, v20, s[20:23], 0 offen sc1
    s_waitcnt vmcnt(0)
    s_add_u32 s71, s66, 2
    v_subrev_u32 v21, s71, v21
    v_cmp_gt_u32 vcc, 8, v21
    s_nop 1
    s_cmp_eq_u64 vcc, exec
    s_cbranch_scc1 L_back_5
    s_sub_u32 s80, s80, 1
    s_cmp_lg_u32 s80, 0
    s_cbranch_scc1 L_spin_6
    s_branch L_back_5
L_slow_7:
    s_mov_b32 s80, 40000
L_spin_9:
    buffer_load_dword v21, v20, s[20:23], 0 offen sc1
    s_waitcnt vmcnt(0)
    s_add_u32 s71, s66, 3
    v_subrev_u32 v21, s71, v21
    v_cmp_gt_u32 vcc, 8, v21
    s_nop 1
    s_cmp_eq_u64 vcc, exec
    s_cbranch_scc1 L_back_8
    s_sub_u32 s80, s80, 1
    s_cmp_lg_u32 s80, 0
    s_cbranch_scc1 L_spin_9
    s_branch L_back_8
L_slow_14:
    s_mov_b32 s80, 40000
L_spin_16:
    buffer_load_dword v21, v250, s[20:23], 0 offen sc1
    s_waitcnt vmcnt(0)
    s_add_u32 s71, s66, 1
    v_subrev_u32 v21, s71, v21
    v_cmp_gt_u32 vcc, 8, v21
    s_nop 1
    s_cmp_eq_u64 vcc, exec
    s_cbranch_scc1 L_back_15
    s_sub_u32 s80, s80, 1
    s_cmp_lg_u32 s80, 0
    s_cbranch_scc1 L_spin_16
    s_branch L_back_15
L_slow_17:
    s_mov_b32 s80, 40000
L_spin_19:
    buffer_load_dword v21, v25, s[20:23], 0 offen sc1
    s_waitcnt vmcnt(0)
    s_add_u32 s71, s66, 1
    v_subrev_u32 v21, s71, v21
    v_cmp_gt_u32 vcc, 8, v21
    s_nop 1
    s_cmp_eq_u64 vcc, exec
    s_cbranch_scc1 L_back_18
    s_sub_u32 s80, s80, 1
    s_cmp_lg_u32 s80, 0
    s_cbranch_scc1 L_spin_19
    s_branch L_back_18
L_slow_21:
    s_mov_b32 s80, 40000
L_spin_23:
    buffer_load_dword v21, v250, s[20:23], 0 offen sc1
    s_waitcnt vmcnt(0)
    s_add_u32 s71, s66, 1
    v_subrev_u32 v21, s71, v21
    v_cmp_gt_u32 vcc, 8, v21
    s_nop 1
    s_cmp_eq_u64 vcc, exec
    s_cbranch_scc1 L_back_22
    s_sub_u32 s80, s80, 1
    s_cmp_lg_u32 s80, 0
    s_cbranch_scc1 L_spin_23
    s_branch L_back_22
L_slow_24:
    s_mov_b32 s80, 40000
L_spin_26:
    buffer_load_dword v21, v25, s[20:23], 0 offen sc1
    s_waitcnt vmcnt(0)
    s_add_u32 s71, s66, 1
    v_subrev_u32 v21, s71, v21
    v_cmp_gt_u32 vcc, 8, v21
    s_nop 1
    s_cmp_eq_u64 vcc, exec
    s_cbranch_scc1 L_back_25
    s_sub_u32 s80, s80, 1
    s_cmp_lg_u32 s80, 0
    s_cbranch_scc1 L_spin_26
    s_branch L_back_25
L_slow_27:
    s_mov_b32 s80, 40000
L_spin_29:
    buffer_load_dword v21, v250, s[20:23], 0 offen sc1
    s_waitcnt vmcnt(0)
    s_add_u32 s71, s66, 1
    v_subrev_u32 v21, s71, v21
    v_cmp_gt_u32 vcc, 8, v21
    s_nop 1
    s_cmp_eq_u64 vcc, exec
    s_cbranch_scc1 L_back_28
    s_sub_u32 s80, s80, 1
    s_cmp_lg_u32 s80, 0
    s_cbranch_scc1 L_spin_29
    s_branch L_back_28
L_slow_30:
    s_mov_b32 s80, 40000
L_spin_32:
    buffer_load_dword v21, v25, s[20:23], 0 offen sc1
    s_waitcnt vmcnt(0)
    s_add_u32 s71, s66, 1
    v_subrev_u32 v21, s71, v21
    v_cmp_gt_u32 vcc, 8, v21
    s_nop 1
    s_cmp_eq_u64 vcc, exec
    s_cbranch_scc1 L_back_31
    s_sub_u32 s80, s80, 1
    s_cmp_lg_u32 s80, 0
    s_cbranch_scc1 L_spin_32
    s_branch L_back_31
L_slow_33:
    s_mov_b32 s80, 40000
L_spin_35:
    buffer_load_dword v21, v250, s[20:23], 0 offen sc1
    s_waitcnt vmcnt(0)
    s_add_u32 s71, s66, 1
    v_subrev_u32 v21, s71, v21
    v_cmp_gt_u32 vcc, 8, v21
    s_nop 1
    s_cmp_eq_u64 vcc, exec
    s_cbranch_scc1 L_back_34
    s_sub_u32 s80, s80, 1
    s_cmp_lg_u32 s80, 0
    s_cbranch_scc1 L_spin_35
    s_branch L_back_34
L_slow_36:
    s_mov_b32 s80, 40000
L_spin_38:
    buffer_load_dword v21, v25, s[20:23], 0 offen sc1
    s_waitcnt vmcnt(0)
    s_add_u32 s71, s66, 1
    v_subrev_u32 v21, s71, v21
    v_cmp_gt_u32 vcc, 8, v21
    s_nop 1
    s_cmp_eq_u64 vcc, exec
    s_cbranch_scc1 L_back_37
    s_sub_u32 s80, s80, 1
    s_cmp_lg_u32 s80, 0
    s_cbranch_scc1 L_spin_38
    s_branch L_back_37
L_attn:
L_pad_a0_0:
    s_cbranch_execz L_pad_a0_1
    s_waitcnt vmcnt(20) lgkmcnt(0)
    s_barrier
    ds_read_b64_tr_b16 a[0:1], v2 offset:0
    ds_read_b64_tr_b16 a[2:3], v2 offset:37440
    ds_read_b64_tr_b16 a[4:5], v6 offset:9344
    ds_read_b64_tr_b16 a[6:7], v6 offset:46784
    ds_read_b64_tr_b16 a[8:9], v3 offset:0
    ds_read_b64_tr_b16 a[10:11], v3 offset:37440
    ds_read_b64_tr_b16 a[12:13], v7 offset:9344
    ds_read_b64_tr_b16 a[14:15], v7 offset:46784
    ds_read_b64_tr_b16 a[16:17], v4 offset:0
    ds_read_b64_tr_b16 a[18:19], v4 offset:37440
    ds_read_b64_tr_b16 a[20:21], v8 offset:9344
    ds_read_b64_tr_b16 a[22:23], v8 offset:46784
    ds_read_b64_tr_b16 a[24:25], v5 offset:0
    ds_read_b64_tr_b16 a[26:27], v5 offset:37440
    ds_read_b64_tr_b16 a[28:29], v9 offset:9344
    ds_read_b64_tr_b16 a[30:31], v9 offset:46784
    s_waitcnt lgkmcnt(14)
    v_mfma_f32_16x16x32_bf16 v[176:179], v[32:35], a[0:3], 0
    s_add_u32 m0, s67, 18432
    ds_read_b64_tr_b16 a[32:33], v2 offset:2048
    s_waitcnt lgkmcnt(13)
    v_mfma_f32_16x16x32_bf16 v[176:179], v[40:43], a[4:7], v[176:179]
    s_add_u32 s72, s73, 663552
    ds_read_b64_tr_b16 a[34:35], v2 offset:39488
    buffer_load_dwordx4 v14, s[12:15], s72 offen lds
    v_mfma_f32_16x16x32_bf16 v[180:183], v[36:39], a[0:3], 0
    ds_read_b64_tr_b16 a[36:37], v6 offset:11392
    v_mfma_f32_16x16x32_bf16 v[180:183], v[44:47], a[4:7], v[180:183]
    ds_read_b64_tr_b16 a[38:39], v6 offset:48832
    s_waitcnt lgkmcnt(14)
    v_mfma_f32_16x16x32_bf16 v[184:187], v[32:35], a[8:11], 0
    ds_read_b64_tr_b16 a[40:41], v3 offset:2048
    buffer_load_dwordx4 v15, s[12:15], s72 offen offset:1024 lds
    s_waitcnt lgkmcnt(13)
    v_mfma_f32_16x16x32_bf16 v[184:187], v[40:43], a[12:15], v[184:187]
    ds_read_b64_tr_b16 a[42:43], v3 offset:39488
    v_mfma_f32_16x16x32_bf16 v[188:191], v[36:39], a[8:11], 0
    s_add_u32 m0, s67, 20480
    ds_read_b64_tr_b16 a[44:45], v7 offset:11392
    v_mfma_f32_16x16x32_bf16 v[188:191], v[44:47], a[12:15], v[188:191]
    s_waitcnt lgkmcnt(7)
    ds_read_b64_tr_b16 a[46:47], v7 offset:48832
    v_mfma_f32_16x16x32_bf16 v[192:195], v[32:35], a[16:19], 0
    s_add_u32 s72, s73, 663680
    ds_read_b64_tr_b16 a[0:1], v4 offset:2048
    buffer_load_dwordx4 v14, s[12:15], s72 offen lds
    v_mfma_f32_16x16x32_bf16 v[192:195], v[40:43], a[20:23], v[192:195]
    ds_read_b64_tr_b16 a[2:3], v4 offset:39488
    v_mfma_f32_16x16x32_bf16 v[196:199], v[36:39], a[16:19], 0
    ds_read_b64_tr_b16 a[4:5], v8 offset:11392
    buffer_load_dwordx4 v15, s[12:15], s72 offen offset:1024 lds
    v_mfma_f32_16x16x32_bf16 v[196:199], v[44:47], a[20:23], v[196:199]
    ds_read_b64_tr_b16 a[6:7], v8 offset:48832
    v_mfma_f32_16x16x32_bf16 v[200:203], v[32:35], a[24:27], 0
    s_add_u32 m0, s67, 22528
    ds_read_b64_tr_b16 a[8:9], v5 offset:2048
    v_mfma_f32_16x16x32_bf16 v[200:203], v[40:43], a[28:31], v[200:203]
    s_add_u32 s72, s73, 663808
    ds_read_b64_tr_b16 a[10:11], v5 offset:39488
    buffer_load_dwordx4 v14, s[12:15], s72 offen lds
    v_mfma_f32_16x16x32_bf16 v[204:207], v[36:39], a[24:27], 0
    ds_read_b64_tr_b16 a[12:13], v9 offset:11392
    v_mfma_f32_16x16x32_bf16 v[204:207], v[44:47], a[28:31], v[204:207]
    s_waitcnt lgkmcnt(7)
    ds_read_b64_tr_b16 a[14:15], v9 offset:48832
    v_mfma_f32_16x16x32_bf16 v[208:211], v[32:35], a[32:35], 0
    ds_read_b64_tr_b16 a[16:17], v2 offset:4096
    buffer_load_dwordx4 v15, s[12:15], s72 offen offset:1024 lds
    v_mfma_f32_16x16x32_bf16 v[208:211], v[40:43], a[36:39], v[208:211]
    ds_read_b64_tr_b16 a[18:19], v2 offset:41536
    v_mfma_f32_16x16x32_bf16 v[212:215], v[36:39], a[32:35], 0
    s_add_u32 m0, s67, 24576
    ds_read_b64_tr_b16 a[20:21], v6 offset:13440
    v_mfma_f32_16x16x32_bf16 v[212:215], v[44:47], a[36:39], v[212:215]
    s_waitcnt vmcnt(20)
    ds_read_b64_tr_b16 a[22:23], v6 offset:50880
    v_mfma_f32_16x16x32_bf16 v[216:219], v[32:35], a[40:43], 0
    s_barrier
    ds_read_b64_tr_b16 a[24:25], v2 offset:6144
    v_mfma_f32_16x16x32_bf16 v[216:219], v[40:43], a[44:47], v[216:219]
    s_add_u32 s72, s73, 884736
    ds_read_b64_tr_b16 a[26:27], v2 offset:43584
    buffer_load_dwordx4 v14, s[12:15], s72 offen lds
    v_mfma_f32_16x16x32_bf16 v[220:223], v[36:39], a[40:43], 0
    ds_read_b64_tr_b16 a[28:29], v6 offset:15488
    buffer_load_dwordx4 v15, s[12:15], s72 offen offset:1024 lds
    v_mfma_f32_16x16x32_bf16 v[220:223], v[44:47], a[44:47], v[220:223]
    s_waitcnt lgkmcnt(7)
    ds_read_b64_tr_b16 a[30:31], v6 offset:52928
    v_mfma_f32_16x16x32_bf16 v[224:227], v[32:35], a[0:3], 0
    s_add_u32 m0, s67, 26624
    ds_read_b64_tr_b16 a[32:33], v3 offset:6144
    v_mfma_f32_16x16x32_bf16 v[224:227], v[40:43], a[4:7], v[224:227]
    s_add_u32 s72, s73, 884864
    ds_read_b64_tr_b16 a[34:35], v3 offset:43584
    buffer_load_dwordx4 v14, s[12:15], s72 offen lds
    v_mfma_f32_16x16x32_bf16 v[228:231], v[36:39], a[0:3], 0
    ds_read_b64_tr_b16 a[36:37], v7 offset:15488
    v_mfma_f32_16x16x32_bf16 v[228:231], v[44:47], a[4:7], v[228:231]
    ds_read_b64_tr_b16 a[38:39], v7 offset:52928
    v_mfma_f32_16x16x32_bf16 v[232:235], v[32:35], a[8:11], 0
    ds_read_b64_tr_b16 a[40:41], v4 offset:6144
    buffer_load_dwordx4 v15, s[12:15], s72 offen offset:1024 lds
    v_mfma_f32_16x16x32_bf16 v[232:235], v[40:43], a[12:15], v[232:235]
    ds_read_b64_tr_b16 a[42:43], v4 offset:43584
    v_mfma_f32_16x16x32_bf16 v[236:239], v[36:39], a[8:11], 0
    s_add_u32 m0, s67, 28672
    ds_read_b64_tr_b16 a[44:45], v8 offset:15488
    v_mfma_f32_16x16x32_bf16 v[236:239], v[44:47], a[12:15], v[236:239]
    s_waitcnt lgkmcnt(7)
    ds_read_b64_tr_b16 a[46:47], v8 offset:52928
    v_mfma_f32_16x16x32_bf16 v[240:243], v[32:35], a[16:19], 0
    s_add_u32 s72, s73, 884992
    ds_read_b64_tr_b16 a[0:1], v5 offset:6144
    buffer_load_dwordx4 v14, s[12:15], s72 offen lds
    v_mfma_f32_16x16x32_bf16 v[240:243], v[40:43], a[20:23], v[240:243]
    ds_read_b64_tr_b16 a[2:3], v5 offset:43584
    v_mfma_f32_16x16x32_bf16 v[244:247], v[36:39], a[16:19], 0
    ds_read_b64_tr_b16 a[4:5], v9 offset:15488
    buffer_load_dwordx4 v15, s[12:15], s72 offen offset:1024 lds
    v_mfma_f32_16x16x32_bf16 v[244:247], v[44:47], a[20:23], v[244:247]
    ds_read_b64_tr_b16 a[6:7], v9 offset:52928
    v_mfma_f32_16x16x32_bf16 v[176:179], v[48:51], a[24:27], v[176:179]
    ds_read_b64_tr_b16 a[8:9], v2 offset:8192
    v_mfma_f32_16x16x32_bf16 v[176:179], v[56:59], a[28:31], v[176:179]
    ds_read_b64_tr_b16 a[10:11], v2 offset:45632
    v_mfma_f32_16x16x32_bf16 v[180:183], v[52:55], a[24:27], v[180:183]
    s_add_u32 m0, s67, 30720
    ds_read_b64_tr_b16 a[12:13], v6 offset:17536
    v_mfma_f32_16x16x32_bf16 v[180:183], v[60:63], a[28:31], v[180:183]
    s_waitcnt lgkmcnt(7)
    ds_read_b64_tr_b16 a[14:15], v6 offset:54976
    v_mfma_f32_16x16x32_bf16 v[184:187], v[48:51], a[32:35], v[184:187]
    s_add_u32 s72, s73, 1105920
    ds_read_b64_tr_b16 a[16:17], v3 offset:8192
    buffer_load_dwordx4 v14, s[12:15], s72 offen lds
    v_mfma_f32_16x16x32_bf16 v[184:187], v[56:59], a[36:39], v[184:187]
    ds_read_b64_tr_b16 a[18:19], v3 offset:45632
    v_mfma_f32_16x16x32_bf16 v[188:191], v[52:55], a[32:35], v[188:191]
    ds_read_b64_tr_b16 a[20:21], v7 offset:17536
    v_mfma_f32_16x16x32_bf16 v[188:191], v[60:63], a[36:39], v[188:191]
    ds_read_b64_tr_b16 a[22:23], v7 offset:54976
    v_mfma_f32_16x16x32_bf16 v[192:195], v[48:51], a[40:43], v[192:195]
    ds_read_b64_tr_b16 a[24:25], v4 offset:8192
    v_mfma_f32_16x16x32_bf16 v[192:195], v[56:59], a[44:47], v[192:195]
    ds_read_b64_tr_b16 a[26:27], v4 offset:45632
    buffer_load_dwordx4 v15, s[12:15], s72 offen offset:1024 lds
    v_mfma_f32_16x16x32_bf16 v[196:199], v[52:55], a[40:43], v[196:199]
    ds_read_b64_tr_b16 a[28:29], v8 offset:17536
    v_mfma_f32_16x16x32_bf16 v[196:199], v[60:63], a[44:47], v[196:199]
    s_waitcnt lgkmcnt(7)
    ds_read_b64_tr_b16 a[30:31], v8 offset:54976
    v_mfma_f32_16x16x32_bf16 v[200:203], v[48:51], a[0:3], v[200:203]
    ds_read_b64_tr_b16 a[32:33], v5 offset:8192
    v_mfma_f32_16x16x32_bf16 v[200:203], v[56:59], a[4:7], v[200:203]
    ds_read_b64_tr_b16 a[34:35], v5 offset:45632
    v_mfma_f32_16x16x32_bf16 v[204:207], v[52:55], a[0:3], v[204:207]
    s_add_u32 m0, s67, 32768
    ds_read_b64_tr_b16 a[36:37], v9 offset:17536
    v_mfma_f32_16x16x32_bf16 v[204:207], v[60:63], a[4:7], v[204:207]
    s_add_u32 s72, s73, 1106048
    ds_read_b64_tr_b16 a[38:39], v9 offset:54976
    buffer_load_dwordx4 v14, s[12:15], s72 offen lds
    v_mfma_f32_16x16x32_bf16 v[208:211], v[48:51], a[8:11], v[208:211]
    ds_read_b64_tr_b16 a[40:41], v2 offset:10240
    v_mfma_f32_16x16x32_bf16 v[208:211], v[56:59], a[12:15], v[208:211]
    ds_read_b64_tr_b16 a[42:43], v2 offset:47680
    v_mfma_f32_16x16x32_bf16 v[212:215], v[52:55], a[8:11], v[212:215]
    ds_read_b64_tr_b16 a[44:45], v6 offset:19584
    v_mfma_f32_16x16x32_bf16 v[212:215], v[60:63], a[12:15], v[212:215]
    s_waitcnt vmcnt(23) lgkmcnt(7)
    ds_read_b64_tr_b16 a[46:47], v6 offset:57024
    v_mfma_f32_16x16x32_bf16 v[216:219], v[48:51], a[16:19], v[216:219]
    s_barrier
    ds_read_b64_tr_b16 a[0:1], v2 offset:12288
    v_mfma_f32_16x16x32_bf16 v[216:219], v[56:59], a[20:23], v[216:219]
    ds_read_b64_tr_b16 a[2:3], v2 offset:49728
    buffer_load_dwordx4 v15, s[12:15], s72 offen offset:1024 lds
    v_mfma_f32_16x16x32_bf16 v[220:223], v[52:55], a[16:19], v[220:223]
    ds_read_b64_tr_b16 a[4:5], v6 offset:21632
    v_mfma_f32_16x16x32_bf16 v[220:223], v[60:63], a[20:23], v[220:223]
    ds_read_b64_tr_b16 a[6:7], v6 offset:59072
    v_mfma_f32_16x16x32_bf16 v[224:227], v[48:51], a[24:27], v[224:227]
    ds_read_b64_tr_b16 a[8:9], v3 offset:12288
    v_mfma_f32_16x16x32_bf16 v[224:227], v[56:59], a[28:31], v[224:227]
    ds_read_b64_tr_b16 a[10:11], v3 offset:49728
    v_mfma_f32_16x16x32_bf16 v[228:231], v[52:55], a[24:27], v[228:231]
    s_add_u32 m0, s67, 34816
    ds_read_b64_tr_b16 a[12:13], v7 offset:21632
    v_mfma_f32_16x16x32_bf16 v[228:231], v[60:63], a[28:31], v[228:231]
    s_waitcnt lgkmcnt(7)
    ds_read_b64_tr_b16 a[14:15], v7 offset:59072
    v_mfma_f32_16x16x32_bf16 v[232:235], v[48:51], a[32:35], v[232:235]
    s_add_u32 s72, s73, 1106176
    ds_read_b64_tr_b16 a[16:17], v4 offset:12288
    buffer_load_dwordx4 v14, s[12:15], s72 offen lds
    v_mfma_f32_16x16x32_bf16 v[232:235], v[56:59], a[36:39], v[232:235]
    ds_read_b64_tr_b16 a[18:19], v4 offset:49728
    v_mfma_f32_16x16x32_bf16 v[236:239], v[52:55], a[32:35], v[236:239]
    ds_read_b64_tr_b16 a[20:21], v8 offset:21632
    v_mfma_f32_16x16x32_bf16 v[236:239], v[60:63], a[36:39], v[236:239]
    ds_read_b64_tr_b16 a[22:23], v8 offset:59072
    v_mfma_f32_16x16x32_bf16 v[240:243], v[48:51], a[40:43], v[240:243]
    ds_read_b64_tr_b16 a[24:25], v5 offset:12288
    v_mfma_f32_16x16x32_bf16 v[240:243], v[56:59], a[44:47], v[240:243]
    ds_read_b64_tr_b16 a[26:27], v5 offset:49728
    buffer_load_dwordx4 v15, s[12:15], s72 offen offset:1024 lds
    v_mfma_f32_16x16x32_bf16 v[244:247], v[52:55], a[40:43], v[244:247]
    ds_read_b64_tr_b16 a[28:29], v9 offset:21632
    v_mfma_f32_16x16x32_bf16 v[244:247], v[60:63], a[44:47], v[244:247]
    s_waitcnt lgkmcnt(7)
    ds_read_b64_tr_b16 a[30:31], v9 offset:59072
    v_mfma_f32_16x16x32_bf16 v[176:179], v[64:67], a[0:3], v[176:179]
    ds_read_b64_tr_b16 a[32:33], v2 offset:14336
    v_mfma_f32_16x16x32_bf16 v[176:179], v[72:75], a[4:7], v[176:179]
    ds_read_b64_tr_b16 a[34:35], v2 offset:51776
    v_mfma_f32_16x16x32_bf16 v[180:183], v[68:71], a[0:3], v[180:183]
    s_add_u32 m0, s67, 0
    ds_read_b64_tr_b16 a[36:37], v6 offset:23680
    v_mfma_f32_16x16x32_bf16 v[180:183], v[76:79], a[4:7], v[180:183]
    s_add_u32 s72, s73, 1327104
    ds_read_b64_tr_b16 a[38:39], v6 offset:61120
    buffer_load_dwordx4 v14, s[12:15], s72 offen lds
    v_mfma_f32_16x16x32_bf16 v[184:187], v[64:67], a[8:11], v[184:187]
    ds_read_b64_tr_b16 a[40:41], v3 offset:14336
    v_mfma_f32_16x16x32_bf16 v[184:187], v[72:75], a[12:15], v[184:187]
    ds_read_b64_tr_b16 a[42:43], v3 offset:51776
    v_mfma_f32_16x16x32_bf16 v[188:191], v[68:71], a[8:11], v[188:191]
    ds_read_b64_tr_b16 a[44:45], v7 offset:23680
    v_mfma_f32_16x16x32_bf16 v[188:191], v[76:79], a[12:15], v[188:191]
    s_waitcnt lgkmcnt(7)
    ds_read_b64_tr_b16 a[46:47], v7 offset:61120
    v_mfma_f32_16x16x32_bf16 v[192:195], v[64:67], a[16:19], v[192:195]
    ds_read_b64_tr_b16 a[0:1], v4 offset:14336
    v_mfma_f32_16x16x32_bf16 v[192:195], v[72:75], a[20:23], v[192:195]
    ds_read_b64_tr_b16 a[2:3], v4 offset:51776
    buffer_load_dwordx4 v15, s[12:15], s72 offen offset:1024 lds
    v_mfma_f32_16x16x32_bf16 v[196:199], v[68:71], a[16:19], v[196:199]
    ds_read_b64_tr_b16 a[4:5], v8 offset:23680
    v_mfma_f32_16x16x32_bf16 v[196:199], v[76:79], a[20:23], v[196:199]
    ds_read_b64_tr_b16 a[6:7], v8 offset:61120
    v_mfma_f32_16x16x32_bf16 v[200:203], v[64:67], a[24:27], v[200:203]
    ds_read_b64_tr_b16 a[8:9], v5 offset:14336
    v_mfma_f32_16x16x32_bf16 v[200:203], v[72:75], a[28:31], v[200:203]
    ds_read_b64_tr_b16 a[10:11], v5 offset:51776
    v_mfma_f32_16x16x32_bf16 v[204:207], v[68:71], a[24:27], v[204:207]
    s_add_u32 m0, s67, 2048
    ds_read_b64_tr_b16 a[12:13], v9 offset:23680
    v_mfma_f32_16x16x32_bf16 v[204:207], v[76:79], a[28:31], v[204:207]
    s_waitcnt lgkmcnt(7)
    ds_read_b64_tr_b16 a[14:15], v9 offset:61120
    v_mfma_f32_16x16x32_bf16 v[208:211], v[64:67], a[32:35], v[208:211]
    s_add_u32 s72, s73, 1327232
    ds_read_b64_tr_b16 a[16:17], v2 offset:16384
    buffer_load_dwordx4 v14, s[12:15], s72 offen lds
    v_mfma_f32_16x16x32_bf16 v[208:211], v[72:75], a[36:39], v[208:211]
    ds_read_b64_tr_b16 a[18:19], v2 offset:53824
    v_mfma_f32_16x16x32_bf16 v[212:215], v[68:71], a[32:35], v[212:215]
    ds_read_b64_tr_b16 a[20:21], v6 offset:25728
    v_mfma_f32_16x16x32_bf16 v[212:215], v[76:79], a[36:39], v[212:215]
    s_waitcnt vmcnt(15)
    ds_read_b64_tr_b16 a[22:23], v6 offset:63168
    v_mfma_f32_16x16x32_bf16 v[216:219], v[64:67], a[40:43], v[216:219]
    s_barrier
    ds_read_b64_tr_b16 a[24:25], v2 offset:18432
    v_mfma_f32_16x16x32_bf16 v[216:219], v[72:75], a[44:47], v[216:219]
    ds_read_b64_tr_b16 a[26:27], v2 offset:55872
    buffer_load_dwordx4 v15, s[12:15], s72 offen offset:1024 lds
    v_mfma_f32_16x16x32_bf16 v[220:223], v[68:71], a[40:43], v[220:223]
    ds_read_b64_tr_b16 a[28:29], v6 offset:27776
    v_mfma_f32_16x16x32_bf16 v[220:223], v[76:79], a[44:47], v[220:223]
    s_waitcnt lgkmcnt(7)
    ds_read_b64_tr_b16 a[30:31], v6 offset:65216
    v_mfma_f32_16x16x32_bf16 v[224:227], v[64:67], a[0:3], v[224:227]
    ds_read_b64_tr_b16 a[32:33], v3 offset:18432
    v_mfma_f32_16x16x32_bf16 v[224:227], v[72:75], a[4:7], v[224:227]
    ds_read_b64_tr_b16 a[34:35], v3 offset:55872
    v_mfma_f32_16x16x32_bf16 v[228:231], v[68:71], a[0:3], v[228:231]
    s_add_u32 m0, s67, 4096
    ds_read_b64_tr_b16 a[36:37], v7 offset:27776
    v_mfma_f32_16x16x32_bf16 v[228:231], v[76:79], a[4:7], v[228:231]
    s_add_u32 s72, s73, 1327360
    ds_read_b64_tr_b16 a[38:39], v7 offset:65216
    buffer_load_dwordx4 v14, s[12:15], s72 offen lds
    v_mfma_f32_16x16x32_bf16 v[232:235], v[64:67], a[8:11], v[232:235]
    ds_read_b64_tr_b16 a[40:41], v4 offset:18432
    v_mfma_f32_16x16x32_bf16 v[232:235], v[72:75], a[12:15], v[232:235]
    ds_read_b64_tr_b16 a[42:43], v4 offset:55872
    v_mfma_f32_16x16x32_bf16 v[236:239], v[68:71], a[8:11], v[236:239]
    ds_read_b64_tr_b16 a[44:45], v8 offset:27776
    v_mfma_f32_16x16x32_bf16 v[236:239], v[76:79], a[12:15], v[236:239]
    s_waitcnt lgkmcnt(7)
    ds_read_b64_tr_b16 a[46:47], v8 offset:65216
    v_mfma_f32_16x16x32_bf16 v[240:243], v[64:67], a[16:19], v[240:243]
    ds_read_b64_tr_b16 a[0:1], v5 offset:18432
    v_mfma_f32_16x16x32_bf16 v[240:243], v[72:75], a[20:23], v[240:243]
    ds_read_b64_tr_b16 a[2:3], v5 offset:55872
    buffer_load_dwordx4 v15, s[12:15], s72 offen offset:1024 lds
    v_mfma_f32_16x16x32_bf16 v[244:247], v[68:71], a[16:19], v[244:247]
    ds_read_b64_tr_b16 a[4:5], v9 offset:27776
    v_mfma_f32_16x16x32_bf16 v[244:247], v[76:79], a[20:23], v[244:247]
    ds_read_b64_tr_b16 a[6:7], v9 offset:65216
    v_mfma_f32_16x16x32_bf16 v[176:179], v[80:83], a[24:27], v[176:179]
    s_mov_b32 s36, s58
    ds_read_b64_tr_b16 a[8:9], v2 offset:20480
    v_mfma_f32_16x16x32_bf16 v[176:179], v[88:91], a[28:31], v[176:179]
    ds_read_b64_tr_b16 a[10:11], v2 offset:57920
    v_mfma_f32_16x16x32_bf16 v[180:183], v[84:87], a[24:27], v[180:183]
    s_add_u32 m0, s67, 6144
    ds_read_b64_tr_b16 a[12:13], v6 offset:29824
    v_mfma_f32_16x16x32_bf16 v[180:183], v[92:95], a[28:31], v[180:183]
    s_waitcnt lgkmcnt(7)
    ds_read_b64_tr_b16 a[14:15], v10 offset:1728
    v_mfma_f32_16x16x32_bf16 v[184:187], v[80:83], a[32:35], v[184:187]
    s_add_u32 s72, s73, 1548288
    ds_read_b64_tr_b16 a[16:17], v3 offset:20480
    buffer_load_dwordx4 v14, s[12:15], s72 offen lds
    v_mfma_f32_16x16x32_bf16 v[184:187], v[88:91], a[36:39], v[184:187]
    s_and_b32 s37, s59, 0xffff
    ds_read_b64_tr_b16 a[18:19], v3 offset:57920
    v_mfma_f32_16x16x32_bf16 v[188:191], v[84:87], a[32:35], v[188:191]
    s_mov_b32 s38, 256
    ds_read_b64_tr_b16 a[20:21], v7 offset:29824
    v_mfma_f32_16x16x32_bf16 v[188:191], v[92:95], a[36:39], v[188:191]
    ds_read_b64_tr_b16 a[22:23], v11 offset:1728
    v_mfma_f32_16x16x32_bf16 v[192:195], v[80:83], a[40:43], v[192:195]
    ds_read_b64_tr_b16 a[24:25], v4 offset:20480
    v_mfma_f32_16x16x32_bf16 v[192:195], v[88:91], a[44:47], v[192:195]
    s_mov_b32 s39, 0x20000
    ds_read_b64_tr_b16 a[26:27], v4 offset:57920
    buffer_load_dwordx4 v15, s[12:15], s72 offen offset:1024 lds
    v_mfma_f32_16x16x32_bf16 v[196:199], v[84:87], a[40:43], v[196:199]
    ds_read_b64_tr_b16 a[28:29], v8 offset:29824
    v_mfma_f32_16x16x32_bf16 v[196:199], v[92:95], a[44:47], v[196:199]
    s_waitcnt lgkmcnt(7)
    ds_read_b64_tr_b16 a[30:31], v12 offset:1728
    v_mfma_f32_16x16x32_bf16 v[200:203], v[80:83], a[0:3], v[200:203]
    s_mov_b32 s27, 0x3f317218
    ds_read_b64_tr_b16 a[32:33], v5 offset:20480
    v_mfma_f32_16x16x32_bf16 v[200:203], v[88:91], a[4:7], v[200:203]
    ds_read_b64_tr_b16 a[34:35], v5 offset:57920
    v_mfma_f32_16x16x32_bf16 v[204:207], v[84:87], a[0:3], v[204:207]
    s_add_u32 m0, s67, 8192
    ds_read_b64_tr_b16 a[36:37], v9 offset:29824
    v_mfma_f32_16x16x32_bf16 v[204:207], v[92:95], a[4:7], v[204:207]
    s_add_u32 s72, s73, 1548416
    ds_read_b64_tr_b16 a[38:39], v13 offset:1728
    buffer_load_dwordx4 v14, s[12:15], s72 offen lds
    v_mfma_f32_16x16x32_bf16 v[208:211], v[80:83], a[8:11], v[208:211]
    s_lshl_b32 s89, s63, 2
    ds_read_b64_tr_b16 a[40:41], v2 offset:22528
    v_mfma_f32_16x16x32_bf16 v[208:211], v[88:91], a[12:15], v[208:211]
    ds_read_b64_tr_b16 a[42:43], v2 offset:59968
    v_mfma_f32_16x16x32_bf16 v[212:215], v[84:87], a[8:11], v[212:215]
    ds_read_b64_tr_b16 a[44:45], v6 offset:31872
    v_mov_b32 v20, s89
    v_mfma_f32_16x16x32_bf16 v[212:215], v[92:95], a[12:15], v[212:215]
    s_waitcnt vmcnt(15) lgkmcnt(7)
    ds_read_b64_tr_b16 a[46:47], v10 offset:3776
    v_mfma_f32_16x16x32_bf16 v[216:219], v[80:83], a[16:19], v[216:219]
    s_barrier
    ds_read_b64_tr_b16 a[0:1], v2 offset:24576
    v_mfma_f32_16x16x32_bf16 v[216:219], v[88:91], a[20:23], v[216:219]
    s_lshl_b32 s68, s63, 20
    ds_read_b64_tr_b16 a[2:3], v2 offset:62016
    buffer_load_dwordx4 v15, s[12:15], s72 offen offset:1024 lds
    v_mfma_f32_16x16x32_bf16 v[220:223], v[84:87], a[16:19], v[220:223]
    ds_read_b64_tr_b16 a[4:5], v6 offset:33920
    v_mfma_f32_16x16x32_bf16 v[220:223], v[92:95], a[20:23], v[220:223]
    ds_read_b64_tr_b16 a[6:7], v10 offset:5824
    v_mfma_f32_16x16x32_bf16 v[224:227], v[80:83], a[24:27], v[224:227]
    s_mul_i32 s79, s81, 10240
    ds_read_b64_tr_b16 a[8:9], v3 offset:24576
    v_mfma_f32_16x16x32_bf16 v[224:227], v[88:91], a[28:31], v[224:227]
    ds_read_b64_tr_b16 a[10:11], v3 offset:62016
    v_mfma_f32_16x16x32_bf16 v[228:231], v[84:87], a[24:27], v[228:231]
    s_add_u32 m0, s67, 10240
    ds_read_b64_tr_b16 a[12:13], v7 offset:33920
    v_mfma_f32_16x16x32_bf16 v[228:231], v[92:95], a[28:31], v[228:231]
    s_waitcnt lgkmcnt(7)
    ds_read_b64_tr_b16 a[14:15], v11 offset:5824
    v_mfma_f32_16x16x32_bf16 v[232:235], v[80:83], a[32:35], v[232:235]
    s_add_u32 s72, s73, 1548544
    ds_read_b64_tr_b16 a[16:17], v4 offset:24576
    buffer_load_dwordx4 v14, s[12:15], s72 offen lds
    v_mfma_f32_16x16x32_bf16 v[232:235], v[88:91], a[36:39], v[232:235]
    s_add_u32 s79, s79, s68
    ds_read_b64_tr_b16 a[18:19], v4 offset:62016
    v_mfma_f32_16x16x32_bf16 v[236:239], v[84:87], a[32:35], v[236:239]
    s_add_u32 s79, s79, 0x2800000
    ds_read_b64_tr_b16 a[20:21], v8 offset:33920
    v_mfma_f32_16x16x32_bf16 v[236:239], v[92:95], a[36:39], v[236:239]
    ds_read_b64_tr_b16 a[22:23], v12 offset:5824
    v_mfma_f32_16x16x32_bf16 v[240:243], v[80:83], a[40:43], v[240:243]
    ds_read_b64_tr_b16 a[24:25], v5 offset:24576
    v_mfma_f32_16x16x32_bf16 v[240:243], v[88:91], a[44:47], v[240:243]
    s_min_u32 s68, s81, 49
    ds_read_b64_tr_b16 a[26:27], v5 offset:62016
    buffer_load_dwordx4 v15, s[12:15], s72 offen offset:1024 lds
    v_mfma_f32_16x16x32_bf16 v[244:247], v[84:87], a[40:43], v[244:247]
    ds_read_b64_tr_b16 a[28:29], v9 offset:33920
    v_mfma_f32_16x16x32_bf16 v[244:247], v[92:95], a[44:47], v[244:247]
    s_waitcnt lgkmcnt(7)
    ds_read_b64_tr_b16 a[30:31], v13 offset:5824
    v_mfma_f32_16x16x32_bf16 v[176:179], v[96:99], a[0:3], v[176:179]
    s_and_b32 s75, s68, 1
    ds_read_b64_tr_b16 a[32:33], v2 offset:26624
    v_mfma_f32_16x16x32_bf16 v[176:179], v[104:107], a[4:7], v[176:179]
    ds_read_b64_tr_b16 a[34:35], v2 offset:64064
    v_mfma_f32_16x16x32_bf16 v[180:183], v[100:103], a[0:3], v[180:183]
    s_add_u32 m0, s67, 12288
    ds_read_b64_tr_b16 a[36:37], v6 offset:35968
    v_mfma_f32_16x16x32_bf16 v[180:183], v[108:111], a[4:7], v[180:183]
    s_add_u32 s72, s73, 1769472
    ds_read_b64_tr_b16 a[38:39], v10 offset:7872
    buffer_load_dwordx4 v14, s[12:15], s72 offen lds
    v_mfma_f32_16x16x32_bf16 v[184:187], v[96:99], a[8:11], v[184:187]
    s_lshr_b32 s76, s68, 1
    ds_read_b64_tr_b16 a[40:41], v3 offset:26624
    v_mfma_f32_16x16x32_bf16 v[184:187], v[104:107], a[12:15], v[184:187]
    ds_read_b64_tr_b16 a[42:43], v3 offset:64064
    v_mfma_f32_16x16x32_bf16 v[188:191], v[100:103], a[8:11], v[188:191]
L_pad_a1_0:
    s_cbranch_execz L_pad_a1_1
    s_add_u32 s68, s76, 1
    ds_read_b64_tr_b16 a[44:45], v7 offset:35968
    v_mfma_f32_16x16x32_bf16 v[188:191], v[108:111], a[12:15], v[188:191]
    s_waitcnt lgkmcnt(7)
    ds_read_b64_tr_b16 a[46:47], v11 offset:7872
    v_mfma_f32_16x16x32_bf16 v[192:195], v[96:99], a[16:19], v[192:195]
    ds_read_b64_tr_b16 a[0:1], v4 offset:26624
    v_mfma_f32_16x16x32_bf16 v[192:195], v[104:107], a[20:23], v[192:195]
    s_mul_i32 s77, s68, 43
    ds_read_b64_tr_b16 a[2:3], v4 offset:64064
    buffer_load_dwordx4 v15, s[12:15], s72 offen offset:1024 lds
    v_mfma_f32_16x16x32_bf16 v[196:199], v[100:103], a[16:19], v[196:199]
    ds_read_b64_tr_b16 a[4:5], v8 offset:35968
    v_mfma_f32_16x16x32_bf16 v[196:199], v[108:111], a[20:23], v[196:199]
    ds_read_b64_tr_b16 a[6:7], v12 offset:7872
    v_mfma_f32_16x16x32_bf16 v[200:203], v[96:99], a[24:27], v[200:203]
    s_lshr_b32 s77, s77, 7
    ds_read_b64_tr_b16 a[8:9], v5 offset:26624
    v_mfma_f32_16x16x32_bf16 v[200:203], v[104:107], a[28:31], v[200:203]
    ds_read_b64_tr_b16 a[10:11], v5 offset:64064
    v_mfma_f32_16x16x32_bf16 v[204:207], v[100:103], a[24:27], v[204:207]
    s_add_u32 m0, s67, 14336
    ds_read_b64_tr_b16 a[12:13], v9 offset:35968
    v_mfma_f32_16x16x32_bf16 v[204:207], v[108:111], a[28:31], v[204:207]
    s_waitcnt lgkmcnt(7)
    ds_read_b64_tr_b16 a[14:15], v13 offset:7872
    v_mfma_f32_16x16x32_bf16 v[208:211], v[96:99], a[32:35], v[208:211]
    s_add_u32 s72, s73, 1769600
    ds_read_b64_tr_b16 a[16:17], v2 offset:28672
    buffer_load_dwordx4 v14, s[12:15], s72 offen lds
    v_mfma_f32_16x16x32_bf16 v[208:211], v[104:107], a[36:39], v[208:211]
    s_mul_i32 s69, s77, 3
    ds_read_b64_tr_b16 a[18:19], v6 offset:576
    v_mfma_f32_16x16x32_bf16 v[212:215], v[100:103], a[32:35], v[212:215]
    s_sub_u32 s78, s68, s69
    ds_read_b64_tr_b16 a[20:21], v6 offset:38016
    v_mfma_f32_16x16x32_bf16 v[212:215], v[108:111], a[36:39], v[212:215]
    s_waitcnt vmcnt(15)
    ds_read_b64_tr_b16 a[22:23], v10 offset:9920
    v_mfma_f32_16x16x32_bf16 v[216:219], v[96:99], a[40:43], v[216:219]
    s_barrier
    ds_read_b64_tr_b16 a[24:25], v2 offset:30720
    v_mfma_f32_16x16x32_bf16 v[216:219], v[104:107], a[44:47], v[216:219]
    s_lshr_b32 s68, s77, 1
    ds_read_b64_tr_b16 a[26:27], v6 offset:2624
    buffer_load_dwordx4 v15, s[12:15], s72 offen offset:1024 lds
    v_mfma_f32_16x16x32_bf16 v[220:223], v[100:103], a[40:43], v[220:223]
    ds_read_b64_tr_b16 a[28:29], v6 offset:40064
    v_mfma_f32_16x16x32_bf16 v[220:223], v[108:111], a[44:47], v[220:223]
    s_waitcnt lgkmcnt(7)
    ds_read_b64_tr_b16 a[30:31], v10 offset:11968
    v_mfma_f32_16x16x32_bf16 v[224:227], v[96:99], a[0:3], v[224:227]
    s_mul_i32 s68, s68, 10240
    ds_read_b64_tr_b16 a[32:33], v3 offset:30720
    v_mfma_f32_16x16x32_bf16 v[224:227], v[104:107], a[4:7], v[224:227]
    ds_read_b64_tr_b16 a[34:35], v7 offset:2624
    v_mfma_f32_16x16x32_bf16 v[228:231], v[100:103], a[0:3], v[228:231]
    s_add_u32 m0, s67, 16384
    ds_read_b64_tr_b16 a[36:37], v7 offset:40064
    v_mfma_f32_16x16x32_bf16 v[228:231], v[108:111], a[4:7], v[228:231]
    s_add_u32 s72, s73, 1769728
    ds_read_b64_tr_b16 a[38:39], v11 offset:11968
    buffer_load_dwordx4 v14, s[12:15], s72 offen lds
    v_mfma_f32_16x16x32_bf16 v[232:235], v[96:99], a[8:11], v[232:235]
    s_and_b32 s69, s77, 1
    ds_read_b64_tr_b16 a[40:41], v4 offset:30720
    v_mfma_f32_16x16x32_bf16 v[232:235], v[104:107], a[12:15], v[232:235]
    ds_read_b64_tr_b16 a[42:43], v8 offset:2624
    v_mfma_f32_16x16x32_bf16 v[236:239], v[100:103], a[8:11], v[236:239]
    s_mul_i32 s70, s69, 3
    ds_read_b64_tr_b16 a[44:45], v8 offset:40064
    v_mfma_f32_16x16x32_bf16 v[236:239], v[108:111], a[12:15], v[236:239]
    s_waitcnt lgkmcnt(7)
    ds_read_b64_tr_b16 a[46:47], v12 offset:11968
    v_mfma_f32_16x16x32_bf16 v[240:243], v[96:99], a[16:19], v[240:243]
    ds_read_b64_tr_b16 a[0:1], v5 offset:30720
    v_mfma_f32_16x16x32_bf16 v[240:243], v[104:107], a[20:23], v[240:243]
    s_add_u32 s70, s70, s78
    ds_read_b64_tr_b16 a[2:3], v9 offset:2624
    buffer_load_dwordx4 v15, s[12:15], s72 offen offset:1024 lds
    v_mfma_f32_16x16x32_bf16 v[244:247], v[100:103], a[16:19], v[244:247]
    ds_read_b64_tr_b16 a[4:5], v9 offset:40064
    v_mfma_f32_16x16x32_bf16 v[244:247], v[108:111], a[20:23], v[244:247]
    ds_read_b64_tr_b16 a[6:7], v13 offset:11968
    v_mfma_f32_16x16x32_bf16 v[176:179], v[112:115], a[24:27], v[176:179]
    s_lshl_b32 s70, s70, 10
    ds_read_b64_tr_b16 a[8:9], v2 offset:32768
    v_mfma_f32_16x16x32_bf16 v[176:179], v[120:123], a[28:31], v[176:179]
    s_add_u32 m0, s67, 18432
    ds_read_b64_tr_b16 a[10:11], v6 offset:4672
    v_mfma_f32_16x16x32_bf16 v[180:183], v[116:119], a[24:27], v[180:183]
    s_add_u32 s72, s73, 1152
    ds_read_b64_tr_b16 a[12:13], v6 offset:42112
    buffer_load_dwordx4 v14, s[12:15], s72 offen lds
    v_mfma_f32_16x16x32_bf16 v[180:183], v[124:127], a[28:31], v[180:183]
    s_waitcnt lgkmcnt(7)
    ds_read_b64_tr_b16 a[14:15], v10 offset:14016
    v_mfma_f32_16x16x32_bf16 v[184:187], v[112:115], a[32:35], v[184:187]
    s_add_u32 s84, s68, s70
    ds_read_b64_tr_b16 a[16:17], v3 offset:32768
    v_mfma_f32_16x16x32_bf16 v[184:187], v[120:123], a[36:39], v[184:187]
    ds_read_b64_tr_b16 a[18:19], v7 offset:4672
    v_mfma_f32_16x16x32_bf16 v[188:191], v[116:119], a[32:35], v[188:191]
    s_lshl_b32 s69, s69, 10
    ds_read_b64_tr_b16 a[20:21], v7 offset:42112
    buffer_load_dwordx4 v15, s[12:15], s72 offen offset:1024 lds
    v_mfma_f32_16x16x32_bf16 v[188:191], v[124:127], a[36:39], v[188:191]
    s_lshl_b32 s47, s63, 8
    ds_read_b64_tr_b16 a[22:23], v11 offset:14016
    v_mfma_f32_16x16x32_bf16 v[192:195], v[112:115], a[40:43], v[192:195]
    s_add_u32 s46, s81, 0
    ds_read_b64_tr_b16 a[24:25], v4 offset:32768
    v_mfma_f32_16x16x32_bf16 v[192:195], v[120:123], a[44:47], v[192:195]
    s_min_u32 s46, s46, 215
    ds_read_b64_tr_b16 a[26:27], v8 offset:4672
    v_mfma_f32_16x16x32_bf16 v[196:199], v[116:119], a[40:43], v[196:199]
    s_mul_i32 s82, s46, 21846
    ds_read_b64_tr_b16 a[28:29], v8 offset:42112
    v_mfma_f32_16x16x32_bf16 v[196:199], v[124:127], a[44:47], v[196:199]
    s_waitcnt lgkmcnt(7)
    ds_read_b64_tr_b16 a[30:31], v12 offset:14016
    v_mfma_f32_16x16x32_bf16 v[200:203], v[112:115], a[0:3], v[200:203]
    s_lshr_b32 s82, s82, 16
    ds_read_b64_tr_b16 a[32:33], v5 offset:32768
    v_mfma_f32_16x16x32_bf16 v[200:203], v[120:123], a[4:7], v[200:203]
    s_mul_i32 s82, s82, 27264
    ds_read_b64_tr_b16 a[34:35], v9 offset:4672
    v_mfma_f32_16x16x32_bf16 v[204:207], v[116:119], a[0:3], v[204:207]
    s_mul_i32 s46, s46, 128
    ds_read_b64_tr_b16 a[36:37], v9 offset:42112
    v_mfma_f32_16x16x32_bf16 v[204:207], v[124:127], a[4:7], v[204:207]
    s_add_u32 s46, s46, s82
    ds_read_b64_tr_b16 a[38:39], v13 offset:14016
    v_mfma_f32_16x16x32_bf16 v[208:211], v[112:115], a[8:11], v[208:211]
    s_add_u32 s46, s46, s47
    ds_read_b64_tr_b16 a[40:41], v2 offset:34816
    buffer_load_dwordx4 a[200:203], v14, s[12:15], s46 offen offset:0
    v_mfma_f32_16x16x32_bf16 v[208:211], v[120:123], a[12:15], v[208:211]
    s_add_u32 m0, s67, 20480
    ds_read_b64_tr_b16 a[42:43], v6 offset:6720
    v_mfma_f32_16x16x32_bf16 v[212:215], v[116:119], a[8:11], v[212:215]
    s_add_u32 s72, s73, 1280
    ds_read_b64_tr_b16 a[44:45], v6 offset:44160
    buffer_load_dwordx4 v14, s[12:15], s72 offen lds
    v_mfma_f32_16x16x32_bf16 v[212:215], v[124:127], a[12:15], v[212:215]
    s_waitcnt vmcnt(16) lgkmcnt(7)
    ds_read_b64_tr_b16 a[46:47], v10 offset:16064
    v_mfma_f32_16x16x32_bf16 v[216:219], v[112:115], a[16:19], v[216:219]
    s_barrier
    ds_read_b64_tr_b16 a[0:1], v2 offset:0
    v_mfma_f32_16x16x32_bf16 v[216:219], v[120:123], a[20:23], v[216:219]
    s_add_u32 s85, s68, s69
    ds_read_b64_tr_b16 a[2:3], v2 offset:37440
    buffer_load_dwordx4 v15, s[12:15], s72 offen offset:1024 lds
    v_mfma_f32_16x16x32_bf16 v[220:223], v[116:119], a[16:19], v[220:223]
    s_add_u32 s85, s85, 6144
    ds_read_b64_tr_b16 a[4:5], v6 offset:9344
    v_mfma_f32_16x16x32_bf16 v[220:223], v[124:127], a[20:23], v[220:223]
    s_add_u32 m0, s67, 22528
    ds_read_b64_tr_b16 a[6:7], v6 offset:46784
    v_mfma_f32_16x16x32_bf16 v[224:227], v[112:115], a[24:27], v[224:227]
    s_add_u32 s72, s73, 1408
    ds_read_b64_tr_b16 a[8:9], v3 offset:0
    buffer_load_dwordx4 v14, s[12:15], s72 offen lds
    v_mfma_f32_16x16x32_bf16 v[224:227], v[120:123], a[28:31], v[224:227]
    s_add_u32 s46, s81, 64
    ds_read_b64_tr_b16 a[10:11], v3 offset:37440
    v_mfma_f32_16x16x32_bf16 v[228:231], v[116:119], a[24:27], v[228:231]
    s_min_u32 s46, s46, 215
    ds_read_b64_tr_b16 a[12:13], v7 offset:9344
    v_mfma_f32_16x16x32_bf16 v[228:231], v[124:127], a[28:31], v[228:231]
    s_waitcnt lgkmcnt(7)
    ds_read_b64_tr_b16 a[14:15], v7 offset:46784
    v_mfma_f32_16x16x32_bf16 v[232:235], v[112:115], a[32:35], v[232:235]
    s_mul_i32 s82, s46, 21846
    ds_read_b64_tr_b16 a[16:17], v4 offset:0
    v_mfma_f32_16x16x32_bf16 v[232:235], v[120:123], a[36:39], v[232:235]
    s_lshr_b32 s82, s82, 16
    ds_read_b64_tr_b16 a[18:19], v4 offset:37440
    v_mfma_f32_16x16x32_bf16 v[236:239], v[116:119], a[32:35], v[236:239]
    s_mul_i32 s82, s82, 27264
    ds_read_b64_tr_b16 a[20:21], v8 offset:9344
    v_mfma_f32_16x16x32_bf16 v[236:239], v[124:127], a[36:39], v[236:239]
    s_mul_i32 s46, s46, 128
    ds_read_b64_tr_b16 a[22:23], v8 offset:46784
    v_mfma_f32_16x16x32_bf16 v[240:243], v[112:115], a[40:43], v[240:243]
    s_add_u32 s46, s46, s82
    ds_read_b64_tr_b16 a[24:25], v5 offset:0
    v_mfma_f32_16x16x32_bf16 v[240:243], v[120:123], a[44:47], v[240:243]
    s_add_u32 s46, s46, s47
    ds_read_b64_tr_b16 a[26:27], v5 offset:37440
    buffer_load_dwordx4 a[204:207], v14, s[12:15], s46 offen offset:0
    v_mfma_f32_16x16x32_bf16 v[244:247], v[116:119], a[40:43], v[244:247]
    s_mul_i32 s68, s78, 10240
    ds_read_b64_tr_b16 a[28:29], v9 offset:9344
    buffer_load_dwordx4 v15, s[12:15], s72 offen offset:1024 lds
    v_mfma_f32_16x16x32_bf16 v[244:247], v[124:127], a[44:47], v[244:247]
    s_waitcnt lgkmcnt(7)
    ds_read_b64_tr_b16 a[30:31], v9 offset:46784
    s_add_u32 s68, s68, 8192
    s_cmp_eq_u32 s77, 8
    s_cselect_b32 s84, s68, s84
    s_cselect_b32 s85, 29696, s85
    s_lshl_b32 s68, s63, 20
    s_lshl_b32 s69, s75, 9
    s_add_u32 s68, s68, s69
    s_add_u32 s68, s68, 0x2800000
    v_mfma_f32_16x16x32_bf16 v[176:179], v[128:131], a[0:3], v[176:179]
    s_add_u32 s84, s84, s68
    ds_read_b64_tr_b16 a[32:33], v2 offset:2048
    v_mfma_f32_16x16x32_bf16 v[176:179], v[136:139], a[4:7], v[176:179]
    s_add_u32 m0, s67, 24576
    ds_read_b64_tr_b16 a[34:35], v2 offset:39488
    v_mfma_f32_16x16x32_bf16 v[180:183], v[132:135], a[0:3], v[180:183]
    s_add_u32 s72, s73, 222336
    ds_read_b64_tr_b16 a[36:37], v6 offset:11392
    buffer_load_dwordx4 v14, s[12:15], s72 offen lds
    v_mfma_f32_16x16x32_bf16 v[180:183], v[140:143], a[4:7], v[180:183]
    s_add_u32 s85, s85, s68
    ds_read_b64_tr_b16 a[38:39], v6 offset:48832
    v_mfma_f32_16x16x32_bf16 v[184:187], v[128:131], a[8:11], v[184:187]
    ds_read_b64_tr_b16 a[40:41], v3 offset:2048
    v_mfma_f32_16x16x32_bf16 v[184:187], v[136:139], a[12:15], v[184:187]
    ds_read_b64_tr_b16 a[42:43], v3 offset:39488
    v_mfma_f32_16x16x32_bf16 v[188:191], v[132:135], a[8:11], v[188:191]
    s_lshl_b32 s74, s63, 20
    ds_read_b64_tr_b16 a[44:45], v7 offset:11392
    buffer_load_dwordx4 v15, s[12:15], s72 offen offset:1024 lds
    v_mfma_f32_16x16x32_bf16 v[188:191], v[140:143], a[12:15], v[188:191]
    s_waitcnt lgkmcnt(7)
    ds_read_b64_tr_b16 a[46:47], v7 offset:48832
    v_mfma_f32_16x16x32_bf16 v[192:195], v[128:131], a[16:19], v[192:195]
    s_add_u32 s46, s81, 128
    ds_read_b64_tr_b16 a[0:1], v4 offset:2048
    v_mfma_f32_16x16x32_bf16 v[192:195], v[136:139], a[20:23], v[192:195]
    s_min_u32 s46, s46, 215
    ds_read_b64_tr_b16 a[2:3], v4 offset:39488
    v_mfma_f32_16x16x32_bf16 v[196:199], v[132:135], a[16:19], v[196:199]
    s_mul_i32 s82, s46, 21846
    ds_read_b64_tr_b16 a[4:5], v8 offset:11392
    v_mfma_f32_16x16x32_bf16 v[196:199], v[140:143], a[20:23], v[196:199]
    s_lshr_b32 s82, s82, 16
    ds_read_b64_tr_b16 a[6:7], v8 offset:48832
    v_mfma_f32_16x16x32_bf16 v[200:203], v[128:131], a[24:27], v[200:203]
    s_mul_i32 s82, s82, 27264
    ds_read_b64_tr_b16 a[8:9], v5 offset:2048
    v_mfma_f32_16x16x32_bf16 v[200:203], v[136:139], a[28:31], v[200:203]
    s_mul_i32 s46, s46, 128
    ds_read_b64_tr_b16 a[10:11], v5 offset:39488
    v_mfma_f32_16x16x32_bf16 v[204:207], v[132:135], a[24:27], v[204:207]
    s_add_u32 s46, s46, s82
    ds_read_b64_tr_b16 a[12:13], v9 offset:11392
    v_mfma_f32_16x16x32_bf16 v[204:207], v[140:143], a[28:31], v[204:207]
    s_waitcnt lgkmcnt(7)
    ds_read_b64_tr_b16 a[14:15], v9 offset:48832
    v_mfma_f32_16x16x32_bf16 v[208:211], v[128:131], a[32:35], v[208:211]
    s_add_u32 s46, s46, s47
    ds_read_b64_tr_b16 a[16:17], v2 offset:4096
    buffer_load_dwordx4 a[208:211], v14, s[12:15], s46 offen offset:0
    v_mfma_f32_16x16x32_bf16 v[208:211], v[136:139], a[36:39], v[208:211]
    s_add_u32 m0, s67, 26624
    ds_read_b64_tr_b16 a[18:19], v2 offset:41536
    v_mfma_f32_16x16x32_bf16 v[212:215], v[132:135], a[32:35], v[212:215]
    s_add_u32 s72, s73, 222464
    ds_read_b64_tr_b16 a[20:21], v6 offset:13440
    buffer_load_dwordx4 v14, s[12:15], s72 offen lds
    v_mfma_f32_16x16x32_bf16 v[212:215], v[140:143], a[36:39], v[212:215]
    s_waitcnt vmcnt(18)
    ds_read_b64_tr_b16 a[22:23], v6 offset:50880
    v_mfma_f32_16x16x32_bf16 v[216:219], v[128:131], a[40:43], v[216:219]
    s_barrier
    ds_read_b64_tr_b16 a[24:25], v2 offset:6144
    v_mfma_f32_16x16x32_bf16 v[216:219], v[136:139], a[44:47], v[216:219]
    s_add_u32 s74, s74, 0x28a0000
    ds_read_b64_tr_b16 a[26:27], v2 offset:43584
    buffer_load_dwordx4 v15, s[12:15], s72 offen offset:1024 lds
    v_mfma_f32_16x16x32_bf16 v[220:223], v[132:135], a[40:43], v[220:223]
    s_lshr_b32 s68, s81, 1
    ds_read_b64_tr_b16 a[28:29], v6 offset:15488
    v_mfma_f32_16x16x32_bf16 v[220:223], v[140:143], a[44:47], v[220:223]
    s_waitcnt lgkmcnt(7)
    ds_read_b64_tr_b16 a[30:31], v6 offset:52928
    v_mfma_f32_16x16x32_bf16 v[224:227], v[128:131], a[0:3], v[224:227]
    s_add_u32 m0, s67, 28672
    ds_read_b64_tr_b16 a[32:33], v3 offset:6144
    v_mfma_f32_16x16x32_bf16 v[224:227], v[136:139], a[4:7], v[224:227]
    s_add_u32 s72, s73, 222592
    ds_read_b64_tr_b16 a[34:35], v3 offset:43584
    buffer_load_dwordx4 v14, s[12:15], s72 offen lds
    v_mfma_f32_16x16x32_bf16 v[228:231], v[132:135], a[0:3], v[228:231]
    s_add_u32 s46, s81, 192
    ds_read_b64_tr_b16 a[36:37], v7 offset:15488
    v_mfma_f32_16x16x32_bf16 v[228:231], v[140:143], a[4:7], v[228:231]
    s_min_u32 s46, s46, 215
    ds_read_b64_tr_b16 a[38:39], v7 offset:52928
    v_mfma_f32_16x16x32_bf16 v[232:235], v[128:131], a[8:11], v[232:235]
    s_mul_i32 s82, s46, 21846
    ds_read_b64_tr_b16 a[40:41], v4 offset:6144
    v_mfma_f32_16x16x32_bf16 v[232:235], v[136:139], a[12:15], v[232:235]
    s_lshr_b32 s82, s82, 16
    ds_read_b64_tr_b16 a[42:43], v4 offset:43584
    v_mfma_f32_16x16x32_bf16 v[236:239], v[132:135], a[8:11], v[236:239]
    s_mul_i32 s82, s82, 27264
    ds_read_b64_tr_b16 a[44:45], v8 offset:15488
    v_mfma_f32_16x16x32_bf16 v[236:239], v[140:143], a[12:15], v[236:239]
    s_waitcnt lgkmcnt(7)
    ds_read_b64_tr_b16 a[46:47], v8 offset:52928
    v_mfma_f32_16x16x32_bf16 v[240:243], v[128:131], a[16:19], v[240:243]
    s_mul_i32 s46, s46, 128
    ds_read_b64_tr_b16 a[0:1], v5 offset:6144
    v_mfma_f32_16x16x32_bf16 v[240:243], v[136:139], a[20:23], v[240:243]
    s_add_u32 s46, s46, s82
    ds_read_b64_tr_b16 a[2:3], v5 offset:43584
    v_mfma_f32_16x16x32_bf16 v[244:247], v[132:135], a[16:19], v[244:247]
    s_add_u32 s46, s46, s47
    ds_read_b64_tr_b16 a[4:5], v9 offset:15488
    buffer_load_dwordx4 a[212:215], v14, s[12:15], s46 offen offset:0
    v_mfma_f32_16x16x32_bf16 v[244:247], v[140:143], a[20:23], v[244:247]
    s_lshl_b32 s83, s68, 10
    s_and_b32 s68, s81, 1
    s_lshl_b32 s68, s68, 8
    s_add_u32 s83, s83, s68
    s_add_u32 s83, s83, s74
    s_lshl_b32 s90, s62, 2
    s_add_u32 s90, s90, s63
    ds_read_b64_tr_b16 a[6:7], v9 offset:52928
    buffer_load_dwordx4 v15, s[12:15], s72 offen offset:1024 lds
    v_mfma_f32_16x16x32_bf16 v[176:179], v[144:147], a[24:27], v[176:179]
    s_mul_i32 s91, s62, 36864
    ds_read_b64_tr_b16 a[8:9], v2 offset:8192
    v_mfma_f32_16x16x32_bf16 v[176:179], v[152:155], a[28:31], v[176:179]
    ds_read_b64_tr_b16 a[10:11], v2 offset:45632
    v_mfma_f32_16x16x32_bf16 v[180:183], v[148:151], a[24:27], v[180:183]
    s_add_u32 m0, s67, 30720
    ds_read_b64_tr_b16 a[12:13], v6 offset:17536
    v_mfma_f32_16x16x32_bf16 v[180:183], v[156:159], a[28:31], v[180:183]
    s_waitcnt lgkmcnt(7)
    ds_read_b64_tr_b16 a[14:15], v6 offset:54976
    v_mfma_f32_16x16x32_bf16 v[184:187], v[144:147], a[32:35], v[184:187]
    s_add_u32 s72, s73, 443520
    ds_read_b64_tr_b16 a[16:17], v3 offset:8192
    buffer_load_dwordx4 v14, s[12:15], s72 offen lds
    v_mfma_f32_16x16x32_bf16 v[184:187], v[152:155], a[36:39], v[184:187]
    s_mul_i32 s68, s63, 9
    ds_read_b64_tr_b16 a[18:19], v3 offset:45632
    v_mfma_f32_16x16x32_bf16 v[188:191], v[148:151], a[32:35], v[188:191]
    s_lshr_b32 s68, s68, 1
    ds_read_b64_tr_b16 a[20:21], v7 offset:17536
    v_mfma_f32_16x16x32_bf16 v[188:191], v[156:159], a[36:39], v[188:191]
    ds_read_b64_tr_b16 a[22:23], v7 offset:54976
    v_mfma_f32_16x16x32_bf16 v[192:195], v[144:147], a[40:43], v[192:195]
    ds_read_b64_tr_b16 a[24:25], v4 offset:8192
    v_mfma_f32_16x16x32_bf16 v[192:195], v[152:155], a[44:47], v[192:195]
    s_lshl_b32 s68, s68, 11
    ds_read_b64_tr_b16 a[26:27], v4 offset:45632
    buffer_load_dwordx4 v15, s[12:15], s72 offen offset:1024 lds
    v_mfma_f32_16x16x32_bf16 v[196:199], v[148:151], a[40:43], v[196:199]
    ds_read_b64_tr_b16 a[28:29], v8 offset:17536
    v_mfma_f32_16x16x32_bf16 v[196:199], v[156:159], a[44:47], v[196:199]
    s_waitcnt lgkmcnt(7)
    ds_read_b64_tr_b16 a[30:31], v8 offset:54976
    v_mfma_f32_16x16x32_bf16 v[200:203], v[144:147], a[0:3], v[200:203]
    s_add_u32 s91, s91, s68
    ds_read_b64_tr_b16 a[32:33], v5 offset:8192
    v_mfma_f32_16x16x32_bf16 v[200:203], v[152:155], a[4:7], v[200:203]
    ds_read_b64_tr_b16 a[34:35], v5 offset:45632
    v_mfma_f32_16x16x32_bf16 v[204:207], v[148:151], a[0:3], v[204:207]
    s_add_u32 m0, s67, 32768
    ds_read_b64_tr_b16 a[36:37], v9 offset:17536
    v_mfma_f32_16x16x32_bf16 v[204:207], v[156:159], a[4:7], v[204:207]
    s_add_u32 s72, s73, 443648
    ds_read_b64_tr_b16 a[38:39], v9 offset:54976
    buffer_load_dwordx4 v14, s[12:15], s72 offen lds
    v_mfma_f32_16x16x32_bf16 v[208:211], v[144:147], a[8:11], v[208:211]
    s_add_u32 s91, s91, s96
    ds_read_b64_tr_b16 a[40:41], v2 offset:10240
    v_mfma_f32_16x16x32_bf16 v[208:211], v[152:155], a[12:15], v[208:211]
    ds_read_b64_tr_b16 a[42:43], v2 offset:47680
    v_mfma_f32_16x16x32_bf16 v[212:215], v[148:151], a[8:11], v[212:215]
    s_add_u32 s91, s91, 0x5000
    ds_read_b64_tr_b16 a[44:45], v6 offset:19584
    v_mfma_f32_16x16x32_bf16 v[212:215], v[156:159], a[12:15], v[212:215]
    s_waitcnt vmcnt(19) lgkmcnt(7)
    ds_read_b64_tr_b16 a[46:47], v6 offset:57024
    v_mfma_f32_16x16x32_bf16 v[216:219], v[144:147], a[16:19], v[216:219]
    s_barrier
    ds_read_b64_tr_b16 a[0:1], v2 offset:12288
    v_mfma_f32_16x16x32_bf16 v[216:219], v[152:155], a[20:23], v[216:219]
    s_lshl_b32 s90, s90, 7
    ds_read_b64_tr_b16 a[2:3], v2 offset:49728
    buffer_load_dwordx4 v15, s[12:15], s72 offen offset:1024 lds
    v_mfma_f32_16x16x32_bf16 v[220:223], v[148:151], a[16:19], v[220:223]
    ds_read_b64_tr_b16 a[4:5], v6 offset:21632
    v_mfma_f32_16x16x32_bf16 v[220:223], v[156:159], a[20:23], v[220:223]
    ds_read_b64_tr_b16 a[6:7], v6 offset:59072
    v_mfma_f32_16x16x32_bf16 v[224:227], v[144:147], a[24:27], v[224:227]
    s_add_u32 s90, s90, s96
    ds_read_b64_tr_b16 a[8:9], v3 offset:12288
    v_mfma_f32_16x16x32_bf16 v[224:227], v[152:155], a[28:31], v[224:227]
    ds_read_b64_tr_b16 a[10:11], v3 offset:49728
    v_mfma_f32_16x16x32_bf16 v[228:231], v[148:151], a[24:27], v[228:231]
    s_add_u32 m0, s67, 34816
    ds_read_b64_tr_b16 a[12:13], v7 offset:21632
    v_mfma_f32_16x16x32_bf16 v[228:231], v[156:159], a[28:31], v[228:231]
    s_waitcnt lgkmcnt(7)
    ds_read_b64_tr_b16 a[14:15], v7 offset:59072
    v_mfma_f32_16x16x32_bf16 v[232:235], v[144:147], a[32:35], v[232:235]
    s_add_u32 s72, s73, 443776
    ds_read_b64_tr_b16 a[16:17], v4 offset:12288
    buffer_load_dwordx4 v14, s[12:15], s72 offen lds
    v_mfma_f32_16x16x32_bf16 v[232:235], v[152:155], a[36:39], v[232:235]
    s_add_u32 s90, s90, 8320
    ds_read_b64_tr_b16 a[18:19], v4 offset:49728
    v_mfma_f32_16x16x32_bf16 v[236:239], v[148:151], a[32:35], v[236:239]
    ds_read_b64_tr_b16 a[20:21], v8 offset:21632
    v_lshlrev_b32 v19, 3, v1
    v_mfma_f32_16x16x32_bf16 v[236:239], v[156:159], a[36:39], v[236:239]
    ds_read_b64_tr_b16 a[22:23], v8 offset:59072
    v_mfma_f32_16x16x32_bf16 v[240:243], v[144:147], a[40:43], v[240:243]
    ds_read_b64_tr_b16 a[24:25], v5 offset:12288
    v_mfma_f32_16x16x32_bf16 v[240:243], v[152:155], a[44:47], v[240:243]
    ds_read_b64_tr_b16 a[26:27], v5 offset:49728
    buffer_load_dwordx4 v15, s[12:15], s72 offen offset:1024 lds
    v_mfma_f32_16x16x32_bf16 v[244:247], v[148:151], a[40:43], v[244:247]
    ds_read_b64_tr_b16 a[28:29], v9 offset:21632
    v_and_b32 v16, 31, v1
    v_mfma_f32_16x16x32_bf16 v[244:247], v[156:159], a[44:47], v[244:247]
    s_waitcnt lgkmcnt(7)
    ds_read_b64_tr_b16 a[30:31], v9 offset:59072
    v_mfma_f32_16x16x32_bf16 v[176:179], v[160:163], a[0:3], v[176:179]
    ds_read_b64_tr_b16 a[32:33], v2 offset:14336
    v_lshlrev_b32 v16, 3, v16
    v_mfma_f32_16x16x32_bf16 v[176:179], v[168:171], a[4:7], v[176:179]
    ds_read_b64_tr_b16 a[34:35], v2 offset:51776
    v_mfma_f32_16x16x32_bf16 v[180:183], v[164:167], a[0:3], v[180:183]
    s_add_u32 m0, s67, 0
    ds_read_b64_tr_b16 a[36:37], v6 offset:23680
    v_mfma_f32_16x16x32_bf16 v[180:183], v[172:175], a[4:7], v[180:183]
    s_add_u32 s72, s73, 664704
    ds_read_b64_tr_b16 a[38:39], v6 offset:61120
    buffer_load_dwordx4 v14, s[12:15], s72 offen lds
    v_mfma_f32_16x16x32_bf16 v[184:187], v[160:163], a[8:11], v[184:187]
    ds_read_b64_tr_b16 a[40:41], v3 offset:14336
    v_mfma_f32_16x16x32_bf16 v[184:187], v[168:171], a[12:15], v[184:187]
    ds_read_b64_tr_b16 a[42:43], v3 offset:51776
    v_lshrrev_b32 v17, 5, v1
    v_mfma_f32_16x16x32_bf16 v[188:191], v[164:167], a[8:11], v[188:191]
    ds_read_b64_tr_b16 a[44:45], v7 offset:23680
    v_mfma_f32_16x16x32_bf16 v[188:191], v[172:175], a[12:15], v[188:191]
    s_waitcnt lgkmcnt(7)
    ds_read_b64_tr_b16 a[46:47], v7 offset:61120
    v_mfma_f32_16x16x32_bf16 v[192:195], v[160:163], a[16:19], v[192:195]
    ds_read_b64_tr_b16 a[0:1], v4 offset:14336
    v_mfma_f32_16x16x32_bf16 v[192:195], v[168:171], a[20:23], v[192:195]
    ds_read_b64_tr_b16 a[2:3], v4 offset:51776
    buffer_load_dwordx4 v15, s[12:15], s72 offen offset:1024 lds
    v_mfma_f32_16x16x32_bf16 v[196:199], v[164:167], a[16:19], v[196:199]
    ds_read_b64_tr_b16 a[4:5], v8 offset:23680
    v_lshl_add_u32 v16, v17, 9, v16
    v_mfma_f32_16x16x32_bf16 v[196:199], v[172:175], a[20:23], v[196:199]
    ds_read_b64_tr_b16 a[6:7], v8 offset:61120
    v_mfma_f32_16x16x32_bf16 v[200:203], v[160:163], a[24:27], v[200:203]
    ds_read_b64_tr_b16 a[8:9], v5 offset:14336
    v_mfma_f32_16x16x32_bf16 v[200:203], v[168:171], a[28:31], v[200:203]
    ds_read_b64_tr_b16 a[10:11], v5 offset:51776
    v_mfma_f32_16x16x32_bf16 v[204:207], v[164:167], a[24:27], v[204:207]
    s_add_u32 m0, s67, 2048
    ds_read_b64_tr_b16 a[12:13], v9 offset:23680
    v_mfma_f32_16x16x32_bf16 v[204:207], v[172:175], a[28:31], v[204:207]
    s_waitcnt lgkmcnt(7)
    ds_read_b64_tr_b16 a[14:15], v9 offset:61120
    v_mfma_f32_16x16x32_bf16 v[208:211], v[160:163], a[32:35], v[208:211]
    s_add_u32 s72, s73, 664832
    ds_read_b64_tr_b16 a[16:17], v2 offset:16384
    buffer_load_dwordx4 v14, s[12:15], s72 offen lds
    v_mfma_f32_16x16x32_bf16 v[208:211], v[168:171], a[36:39], v[208:211]
    s_sub_u32 s68, s85, s84
    ds_read_b64_tr_b16 a[18:19], v2 offset:53824
    v_mfma_f32_16x16x32_bf16 v[212:215], v[164:167], a[32:35], v[212:215]
    ds_read_b64_tr_b16 a[20:21], v6 offset:25728
    v_mfma_f32_16x16x32_bf16 v[212:215], v[172:175], a[36:39], v[212:215]
    s_waitcnt vmcnt(17)
    ds_read_b64_tr_b16 a[22:23], v6 offset:63168
    v_mfma_f32_16x16x32_bf16 v[216:219], v[160:163], a[40:43], v[216:219]
    s_barrier
    ds_read_b64_tr_b16 a[24:25], v2 offset:18432
    v_mfma_f32_16x16x32_bf16 v[216:219], v[168:171], a[44:47], v[216:219]
    ds_read_b64_tr_b16 a[26:27], v2 offset:55872
    buffer_load_dwordx4 v15, s[12:15], s72 offen offset:1024 lds
    v_mfma_f32_16x16x32_bf16 v[220:223], v[164:167], a[40:43], v[220:223]
    ds_read_b64_tr_b16 a[28:29], v6 offset:27776
    v_mul_lo_u32 v17, v17, s68
    v_mfma_f32_16x16x32_bf16 v[220:223], v[172:175], a[44:47], v[220:223]
    s_waitcnt lgkmcnt(7)
    ds_read_b64_tr_b16 a[30:31], v6 offset:65216
    v_mfma_f32_16x16x32_bf16 v[224:227], v[160:163], a[0:3], v[224:227]
    ds_read_b64_tr_b16 a[32:33], v3 offset:18432
    v_mfma_f32_16x16x32_bf16 v[224:227], v[168:171], a[4:7], v[224:227]
    ds_read_b64_tr_b16 a[34:35], v3 offset:55872
    v_and_b32 v27, 0x1f0, v18
    v_mfma_f32_16x16x32_bf16 v[228:231], v[164:167], a[0:3], v[228:231]
    s_add_u32 m0, s67, 4096
    ds_read_b64_tr_b16 a[36:37], v7 offset:27776
    v_mfma_f32_16x16x32_bf16 v[228:231], v[172:175], a[4:7], v[228:231]
    s_add_u32 s72, s73, 664960
    ds_read_b64_tr_b16 a[38:39], v7 offset:65216
    buffer_load_dwordx4 v14, s[12:15], s72 offen lds
    v_mfma_f32_16x16x32_bf16 v[232:235], v[160:163], a[8:11], v[232:235]
    ds_read_b64_tr_b16 a[40:41], v4 offset:18432
    v_mfma_f32_16x16x32_bf16 v[232:235], v[168:171], a[12:15], v[232:235]
    ds_read_b64_tr_b16 a[42:43], v4 offset:55872
    v_mfma_f32_16x16x32_bf16 v[236:239], v[164:167], a[8:11], v[236:239]
    ds_read_b64_tr_b16 a[44:45], v8 offset:27776
    v_add_u32 v17, v17, v27
    v_mfma_f32_16x16x32_bf16 v[236:239], v[172:175], a[12:15], v[236:239]
    s_waitcnt lgkmcnt(7)
    ds_read_b64_tr_b16 a[46:47], v8 offset:65216
    v_mfma_f32_16x16x32_bf16 v[240:243], v[160:163], a[16:19], v[240:243]
    ds_read_b64_tr_b16 a[0:1], v5 offset:18432
    v_mfma_f32_16x16x32_bf16 v[240:243], v[168:171], a[20:23], v[240:243]
    ds_read_b64_tr_b16 a[2:3], v5 offset:55872
    buffer_load_dwordx4 v15, s[12:15], s72 offen offset:1024 lds
    v_mfma_f32_16x16x32_bf16 v[244:247], v[164:167], a[16:19], v[244:247]
    ds_read_b64_tr_b16 a[4:5], v9 offset:27776
    v_mfma_f32_16x16x32_bf16 v[244:247], v[172:175], a[20:23], v[244:247]
    ds_read_b64_tr_b16 a[6:7], v9 offset:65216
    v_exp_f32 v248, v176 clamp
    v_exp_f32 v249, v177 clamp
    v_exp_f32 v250, v178 clamp
    v_exp_f32 v251, v179 clamp
    v_max_f32 v176, 0x35c1a2a0, v176
    v_max_f32 v177, 0x35c1a2a0, v177
    v_max_f32 v178, 0x35c1a2a0, v178
    v_mov_b32 v252, -1
    v_max_f32 v179, 0x35c1a2a0, v179
    v_fma_f32 v176, v176, s27, v248
    v_fma_f32 v177, v177, s27, v249
    v_fma_f32 v178, v178, s27, v250
    v_fma_f32 v179, v179, s27, v251
    v_cvt_pk_bf16_f32 v176, v176, v177
    v_cvt_pk_bf16_f32 v177, v178, v179
    v_accvgpr_write_b32 a48, v176
    v_accvgpr_write_b32 a49, v177
    v_exp_f32 v248, v180 clamp
    v_exp_f32 v249, v181 clamp
    v_exp_f32 v250, v182 clamp
    v_exp_f32 v251, v183 clamp
    v_mov_b32 v253, -1
    v_max_f32 v180, 0x35c1a2a0, v180
    v_max_f32 v181, 0x35c1a2a0, v181
    v_max_f32 v182, 0x35c1a2a0, v182
    v_max_f32 v183, 0x35c1a2a0, v183
    v_fma_f32 v180, v180, s27, v248
    v_fma_f32 v181, v181, s27, v249
    v_fma_f32 v182, v182, s27, v250
    v_fma_f32 v183, v183, s27, v251
L_pad_a2_0:
    s_cbranch_execz L_pad_a2_1
    v_cvt_pk_bf16_f32 v180, v180, v181
    v_cvt_pk_bf16_f32 v181, v182, v183
    v_accvgpr_write_b32 a50, v180
    v_accvgpr_write_b32 a51, v181
    v_exp_f32 v248, v184 clamp
    v_exp_f32 v249, v185 clamp
    v_mov_b32 v254, -1
    v_exp_f32 v250, v186 clamp
    v_exp_f32 v251, v187 clamp
    v_max_f32 v184, 0x35c1a2a0, v184
    v_max_f32 v185, 0x35c1a2a0, v185
    v_max_f32 v186, 0x35c1a2a0, v186
    v_max_f32 v187, 0x35c1a2a0, v187
    v_fma_f32 v184, v184, s27, v248
    v_fma_f32 v185, v185, s27, v249
    v_fma_f32 v186, v186, s27, v250
    v_fma_f32 v187, v187, s27, v251
    v_cvt_pk_bf16_f32 v184, v184, v185
    v_cvt_pk_bf16_f32 v185, v186, v187
    v_accvgpr_write_b32 a52, v184
    v_accvgpr_write_b32 a53, v185
    v_mov_b32 v255, -1
    v_exp_f32 v248, v188 clamp
    v_exp_f32 v249, v189 clamp
    v_exp_f32 v250, v190 clamp
    v_exp_f32 v251, v191 clamp
    v_max_f32 v188, 0x35c1a2a0, v188
    v_max_f32 v189, 0x35c1a2a0, v189
    v_max_f32 v190, 0x35c1a2a0, v190
    v_max_f32 v191, 0x35c1a2a0, v191
    v_fma_f32 v188, v188, s27, v248
    v_fma_f32 v189, v189, s27, v249
    v_fma_f32 v190, v190, s27, v250
    v_fma_f32 v191, v191, s27, v251
    v_cvt_pk_bf16_f32 v188, v188, v189
    s_add_u32 s68, s79, 4096
    v_cvt_pk_bf16_f32 v189, v190, v191
    v_accvgpr_write_b32 a54, v188
    v_accvgpr_write_b32 a55, v189
    v_exp_f32 v248, v192 clamp
    v_exp_f32 v249, v193 clamp
    v_exp_f32 v250, v194 clamp
    v_exp_f32 v251, v195 clamp
    v_max_f32 v192, 0x35c1a2a0, v192
    v_max_f32 v193, 0x35c1a2a0, v193
    v_max_f32 v194, 0x35c1a2a0, v194
    v_max_f32 v195, 0x35c1a2a0, v195
    v_fma_f32 v192, v192, s27, v248
    v_fma_f32 v193, v193, s27, v249
    v_fma_f32 v194, v194, s27, v250
    s_add_u32 s69, s79, 8192
    v_fma_f32 v195, v195, s27, v251
    v_cvt_pk_bf16_f32 v192, v192, v193
    v_cvt_pk_bf16_f32 v193, v194, v195
    v_accvgpr_write_b32 a56, v192
    v_accvgpr_write_b32 a57, v193
    v_exp_f32 v248, v196 clamp
    v_exp_f32 v249, v197 clamp
    v_exp_f32 v250, v198 clamp
    v_exp_f32 v251, v199 clamp
    v_max_f32 v196, 0x35c1a2a0, v196
    v_max_f32 v197, 0x35c1a2a0, v197
    v_max_f32 v198, 0x35c1a2a0, v198
    v_max_f32 v199, 0x35c1a2a0, v199
    v_fma_f32 v196, v196, s27, v248
    buffer_store_dwordx4 v[252:255], v18, s[20:23], s79 offen offset:0 sc1
    v_fma_f32 v197, v197, s27, v249
    v_fma_f32 v198, v198, s27, v250
    v_fma_f32 v199, v199, s27, v251
    v_cvt_pk_bf16_f32 v196, v196, v197
    v_cvt_pk_bf16_f32 v197, v198, v199
    v_accvgpr_write_b32 a58, v196
    v_accvgpr_write_b32 a59, v197
    v_exp_f32 v248, v200 clamp
    v_exp_f32 v249, v201 clamp
    v_exp_f32 v250, v202 clamp
    v_exp_f32 v251, v203 clamp
    v_max_f32 v200, 0x35c1a2a0, v200
    v_max_f32 v201, 0x35c1a2a0, v201
    buffer_store_dwordx4 v[252:255], v18, s[20:23], s79 offen offset:1024 sc1
    v_max_f32 v202, 0x35c1a2a0, v202
    v_max_f32 v203, 0x35c1a2a0, v203
    v_fma_f32 v200, v200, s27, v248
    v_fma_f32 v201, v201, s27, v249
    v_fma_f32 v202, v202, s27, v250
    v_fma_f32 v203, v203, s27, v251
    v_cvt_pk_bf16_f32 v200, v200, v201
    v_cvt_pk_bf16_f32 v201, v202, v203
    v_accvgpr_write_b32 a60, v200
    v_accvgpr_write_b32 a61, v201
    v_exp_f32 v248, v204 clamp
    v_exp_f32 v249, v205 clamp
    v_exp_f32 v250, v206 clamp
    v_exp_f32 v251, v207 clamp
    buffer_store_dwordx4 v[252:255], v18, s[20:23], s79 offen offset:2048 sc1
    v_max_f32 v204, 0x35c1a2a0, v204
    v_max_f32 v205, 0x35c1a2a0, v205
    v_max_f32 v206, 0x35c1a2a0, v206
    v_max_f32 v207, 0x35c1a2a0, v207
    v_fma_f32 v204, v204, s27, v248
    v_fma_f32 v205, v205, s27, v249
    v_fma_f32 v206, v206, s27, v250
    v_fma_f32 v207, v207, s27, v251
    v_cvt_pk_bf16_f32 v204, v204, v205
    v_cvt_pk_bf16_f32 v205, v206, v207
    v_accvgpr_write_b32 a62, v204
    v_accvgpr_write_b32 a63, v205
    v_exp_f32 v248, v208 clamp
    v_exp_f32 v249, v209 clamp
    buffer_store_dwordx4 v[252:255], v18, s[20:23], s79 offen offset:3072 sc1
    v_exp_f32 v250, v210 clamp
    v_exp_f32 v251, v211 clamp
    v_max_f32 v208, 0x35c1a2a0, v208
    v_max_f32 v209, 0x35c1a2a0, v209
    v_max_f32 v210, 0x35c1a2a0, v210
    v_max_f32 v211, 0x35c1a2a0, v211
    v_fma_f32 v208, v208, s27, v248
    v_fma_f32 v209, v209, s27, v249
    v_fma_f32 v210, v210, s27, v250
    v_fma_f32 v211, v211, s27, v251
    v_cvt_pk_bf16_f32 v208, v208, v209
    v_cvt_pk_bf16_f32 v209, v210, v211
    v_accvgpr_write_b32 a64, v208
    buffer_store_dwordx4 v[252:255], v18, s[20:23], s68 offen offset:0 sc1
    v_accvgpr_write_b32 a65, v209
    v_exp_f32 v248, v212 clamp
    v_exp_f32 v249, v213 clamp
    v_exp_f32 v250, v214 clamp
    v_exp_f32 v251, v215 clamp
    v_max_f32 v212, 0x35c1a2a0, v212
    v_max_f32 v213, 0x35c1a2a0, v213
    v_max_f32 v214, 0x35c1a2a0, v214
    v_max_f32 v215, 0x35c1a2a0, v215
    v_fma_f32 v212, v212, s27, v248
    v_fma_f32 v213, v213, s27, v249
    v_fma_f32 v214, v214, s27, v250
    v_fma_f32 v215, v215, s27, v251
    v_cvt_pk_bf16_f32 v212, v212, v213
    buffer_store_dwordx4 v[252:255], v18, s[20:23], s68 offen offset:1024 sc1
    v_cvt_pk_bf16_f32 v213, v214, v215
    v_accvgpr_write_b32 a66, v212
    v_accvgpr_write_b32 a67, v213
    v_exp_f32 v248, v216 clamp
    v_exp_f32 v249, v217 clamp
    v_exp_f32 v250, v218 clamp
    v_exp_f32 v251, v219 clamp
    v_max_f32 v216, 0x35c1a2a0, v216
    v_max_f32 v217, 0x35c1a2a0, v217
    v_max_f32 v218, 0x35c1a2a0, v218
    v_max_f32 v219, 0x35c1a2a0, v219
    v_fma_f32 v216, v216, s27, v248
    v_fma_f32 v217, v217, s27, v249
    buffer_store_dwordx4 v[252:255], v18, s[20:23], s68 offen offset:2048 sc1
    v_fma_f32 v218, v218, s27, v250
    v_fma_f32 v219, v219, s27, v251
    v_cvt_pk_bf16_f32 v216, v216, v217
    v_cvt_pk_bf16_f32 v217, v218, v219
    v_accvgpr_write_b32 a68, v216
    v_accvgpr_write_b32 a69, v217
    v_exp_f32 v248, v220 clamp
    v_exp_f32 v249, v221 clamp
    v_exp_f32 v250, v222 clamp
    v_exp_f32 v251, v223 clamp
    v_max_f32 v220, 0x35c1a2a0, v220
    v_max_f32 v221, 0x35c1a2a0, v221
    v_max_f32 v222, 0x35c1a2a0, v222
    v_max_f32 v223, 0x35c1a2a0, v223
    buffer_store_dwordx4 v[252:255], v18, s[20:23], s68 offen offset:3072 sc1
    v_fma_f32 v220, v220, s27, v248
    v_fma_f32 v221, v221, s27, v249
    v_fma_f32 v222, v222, s27, v250
    v_fma_f32 v223, v223, s27, v251
    v_cvt_pk_bf16_f32 v220, v220, v221
    v_cvt_pk_bf16_f32 v221, v222, v223
    v_accvgpr_write_b32 a70, v220
    v_accvgpr_write_b32 a71, v221
    v_exp_f32 v248, v224 clamp
    v_exp_f32 v249, v225 clamp
    v_exp_f32 v250, v226 clamp
    v_exp_f32 v251, v227 clamp
    v_max_f32 v224, 0x35c1a2a0, v224
    v_max_f32 v225, 0x35c1a2a0, v225
    buffer_store_dwordx4 v[252:255], v18, s[20:23], s69 offen offset:0 sc1
    v_max_f32 v226, 0x35c1a2a0, v226
    v_max_f32 v227, 0x35c1a2a0, v227
    v_fma_f32 v224, v224, s27, v248
    v_fma_f32 v225, v225, s27, v249
    v_fma_f32 v226, v226, s27, v250
    v_fma_f32 v227, v227, s27, v251
    v_cvt_pk_bf16_f32 v224, v224, v225
    v_cvt_pk_bf16_f32 v225, v226, v227
    v_accvgpr_write_b32 a72, v224
    v_accvgpr_write_b32 a73, v225
    v_exp_f32 v248, v228 clamp
    v_exp_f32 v249, v229 clamp
    v_exp_f32 v250, v230 clamp
    buffer_store_dwordx4 v[252:255], v18, s[20:23], s69 offen offset:1024 sc1
    v_exp_f32 v251, v231 clamp
    v_max_f32 v228, 0x35c1a2a0, v228
    v_max_f32 v229, 0x35c1a2a0, v229
    v_max_f32 v230, 0x35c1a2a0, v230
    v_max_f32 v231, 0x35c1a2a0, v231
    v_fma_f32 v228, v228, s27, v248
    v_fma_f32 v229, v229, s27, v249
    v_fma_f32 v230, v230, s27, v250
    v_fma_f32 v231, v231, s27, v251
    v_cvt_pk_bf16_f32 v228, v228, v229
    v_cvt_pk_bf16_f32 v229, v230, v231
    v_accvgpr_write_b32 a74, v228
    v_accvgpr_write_b32 a75, v229
    v_exp_f32 v248, v232 clamp
    s_add_u32 s68, s91, 4096
    v_exp_f32 v249, v233 clamp
    v_exp_f32 v250, v234 clamp
    v_exp_f32 v251, v235 clamp
    v_max_f32 v232, 0x35c1a2a0, v232
    v_max_f32 v233, 0x35c1a2a0, v233
    v_max_f32 v234, 0x35c1a2a0, v234
    v_max_f32 v235, 0x35c1a2a0, v235
    v_fma_f32 v232, v232, s27, v248
    v_fma_f32 v233, v233, s27, v249
    v_fma_f32 v234, v234, s27, v250
    v_fma_f32 v235, v235, s27, v251
    v_cvt_pk_bf16_f32 v232, v232, v233
    v_cvt_pk_bf16_f32 v233, v234, v235
    v_accvgpr_write_b32 a76, v232
    s_add_u32 s69, s91, 8192
    v_accvgpr_write_b32 a77, v233
    v_exp_f32 v248, v236 clamp
    v_exp_f32 v249, v237 clamp
    v_exp_f32 v250, v238 clamp
    v_exp_f32 v251, v239 clamp
    v_max_f32 v236, 0x35c1a2a0, v236
    v_max_f32 v237, 0x35c1a2a0, v237
    v_max_f32 v238, 0x35c1a2a0, v238
    v_max_f32 v239, 0x35c1a2a0, v239
    v_fma_f32 v236, v236, s27, v248
    v_fma_f32 v237, v237, s27, v249
    v_fma_f32 v238, v238, s27, v250
    v_fma_f32 v239, v239, s27, v251
    buffer_store_dwordx2 v[252:253], v16, s[20:23], s83 offen sc1
    v_cvt_pk_bf16_f32 v236, v236, v237
    v_cvt_pk_bf16_f32 v237, v238, v239
    v_accvgpr_write_b32 a78, v236
    v_accvgpr_write_b32 a79, v237
    v_exp_f32 v248, v240 clamp
    v_exp_f32 v249, v241 clamp
    v_exp_f32 v250, v242 clamp
    v_exp_f32 v251, v243 clamp
    v_max_f32 v240, 0x35c1a2a0, v240
    v_max_f32 v241, 0x35c1a2a0, v241
    v_max_f32 v242, 0x35c1a2a0, v242
    v_max_f32 v243, 0x35c1a2a0, v243
    v_fma_f32 v240, v240, s27, v248
    v_fma_f32 v241, v241, s27, v249
    v_fma_f32 v242, v242, s27, v250
    v_fma_f32 v243, v243, s27, v251
    v_cvt_pk_bf16_f32 v240, v240, v241
    v_cvt_pk_bf16_f32 v241, v242, v243
    v_accvgpr_write_b32 a80, v240
    v_accvgpr_write_b32 a81, v241
    v_exp_f32 v248, v244 clamp
    v_exp_f32 v249, v245 clamp
    v_exp_f32 v250, v246 clamp
    v_exp_f32 v251, v247 clamp
    v_max_f32 v244, 0x35c1a2a0, v244
    v_max_f32 v245, 0x35c1a2a0, v245
    v_max_f32 v246, 0x35c1a2a0, v246
    v_max_f32 v247, 0x35c1a2a0, v247
    v_fma_f32 v244, v244, s27, v248
    v_fma_f32 v245, v245, s27, v249
    v_fma_f32 v246, v246, s27, v250
    v_fma_f32 v247, v247, s27, v251
    v_cvt_pk_bf16_f32 v244, v244, v245
    v_cvt_pk_bf16_f32 v245, v246, v247
    v_accvgpr_write_b32 a82, v244
    v_accvgpr_write_b32 a83, v245
    v_mfma_f32_16x16x32_bf16 v[176:179], v[32:35], a[24:27], 0
    ds_read_b64_tr_b16 a[8:9], v2 offset:20480
    v_mfma_f32_16x16x32_bf16 v[176:179], v[40:43], a[28:31], v[176:179]
    ds_read_b64_tr_b16 a[10:11], v2 offset:57920
    v_mfma_f32_16x16x32_bf16 v[180:183], v[36:39], a[24:27], 0
    s_add_u32 m0, s67, 6144
    ds_read_b64_tr_b16 a[12:13], v6 offset:29824
    v_mfma_f32_16x16x32_bf16 v[180:183], v[44:47], a[28:31], v[180:183]
    s_waitcnt lgkmcnt(7)
    ds_read_b64_tr_b16 a[14:15], v10 offset:1728
    v_mfma_f32_16x16x32_bf16 v[184:187], v[32:35], a[32:35], 0
    s_add_u32 s72, s73, 885888
    ds_read_b64_tr_b16 a[16:17], v3 offset:20480
    buffer_load_dwordx4 v14, s[12:15], s72 offen lds
    v_mfma_f32_16x16x32_bf16 v[184:187], v[40:43], a[36:39], v[184:187]
    ds_read_b64_tr_b16 a[18:19], v3 offset:57920
    v_mfma_f32_16x16x32_bf16 v[188:191], v[36:39], a[32:35], 0
    ds_read_b64_tr_b16 a[20:21], v7 offset:29824
    v_mfma_f32_16x16x32_bf16 v[188:191], v[44:47], a[36:39], v[188:191]
    ds_read_b64_tr_b16 a[22:23], v11 offset:1728
    v_mfma_f32_16x16x32_bf16 v[192:195], v[32:35], a[40:43], 0
    ds_read_b64_tr_b16 a[24:25], v4 offset:20480
    v_mfma_f32_16x16x32_bf16 v[192:195], v[40:43], a[44:47], v[192:195]
    ds_read_b64_tr_b16 a[26:27], v4 offset:57920
    buffer_load_dwordx4 v15, s[12:15], s72 offen offset:1024 lds
    v_mfma_f32_16x16x32_bf16 v[196:199], v[36:39], a[40:43], 0
    ds_read_b64_tr_b16 a[28:29], v8 offset:29824
    v_mfma_f32_16x16x32_bf16 v[196:199], v[44:47], a[44:47], v[196:199]
    s_waitcnt lgkmcnt(7)
    ds_read_b64_tr_b16 a[30:31], v12 offset:1728
    v_mfma_f32_16x16x32_bf16 v[200:203], v[32:35], a[0:3], 0
    ds_read_b64_tr_b16 a[32:33], v5 offset:20480
    v_mfma_f32_16x16x32_bf16 v[200:203], v[40:43], a[4:7], v[200:203]
    ds_read_b64_tr_b16 a[34:35], v5 offset:57920
    v_mfma_f32_16x16x32_bf16 v[204:207], v[36:39], a[0:3], 0
    s_add_u32 m0, s67, 8192
    ds_read_b64_tr_b16 a[36:37], v9 offset:29824
    v_mfma_f32_16x16x32_bf16 v[204:207], v[44:47], a[4:7], v[204:207]
    s_add_u32 s72, s73, 886016
    ds_read_b64_tr_b16 a[38:39], v13 offset:1728
    buffer_load_dwordx4 v14, s[12:15], s72 offen lds
    v_mfma_f32_16x16x32_bf16 v[208:211], v[32:35], a[8:11], 0
    ds_read_b64_tr_b16 a[40:41], v2 offset:22528
    v_mfma_f32_16x16x32_bf16 v[208:211], v[40:43], a[12:15], v[208:211]
    ds_read_b64_tr_b16 a[42:43], v2 offset:59968
    v_mfma_f32_16x16x32_bf16 v[212:215], v[36:39], a[8:11], 0
    ds_read_b64_tr_b16 a[44:45], v6 offset:31872
    v_mfma_f32_16x16x32_bf16 v[212:215], v[44:47], a[12:15], v[212:215]
    s_waitcnt vmcnt(26) lgkmcnt(7)
    ds_read_b64_tr_b16 a[46:47], v10 offset:3776
    v_mfma_f32_16x16x32_bf16 v[216:219], v[32:35], a[16:19], 0
    s_barrier
    ds_read_b64_tr_b16 a[0:1], v2 offset:24576
    v_mfma_f32_16x16x32_bf16 v[216:219], v[40:43], a[20:23], v[216:219]
    ds_read_b64_tr_b16 a[2:3], v2 offset:62016
    buffer_load_dwordx4 v15, s[12:15], s72 offen offset:1024 lds
    v_mfma_f32_16x16x32_bf16 v[220:223], v[36:39], a[16:19], 0
    ds_read_b64_tr_b16 a[4:5], v6 offset:33920
    v_mfma_f32_16x16x32_bf16 v[220:223], v[44:47], a[20:23], v[220:223]
    ds_read_b64_tr_b16 a[6:7], v10 offset:5824
    v_mfma_f32_16x16x32_bf16 v[224:227], v[32:35], a[24:27], 0
    ds_read_b64_tr_b16 a[8:9], v3 offset:24576
    v_mfma_f32_16x16x32_bf16 v[224:227], v[40:43], a[28:31], v[224:227]
    ds_read_b64_tr_b16 a[10:11], v3 offset:62016
    v_mfma_f32_16x16x32_bf16 v[228:231], v[36:39], a[24:27], 0
    s_add_u32 m0, s67, 10240
    ds_read_b64_tr_b16 a[12:13], v7 offset:33920
    v_mfma_f32_16x16x32_bf16 v[228:231], v[44:47], a[28:31], v[228:231]
    s_waitcnt lgkmcnt(7)
    ds_read_b64_tr_b16 a[14:15], v11 offset:5824
    v_mfma_f32_16x16x32_bf16 v[232:235], v[32:35], a[32:35], 0
    s_add_u32 s72, s73, 886144
    ds_read_b64_tr_b16 a[16:17], v4 offset:24576
    buffer_load_dwordx4 v14, s[12:15], s72 offen lds
    v_mfma_f32_16x16x32_bf16 v[232:235], v[40:43], a[36:39], v[232:235]
    ds_read_b64_tr_b16 a[18:19], v4 offset:62016
    v_mfma_f32_16x16x32_bf16 v[236:239], v[36:39], a[32:35], 0
    ds_read_b64_tr_b16 a[20:21], v8 offset:33920
    v_mfma_f32_16x16x32_bf16 v[236:239], v[44:47], a[36:39], v[236:239]
    ds_read_b64_tr_b16 a[22:23], v12 offset:5824
    v_mfma_f32_16x16x32_bf16 v[240:243], v[32:35], a[40:43], 0
    ds_read_b64_tr_b16 a[24:25], v5 offset:24576
    v_mfma_f32_16x16x32_bf16 v[240:243], v[40:43], a[44:47], v[240:243]
    ds_read_b64_tr_b16 a[26:27], v5 offset:62016
    buffer_load_dwordx4 v15, s[12:15], s72 offen offset:1024 lds
    v_mfma_f32_16x16x32_bf16 v[244:247], v[36:39], a[40:43], 0
    ds_read_b64_tr_b16 a[28:29], v9 offset:33920
    v_mfma_f32_16x16x32_bf16 v[244:247], v[44:47], a[44:47], v[244:247]
    s_waitcnt lgkmcnt(7)
    ds_read_b64_tr_b16 a[30:31], v13 offset:5824
    v_mfma_f32_16x16x32_bf16 v[176:179], v[48:51], a[0:3], v[176:179]
    s_lshl_b32 s70, s77, 4
    ds_read_b64_tr_b16 a[32:33], v2 offset:26624
    v_mfma_f32_16x16x32_bf16 v[176:179], v[56:59], a[4:7], v[176:179]
    ds_read_b64_tr_b16 a[34:35], v2 offset:64064
    v_mfma_f32_16x16x32_bf16 v[180:183], v[52:55], a[0:3], v[180:183]
    s_add_u32 m0, s67, 12288
    ds_read_b64_tr_b16 a[36:37], v6 offset:35968
    v_mfma_f32_16x16x32_bf16 v[180:183], v[60:63], a[4:7], v[180:183]
    s_add_u32 s72, s73, 1107072
    ds_read_b64_tr_b16 a[38:39], v10 offset:7872
    buffer_load_dwordx4 v14, s[12:15], s72 offen lds
    v_mfma_f32_16x16x32_bf16 v[184:187], v[48:51], a[8:11], v[184:187]
    s_lshl_b32 s71, s75, 3
    ds_read_b64_tr_b16 a[40:41], v3 offset:26624
    v_mfma_f32_16x16x32_bf16 v[184:187], v[56:59], a[12:15], v[184:187]
    ds_read_b64_tr_b16 a[42:43], v3 offset:64064
    v_mfma_f32_16x16x32_bf16 v[188:191], v[52:55], a[8:11], v[188:191]
    s_add_u32 s71, s71, s70
    ds_read_b64_tr_b16 a[44:45], v7 offset:35968
    v_mfma_f32_16x16x32_bf16 v[188:191], v[60:63], a[12:15], v[188:191]
    s_waitcnt lgkmcnt(7)
    ds_read_b64_tr_b16 a[46:47], v11 offset:7872
    v_mfma_f32_16x16x32_bf16 v[192:195], v[48:51], a[16:19], v[192:195]
    ds_read_b64_tr_b16 a[0:1], v4 offset:26624
    v_mfma_f32_16x16x32_bf16 v[192:195], v[56:59], a[20:23], v[192:195]
    ds_read_b64_tr_b16 a[2:3], v4 offset:64064
    buffer_load_dwordx4 v15, s[12:15], s72 offen offset:1024 lds
    v_mfma_f32_16x16x32_bf16 v[196:199], v[52:55], a[16:19], v[196:199]
    ds_read_b64_tr_b16 a[4:5], v8 offset:35968
    v_bfe_u32 v27, v1, 4, 1
    v_mfma_f32_16x16x32_bf16 v[196:199], v[60:63], a[20:23], v[196:199]
    ds_read_b64_tr_b16 a[6:7], v12 offset:7872
    v_mfma_f32_16x16x32_bf16 v[200:203], v[48:51], a[24:27], v[200:203]
    ds_read_b64_tr_b16 a[8:9], v5 offset:26624
    v_lshlrev_b32 v27, 2, v27
    v_mfma_f32_16x16x32_bf16 v[200:203], v[56:59], a[28:31], v[200:203]
    ds_read_b64_tr_b16 a[10:11], v5 offset:64064
    v_mfma_f32_16x16x32_bf16 v[204:207], v[52:55], a[24:27], v[204:207]
    s_add_u32 m0, s67, 14336
    ds_read_b64_tr_b16 a[12:13], v9 offset:35968
    v_mfma_f32_16x16x32_bf16 v[204:207], v[60:63], a[28:31], v[204:207]
    s_waitcnt lgkmcnt(7)
    ds_read_b64_tr_b16 a[14:15], v13 offset:7872
    v_add_u32 v27, s71, v27
    v_mfma_f32_16x16x32_bf16 v[208:211], v[48:51], a[32:35], v[208:211]
    s_add_u32 s72, s73, 1107200
    ds_read_b64_tr_b16 a[16:17], v2 offset:28672
    buffer_load_dwordx4 v14, s[12:15], s72 offen lds
    v_mfma_f32_16x16x32_bf16 v[208:211], v[56:59], a[36:39], v[208:211]
    ds_read_b64_tr_b16 a[18:19], v6 offset:576
    v_mfma_f32_16x16x32_bf16 v[212:215], v[52:55], a[32:35], v[212:215]
    ds_read_b64_tr_b16 a[20:21], v6 offset:38016
    v_add_u32 v23, 0, v27
    v_mfma_f32_16x16x32_bf16 v[212:215], v[60:63], a[36:39], v[212:215]
    s_waitcnt vmcnt(26)
    ds_read_b64_tr_b16 a[22:23], v10 offset:9920
    v_mfma_f32_16x16x32_bf16 v[216:219], v[48:51], a[40:43], v[216:219]
    s_barrier
    ds_read_b64_tr_b16 a[24:25], v2 offset:30720
    v_mfma_f32_16x16x32_bf16 v[216:219], v[56:59], a[44:47], v[216:219]
    ds_read_b64_tr_b16 a[26:27], v6 offset:2624
    buffer_load_dwordx4 v15, s[12:15], s72 offen offset:1024 lds
    v_mfma_f32_16x16x32_bf16 v[220:223], v[52:55], a[40:43], v[220:223]
    ds_read_b64_tr_b16 a[28:29], v6 offset:40064
    v_mul_u32_u24 v23, 3641, v23
    v_mfma_f32_16x16x32_bf16 v[220:223], v[60:63], a[44:47], v[220:223]
    s_waitcnt lgkmcnt(7)
    ds_read_b64_tr_b16 a[30:31], v10 offset:11968
    v_mfma_f32_16x16x32_bf16 v[224:227], v[48:51], a[0:3], v[224:227]
    ds_read_b64_tr_b16 a[32:33], v3 offset:30720
    v_lshrrev_b32 v23, 16, v23
    v_mfma_f32_16x16x32_bf16 v[224:227], v[56:59], a[4:7], v[224:227]
    ds_read_b64_tr_b16 a[34:35], v7 offset:2624
    v_mfma_f32_16x16x32_bf16 v[228:231], v[52:55], a[0:3], v[228:231]
    s_add_u32 m0, s67, 16384
    ds_read_b64_tr_b16 a[36:37], v7 offset:40064
    v_mfma_f32_16x16x32_bf16 v[228:231], v[60:63], a[4:7], v[228:231]
    s_add_u32 s72, s73, 1107328
    ds_read_b64_tr_b16 a[38:39], v11 offset:11968
    buffer_load_dwordx4 v14, s[12:15], s72 offen lds
    v_mfma_f32_16x16x32_bf16 v[232:235], v[48:51], a[8:11], v[232:235]
    ds_read_b64_tr_b16 a[40:41], v4 offset:30720
    v_add_u32 v24, 1, v27
    v_mfma_f32_16x16x32_bf16 v[232:235], v[56:59], a[12:15], v[232:235]
    ds_read_b64_tr_b16 a[42:43], v8 offset:2624
    v_mfma_f32_16x16x32_bf16 v[236:239], v[52:55], a[8:11], v[236:239]
    ds_read_b64_tr_b16 a[44:45], v8 offset:40064
    v_mul_u32_u24 v24, 3641, v24
    v_mfma_f32_16x16x32_bf16 v[236:239], v[60:63], a[12:15], v[236:239]
    s_waitcnt lgkmcnt(7)
    ds_read_b64_tr_b16 a[46:47], v12 offset:11968
    v_mfma_f32_16x16x32_bf16 v[240:243], v[48:51], a[16:19], v[240:243]
    ds_read_b64_tr_b16 a[0:1], v5 offset:30720
    v_mfma_f32_16x16x32_bf16 v[240:243], v[56:59], a[20:23], v[240:243]
    ds_read_b64_tr_b16 a[2:3], v9 offset:2624
    buffer_load_dwordx4 v15, s[12:15], s72 offen offset:1024 lds
    v_mfma_f32_16x16x32_bf16 v[244:247], v[52:55], a[16:19], v[244:247]
    ds_read_b64_tr_b16 a[4:5], v9 offset:40064
    v_lshrrev_b32 v24, 16, v24
    v_mfma_f32_16x16x32_bf16 v[244:247], v[60:63], a[20:23], v[244:247]
    ds_read_b64_tr_b16 a[6:7], v13 offset:11968
    v_mfma_f32_16x16x32_bf16 v[176:179], v[64:67], a[24:27], v[176:179]
    ds_read_b64_tr_b16 a[8:9], v2 offset:32768
    v_add_u32 v25, 2, v27
    v_mfma_f32_16x16x32_bf16 v[176:179], v[72:75], a[28:31], v[176:179]
    ds_read_b64_tr_b16 a[10:11], v6 offset:4672
    v_mfma_f32_16x16x32_bf16 v[180:183], v[68:71], a[24:27], v[180:183]
    s_add_u32 m0, s67, 18432
    ds_read_b64_tr_b16 a[12:13], v6 offset:42112
    v_mul_u32_u24 v25, 3641, v25
    v_mfma_f32_16x16x32_bf16 v[180:183], v[76:79], a[28:31], v[180:183]
    s_waitcnt lgkmcnt(7)
    ds_read_b64_tr_b16 a[14:15], v10 offset:14016
    v_mfma_f32_16x16x32_bf16 v[184:187], v[64:67], a[32:35], v[184:187]
    s_add_u32 s72, s73, 1328256
    ds_read_b64_tr_b16 a[16:17], v3 offset:32768
    buffer_load_dwordx4 v14, s[12:15], s72 offen lds
    v_mfma_f32_16x16x32_bf16 v[184:187], v[72:75], a[36:39], v[184:187]
    ds_read_b64_tr_b16 a[18:19], v7 offset:4672
    v_lshrrev_b32 v25, 16, v25
    v_mfma_f32_16x16x32_bf16 v[188:191], v[68:71], a[32:35], v[188:191]
    ds_read_b64_tr_b16 a[20:21], v7 offset:42112
    v_mfma_f32_16x16x32_bf16 v[188:191], v[76:79], a[36:39], v[188:191]
    ds_read_b64_tr_b16 a[22:23], v11 offset:14016
    v_mfma_f32_16x16x32_bf16 v[192:195], v[64:67], a[40:43], v[192:195]
    ds_read_b64_tr_b16 a[24:25], v4 offset:32768
    v_add_u32 v26, 3, v27
    v_mfma_f32_16x16x32_bf16 v[192:195], v[72:75], a[44:47], v[192:195]
    ds_read_b64_tr_b16 a[26:27], v8 offset:4672
    buffer_load_dwordx4 v15, s[12:15], s72 offen offset:1024 lds
    v_mfma_f32_16x16x32_bf16 v[196:199], v[68:71], a[40:43], v[196:199]
    ds_read_b64_tr_b16 a[28:29], v8 offset:42112
    v_mfma_f32_16x16x32_bf16 v[196:199], v[76:79], a[44:47], v[196:199]
    s_waitcnt lgkmcnt(7)
    ds_read_b64_tr_b16 a[30:31], v12 offset:14016
    v_mul_u32_u24 v26, 3641, v26
    v_mfma_f32_16x16x32_bf16 v[200:203], v[64:67], a[0:3], v[200:203]
    ds_read_b64_tr_b16 a[32:33], v5 offset:32768
    v_mfma_f32_16x16x32_bf16 v[200:203], v[72:75], a[4:7], v[200:203]
    ds_read_b64_tr_b16 a[34:35], v9 offset:4672
    v_lshrrev_b32 v26, 16, v26
    v_mfma_f32_16x16x32_bf16 v[204:207], v[68:71], a[0:3], v[204:207]
    s_add_u32 m0, s67, 20480
    ds_read_b64_tr_b16 a[36:37], v9 offset:42112
    v_mfma_f32_16x16x32_bf16 v[204:207], v[76:79], a[4:7], v[204:207]
    s_add_u32 s72, s73, 1328384
    ds_read_b64_tr_b16 a[38:39], v13 offset:14016
    buffer_load_dwordx4 v14, s[12:15], s72 offen lds
    v_mfma_f32_16x16x32_bf16 v[208:211], v[64:67], a[8:11], v[208:211]
    s_lshl_b32 s71, s78, 4
    ds_read_b64_tr_b16 a[40:41], v2 offset:34816
    v_mfma_f32_16x16x32_bf16 v[208:211], v[72:75], a[12:15], v[208:211]
    ds_read_b64_tr_b16 a[42:43], v6 offset:6720
    v_mfma_f32_16x16x32_bf16 v[212:215], v[68:71], a[8:11], v[212:215]
    ds_read_b64_tr_b16 a[44:45], v6 offset:44160
    v_mfma_f32_16x16x32_bf16 v[212:215], v[76:79], a[12:15], v[212:215]
    s_waitcnt vmcnt(26) lgkmcnt(7)
    ds_read_b64_tr_b16 a[46:47], v10 offset:16064
    v_mfma_f32_16x16x32_bf16 v[216:219], v[64:67], a[16:19], v[216:219]
L_pad_a3_0:
    s_cbranch_execz L_pad_a3_1
    s_barrier
    ds_read_b64_tr_b16 a[0:1], v2 offset:0
    v_mfma_f32_16x16x32_bf16 v[216:219], v[72:75], a[20:23], v[216:219]
    s_add_u32 s71, s71, s70
    ds_read_b64_tr_b16 a[2:3], v2 offset:37440
    buffer_load_dwordx4 v15, s[12:15], s72 offen offset:1024 lds
    v_mfma_f32_16x16x32_bf16 v[220:223], v[68:71], a[16:19], v[220:223]
    s_sub_u32 s71, s71, 16
    ds_read_b64_tr_b16 a[4:5], v6 offset:9344
    v_mfma_f32_16x16x32_bf16 v[220:223], v[76:79], a[20:23], v[220:223]
    ds_read_b64_tr_b16 a[6:7], v6 offset:46784
    v_mfma_f32_16x16x32_bf16 v[224:227], v[64:67], a[24:27], v[224:227]
    ds_read_b64_tr_b16 a[8:9], v3 offset:0
    v_and_b32 v27, 15, v1
    v_mfma_f32_16x16x32_bf16 v[224:227], v[72:75], a[28:31], v[224:227]
    ds_read_b64_tr_b16 a[10:11], v3 offset:37440
    v_mfma_f32_16x16x32_bf16 v[228:231], v[68:71], a[24:27], v[228:231]
    s_add_u32 m0, s67, 22528
    ds_read_b64_tr_b16 a[12:13], v7 offset:9344
    v_mfma_f32_16x16x32_bf16 v[228:231], v[76:79], a[28:31], v[228:231]
    s_waitcnt lgkmcnt(7)
    ds_read_b64_tr_b16 a[14:15], v7 offset:46784
    v_add_u32 v27, s71, v27
    v_mfma_f32_16x16x32_bf16 v[232:235], v[64:67], a[32:35], v[232:235]
    s_add_u32 s72, s73, 1328512
    ds_read_b64_tr_b16 a[16:17], v4 offset:0
    buffer_load_dwordx4 v14, s[12:15], s72 offen lds
    v_mfma_f32_16x16x32_bf16 v[232:235], v[72:75], a[36:39], v[232:235]
    ds_read_b64_tr_b16 a[18:19], v4 offset:37440
    v_mfma_f32_16x16x32_bf16 v[236:239], v[68:71], a[32:35], v[236:239]
    ds_read_b64_tr_b16 a[20:21], v8 offset:9344
    v_mul_u32_u24 v27, 3641, v27
    v_mfma_f32_16x16x32_bf16 v[236:239], v[76:79], a[36:39], v[236:239]
    ds_read_b64_tr_b16 a[22:23], v8 offset:46784
    v_mfma_f32_16x16x32_bf16 v[240:243], v[64:67], a[40:43], v[240:243]
    ds_read_b64_tr_b16 a[24:25], v5 offset:0
    v_mfma_f32_16x16x32_bf16 v[240:243], v[72:75], a[44:47], v[240:243]
    ds_read_b64_tr_b16 a[26:27], v5 offset:37440
    buffer_load_dwordx4 v15, s[12:15], s72 offen offset:1024 lds
    v_mfma_f32_16x16x32_bf16 v[244:247], v[68:71], a[40:43], v[244:247]
    ds_read_b64_tr_b16 a[28:29], v9 offset:9344
    v_lshrrev_b32 v27, 16, v27
    v_mfma_f32_16x16x32_bf16 v[244:247], v[76:79], a[44:47], v[244:247]
    s_waitcnt lgkmcnt(7)
    ds_read_b64_tr_b16 a[30:31], v9 offset:46784
    v_mfma_f32_16x16x32_bf16 v[176:179], v[80:83], a[0:3], v[176:179]
    ds_read_b64_tr_b16 a[32:33], v2 offset:2048
    s_waitcnt vmcnt(18)
    v_mfma_f32_16x16x32_bf16 v[176:179], v[88:91], a[4:7], v[176:179]
    ds_read_b64_tr_b16 a[34:35], v2 offset:39488
    v_mfma_f32_16x16x32_bf16 v[180:183], v[84:87], a[0:3], v[180:183]
    s_add_u32 m0, s67, 24576
    ds_read_b64_tr_b16 a[36:37], v6 offset:11392
    v_mfma_f32_16x16x32_bf16 v[180:183], v[92:95], a[4:7], v[180:183]
    s_add_u32 s72, s73, 1549440
    ds_read_b64_tr_b16 a[38:39], v6 offset:48832
    buffer_load_dwordx4 v14, s[12:15], s72 offen lds
    v_mfma_f32_16x16x32_bf16 v[184:187], v[80:83], a[8:11], v[184:187]
    ds_read_b64_tr_b16 a[40:41], v3 offset:2048
    v_mfma_f32_16x16x32_bf16 v[184:187], v[88:91], a[12:15], v[184:187]
    ds_read_b64_tr_b16 a[42:43], v3 offset:39488
    v_mfma_f32_16x16x32_bf16 v[188:191], v[84:87], a[8:11], v[188:191]
    ds_read_b64_tr_b16 a[44:45], v7 offset:11392
    v_mfma_f32_16x16x32_bf16 v[188:191], v[92:95], a[12:15], v[188:191]
    s_waitcnt lgkmcnt(7)
    ds_read_b64_tr_b16 a[46:47], v7 offset:48832
    v_mfma_f32_16x16x32_bf16 v[192:195], v[80:83], a[16:19], v[192:195]
    ds_read_b64_tr_b16 a[0:1], v4 offset:2048
    v_mfma_f32_16x16x32_bf16 v[192:195], v[88:91], a[20:23], v[192:195]
    ds_read_b64_tr_b16 a[2:3], v4 offset:39488
    buffer_load_dwordx4 v15, s[12:15], s72 offen offset:1024 lds
    v_mfma_f32_16x16x32_bf16 v[196:199], v[84:87], a[16:19], v[196:199]
    ds_read_b64_tr_b16 a[4:5], v8 offset:11392
    v_mfma_f32_16x16x32_bf16 v[196:199], v[92:95], a[20:23], v[196:199]
    ds_read_b64_tr_b16 a[6:7], v8 offset:48832
    v_mfma_f32_16x16x32_bf16 v[200:203], v[80:83], a[24:27], v[200:203]
    ds_read_b64_tr_b16 a[8:9], v5 offset:2048
    v_mfma_f32_16x16x32_bf16 v[200:203], v[88:91], a[28:31], v[200:203]
    ds_read_b64_tr_b16 a[10:11], v5 offset:39488
    v_mfma_f32_16x16x32_bf16 v[204:207], v[84:87], a[24:27], v[204:207]
    s_add_u32 m0, s67, 26624
    ds_read_b64_tr_b16 a[12:13], v9 offset:11392
    v_mfma_f32_16x16x32_bf16 v[204:207], v[92:95], a[28:31], v[204:207]
    s_waitcnt lgkmcnt(7)
    ds_read_b64_tr_b16 a[14:15], v9 offset:48832
    v_mfma_f32_16x16x32_bf16 v[208:211], v[80:83], a[32:35], v[208:211]
    s_add_u32 s72, s73, 1549568
    ds_read_b64_tr_b16 a[16:17], v2 offset:4096
    buffer_load_dwordx4 v14, s[12:15], s72 offen lds
    v_mfma_f32_16x16x32_bf16 v[208:211], v[88:91], a[36:39], v[208:211]
    ds_read_b64_tr_b16 a[18:19], v2 offset:41536
    v_mfma_f32_16x16x32_bf16 v[212:215], v[84:87], a[32:35], v[212:215]
    ds_read_b64_tr_b16 a[20:21], v6 offset:13440
    v_mfma_f32_16x16x32_bf16 v[212:215], v[92:95], a[36:39], v[212:215]
    s_waitcnt vmcnt(15)
    ds_read_b64_tr_b16 a[22:23], v6 offset:50880
    v_mfma_f32_16x16x32_bf16 v[216:219], v[80:83], a[40:43], v[216:219]
    s_barrier
    ds_read_b64_tr_b16 a[24:25], v2 offset:6144
    v_mfma_f32_16x16x32_bf16 v[216:219], v[88:91], a[44:47], v[216:219]
    ds_read_b64_tr_b16 a[26:27], v2 offset:43584
    buffer_load_dwordx4 v15, s[12:15], s72 offen offset:1024 lds
    v_mfma_f32_16x16x32_bf16 v[220:223], v[84:87], a[40:43], v[220:223]
    ds_read_b64_tr_b16 a[28:29], v6 offset:15488
    v_mfma_f32_16x16x32_bf16 v[220:223], v[92:95], a[44:47], v[220:223]
    s_waitcnt lgkmcnt(7)
    ds_read_b64_tr_b16 a[30:31], v6 offset:52928
    v_mfma_f32_16x16x32_bf16 v[224:227], v[80:83], a[0:3], v[224:227]
    ds_read_b64_tr_b16 a[32:33], v3 offset:6144
    v_mfma_f32_16x16x32_bf16 v[224:227], v[88:91], a[4:7], v[224:227]
    ds_read_b64_tr_b16 a[34:35], v3 offset:43584
    v_mfma_f32_16x16x32_bf16 v[228:231], v[84:87], a[0:3], v[228:231]
    s_add_u32 m0, s67, 28672
    ds_read_b64_tr_b16 a[36:37], v7 offset:15488
    v_mfma_f32_16x16x32_bf16 v[228:231], v[92:95], a[4:7], v[228:231]
    s_add_u32 s72, s73, 1549696
    ds_read_b64_tr_b16 a[38:39], v7 offset:52928
    buffer_load_dwordx4 v14, s[12:15], s72 offen lds
    v_mfma_f32_16x16x32_bf16 v[232:235], v[80:83], a[8:11], v[232:235]
    ds_read_b64_tr_b16 a[40:41], v4 offset:6144
    v_mfma_f32_16x16x32_bf16 v[232:235], v[88:91], a[12:15], v[232:235]
    ds_read_b64_tr_b16 a[42:43], v4 offset:43584
    v_mfma_f32_16x16x32_bf16 v[236:239], v[84:87], a[8:11], v[236:239]
    ds_read_b64_tr_b16 a[44:45], v8 offset:15488
    v_mfma_f32_16x16x32_bf16 v[236:239], v[92:95], a[12:15], v[236:239]
    s_waitcnt lgkmcnt(7)
    ds_read_b64_tr_b16 a[46:47], v8 offset:52928
    v_mfma_f32_16x16x32_bf16 v[240:243], v[80:83], a[16:19], v[240:243]
    ds_read_b64_tr_b16 a[0:1], v5 offset:6144
    v_mfma_f32_16x16x32_bf16 v[240:243], v[88:91], a[20:23], v[240:243]
    ds_read_b64_tr_b16 a[2:3], v5 offset:43584
    buffer_load_dwordx4 v15, s[12:15], s72 offen offset:1024 lds
    v_mfma_f32_16x16x32_bf16 v[244:247], v[84:87], a[16:19], v[244:247]
    ds_read_b64_tr_b16 a[4:5], v9 offset:15488
    v_mfma_f32_16x16x32_bf16 v[244:247], v[92:95], a[20:23], v[244:247]
    ds_read_b64_tr_b16 a[6:7], v9 offset:52928
    v_mfma_f32_16x16x32_bf16 v[176:179], v[96:99], a[24:27], v[176:179]
    ds_read_b64_tr_b16 a[8:9], v2 offset:8192
    s_cmp_lg_u32 s62, 0
    s_cbranch_scc1 L_cnt_39
    v_mov_b32 v22, 1
    s_mov_b64 exec, 1
    buffer_atomic_add v22, off, s[36:39], s89 offset:0 sc1
    s_mov_b64 exec, -1
L_cnt_39:
    v_mfma_f32_16x16x32_bf16 v[176:179], v[104:107], a[28:31], v[176:179]
    ds_read_b64_tr_b16 a[10:11], v2 offset:45632
    v_mfma_f32_16x16x32_bf16 v[180:183], v[100:103], a[24:27], v[180:183]
    s_add_u32 m0, s67, 30720
    ds_read_b64_tr_b16 a[12:13], v6 offset:17536
    v_mfma_f32_16x16x32_bf16 v[180:183], v[108:111], a[28:31], v[180:183]
    s_waitcnt lgkmcnt(7)
    ds_read_b64_tr_b16 a[14:15], v6 offset:54976
    v_mfma_f32_16x16x32_bf16 v[184:187], v[96:99], a[32:35], v[184:187]
    s_add_u32 s72, s73, 1770624
    ds_read_b64_tr_b16 a[16:17], v3 offset:8192
    buffer_load_dwordx4 v14, s[12:15], s72 offen lds
    v_mfma_f32_16x16x32_bf16 v[184:187], v[104:107], a[36:39], v[184:187]
    ds_read_b64_tr_b16 a[18:19], v3 offset:45632
    v_mfma_f32_16x16x32_bf16 v[188:191], v[100:103], a[32:35], v[188:191]
    ds_read_b64_tr_b16 a[20:21], v7 offset:17536
    v_mfma_f32_16x16x32_bf16 v[188:191], v[108:111], a[36:39], v[188:191]
    ds_read_b64_tr_b16 a[22:23], v7 offset:54976
    v_mfma_f32_16x16x32_bf16 v[192:195], v[96:99], a[40:43], v[192:195]
    ds_read_b64_tr_b16 a[24:25], v4 offset:8192
    v_mfma_f32_16x16x32_bf16 v[192:195], v[104:107], a[44:47], v[192:195]
    ds_read_b64_tr_b16 a[26:27], v4 offset:45632
    buffer_load_dwordx4 v15, s[12:15], s72 offen offset:1024 lds
    v_mfma_f32_16x16x32_bf16 v[196:199], v[100:103], a[40:43], v[196:199]
    ds_read_b64_tr_b16 a[28:29], v8 offset:17536
    v_mfma_f32_16x16x32_bf16 v[196:199], v[108:111], a[44:47], v[196:199]
    s_waitcnt lgkmcnt(7)
    ds_read_b64_tr_b16 a[30:31], v8 offset:54976
    v_mfma_f32_16x16x32_bf16 v[200:203], v[96:99], a[0:3], v[200:203]
    ds_read_b64_tr_b16 a[32:33], v5 offset:8192
    v_mfma_f32_16x16x32_bf16 v[200:203], v[104:107], a[4:7], v[200:203]
    ds_read_b64_tr_b16 a[34:35], v5 offset:45632
    v_mfma_f32_16x16x32_bf16 v[204:207], v[100:103], a[0:3], v[204:207]
    s_add_u32 m0, s67, 32768
    ds_read_b64_tr_b16 a[36:37], v9 offset:17536
    v_mfma_f32_16x16x32_bf16 v[204:207], v[108:111], a[4:7], v[204:207]
    s_add_u32 s72, s73, 1770752
    ds_read_b64_tr_b16 a[38:39], v9 offset:54976
    buffer_load_dwordx4 v14, s[12:15], s72 offen lds
    v_mfma_f32_16x16x32_bf16 v[208:211], v[96:99], a[8:11], v[208:211]
    ds_read_b64_tr_b16 a[40:41], v2 offset:10240
    v_mfma_f32_16x16x32_bf16 v[208:211], v[104:107], a[12:15], v[208:211]
    ds_read_b64_tr_b16 a[42:43], v2 offset:47680
    v_mfma_f32_16x16x32_bf16 v[212:215], v[100:103], a[8:11], v[212:215]
    ds_read_b64_tr_b16 a[44:45], v6 offset:19584
    v_mfma_f32_16x16x32_bf16 v[212:215], v[108:111], a[12:15], v[212:215]
    s_waitcnt vmcnt(15) lgkmcnt(7)
    ds_read_b64_tr_b16 a[46:47], v6 offset:57024
    v_mfma_f32_16x16x32_bf16 v[216:219], v[96:99], a[16:19], v[216:219]
    s_barrier
    ds_read_b64_tr_b16 a[0:1], v2 offset:12288
    v_mfma_f32_16x16x32_bf16 v[216:219], v[104:107], a[20:23], v[216:219]
    ds_read_b64_tr_b16 a[2:3], v2 offset:49728
    buffer_load_dwordx4 v15, s[12:15], s72 offen offset:1024 lds
    v_mfma_f32_16x16x32_bf16 v[220:223], v[100:103], a[16:19], v[220:223]
    ds_read_b64_tr_b16 a[4:5], v6 offset:21632
    v_mfma_f32_16x16x32_bf16 v[220:223], v[108:111], a[20:23], v[220:223]
    ds_read_b64_tr_b16 a[6:7], v6 offset:59072
    v_mfma_f32_16x16x32_bf16 v[224:227], v[96:99], a[24:27], v[224:227]
    ds_read_b64_tr_b16 a[8:9], v3 offset:12288
    v_mfma_f32_16x16x32_bf16 v[224:227], v[104:107], a[28:31], v[224:227]
    ds_read_b64_tr_b16 a[10:11], v3 offset:49728
    v_mfma_f32_16x16x32_bf16 v[228:231], v[100:103], a[24:27], v[228:231]
    s_add_u32 m0, s67, 34816
    ds_read_b64_tr_b16 a[12:13], v7 offset:21632
    v_mfma_f32_16x16x32_bf16 v[228:231], v[108:111], a[28:31], v[228:231]
    s_waitcnt lgkmcnt(7)
    ds_read_b64_tr_b16 a[14:15], v7 offset:59072
    v_mfma_f32_16x16x32_bf16 v[232:235], v[96:99], a[32:35], v[232:235]
    s_add_u32 s72, s73, 1770880
    ds_read_b64_tr_b16 a[16:17], v4 offset:12288
    buffer_load_dwordx4 v14, s[12:15], s72 offen lds
    v_mfma_f32_16x16x32_bf16 v[232:235], v[104:107], a[36:39], v[232:235]
    ds_read_b64_tr_b16 a[18:19], v4 offset:49728
    v_mfma_f32_16x16x32_bf16 v[236:239], v[100:103], a[32:35], v[236:239]
    ds_read_b64_tr_b16 a[20:21], v8 offset:21632
    v_mfma_f32_16x16x32_bf16 v[236:239], v[108:111], a[36:39], v[236:239]
    ds_read_b64_tr_b16 a[22:23], v8 offset:59072
    v_mfma_f32_16x16x32_bf16 v[240:243], v[96:99], a[40:43], v[240:243]
    ds_read_b64_tr_b16 a[24:25], v5 offset:12288
    v_mfma_f32_16x16x32_bf16 v[240:243], v[104:107], a[44:47], v[240:243]
    ds_read_b64_tr_b16 a[26:27], v5 offset:49728
    buffer_load_dwordx4 v15, s[12:15], s72 offen offset:1024 lds
    v_mfma_f32_16x16x32_bf16 v[244:247], v[100:103], a[40:43], v[244:247]
    ds_read_b64_tr_b16 a[28:29], v9 offset:21632
    v_mfma_f32_16x16x32_bf16 v[244:247], v[108:111], a[44:47], v[244:247]
    s_waitcnt lgkmcnt(7)
    ds_read_b64_tr_b16 a[30:31], v9 offset:59072
    v_mfma_f32_16x16x32_bf16 v[176:179], v[112:115], a[0:3], v[176:179]
    ds_read_b64_tr_b16 a[32:33], v2 offset:14336
    v_add_u32 v28, s67, v18
    v_mfma_f32_16x16x32_bf16 v[176:179], v[120:123], a[4:7], v[176:179]
    ds_read_b64_tr_b16 a[34:35], v2 offset:51776
    v_mfma_f32_16x16x32_bf16 v[180:183], v[116:119], a[0:3], v[180:183]
    s_add_u32 m0, s67, 0
    ds_read_b64_tr_b16 a[36:37], v6 offset:23680
    v_mfma_f32_16x16x32_bf16 v[180:183], v[124:127], a[4:7], v[180:183]
    s_add_u32 s72, s73, 4294966144
    ds_read_b64_tr_b16 a[38:39], v6 offset:61120
    buffer_load_dwordx4 v14, s[12:15], s72 offen lds
    v_mfma_f32_16x16x32_bf16 v[184:187], v[112:115], a[8:11], v[184:187]
    s_lshl_b32 s68, s62, 11
    ds_read_b64_tr_b16 a[40:41], v3 offset:14336
    v_mfma_f32_16x16x32_bf16 v[184:187], v[120:123], a[12:15], v[184:187]
    ds_read_b64_tr_b16 a[42:43], v3 offset:51776
    v_mfma_f32_16x16x32_bf16 v[188:191], v[116:119], a[8:11], v[188:191]
    ds_read_b64_tr_b16 a[44:45], v7 offset:23680
    v_add_u32 v29, s68, v18
    v_mfma_f32_16x16x32_bf16 v[188:191], v[124:127], a[12:15], v[188:191]
    s_waitcnt lgkmcnt(7)
    ds_read_b64_tr_b16 a[46:47], v7 offset:61120
    v_mfma_f32_16x16x32_bf16 v[192:195], v[112:115], a[16:19], v[192:195]
    ds_read_b64_tr_b16 a[0:1], v4 offset:14336
    v_mfma_f32_16x16x32_bf16 v[192:195], v[120:123], a[20:23], v[192:195]
    s_max_u32 s69, s68, 1024
    ds_read_b64_tr_b16 a[2:3], v4 offset:51776
    buffer_load_dwordx4 v15, s[12:15], s72 offen offset:1024 lds
    v_mfma_f32_16x16x32_bf16 v[196:199], v[116:119], a[16:19], v[196:199]
    ds_read_b64_tr_b16 a[4:5], v8 offset:23680
    v_mfma_f32_16x16x32_bf16 v[196:199], v[124:127], a[20:23], v[196:199]
    ds_read_b64_tr_b16 a[6:7], v8 offset:61120
    v_mfma_f32_16x16x32_bf16 v[200:203], v[112:115], a[24:27], v[200:203]
    s_sub_u32 s69, s69, 1024
    ds_read_b64_tr_b16 a[8:9], v5 offset:14336
    v_mfma_f32_16x16x32_bf16 v[200:203], v[120:123], a[28:31], v[200:203]
    ds_read_b64_tr_b16 a[10:11], v5 offset:51776
    v_mfma_f32_16x16x32_bf16 v[204:207], v[116:119], a[24:27], v[204:207]
    s_add_u32 m0, s67, 2048
    ds_read_b64_tr_b16 a[12:13], v9 offset:23680
    v_mfma_f32_16x16x32_bf16 v[204:207], v[124:127], a[28:31], v[204:207]
    s_waitcnt lgkmcnt(7)
    ds_read_b64_tr_b16 a[14:15], v9 offset:61120
    v_add_u32 v30, s69, v18
    v_mfma_f32_16x16x32_bf16 v[208:211], v[112:115], a[32:35], v[208:211]
    s_add_u32 s72, s73, 4294966272
    ds_read_b64_tr_b16 a[16:17], v2 offset:16384
    buffer_load_dwordx4 v14, s[12:15], s72 offen lds
    v_mfma_f32_16x16x32_bf16 v[208:211], v[120:123], a[36:39], v[208:211]
    ds_read_b64_tr_b16 a[18:19], v2 offset:53824
    v_mfma_f32_16x16x32_bf16 v[212:215], v[116:119], a[32:35], v[212:215]
    s_min_u32 s69, s68, 1024
    ds_read_b64_tr_b16 a[20:21], v6 offset:25728
    v_mfma_f32_16x16x32_bf16 v[212:215], v[124:127], a[36:39], v[212:215]
    s_waitcnt vmcnt(15)
    ds_read_b64_tr_b16 a[22:23], v6 offset:63168
    v_mfma_f32_16x16x32_bf16 v[216:219], v[112:115], a[40:43], v[216:219]
    s_barrier
    ds_read_b64_tr_b16 a[24:25], v2 offset:18432
    v_mfma_f32_16x16x32_bf16 v[216:219], v[120:123], a[44:47], v[216:219]
    ds_read_b64_tr_b16 a[26:27], v2 offset:55872
    buffer_load_dwordx4 v15, s[12:15], s72 offen offset:1024 lds
    v_mfma_f32_16x16x32_bf16 v[220:223], v[116:119], a[40:43], v[220:223]
    ds_read_b64_tr_b16 a[28:29], v6 offset:27776
    v_add_u32 v31, s69, v18
    v_mfma_f32_16x16x32_bf16 v[220:223], v[124:127], a[44:47], v[220:223]
    s_waitcnt lgkmcnt(7)
    ds_read_b64_tr_b16 a[30:31], v6 offset:65216
    v_mfma_f32_16x16x32_bf16 v[224:227], v[112:115], a[0:3], v[224:227]
    ds_read_b64_tr_b16 a[32:33], v3 offset:18432
    v_mov_b32 v248, 0x3f803f80
    v_mfma_f32_16x16x32_bf16 v[224:227], v[120:123], a[4:7], v[224:227]
    ds_read_b64_tr_b16 a[34:35], v3 offset:55872
    v_mfma_f32_16x16x32_bf16 v[228:231], v[116:119], a[0:3], v[228:231]
    s_add_u32 m0, s67, 4096
    ds_read_b64_tr_b16 a[36:37], v7 offset:27776
    v_mfma_f32_16x16x32_bf16 v[228:231], v[124:127], a[4:7], v[228:231]
    s_add_u32 s72, s73, 4294966400
    ds_read_b64_tr_b16 a[38:39], v7 offset:65216
    buffer_load_dwordx4 v14, s[12:15], s72 offen lds
    v_mfma_f32_16x16x32_bf16 v[232:235], v[112:115], a[8:11], v[232:235]
    ds_read_b64_tr_b16 a[40:41], v4 offset:18432
    v_mov_b32 v249, 0x3f803f80
    v_mfma_f32_16x16x32_bf16 v[232:235], v[120:123], a[12:15], v[232:235]
    ds_read_b64_tr_b16 a[42:43], v4 offset:55872
    v_mfma_f32_16x16x32_bf16 v[236:239], v[116:119], a[8:11], v[236:239]
    ds_read_b64_tr_b16 a[44:45], v8 offset:27776
    v_mov_b32 v250, 0x3f803f80
    v_mfma_f32_16x16x32_bf16 v[236:239], v[124:127], a[12:15], v[236:239]
    s_waitcnt lgkmcnt(7)
    ds_read_b64_tr_b16 a[46:47], v8 offset:65216
    v_mfma_f32_16x16x32_bf16 v[240:243], v[112:115], a[16:19], v[240:243]
    ds_read_b64_tr_b16 a[0:1], v5 offset:18432
    v_mfma_f32_16x16x32_bf16 v[240:243], v[120:123], a[20:23], v[240:243]
    ds_read_b64_tr_b16 a[2:3], v5 offset:55872
    buffer_load_dwordx4 v15, s[12:15], s72 offen offset:1024 lds
    v_mfma_f32_16x16x32_bf16 v[244:247], v[116:119], a[16:19], v[244:247]
    ds_read_b64_tr_b16 a[4:5], v9 offset:27776
    v_mov_b32 v251, 0x3f803f80
    v_mfma_f32_16x16x32_bf16 v[244:247], v[124:127], a[20:23], v[244:247]
    ds_read_b64_tr_b16 a[6:7], v9 offset:65216
    v_mfma_f32_16x16x32_bf16 v[176:179], v[128:131], a[24:27], v[176:179]
    ds_read_b64_tr_b16 a[8:9], v2 offset:20480
    v_mfma_f32_16x16x32_bf16 v[176:179], v[136:139], a[28:31], v[176:179]
    ds_read_b64_tr_b16 a[10:11], v2 offset:57920
    v_mfma_f32_16x16x32_bf16 v[180:183], v[132:135], a[24:27], v[180:183]
    s_add_u32 m0, s67, 6144
    ds_read_b64_tr_b16 a[12:13], v6 offset:29824
    v_mfma_f32_16x16x32_bf16 v[180:183], v[140:143], a[28:31], v[180:183]
    s_waitcnt lgkmcnt(7)
    ds_read_b64_tr_b16 a[14:15], v10 offset:1728
    v_mfma_f32_16x16x32_bf16 v[184:187], v[128:131], a[32:35], v[184:187]
    s_add_u32 s72, s73, 220032
    ds_read_b64_tr_b16 a[16:17], v3 offset:20480
    buffer_load_dwordx4 v14, s[12:15], s72 offen lds
    v_mfma_f32_16x16x32_bf16 v[184:187], v[136:139], a[36:39], v[184:187]
    ds_read_b64_tr_b16 a[18:19], v3 offset:57920
    v_mfma_f32_16x16x32_bf16 v[188:191], v[132:135], a[32:35], v[188:191]
    ds_read_b64_tr_b16 a[20:21], v7 offset:29824
    v_mfma_f32_16x16x32_bf16 v[188:191], v[140:143], a[36:39], v[188:191]
    ds_read_b64_tr_b16 a[22:23], v11 offset:1728
    v_mfma_f32_16x16x32_bf16 v[192:195], v[128:131], a[40:43], v[192:195]
    ds_read_b64_tr_b16 a[24:25], v4 offset:20480
    v_mfma_f32_16x16x32_bf16 v[192:195], v[136:139], a[44:47], v[192:195]
    ds_read_b64_tr_b16 a[26:27], v4 offset:57920
    buffer_load_dwordx4 v15, s[12:15], s72 offen offset:1024 lds
    v_mfma_f32_16x16x32_bf16 v[196:199], v[132:135], a[40:43], v[196:199]
    ds_read_b64_tr_b16 a[28:29], v8 offset:29824
    v_mfma_f32_16x16x32_bf16 v[196:199], v[140:143], a[44:47], v[196:199]
    s_waitcnt lgkmcnt(7)
    ds_read_b64_tr_b16 a[30:31], v12 offset:1728
    v_mfma_f32_16x16x32_bf16 v[200:203], v[128:131], a[0:3], v[200:203]
    ds_read_b64_tr_b16 a[32:33], v5 offset:20480
    v_mfma_f32_16x16x32_bf16 v[200:203], v[136:139], a[4:7], v[200:203]
    ds_read_b64_tr_b16 a[34:35], v5 offset:57920
    v_mfma_f32_16x16x32_bf16 v[204:207], v[132:135], a[0:3], v[204:207]
    s_add_u32 m0, s67, 8192
    ds_read_b64_tr_b16 a[36:37], v9 offset:29824
    v_mfma_f32_16x16x32_bf16 v[204:207], v[140:143], a[4:7], v[204:207]
    s_add_u32 s72, s73, 220160
    ds_read_b64_tr_b16 a[38:39], v13 offset:1728
    buffer_load_dwordx4 v14, s[12:15], s72 offen lds
    v_mfma_f32_16x16x32_bf16 v[208:211], v[128:131], a[8:11], v[208:211]
    ds_read_b64_tr_b16 a[40:41], v2 offset:22528
    v_mfma_f32_16x16x32_bf16 v[208:211], v[136:139], a[12:15], v[208:211]
    ds_read_b64_tr_b16 a[42:43], v2 offset:59968
    v_mfma_f32_16x16x32_bf16 v[212:215], v[132:135], a[8:11], v[212:215]
    ds_read_b64_tr_b16 a[44:45], v6 offset:31872
    v_mfma_f32_16x16x32_bf16 v[212:215], v[140:143], a[12:15], v[212:215]
    s_waitcnt vmcnt(15) lgkmcnt(7)
    ds_read_b64_tr_b16 a[46:47], v10 offset:3776
    v_mfma_f32_16x16x32_bf16 v[216:219], v[128:131], a[16:19], v[216:219]
    s_barrier
    ds_read_b64_tr_b16 a[0:1], v2 offset:24576
    v_mfma_f32_16x16x32_bf16 v[216:219], v[136:139], a[20:23], v[216:219]
    ds_read_b64_tr_b16 a[2:3], v2 offset:62016
    buffer_load_dwordx4 v15, s[12:15], s72 offen offset:1024 lds
    v_mfma_f32_16x16x32_bf16 v[220:223], v[132:135], a[16:19], v[220:223]
    ds_read_b64_tr_b16 a[4:5], v6 offset:33920
    v_mfma_f32_16x16x32_bf16 v[220:223], v[140:143], a[20:23], v[220:223]
    ds_read_b64_tr_b16 a[6:7], v10 offset:5824
    v_mfma_f32_16x16x32_bf16 v[224:227], v[128:131], a[24:27], v[224:227]
    ds_read_b64_tr_b16 a[8:9], v3 offset:24576
    v_mfma_f32_16x16x32_bf16 v[224:227], v[136:139], a[28:31], v[224:227]
    ds_read_b64_tr_b16 a[10:11], v3 offset:62016
    v_mfma_f32_16x16x32_bf16 v[228:231], v[132:135], a[24:27], v[228:231]
    s_add_u32 m0, s67, 10240
    ds_read_b64_tr_b16 a[12:13], v7 offset:33920
    v_mfma_f32_16x16x32_bf16 v[228:231], v[140:143], a[28:31], v[228:231]
    s_waitcnt lgkmcnt(7)
    ds_read_b64_tr_b16 a[14:15], v11 offset:5824
    v_mfma_f32_16x16x32_bf16 v[232:235], v[128:131], a[32:35], v[232:235]
    s_add_u32 s72, s73, 220288
    ds_read_b64_tr_b16 a[16:17], v4 offset:24576
    buffer_load_dwordx4 v14, s[12:15], s72 offen lds
    v_mfma_f32_16x16x32_bf16 v[232:235], v[136:139], a[36:39], v[232:235]
    ds_read_b64_tr_b16 a[18:19], v4 offset:62016
    v_mfma_f32_16x16x32_bf16 v[236:239], v[132:135], a[32:35], v[236:239]
    ds_read_b64_tr_b16 a[20:21], v8 offset:33920
    v_mfma_f32_16x16x32_bf16 v[236:239], v[140:143], a[36:39], v[236:239]
    ds_read_b64_tr_b16 a[22:23], v12 offset:5824
    v_mfma_f32_16x16x32_bf16 v[240:243], v[128:131], a[40:43], v[240:243]
    ds_read_b64_tr_b16 a[24:25], v5 offset:24576
    v_mfma_f32_16x16x32_bf16 v[240:243], v[136:139], a[44:47], v[240:243]
    ds_read_b64_tr_b16 a[26:27], v5 offset:62016
    buffer_load_dwordx4 v15, s[12:15], s72 offen offset:1024 lds
    v_mfma_f32_16x16x32_bf16 v[244:247], v[132:135], a[40:43], v[244:247]
    ds_read_b64_tr_b16 a[28:29], v9 offset:33920
    v_mfma_f32_16x16x32_bf16 v[244:247], v[140:143], a[44:47], v[244:247]
    s_waitcnt lgkmcnt(7)
    ds_read_b64_tr_b16 a[30:31], v13 offset:5824
    v_mfma_f32_16x16x32_bf16 v[176:179], v[144:147], a[0:3], v[176:179]
    ds_read_b64_tr_b16 a[32:33], v2 offset:26624
    v_mfma_f32_16x16x32_bf16 v[176:179], v[152:155], a[4:7], v[176:179]
    ds_read_b64_tr_b16 a[34:35], v2 offset:64064
    v_mfma_f32_16x16x32_bf16 v[180:183], v[148:151], a[0:3], v[180:183]
    s_add_u32 m0, s67, 12288
    ds_read_b64_tr_b16 a[36:37], v6 offset:35968
    v_mfma_f32_16x16x32_bf16 v[180:183], v[156:159], a[4:7], v[180:183]
    s_add_u32 s72, s73, 441216
    ds_read_b64_tr_b16 a[38:39], v10 offset:7872
    buffer_load_dwordx4 v14, s[12:15], s72 offen lds
    v_mfma_f32_16x16x32_bf16 v[184:187], v[144:147], a[8:11], v[184:187]
    ds_read_b64_tr_b16 a[40:41], v3 offset:26624
    v_mfma_f32_16x16x32_bf16 v[184:187], v[152:155], a[12:15], v[184:187]
    ds_read_b64_tr_b16 a[42:43], v3 offset:64064
    v_mfma_f32_16x16x32_bf16 v[188:191], v[148:151], a[8:11], v[188:191]
    ds_read_b64_tr_b16 a[44:45], v7 offset:35968
    v_mfma_f32_16x16x32_bf16 v[188:191], v[156:159], a[12:15], v[188:191]
    s_waitcnt lgkmcnt(7)
    ds_read_b64_tr_b16 a[46:47], v11 offset:7872
    v_mfma_f32_16x16x32_bf16 v[192:195], v[144:147], a[16:19], v[192:195]
    ds_read_b64_tr_b16 a[0:1], v4 offset:26624
    v_mfma_f32_16x16x32_bf16 v[192:195], v[152:155], a[20:23], v[192:195]
    ds_read_b64_tr_b16 a[2:3], v4 offset:64064
    buffer_load_dwordx4 v15, s[12:15], s72 offen offset:1024 lds
    v_mfma_f32_16x16x32_bf16 v[196:199], v[148:151], a[16:19], v[196:199]
    ds_read_b64_tr_b16 a[4:5], v8 offset:35968
    v_mfma_f32_16x16x32_bf16 v[196:199], v[156:159], a[20:23], v[196:199]
    ds_read_b64_tr_b16 a[6:7], v12 offset:7872
    v_mfma_f32_16x16x32_bf16 v[200:203], v[144:147], a[24:27], v[200:203]
    ds_read_b64_tr_b16 a[8:9], v5 offset:26624
    v_mfma_f32_16x16x32_bf16 v[200:203], v[152:155], a[28:31], v[200:203]
    ds_read_b64_tr_b16 a[10:11], v5 offset:64064
    v_mfma_f32_16x16x32_bf16 v[204:207], v[148:151], a[24:27], v[204:207]
    s_add_u32 m0, s67, 14336
    ds_read_b64_tr_b16 a[12:13], v9 offset:35968
    v_mfma_f32_16x16x32_bf16 v[204:207], v[156:159], a[28:31], v[204:207]
    s_waitcnt lgkmcnt(7)
    ds_read_b64_tr_b16 a[14:15], v13 offset:7872
    v_mfma_f32_16x16x32_bf16 v[208:211], v[144:147], a[32:35], v[208:211]
    s_add_u32 s72, s73, 441344
    ds_read_b64_tr_b16 a[16:17], v2 offset:28672
    buffer_load_dwordx4 v14, s[12:15], s72 offen lds
    v_mfma_f32_16x16x32_bf16 v[208:211], v[152:155], a[36:39], v[208:211]
    ds_read_b64_tr_b16 a[18:19], v6 offset:576
    v_mfma_f32_16x16x32_bf16 v[212:215], v[148:151], a[32:35], v[212:215]
    ds_read_b64_tr_b16 a[20:21], v6 offset:38016
    v_mfma_f32_16x16x32_bf16 v[212:215], v[156:159], a[36:39], v[212:215]
    s_waitcnt vmcnt(15)
    ds_read_b64_tr_b16 a[22:23], v10 offset:9920
    v_mfma_f32_16x16x32_bf16 v[216:219], v[144:147], a[40:43], v[216:219]
    s_barrier
    ds_read_b64_tr_b16 a[24:25], v2 offset:30720
    v_mfma_f32_16x16x32_bf16 v[216:219], v[152:155], a[44:47], v[216:219]
    ds_read_b64_tr_b16 a[26:27], v6 offset:2624
    buffer_load_dwordx4 v15, s[12:15], s72 offen offset:1024 lds
    v_mfma_f32_16x16x32_bf16 v[220:223], v[148:151], a[40:43], v[220:223]
    ds_read_b64_tr_b16 a[28:29], v6 offset:40064
    v_mfma_f32_16x16x32_bf16 v[220:223], v[156:159], a[44:47], v[220:223]
    s_waitcnt lgkmcnt(7)
    ds_read_b64_tr_b16 a[30:31], v10 offset:11968
    v_mfma_f32_16x16x32_bf16 v[224:227], v[144:147], a[0:3], v[224:227]
    ds_read_b64_tr_b16 a[32:33], v3 offset:30720
    v_mfma_f32_16x16x32_bf16 v[224:227], v[152:155], a[4:7], v[224:227]
    ds_read_b64_tr_b16 a[34:35], v7 offset:2624
    v_mfma_f32_16x16x32_bf16 v[228:231], v[148:151], a[0:3], v[228:231]
    s_add_u32 m0, s67, 16384
    ds_read_b64_tr_b16 a[36:37], v7 offset:40064
    v_mfma_f32_16x16x32_bf16 v[228:231], v[156:159], a[4:7], v[228:231]
    s_add_u32 s72, s73, 441472
    ds_read_b64_tr_b16 a[38:39], v11 offset:11968
    buffer_load_dwordx4 v14, s[12:15], s72 offen lds
    v_mfma_f32_16x16x32_bf16 v[232:235], v[144:147], a[8:11], v[232:235]
    ds_read_b64_tr_b16 a[40:41], v4 offset:30720
    v_mfma_f32_16x16x32_bf16 v[232:235], v[152:155], a[12:15], v[232:235]
    ds_read_b64_tr_b16 a[42:43], v8 offset:2624
    v_mfma_f32_16x16x32_bf16 v[236:239], v[148:151], a[8:11], v[236:239]
    ds_read_b64_tr_b16 a[44:45], v8 offset:40064
    v_mfma_f32_16x16x32_bf16 v[236:239], v[156:159], a[12:15], v[236:239]
    s_waitcnt lgkmcnt(7)
    ds_read_b64_tr_b16 a[46:47], v12 offset:11968
    v_mfma_f32_16x16x32_bf16 v[240:243], v[144:147], a[16:19], v[240:243]
    ds_read_b64_tr_b16 a[0:1], v5 offset:30720
    v_mfma_f32_16x16x32_bf16 v[240:243], v[152:155], a[20:23], v[240:243]
    ds_read_b64_tr_b16 a[2:3], v9 offset:2624
    buffer_load_dwordx4 v15, s[12:15], s72 offen offset:1024 lds
    v_mfma_f32_16x16x32_bf16 v[244:247], v[148:151], a[16:19], v[244:247]
    ds_read_b64_tr_b16 a[4:5], v9 offset:40064
    v_mfma_f32_16x16x32_bf16 v[244:247], v[156:159], a[20:23], v[244:247]
    ds_read_b64_tr_b16 a[6:7], v13 offset:11968
    v_mfma_f32_16x16x32_bf16 v[176:179], v[160:163], a[24:27], v[176:179]
    ds_read_b64_tr_b16 a[8:9], v2 offset:32768
    ds_write_b128 v28, a[48:51] offset:18432
    v_mfma_f32_16x16x32_bf16 v[176:179], v[168:171], a[28:31], v[176:179]
    ds_read_b64_tr_b16 a[10:11], v6 offset:4672
    v_mfma_f32_16x16x32_bf16 v[180:183], v[164:167], a[24:27], v[180:183]
    ds_read_b64_tr_b16 a[12:13], v6 offset:42112
    v_mfma_f32_16x16x32_bf16 v[180:183], v[172:175], a[28:31], v[180:183]
    s_waitcnt lgkmcnt(8)
    ds_read_b64_tr_b16 a[14:15], v10 offset:14016
    v_mfma_f32_16x16x32_bf16 v[184:187], v[160:163], a[32:35], v[184:187]
    ds_read_b64_tr_b16 a[16:17], v3 offset:32768
    v_mfma_f32_16x16x32_bf16 v[184:187], v[168:171], a[36:39], v[184:187]
    ds_read_b64_tr_b16 a[18:19], v7 offset:4672
    v_mfma_f32_16x16x32_bf16 v[188:191], v[164:167], a[32:35], v[188:191]
    ds_read_b64_tr_b16 a[20:21], v7 offset:42112
    ds_write_b128 v28, a[52:55] offset:19456
    v_mfma_f32_16x16x32_bf16 v[188:191], v[172:175], a[36:39], v[188:191]
    ds_read_b64_tr_b16 a[22:23], v11 offset:14016
    v_mfma_f32_16x16x32_bf16 v[192:195], v[160:163], a[40:43], v[192:195]
    ds_read_b64_tr_b16 a[24:25], v4 offset:32768
    v_mfma_f32_16x16x32_bf16 v[192:195], v[168:171], a[44:47], v[192:195]
    ds_read_b64_tr_b16 a[26:27], v8 offset:4672
L_pad_a0_1:
    s_cbranch_execz L_walk_ret
    v_mfma_f32_16x16x32_bf16 v[196:199], v[164:167], a[40:43], v[196:199]
    ds_read_b64_tr_b16 a[28:29], v8 offset:42112
    v_mfma_f32_16x16x32_bf16 v[196:199], v[172:175], a[44:47], v[196:199]
    s_waitcnt lgkmcnt(8)
    ds_read_b64_tr_b16 a[30:31], v12 offset:14016
    v_mfma_f32_16x16x32_bf16 v[200:203], v[160:163], a[0:3], v[200:203]
    ds_read_b64_tr_b16 a[32:33], v5 offset:32768
    ds_write_b128 v28, a[56:59] offset:20480
    v_mfma_f32_16x16x32_bf16 v[200:203], v[168:171], a[4:7], v[200:203]
    ds_read_b64_tr_b16 a[34:35], v9 offset:4672
    v_mfma_f32_16x16x32_bf16 v[204:207], v[164:167], a[0:3], v[204:207]
    ds_read_b64_tr_b16 a[36:37], v9 offset:42112
    v_mfma_f32_16x16x32_bf16 v[204:207], v[172:175], a[4:7], v[204:207]
    ds_read_b64_tr_b16 a[38:39], v13 offset:14016
    v_mfma_f32_16x16x32_bf16 v[208:211], v[160:163], a[8:11], v[208:211]
    ds_read_b64_tr_b16 a[40:41], v2 offset:34816
    v_mfma_f32_16x16x32_bf16 v[208:211], v[168:171], a[12:15], v[208:211]
    ds_read_b64_tr_b16 a[42:43], v6 offset:6720
    v_mfma_f32_16x16x32_bf16 v[212:215], v[164:167], a[8:11], v[212:215]
    ds_read_b64_tr_b16 a[44:45], v6 offset:44160
    buffer_load_dword v21, v20, s[36:39], 0 offen sc1
    v_mfma_f32_16x16x32_bf16 v[212:215], v[172:175], a[12:15], v[212:215]
    s_waitcnt vmcnt(13) lgkmcnt(8)
    ds_read_b64_tr_b16 a[46:47], v10 offset:16064
    ds_write_b128 v28, a[60:63] offset:21504
    v_mfma_f32_16x16x32_bf16 v[216:219], v[160:163], a[16:19], v[216:219]
    s_barrier
    ds_read_b64_tr_b16 a[0:1], v2 offset:0
    v_mfma_f32_16x16x32_bf16 v[216:219], v[168:171], a[20:23], v[216:219]
    ds_read_b64_tr_b16 a[2:3], v2 offset:37440
    v_mfma_f32_16x16x32_bf16 v[220:223], v[164:167], a[16:19], v[220:223]
    ds_read_b64_tr_b16 a[4:5], v6 offset:9344
    v_mfma_f32_16x16x32_bf16 v[220:223], v[172:175], a[20:23], v[220:223]
    ds_read_b64_tr_b16 a[6:7], v6 offset:46784
    v_mfma_f32_16x16x32_bf16 v[224:227], v[160:163], a[24:27], v[224:227]
    ds_read_b64_tr_b16 a[8:9], v3 offset:0
    ds_write_b128 v28, a[64:67] offset:22528
    v_mfma_f32_16x16x32_bf16 v[224:227], v[168:171], a[28:31], v[224:227]
    ds_read_b64_tr_b16 a[10:11], v3 offset:37440
    v_mfma_f32_16x16x32_bf16 v[228:231], v[164:167], a[24:27], v[228:231]
    ds_read_b64_tr_b16 a[12:13], v7 offset:9344
    v_mfma_f32_16x16x32_bf16 v[228:231], v[172:175], a[28:31], v[228:231]
    s_waitcnt lgkmcnt(9)
    ds_read_b64_tr_b16 a[14:15], v7 offset:46784
    v_mfma_f32_16x16x32_bf16 v[232:235], v[160:163], a[32:35], v[232:235]
    ds_read_b64_tr_b16 a[16:17], v4 offset:0
    v_mfma_f32_16x16x32_bf16 v[232:235], v[168:171], a[36:39], v[232:235]
    ds_read_b64_tr_b16 a[18:19], v4 offset:37440
    v_mfma_f32_16x16x32_bf16 v[236:239], v[164:167], a[32:35], v[236:239]
    ds_read_b64_tr_b16 a[20:21], v8 offset:9344
    ds_write_b128 v28, a[68:71] offset:23552
    v_mfma_f32_16x16x32_bf16 v[236:239], v[172:175], a[36:39], v[236:239]
    ds_read_b64_tr_b16 a[22:23], v8 offset:46784
    v_mfma_f32_16x16x32_bf16 v[240:243], v[160:163], a[40:43], v[240:243]
    ds_read_b64_tr_b16 a[24:25], v5 offset:0
    v_mfma_f32_16x16x32_bf16 v[240:243], v[168:171], a[44:47], v[240:243]
    ds_read_b64_tr_b16 a[26:27], v5 offset:37440
    v_mfma_f32_16x16x32_bf16 v[244:247], v[164:167], a[40:43], v[244:247]
    ds_read_b64_tr_b16 a[28:29], v9 offset:9344
    v_mfma_f32_16x16x32_bf16 v[244:247], v[172:175], a[44:47], v[244:247]
    s_waitcnt lgkmcnt(8)
    ds_read_b64_tr_b16 a[30:31], v9 offset:46784
    ds_write_b128 v28, a[72:75] offset:24576
    v_cvt_pk_bf16_f32 v176, v176, v177
    v_cvt_pk_bf16_f32 v177, v178, v179
    v_cvt_pk_bf16_f32 v178, v180, v181
    v_cvt_pk_bf16_f32 v179, v182, v183
    ds_write_b128 v28, v[176:179] offset:27648
    ds_write_b128 v28, a[76:79] offset:25600
    v_cvt_pk_bf16_f32 v184, v184, v185
    v_cvt_pk_bf16_f32 v185, v186, v187
    v_cvt_pk_bf16_f32 v186, v188, v189
    v_cvt_pk_bf16_f32 v187, v190, v191
    ds_write_b128 v28, v[184:187] offset:28672
    ds_write_b128 v28, a[80:83] offset:26624
    v_cvt_pk_bf16_f32 v192, v192, v193
    v_cvt_pk_bf16_f32 v193, v194, v195
    v_cvt_pk_bf16_f32 v194, v196, v197
    v_cvt_pk_bf16_f32 v195, v198, v199
    ds_write_b128 v28, v[192:195] offset:29696
    s_barrier
    v_cvt_pk_bf16_f32 v200, v200, v201
    v_cvt_pk_bf16_f32 v201, v202, v203
    v_cvt_pk_bf16_f32 v202, v204, v205
    v_cvt_pk_bf16_f32 v203, v206, v207
    ds_write_b128 v28, v[200:203] offset:30720
    v_cvt_pk_bf16_f32 v208, v208, v209
    v_cvt_pk_bf16_f32 v209, v210, v211
    v_cvt_pk_bf16_f32 v210, v212, v213
    v_cvt_pk_bf16_f32 v211, v214, v215
    ds_write_b128 v28, v[208:211] offset:31744
    v_cvt_pk_bf16_f32 v216, v216, v217
    v_cvt_pk_bf16_f32 v217, v218, v219
    v_cvt_pk_bf16_f32 v218, v220, v221
    v_cvt_pk_bf16_f32 v219, v222, v223
    ds_write_b128 v28, v[216:219] offset:32768
    v_cvt_pk_bf16_f32 v224, v224, v225
    v_cvt_pk_bf16_f32 v225, v226, v227
    v_cvt_pk_bf16_f32 v226, v228, v229
    v_cvt_pk_bf16_f32 v227, v230, v231
    ds_write_b128 v28, v[224:227] offset:33792
    v_cvt_pk_bf16_f32 v232, v232, v233
    v_cvt_pk_bf16_f32 v233, v234, v235
    v_cvt_pk_bf16_f32 v234, v236, v237
    v_cvt_pk_bf16_f32 v235, v238, v239
    ds_write_b128 v28, v[232:235] offset:34816
    v_cvt_pk_bf16_f32 v240, v240, v241
    v_cvt_pk_bf16_f32 v241, v242, v243
    v_cvt_pk_bf16_f32 v242, v244, v245
    v_cvt_pk_bf16_f32 v243, v246, v247
    ds_write_b128 v28, v[240:243] offset:35840
    v_mov_b32 v28, v18
    s_waitcnt lgkmcnt(0)
    s_barrier
    ds_read_b128 a[88:91], v29 offset:18432
    ds_read_b128 a[92:95], v29 offset:19456
    ds_read_b128 a[96:99], v30 offset:27648
    ds_read_b128 a[100:103], v29 offset:27648
    ds_read_b128 a[104:107], v29 offset:28672
    ds_read_b128 a[108:111], v29 offset:29696
    ds_read_b128 a[112:115], v28 offset:26624
    ds_read_b128 a[116:119], v31 offset:34816
    v_add_u32 v29, 37440, v29
    v_add_u32 v30, 37440, v30
    v_add_u32 v31, 37440, v31
    v_add_u32 v28, 37440, v28
    ds_read_b128 a[120:123], v29 offset:18432
    ds_read_b128 a[124:127], v29 offset:19456
    ds_read_b128 a[128:131], v30 offset:27648
    ds_read_b128 a[132:135], v29 offset:27648
    ds_read_b128 a[136:139], v29 offset:28672
    ds_read_b128 a[140:143], v29 offset:29696
    ds_read_b128 a[144:147], v28 offset:26624
    ds_read_b128 a[148:151], v31 offset:34816
    v_add_u32 v29, 37440, v29
    v_add_u32 v30, 37440, v30
    v_add_u32 v31, 37440, v31
    v_add_u32 v28, 37440, v28
    ds_read_b128 a[152:155], v29 offset:18432
    ds_read_b128 a[156:159], v29 offset:19456
    ds_read_b128 a[160:163], v30 offset:27648
    ds_read_b128 a[164:167], v29 offset:27648
    ds_read_b128 a[168:171], v29 offset:28672
    ds_read_b128 a[172:175], v29 offset:29696
    ds_read_b128 a[176:179], v28 offset:26624
    ds_read_b128 a[180:183], v31 offset:34816
    v_add_u32 v29, 37440, v29
    v_add_u32 v30, 37440, v30
    v_add_u32 v31, 37440, v31
    v_add_u32 v28, 37440, v28
    ds_read_b128 a[184:187], v29 offset:18432
    ds_read_b128 a[188:191], v29 offset:19456
    ds_read_b128 a[192:195], v30 offset:27648
    ds_read_b128 a[196:199], v29 offset:27648
    ds_read_b128 a[200:203], v29 offset:28672
    ds_read_b128 a[204:207], v29 offset:29696
    ds_read_b128 a[208:211], v28 offset:26624
    ds_read_b128 a[212:215], v31 offset:34816
    s_waitcnt lgkmcnt(15)
    v_mfma_f32_16x16x32_bf16 a[216:219], a[88:91], a[96:99], 0
    v_mfma_f32_16x16x32_bf16 a[220:223], a[88:91], a[100:103], 0
    v_mfma_f32_16x16x32_bf16 a[224:227], a[88:91], a[104:107], 0
    v_mfma_f32_16x16x32_bf16 a[228:231], a[92:95], a[100:103], 0
    v_mfma_f32_16x16x32_bf16 a[232:235], a[92:95], a[104:107], 0
    v_mfma_f32_16x16x32_bf16 a[236:239], a[92:95], a[108:111], 0
    v_mfma_f32_16x16x32_bf16 a[240:243], a[88:91], v[248:251], 0
    v_mfma_f32_16x16x32_bf16 a[244:247], a[92:95], v[248:251], 0
    v_mfma_f32_16x16x32_bf16 a[248:251], a[112:115], a[116:119], 0
    v_mfma_f32_16x16x32_bf16 a[252:255], a[112:115], v[248:251], 0
    v_mfma_f32_16x16x32_bf16 a[216:219], a[120:123], a[128:131], a[216:219]
    v_mfma_f32_16x16x32_bf16 a[220:223], a[120:123], a[132:135], a[220:223]
    v_mfma_f32_16x16x32_bf16 a[224:227], a[120:123], a[136:139], a[224:227]
    v_mfma_f32_16x16x32_bf16 a[228:231], a[124:127], a[132:135], a[228:231]
    v_mfma_f32_16x16x32_bf16 a[232:235], a[124:127], a[136:139], a[232:235]
    v_mfma_f32_16x16x32_bf16 a[236:239], a[124:127], a[140:143], a[236:239]
    v_mfma_f32_16x16x32_bf16 a[240:243], a[120:123], v[248:251], a[240:243]
    v_mfma_f32_16x16x32_bf16 a[244:247], a[124:127], v[248:251], a[244:247]
    v_mfma_f32_16x16x32_bf16 a[248:251], a[144:147], a[148:151], a[248:251]
    v_mfma_f32_16x16x32_bf16 a[252:255], a[144:147], v[248:251], a[252:255]
    s_add_u32 s68, s79, 4096
    s_add_u32 s69, s79, 8192
    s_waitcnt lgkmcnt(13)
    v_mfma_f32_16x16x32_bf16 a[216:219], a[152:155], a[160:163], a[216:219]
    s_waitcnt lgkmcnt(5)
    v_mfma_f32_16x16x32_bf16 a[216:219], a[184:187], a[192:195], a[216:219]
    v_mfma_f32_16x16x32_bf16 a[220:223], a[152:155], a[164:167], a[220:223]
    s_waitcnt lgkmcnt(4)
    v_mfma_f32_16x16x32_bf16 a[220:223], a[184:187], a[196:199], a[220:223]
    v_mfma_f32_16x16x32_bf16 a[224:227], a[152:155], a[168:171], a[224:227]
    s_waitcnt lgkmcnt(3)
    v_mfma_f32_16x16x32_bf16 a[224:227], a[184:187], a[200:203], a[224:227]
    v_mfma_f32_16x16x32_bf16 a[228:231], a[156:159], a[164:167], a[228:231]
    v_mfma_f32_16x16x32_bf16 a[228:231], a[188:191], a[196:199], a[228:231]
    v_mfma_f32_16x16x32_bf16 a[232:235], a[156:159], a[168:171], a[232:235]
    v_mfma_f32_16x16x32_bf16 a[232:235], a[188:191], a[200:203], a[232:235]
    buffer_store_dwordx4 a[216:219], v18, s[20:23], s79 offen offset:0 sc1
    v_mfma_f32_16x16x32_bf16 a[236:239], a[156:159], a[172:175], a[236:239]
    s_waitcnt lgkmcnt(2)
    v_mfma_f32_16x16x32_bf16 a[236:239], a[188:191], a[204:207], a[236:239]
    buffer_store_dwordx4 a[220:223], v18, s[20:23], s79 offen offset:1024 sc1
    v_mfma_f32_16x16x32_bf16 a[240:243], a[152:155], v[248:251], a[240:243]
    v_mfma_f32_16x16x32_bf16 a[240:243], a[184:187], v[248:251], a[240:243]
    buffer_store_dwordx4 a[224:227], v18, s[20:23], s79 offen offset:2048 sc1
    v_mfma_f32_16x16x32_bf16 a[244:247], a[156:159], v[248:251], a[244:247]
    v_mfma_f32_16x16x32_bf16 a[244:247], a[188:191], v[248:251], a[244:247]
    buffer_store_dwordx4 a[228:231], v18, s[20:23], s79 offen offset:3072 sc1
    v_mfma_f32_16x16x32_bf16 a[248:251], a[176:179], a[180:183], a[248:251]
    s_waitcnt lgkmcnt(0)
    v_mfma_f32_16x16x32_bf16 a[248:251], a[208:211], a[212:215], a[248:251]
    buffer_store_dwordx4 a[232:235], v18, s[20:23], s68 offen offset:0 sc1
    v_mfma_f32_16x16x32_bf16 a[252:255], a[176:179], v[248:251], a[252:255]
    v_mfma_f32_16x16x32_bf16 a[252:255], a[208:211], v[248:251], a[252:255]
    buffer_store_dwordx4 a[236:239], v18, s[20:23], s68 offen offset:1024 sc1
    v_mfma_f32_16x16x32_bf16 v[176:179], a[0:3], v[32:35], 0
    ds_read_b64_tr_b16 a[32:33], v2 offset:2048
    v_mfma_f32_16x16x32_bf16 v[176:179], a[4:7], v[40:43], v[176:179]
    ds_read_b64_tr_b16 a[34:35], v2 offset:39488
    v_mfma_f32_16x16x32_bf16 v[180:183], a[0:3], v[36:39], 0
    ds_read_b64_tr_b16 a[36:37], v6 offset:11392
    buffer_store_dwordx4 a[240:243], v18, s[20:23], s68 offen offset:2048 sc1
    v_mfma_f32_16x16x32_bf16 v[180:183], a[4:7], v[44:47], v[180:183]
    ds_read_b64_tr_b16 a[38:39], v6 offset:48832
    v_mfma_f32_16x16x32_bf16 v[184:187], a[8:11], v[32:35], 0
    ds_read_b64_tr_b16 a[40:41], v3 offset:2048
    v_mfma_f32_16x16x32_bf16 v[184:187], a[12:15], v[40:43], v[184:187]
    ds_read_b64_tr_b16 a[42:43], v3 offset:39488
    v_mfma_f32_16x16x32_bf16 v[188:191], a[8:11], v[36:39], 0
    ds_read_b64_tr_b16 a[44:45], v7 offset:11392
    buffer_store_dwordx4 a[244:247], v18, s[20:23], s68 offen offset:3072 sc1
    v_mfma_f32_16x16x32_bf16 v[188:191], a[12:15], v[44:47], v[188:191]
    ds_read_b64_tr_b16 a[46:47], v7 offset:48832
    v_mfma_f32_16x16x32_bf16 v[192:195], a[16:19], v[32:35], 0
    ds_read_b64_tr_b16 a[0:1], v4 offset:2048
    v_mfma_f32_16x16x32_bf16 v[192:195], a[20:23], v[40:43], v[192:195]
    ds_read_b64_tr_b16 a[2:3], v4 offset:39488
    v_mfma_f32_16x16x32_bf16 v[196:199], a[16:19], v[36:39], 0
    ds_read_b64_tr_b16 a[4:5], v8 offset:11392
    v_mfma_f32_16x16x32_bf16 v[196:199], a[20:23], v[44:47], v[196:199]
    ds_read_b64_tr_b16 a[6:7], v8 offset:48832
    buffer_store_dwordx4 a[248:251], v18, s[20:23], s69 offen offset:0 sc1
    v_mfma_f32_16x16x32_bf16 v[200:203], a[24:27], v[32:35], 0
    ds_read_b64_tr_b16 a[8:9], v5 offset:2048
    v_mfma_f32_16x16x32_bf16 v[200:203], a[28:31], v[40:43], v[200:203]
    ds_read_b64_tr_b16 a[10:11], v5 offset:39488
    v_mfma_f32_16x16x32_bf16 v[204:207], a[24:27], v[36:39], 0
    ds_read_b64_tr_b16 a[12:13], v9 offset:11392
    v_mfma_f32_16x16x32_bf16 v[204:207], a[28:31], v[44:47], v[204:207]
    s_waitcnt lgkmcnt(7)
    ds_read_b64_tr_b16 a[14:15], v9 offset:48832
    buffer_store_dwordx4 a[252:255], v18, s[20:23], s69 offen offset:1024 sc1
    v_mfma_f32_16x16x32_bf16 v[208:211], a[32:35], v[32:35], 0
    ds_read_b64_tr_b16 a[16:17], v2 offset:4096
    v_mfma_f32_16x16x32_bf16 v[208:211], a[36:39], v[40:43], v[208:211]
    ds_read_b64_tr_b16 a[18:19], v2 offset:41536
    v_mfma_f32_16x16x32_bf16 v[212:215], a[32:35], v[36:39], 0
    ds_read_b64_tr_b16 a[20:21], v6 offset:13440
    v_mfma_f32_16x16x32_bf16 v[212:215], a[36:39], v[44:47], v[212:215]
    s_waitcnt vmcnt(17)
    ds_read_b64_tr_b16 a[22:23], v6 offset:50880
    v_mfma_f32_16x16x32_bf16 v[216:219], a[40:43], v[32:35], 0
    s_barrier
    ds_read_b64_tr_b16 a[24:25], v2 offset:6144
    v_mfma_f32_16x16x32_bf16 v[216:219], a[44:47], v[40:43], v[216:219]
    ds_read_b64_tr_b16 a[26:27], v2 offset:43584
    v_mfma_f32_16x16x32_bf16 v[220:223], a[40:43], v[36:39], 0
    ds_read_b64_tr_b16 a[28:29], v6 offset:15488
    v_mfma_f32_16x16x32_bf16 v[220:223], a[44:47], v[44:47], v[220:223]
    s_waitcnt lgkmcnt(7)
    ds_read_b64_tr_b16 a[30:31], v6 offset:52928
    v_mfma_f32_16x16x32_bf16 v[224:227], a[0:3], v[32:35], 0
    ds_read_b64_tr_b16 a[32:33], v3 offset:6144
    v_mfma_f32_16x16x32_bf16 v[224:227], a[4:7], v[40:43], v[224:227]
    ds_read_b64_tr_b16 a[34:35], v3 offset:43584
    v_mfma_f32_16x16x32_bf16 v[228:231], a[0:3], v[36:39], 0
    ds_read_b64_tr_b16 a[36:37], v7 offset:15488
    v_mfma_f32_16x16x32_bf16 v[228:231], a[4:7], v[44:47], v[228:231]
    ds_read_b64_tr_b16 a[38:39], v7 offset:52928
    v_mfma_f32_16x16x32_bf16 v[232:235], a[8:11], v[32:35], 0
    ds_read_b64_tr_b16 a[40:41], v4 offset:6144
    v_mfma_f32_16x16x32_bf16 v[232:235], a[12:15], v[40:43], v[232:235]
    ds_read_b64_tr_b16 a[42:43], v4 offset:43584
    v_mfma_f32_16x16x32_bf16 v[236:239], a[8:11], v[36:39], 0
    ds_read_b64_tr_b16 a[44:45], v8 offset:15488
    v_mfma_f32_16x16x32_bf16 v[236:239], a[12:15], v[44:47], v[236:239]
    s_waitcnt lgkmcnt(7)
    ds_read_b64_tr_b16 a[46:47], v8 offset:52928
    v_mfma_f32_16x16x32_bf16 v[240:243], a[16:19], v[32:35], 0
    ds_read_b64_tr_b16 a[0:1], v5 offset:6144
    v_mfma_f32_16x16x32_bf16 v[240:243], a[20:23], v[40:43], v[240:243]
    ds_read_b64_tr_b16 a[2:3], v5 offset:43584
    v_mfma_f32_16x16x32_bf16 v[244:247], a[16:19], v[36:39], 0
    ds_read_b64_tr_b16 a[4:5], v9 offset:15488
    v_mfma_f32_16x16x32_bf16 v[244:247], a[20:23], v[44:47], v[244:247]
    ds_read_b64_tr_b16 a[6:7], v9 offset:52928
    v_mfma_f32_16x16x32_bf16 v[176:179], a[24:27], v[48:51], v[176:179]
    s_add_u32 m0, s67, 18432
    ds_read_b64_tr_b16 a[8:9], v2 offset:8192
    s_waitcnt vmcnt(10)
    v_cmp_le_u32 vcc, 16, v21
    s_nop 0
    s_cmp_eq_u64 vcc, exec
    s_cbranch_scc0 L_slow_40
L_back_41:
    v_mfma_f32_16x16x32_bf16 v[176:179], a[28:31], v[56:59], v[176:179]
    s_add_u32 s72, s73, 662400
    ds_read_b64_tr_b16 a[10:11], v2 offset:45632
    buffer_load_dwordx4 v14, s[12:15], s72 offen lds
    v_mfma_f32_16x16x32_bf16 v[180:183], a[24:27], v[52:55], v[180:183]
    ds_read_b64_tr_b16 a[12:13], v6 offset:17536
    v_mfma_f32_16x16x32_bf16 v[180:183], a[28:31], v[60:63], v[180:183]
    s_waitcnt lgkmcnt(7)
    ds_read_b64_tr_b16 a[14:15], v6 offset:54976
    v_mfma_f32_16x16x32_bf16 v[184:187], a[32:35], v[48:51], v[184:187]
    ds_read_b64_tr_b16 a[16:17], v3 offset:8192
    buffer_load_dwordx4 v15, s[12:15], s72 offen offset:1024 lds
    v_mfma_f32_16x16x32_bf16 v[184:187], a[36:39], v[56:59], v[184:187]
    ds_read_b64_tr_b16 a[18:19], v3 offset:45632
    v_mfma_f32_16x16x32_bf16 v[188:191], a[32:35], v[52:55], v[188:191]
    s_add_u32 m0, s67, 20480
    ds_read_b64_tr_b16 a[20:21], v7 offset:17536
    v_mfma_f32_16x16x32_bf16 v[188:191], a[36:39], v[60:63], v[188:191]
    s_add_u32 s72, s73, 662528
    ds_read_b64_tr_b16 a[22:23], v7 offset:54976
    buffer_load_dwordx4 v14, s[12:15], s72 offen lds
    v_mfma_f32_16x16x32_bf16 v[192:195], a[40:43], v[48:51], v[192:195]
    ds_read_b64_tr_b16 a[24:25], v4 offset:8192
    v_mfma_f32_16x16x32_bf16 v[192:195], a[44:47], v[56:59], v[192:195]
    ds_read_b64_tr_b16 a[26:27], v4 offset:45632
    v_mfma_f32_16x16x32_bf16 v[196:199], a[40:43], v[52:55], v[196:199]
    ds_read_b64_tr_b16 a[28:29], v8 offset:17536
    buffer_load_dwordx4 v15, s[12:15], s72 offen offset:1024 lds
    v_mfma_f32_16x16x32_bf16 v[196:199], a[44:47], v[60:63], v[196:199]
    s_waitcnt lgkmcnt(7)
    ds_read_b64_tr_b16 a[30:31], v8 offset:54976
    v_mfma_f32_16x16x32_bf16 v[200:203], a[0:3], v[48:51], v[200:203]
    s_add_u32 m0, s67, 22528
    ds_read_b64_tr_b16 a[32:33], v5 offset:8192
    v_mfma_f32_16x16x32_bf16 v[200:203], a[4:7], v[56:59], v[200:203]
    s_add_u32 s72, s73, 662656
    ds_read_b64_tr_b16 a[34:35], v5 offset:45632
    buffer_load_dwordx4 v14, s[12:15], s72 offen lds
    v_mfma_f32_16x16x32_bf16 v[204:207], a[0:3], v[52:55], v[204:207]
    ds_read_b64_tr_b16 a[36:37], v9 offset:17536
    v_mfma_f32_16x16x32_bf16 v[204:207], a[4:7], v[60:63], v[204:207]
    ds_read_b64_tr_b16 a[38:39], v9 offset:54976
    v_mfma_f32_16x16x32_bf16 v[208:211], a[8:11], v[48:51], v[208:211]
    ds_read_b64_tr_b16 a[40:41], v2 offset:10240
    buffer_load_dwordx4 v15, s[12:15], s72 offen offset:1024 lds
    v_mfma_f32_16x16x32_bf16 v[208:211], a[12:15], v[56:59], v[208:211]
    ds_read_b64_tr_b16 a[42:43], v2 offset:47680
    v_mfma_f32_16x16x32_bf16 v[212:215], a[8:11], v[52:55], v[212:215]
    s_add_u32 m0, s67, 24576
    ds_read_b64_tr_b16 a[44:45], v6 offset:19584
    v_mfma_f32_16x16x32_bf16 v[212:215], a[12:15], v[60:63], v[212:215]
    s_waitcnt lgkmcnt(7)
    ds_read_b64_tr_b16 a[46:47], v6 offset:57024
    v_mfma_f32_16x16x32_bf16 v[216:219], a[16:19], v[48:51], v[216:219]
    s_barrier
    ds_read_b64_tr_b16 a[0:1], v2 offset:12288
    v_mfma_f32_16x16x32_bf16 v[216:219], a[20:23], v[56:59], v[216:219]
    s_add_u32 s72, s73, 883584
    ds_read_b64_tr_b16 a[2:3], v2 offset:49728
    buffer_load_dwordx4 v14, s[12:15], s72 offen lds
    v_mfma_f32_16x16x32_bf16 v[220:223], a[16:19], v[52:55], v[220:223]
    ds_read_b64_tr_b16 a[4:5], v6 offset:21632
    buffer_load_dwordx4 v15, s[12:15], s72 offen offset:1024 lds
    v_mfma_f32_16x16x32_bf16 v[220:223], a[20:23], v[60:63], v[220:223]
    ds_read_b64_tr_b16 a[6:7], v6 offset:59072
    v_mfma_f32_16x16x32_bf16 v[224:227], a[24:27], v[48:51], v[224:227]
    s_add_u32 m0, s67, 26624
    ds_read_b64_tr_b16 a[8:9], v3 offset:12288
    v_mfma_f32_16x16x32_bf16 v[224:227], a[28:31], v[56:59], v[224:227]
    s_add_u32 s72, s73, 883712
    ds_read_b64_tr_b16 a[10:11], v3 offset:49728
    buffer_load_dwordx4 v14, s[12:15], s72 offen lds
    v_mfma_f32_16x16x32_bf16 v[228:231], a[24:27], v[52:55], v[228:231]
    ds_read_b64_tr_b16 a[12:13], v7 offset:21632
    v_mfma_f32_16x16x32_bf16 v[228:231], a[28:31], v[60:63], v[228:231]
    s_waitcnt lgkmcnt(7)
    ds_read_b64_tr_b16 a[14:15], v7 offset:59072
    v_mfma_f32_16x16x32_bf16 v[232:235], a[32:35], v[48:51], v[232:235]
    ds_read_b64_tr_b16 a[16:17], v4 offset:12288
    buffer_load_dwordx4 v15, s[12:15], s72 offen offset:1024 lds
    v_mfma_f32_16x16x32_bf16 v[232:235], a[36:39], v[56:59], v[232:235]
    ds_read_b64_tr_b16 a[18:19], v4 offset:49728
    v_mfma_f32_16x16x32_bf16 v[236:239], a[32:35], v[52:55], v[236:239]
    s_add_u32 m0, s67, 28672
    ds_read_b64_tr_b16 a[20:21], v8 offset:21632
    v_mfma_f32_16x16x32_bf16 v[236:239], a[36:39], v[60:63], v[236:239]
    s_add_u32 s72, s73, 883840
    ds_read_b64_tr_b16 a[22:23], v8 offset:59072
    buffer_load_dwordx4 v14, s[12:15], s72 offen lds
    v_mfma_f32_16x16x32_bf16 v[240:243], a[40:43], v[48:51], v[240:243]
    ds_read_b64_tr_b16 a[24:25], v5 offset:12288
    v_mfma_f32_16x16x32_bf16 v[240:243], a[44:47], v[56:59], v[240:243]
    ds_read_b64_tr_b16 a[26:27], v5 offset:49728
    v_mfma_f32_16x16x32_bf16 v[244:247], a[40:43], v[52:55], v[244:247]
    ds_read_b64_tr_b16 a[28:29], v9 offset:21632
    buffer_load_dwordx4 v15, s[12:15], s72 offen offset:1024 lds
    v_mfma_f32_16x16x32_bf16 v[244:247], a[44:47], v[60:63], v[244:247]
    s_waitcnt lgkmcnt(7)
    ds_read_b64_tr_b16 a[30:31], v9 offset:59072
    v_mfma_f32_16x16x32_bf16 v[176:179], a[0:3], v[64:67], v[176:179]
    ds_read_b64_tr_b16 a[32:33], v2 offset:14336
    v_mfma_f32_16x16x32_bf16 v[176:179], a[4:7], v[72:75], v[176:179]
    ds_read_b64_tr_b16 a[34:35], v2 offset:51776
    v_mfma_f32_16x16x32_bf16 v[180:183], a[0:3], v[68:71], v[180:183]
    s_add_u32 m0, s67, 30720
    ds_read_b64_tr_b16 a[36:37], v6 offset:23680
    v_mfma_f32_16x16x32_bf16 v[180:183], a[4:7], v[76:79], v[180:183]
    s_add_u32 s72, s73, 1104768
    ds_read_b64_tr_b16 a[38:39], v6 offset:61120
    buffer_load_dwordx4 v14, s[12:15], s72 offen lds
    v_mfma_f32_16x16x32_bf16 v[184:187], a[8:11], v[64:67], v[184:187]
    ds_read_b64_tr_b16 a[40:41], v3 offset:14336
    v_mfma_f32_16x16x32_bf16 v[184:187], a[12:15], v[72:75], v[184:187]
    ds_read_b64_tr_b16 a[42:43], v3 offset:51776
    v_mfma_f32_16x16x32_bf16 v[188:191], a[8:11], v[68:71], v[188:191]
    ds_read_b64_tr_b16 a[44:45], v7 offset:23680
    v_mfma_f32_16x16x32_bf16 v[188:191], a[12:15], v[76:79], v[188:191]
    s_waitcnt lgkmcnt(7)
    ds_read_b64_tr_b16 a[46:47], v7 offset:61120
    v_mfma_f32_16x16x32_bf16 v[192:195], a[16:19], v[64:67], v[192:195]
    ds_read_b64_tr_b16 a[0:1], v4 offset:14336
    v_mfma_f32_16x16x32_bf16 v[192:195], a[20:23], v[72:75], v[192:195]
    ds_read_b64_tr_b16 a[2:3], v4 offset:51776
    buffer_load_dwordx4 v15, s[12:15], s72 offen offset:1024 lds
    v_mfma_f32_16x16x32_bf16 v[196:199], a[16:19], v[68:71], v[196:199]
    ds_read_b64_tr_b16 a[4:5], v8 offset:23680
    v_mfma_f32_16x16x32_bf16 v[196:199], a[20:23], v[76:79], v[196:199]
    ds_read_b64_tr_b16 a[6:7], v8 offset:61120
    v_mfma_f32_16x16x32_bf16 v[200:203], a[24:27], v[64:67], v[200:203]
    ds_read_b64_tr_b16 a[8:9], v5 offset:14336
    v_mfma_f32_16x16x32_bf16 v[200:203], a[28:31], v[72:75], v[200:203]
    ds_read_b64_tr_b16 a[10:11], v5 offset:51776
    v_mfma_f32_16x16x32_bf16 v[204:207], a[24:27], v[68:71], v[204:207]
    s_add_u32 m0, s67, 32768
    ds_read_b64_tr_b16 a[12:13], v9 offset:23680
    v_mfma_f32_16x16x32_bf16 v[204:207], a[28:31], v[76:79], v[204:207]
    s_waitcnt lgkmcnt(7)
    ds_read_b64_tr_b16 a[14:15], v9 offset:61120
    v_mfma_f32_16x16x32_bf16 v[208:211], a[32:35], v[64:67], v[208:211]
    s_add_u32 s72, s73, 1104896
    ds_read_b64_tr_b16 a[16:17], v2 offset:16384
    buffer_load_dwordx4 v14, s[12:15], s72 offen lds
    v_mfma_f32_16x16x32_bf16 v[208:211], a[36:39], v[72:75], v[208:211]
    ds_read_b64_tr_b16 a[18:19], v2 offset:53824
    v_mfma_f32_16x16x32_bf16 v[212:215], a[32:35], v[68:71], v[212:215]
    ds_read_b64_tr_b16 a[20:21], v6 offset:25728
    v_mfma_f32_16x16x32_bf16 v[212:215], a[36:39], v[76:79], v[212:215]
    s_waitcnt vmcnt(9)
    ds_read_b64_tr_b16 a[22:23], v6 offset:63168
    v_mfma_f32_16x16x32_bf16 v[216:219], a[40:43], v[64:67], v[216:219]
    s_barrier
    ds_read_b64_tr_b16 a[24:25], v2 offset:18432
    v_mfma_f32_16x16x32_bf16 v[216:219], a[44:47], v[72:75], v[216:219]
    ds_read_b64_tr_b16 a[26:27], v2 offset:55872
    buffer_load_dwordx4 v15, s[12:15], s72 offen offset:1024 lds
    v_mfma_f32_16x16x32_bf16 v[220:223], a[40:43], v[68:71], v[220:223]
    ds_read_b64_tr_b16 a[28:29], v6 offset:27776
    v_mfma_f32_16x16x32_bf16 v[220:223], a[44:47], v[76:79], v[220:223]
    s_waitcnt lgkmcnt(7)
    ds_read_b64_tr_b16 a[30:31], v6 offset:65216
    v_mfma_f32_16x16x32_bf16 v[224:227], a[0:3], v[64:67], v[224:227]
    ds_read_b64_tr_b16 a[32:33], v3 offset:18432
    v_mfma_f32_16x16x32_bf16 v[224:227], a[4:7], v[72:75], v[224:227]
    ds_read_b64_tr_b16 a[34:35], v3 offset:55872
    v_mfma_f32_16x16x32_bf16 v[228:231], a[0:3], v[68:71], v[228:231]
    s_add_u32 m0, s67, 34816
    ds_read_b64_tr_b16 a[36:37], v7 offset:27776
    v_mfma_f32_16x16x32_bf16 v[228:231], a[4:7], v[76:79], v[228:231]
    s_add_u32 s72, s73, 1105024
    ds_read_b64_tr_b16 a[38:39], v7 offset:65216
    buffer_load_dwordx4 v14, s[12:15], s72 offen lds
    v_mfma_f32_16x16x32_bf16 v[232:235], a[8:11], v[64:67], v[232:235]
    ds_read_b64_tr_b16 a[40:41], v4 offset:18432
    v_mfma_f32_16x16x32_bf16 v[232:235], a[12:15], v[72:75], v[232:235]
    ds_read_b64_tr_b16 a[42:43], v4 offset:55872
    v_mfma_f32_16x16x32_bf16 v[236:239], a[8:11], v[68:71], v[236:239]
    ds_read_b64_tr_b16 a[44:45], v8 offset:27776
    v_mfma_f32_16x16x32_bf16 v[236:239], a[12:15], v[76:79], v[236:239]
    s_waitcnt lgkmcnt(7)
    ds_read_b64_tr_b16 a[46:47], v8 offset:65216
    v_mfma_f32_16x16x32_bf16 v[240:243], a[16:19], v[64:67], v[240:243]
    ds_read_b64_tr_b16 a[0:1], v5 offset:18432
    v_mfma_f32_16x16x32_bf16 v[240:243], a[20:23], v[72:75], v[240:243]
    ds_read_b64_tr_b16 a[2:3], v5 offset:55872
    buffer_load_dwordx4 v15, s[12:15], s72 offen offset:1024 lds
    v_mfma_f32_16x16x32_bf16 v[244:247], a[16:19], v[68:71], v[244:247]
    ds_read_b64_tr_b16 a[4:5], v9 offset:27776
    v_mfma_f32_16x16x32_bf16 v[244:247], a[20:23], v[76:79], v[244:247]
    ds_read_b64_tr_b16 a[6:7], v9 offset:65216
    v_mfma_f32_16x16x32_bf16 v[176:179], a[24:27], v[80:83], v[176:179]
    ds_read_b64_tr_b16 a[8:9], v2 offset:20480
    v_mfma_f32_16x16x32_bf16 v[176:179], a[28:31], v[88:91], v[176:179]
    s_add_u32 s68, s84, 0
    ds_read_b64_tr_b16 a[10:11], v2 offset:57920
    buffer_load_dwordx4 v[32:35], v17, s[20:23], s68 offen sc1
    v_mfma_f32_16x16x32_bf16 v[180:183], a[24:27], v[84:87], v[180:183]
    s_add_u32 m0, s67, 0
    ds_read_b64_tr_b16 a[12:13], v6 offset:29824
    v_mfma_f32_16x16x32_bf16 v[180:183], a[28:31], v[92:95], v[180:183]
    s_waitcnt lgkmcnt(7)
    ds_read_b64_tr_b16 a[14:15], v10 offset:1728
    v_mfma_f32_16x16x32_bf16 v[184:187], a[32:35], v[80:83], v[184:187]
    s_add_u32 s72, s73, 1325952
    ds_read_b64_tr_b16 a[16:17], v3 offset:20480
    buffer_load_dwordx4 v14, s[12:15], s72 offen lds
    v_mfma_f32_16x16x32_bf16 v[184:187], a[36:39], v[88:91], v[184:187]
    ds_read_b64_tr_b16 a[18:19], v3 offset:57920
    v_mfma_f32_16x16x32_bf16 v[188:191], a[32:35], v[84:87], v[188:191]
    s_add_u32 s68, s84, 40960
    ds_read_b64_tr_b16 a[20:21], v7 offset:29824
    buffer_load_dwordx4 v[36:39], v17, s[20:23], s68 offen sc1
    v_mfma_f32_16x16x32_bf16 v[188:191], a[36:39], v[92:95], v[188:191]
    ds_read_b64_tr_b16 a[22:23], v11 offset:1728
    v_mfma_f32_16x16x32_bf16 v[192:195], a[40:43], v[80:83], v[192:195]
    ds_read_b64_tr_b16 a[24:25], v4 offset:20480
    v_mfma_f32_16x16x32_bf16 v[192:195], a[44:47], v[88:91], v[192:195]
    ds_read_b64_tr_b16 a[26:27], v4 offset:57920
    buffer_load_dwordx4 v15, s[12:15], s72 offen offset:1024 lds
    v_mfma_f32_16x16x32_bf16 v[196:199], a[40:43], v[84:87], v[196:199]
    ds_read_b64_tr_b16 a[28:29], v8 offset:29824
    v_mfma_f32_16x16x32_bf16 v[196:199], a[44:47], v[92:95], v[196:199]
    s_waitcnt lgkmcnt(7)
    ds_read_b64_tr_b16 a[30:31], v12 offset:1728
    v_mfma_f32_16x16x32_bf16 v[200:203], a[0:3], v[80:83], v[200:203]
    s_add_u32 s68, s84, 81920
    ds_read_b64_tr_b16 a[32:33], v5 offset:20480
    buffer_load_dwordx4 v[40:43], v17, s[20:23], s68 offen sc1
    v_mfma_f32_16x16x32_bf16 v[200:203], a[4:7], v[88:91], v[200:203]
    s_add_u32 m0, s67, 2048
    ds_read_b64_tr_b16 a[34:35], v5 offset:57920
    v_mfma_f32_16x16x32_bf16 v[204:207], a[0:3], v[84:87], v[204:207]
L_pad_a1_1:
    s_cbranch_execz L_walk_ret
    s_add_u32 s72, s73, 1326080
    ds_read_b64_tr_b16 a[36:37], v9 offset:29824
    buffer_load_dwordx4 v14, s[12:15], s72 offen lds
    v_mfma_f32_16x16x32_bf16 v[204:207], a[4:7], v[92:95], v[204:207]
    ds_read_b64_tr_b16 a[38:39], v13 offset:1728
    v_mfma_f32_16x16x32_bf16 v[208:211], a[8:11], v[80:83], v[208:211]
    s_add_u32 s68, s84, 122880
    ds_read_b64_tr_b16 a[40:41], v2 offset:22528
    buffer_load_dwordx4 v[44:47], v17, s[20:23], s68 offen sc1
    v_mfma_f32_16x16x32_bf16 v[208:211], a[12:15], v[88:91], v[208:211]
    ds_read_b64_tr_b16 a[42:43], v2 offset:59968
    v_mfma_f32_16x16x32_bf16 v[212:215], a[8:11], v[84:87], v[212:215]
    ds_read_b64_tr_b16 a[44:45], v6 offset:31872
    v_mfma_f32_16x16x32_bf16 v[212:215], a[12:15], v[92:95], v[212:215]
    s_waitcnt vmcnt(13) lgkmcnt(7)
    ds_read_b64_tr_b16 a[46:47], v10 offset:3776
    v_mfma_f32_16x16x32_bf16 v[216:219], a[16:19], v[80:83], v[216:219]
    s_barrier
    ds_read_b64_tr_b16 a[0:1], v2 offset:24576
    v_mfma_f32_16x16x32_bf16 v[216:219], a[20:23], v[88:91], v[216:219]
    s_add_u32 s68, s84, 163840
    ds_read_b64_tr_b16 a[2:3], v2 offset:62016
    buffer_load_dwordx4 v[48:51], v17, s[20:23], s68 offen sc1
    v_mfma_f32_16x16x32_bf16 v[220:223], a[16:19], v[84:87], v[220:223]
    ds_read_b64_tr_b16 a[4:5], v6 offset:33920
    buffer_load_dwordx4 v15, s[12:15], s72 offen offset:1024 lds
    v_mfma_f32_16x16x32_bf16 v[220:223], a[20:23], v[92:95], v[220:223]
    ds_read_b64_tr_b16 a[6:7], v10 offset:5824
    v_mfma_f32_16x16x32_bf16 v[224:227], a[24:27], v[80:83], v[224:227]
    s_add_u32 s68, s84, 204800
    ds_read_b64_tr_b16 a[8:9], v3 offset:24576
    buffer_load_dwordx4 v[52:55], v17, s[20:23], s68 offen sc1
    v_mfma_f32_16x16x32_bf16 v[224:227], a[28:31], v[88:91], v[224:227]
    ds_read_b64_tr_b16 a[10:11], v3 offset:62016
    v_mfma_f32_16x16x32_bf16 v[228:231], a[24:27], v[84:87], v[228:231]
    s_add_u32 m0, s67, 4096
    ds_read_b64_tr_b16 a[12:13], v7 offset:33920
    v_mfma_f32_16x16x32_bf16 v[228:231], a[28:31], v[92:95], v[228:231]
    s_waitcnt lgkmcnt(7)
    ds_read_b64_tr_b16 a[14:15], v11 offset:5824
    v_mfma_f32_16x16x32_bf16 v[232:235], a[32:35], v[80:83], v[232:235]
    s_add_u32 s72, s73, 1326208
    ds_read_b64_tr_b16 a[16:17], v4 offset:24576
    buffer_load_dwordx4 v14, s[12:15], s72 offen lds
    v_mfma_f32_16x16x32_bf16 v[232:235], a[36:39], v[88:91], v[232:235]
    s_add_u32 s68, s84, 245760
    ds_read_b64_tr_b16 a[18:19], v4 offset:62016
    buffer_load_dwordx4 v[56:59], v17, s[20:23], s68 offen sc1
    v_mfma_f32_16x16x32_bf16 v[236:239], a[32:35], v[84:87], v[236:239]
    ds_read_b64_tr_b16 a[20:21], v8 offset:33920
    v_mfma_f32_16x16x32_bf16 v[236:239], a[36:39], v[92:95], v[236:239]
    ds_read_b64_tr_b16 a[22:23], v12 offset:5824
    v_mfma_f32_16x16x32_bf16 v[240:243], a[40:43], v[80:83], v[240:243]
    ds_read_b64_tr_b16 a[24:25], v5 offset:24576
    buffer_load_dwordx4 v15, s[12:15], s72 offen offset:1024 lds
    v_mfma_f32_16x16x32_bf16 v[240:243], a[44:47], v[88:91], v[240:243]
    ds_read_b64_tr_b16 a[26:27], v5 offset:62016
    v_mfma_f32_16x16x32_bf16 v[244:247], a[40:43], v[84:87], v[244:247]
    s_add_u32 s68, s84, 286720
    ds_read_b64_tr_b16 a[28:29], v9 offset:33920
    buffer_load_dwordx4 v[60:63], v17, s[20:23], s68 offen sc1
    v_mfma_f32_16x16x32_bf16 v[244:247], a[44:47], v[92:95], v[244:247]
    s_waitcnt lgkmcnt(7)
    ds_read_b64_tr_b16 a[30:31], v13 offset:5824
    v_mfma_f32_16x16x32_bf16 v[176:179], a[0:3], v[96:99], v[176:179]
    s_add_u32 m0, s67, 6144
    ds_read_b64_tr_b16 a[32:33], v2 offset:26624
    v_mfma_f32_16x16x32_bf16 v[176:179], a[4:7], v[104:107], v[176:179]
    s_add_u32 s72, s73, 1547136
    ds_read_b64_tr_b16 a[34:35], v2 offset:64064
    buffer_load_dwordx4 v14, s[12:15], s72 offen lds
    v_mfma_f32_16x16x32_bf16 v[180:183], a[0:3], v[100:103], v[180:183]
    ds_read_b64_tr_b16 a[36:37], v6 offset:35968
    v_mfma_f32_16x16x32_bf16 v[180:183], a[4:7], v[108:111], v[180:183]
    ds_read_b64_tr_b16 a[38:39], v10 offset:7872
    v_mfma_f32_16x16x32_bf16 v[184:187], a[8:11], v[96:99], v[184:187]
    ds_read_b64_tr_b16 a[40:41], v3 offset:26624
    v_mfma_f32_16x16x32_bf16 v[184:187], a[12:15], v[104:107], v[184:187]
    s_add_u32 s68, s84, 327680
    ds_read_b64_tr_b16 a[42:43], v3 offset:64064
    buffer_load_dwordx4 v[64:67], v17, s[20:23], s68 offen sc1
    v_mfma_f32_16x16x32_bf16 v[188:191], a[8:11], v[100:103], v[188:191]
    ds_read_b64_tr_b16 a[44:45], v7 offset:35968
    v_mfma_f32_16x16x32_bf16 v[188:191], a[12:15], v[108:111], v[188:191]
    s_waitcnt lgkmcnt(7)
    ds_read_b64_tr_b16 a[46:47], v11 offset:7872
    v_mfma_f32_16x16x32_bf16 v[192:195], a[16:19], v[96:99], v[192:195]
    ds_read_b64_tr_b16 a[0:1], v4 offset:26624
    v_mfma_f32_16x16x32_bf16 v[192:195], a[20:23], v[104:107], v[192:195]
    ds_read_b64_tr_b16 a[2:3], v4 offset:64064
    buffer_load_dwordx4 v15, s[12:15], s72 offen offset:1024 lds
    v_mfma_f32_16x16x32_bf16 v[196:199], a[16:19], v[100:103], v[196:199]
    ds_read_b64_tr_b16 a[4:5], v8 offset:35968
    v_mfma_f32_16x16x32_bf16 v[196:199], a[20:23], v[108:111], v[196:199]
    ds_read_b64_tr_b16 a[6:7], v12 offset:7872
    v_mfma_f32_16x16x32_bf16 v[200:203], a[24:27], v[96:99], v[200:203]
    s_add_u32 s68, s84, 368640
    ds_read_b64_tr_b16 a[8:9], v5 offset:26624
    buffer_load_dwordx4 v[68:71], v17, s[20:23], s68 offen sc1
    v_mfma_f32_16x16x32_bf16 v[200:203], a[28:31], v[104:107], v[200:203]
    ds_read_b64_tr_b16 a[10:11], v5 offset:64064
    v_mfma_f32_16x16x32_bf16 v[204:207], a[24:27], v[100:103], v[204:207]
    ds_read_b64_tr_b16 a[12:13], v9 offset:35968
    v_mfma_f32_16x16x32_bf16 v[204:207], a[28:31], v[108:111], v[204:207]
    s_waitcnt lgkmcnt(7)
    ds_read_b64_tr_b16 a[14:15], v13 offset:7872
    v_mfma_f32_16x16x32_bf16 v[208:211], a[32:35], v[96:99], v[208:211]
    s_add_u32 m0, s67, 8192
    ds_read_b64_tr_b16 a[16:17], v2 offset:28672
    v_mfma_f32_16x16x32_bf16 v[208:211], a[36:39], v[104:107], v[208:211]
    s_add_u32 s72, s73, 1547264
    ds_read_b64_tr_b16 a[18:19], v6 offset:576
    buffer_load_dwordx4 v14, s[12:15], s72 offen lds
    v_mfma_f32_16x16x32_bf16 v[212:215], a[32:35], v[100:103], v[212:215]
    ds_read_b64_tr_b16 a[20:21], v6 offset:38016
    v_mfma_f32_16x16x32_bf16 v[212:215], a[36:39], v[108:111], v[212:215]
    s_waitcnt vmcnt(19)
    ds_read_b64_tr_b16 a[22:23], v10 offset:9920
    buffer_load_dwordx4 v15, s[12:15], s72 offen offset:1024 lds
    v_mfma_f32_16x16x32_bf16 v[216:219], a[40:43], v[96:99], v[216:219]
    s_barrier
    ds_read_b64_tr_b16 a[24:25], v2 offset:30720
    v_mfma_f32_16x16x32_bf16 v[216:219], a[44:47], v[104:107], v[216:219]
    ds_read_b64_tr_b16 a[26:27], v6 offset:2624
    v_mfma_f32_16x16x32_bf16 v[220:223], a[40:43], v[100:103], v[220:223]
    ds_read_b64_tr_b16 a[28:29], v6 offset:40064
    v_mfma_f32_16x16x32_bf16 v[220:223], a[44:47], v[108:111], v[220:223]
    s_waitcnt lgkmcnt(7)
    ds_read_b64_tr_b16 a[30:31], v10 offset:11968
    v_mfma_f32_16x16x32_bf16 v[224:227], a[0:3], v[96:99], v[224:227]
    s_add_u32 s68, s84, 409600
    ds_read_b64_tr_b16 a[32:33], v3 offset:30720
    buffer_load_dwordx4 v[72:75], v17, s[20:23], s68 offen sc1
    v_mfma_f32_16x16x32_bf16 v[224:227], a[4:7], v[104:107], v[224:227]
    ds_read_b64_tr_b16 a[34:35], v7 offset:2624
    v_mfma_f32_16x16x32_bf16 v[228:231], a[0:3], v[100:103], v[228:231]
    s_add_u32 m0, s67, 10240
    ds_read_b64_tr_b16 a[36:37], v7 offset:40064
    v_mfma_f32_16x16x32_bf16 v[228:231], a[4:7], v[108:111], v[228:231]
    s_add_u32 s72, s73, 1547392
    ds_read_b64_tr_b16 a[38:39], v11 offset:11968
    buffer_load_dwordx4 v14, s[12:15], s72 offen lds
    v_mfma_f32_16x16x32_bf16 v[232:235], a[8:11], v[96:99], v[232:235]
    ds_read_b64_tr_b16 a[40:41], v4 offset:30720
    v_mfma_f32_16x16x32_bf16 v[232:235], a[12:15], v[104:107], v[232:235]
    ds_read_b64_tr_b16 a[42:43], v8 offset:2624
    v_mfma_f32_16x16x32_bf16 v[236:239], a[8:11], v[100:103], v[236:239]
    s_add_u32 s68, s84, 450560
    ds_read_b64_tr_b16 a[44:45], v8 offset:40064
    buffer_load_dwordx4 v[76:79], v17, s[20:23], s68 offen sc1
    v_mfma_f32_16x16x32_bf16 v[236:239], a[12:15], v[108:111], v[236:239]
    s_waitcnt lgkmcnt(7)
    ds_read_b64_tr_b16 a[46:47], v12 offset:11968
    v_mfma_f32_16x16x32_bf16 v[240:243], a[16:19], v[96:99], v[240:243]
    ds_read_b64_tr_b16 a[0:1], v5 offset:30720
    v_mfma_f32_16x16x32_bf16 v[240:243], a[20:23], v[104:107], v[240:243]
    ds_read_b64_tr_b16 a[2:3], v9 offset:2624
    v_mfma_f32_16x16x32_bf16 v[244:247], a[16:19], v[100:103], v[244:247]
    ds_read_b64_tr_b16 a[4:5], v9 offset:40064
    buffer_load_dwordx4 v15, s[12:15], s72 offen offset:1024 lds
    v_mfma_f32_16x16x32_bf16 v[244:247], a[20:23], v[108:111], v[244:247]
    ds_read_b64_tr_b16 a[6:7], v13 offset:11968
    v_mfma_f32_16x16x32_bf16 v[176:179], a[24:27], v[112:115], v[176:179]
    ds_read_b64_tr_b16 a[8:9], v2 offset:32768
    s_waitcnt vmcnt(21)
    v_add_f32 v32, v32, v36
    v_mfma_f32_16x16x32_bf16 v[176:179], a[28:31], v[120:123], v[176:179]
    s_add_u32 s68, s84, 491520
    ds_read_b64_tr_b16 a[10:11], v6 offset:4672
    buffer_load_dwordx4 v[80:83], v17, s[20:23], s68 offen sc1
    v_mfma_f32_16x16x32_bf16 v[180:183], a[24:27], v[116:119], v[180:183]
    ds_read_b64_tr_b16 a[12:13], v6 offset:42112
    v_add_f32 v33, v33, v37
    v_mfma_f32_16x16x32_bf16 v[180:183], a[28:31], v[124:127], v[180:183]
    s_waitcnt lgkmcnt(7)
    ds_read_b64_tr_b16 a[14:15], v10 offset:14016
    v_add_f32 v34, v34, v38
    v_mfma_f32_16x16x32_bf16 v[184:187], a[32:35], v[112:115], v[184:187]
    ds_read_b64_tr_b16 a[16:17], v3 offset:32768
    v_mfma_f32_16x16x32_bf16 v[184:187], a[36:39], v[120:123], v[184:187]
    s_add_u32 s68, s84, 532480
    ds_read_b64_tr_b16 a[18:19], v7 offset:4672
    buffer_load_dwordx4 v[84:87], v17, s[20:23], s68 offen sc1
    v_mfma_f32_16x16x32_bf16 v[188:191], a[32:35], v[116:119], v[188:191]
    ds_read_b64_tr_b16 a[20:21], v7 offset:42112
    v_add_f32 v35, v35, v39
    v_mfma_f32_16x16x32_bf16 v[188:191], a[36:39], v[124:127], v[188:191]
    ds_read_b64_tr_b16 a[22:23], v11 offset:14016
    s_waitcnt vmcnt(21)
    v_add_f32 v32, v32, v40
    v_mfma_f32_16x16x32_bf16 v[192:195], a[40:43], v[112:115], v[192:195]
    ds_read_b64_tr_b16 a[24:25], v4 offset:32768
    v_mfma_f32_16x16x32_bf16 v[192:195], a[44:47], v[120:123], v[192:195]
    s_add_u32 s68, s84, 573440
    ds_read_b64_tr_b16 a[26:27], v8 offset:4672
    buffer_load_dwordx4 v[88:91], v17, s[20:23], s68 offen sc1
    v_mfma_f32_16x16x32_bf16 v[196:199], a[40:43], v[116:119], v[196:199]
    ds_read_b64_tr_b16 a[28:29], v8 offset:42112
    v_add_f32 v33, v33, v41
    v_mfma_f32_16x16x32_bf16 v[196:199], a[44:47], v[124:127], v[196:199]
    s_waitcnt lgkmcnt(7)
    ds_read_b64_tr_b16 a[30:31], v12 offset:14016
    v_add_f32 v34, v34, v42
    v_mfma_f32_16x16x32_bf16 v[200:203], a[0:3], v[112:115], v[200:203]
    s_add_u32 s68, s84, 614400
    ds_read_b64_tr_b16 a[32:33], v5 offset:32768
    buffer_load_dwordx4 v[92:95], v17, s[20:23], s68 offen sc1
    v_mfma_f32_16x16x32_bf16 v[200:203], a[4:7], v[120:123], v[200:203]
    ds_read_b64_tr_b16 a[34:35], v9 offset:4672
    v_add_f32 v35, v35, v43
    v_mfma_f32_16x16x32_bf16 v[204:207], a[0:3], v[116:119], v[204:207]
    ds_read_b64_tr_b16 a[36:37], v9 offset:42112
    s_waitcnt vmcnt(21)
    v_add_f32 v32, v32, v44
    v_mfma_f32_16x16x32_bf16 v[204:207], a[4:7], v[124:127], v[204:207]
    s_add_u32 m0, s67, 12288
    ds_read_b64_tr_b16 a[38:39], v13 offset:14016
    v_mfma_f32_16x16x32_bf16 v[208:211], a[8:11], v[112:115], v[208:211]
    s_add_u32 s72, s73, 1768320
    ds_read_b64_tr_b16 a[40:41], v2 offset:34816
    buffer_load_dwordx4 v14, s[12:15], s72 offen lds
    v_mfma_f32_16x16x32_bf16 v[208:211], a[12:15], v[120:123], v[208:211]
    ds_read_b64_tr_b16 a[42:43], v6 offset:6720
    v_add_f32 v33, v33, v45
    v_mfma_f32_16x16x32_bf16 v[212:215], a[8:11], v[116:119], v[212:215]
    ds_read_b64_tr_b16 a[44:45], v6 offset:44160
    v_add_f32 v34, v34, v46
    v_mfma_f32_16x16x32_bf16 v[212:215], a[12:15], v[124:127], v[212:215]
    s_waitcnt vmcnt(16) lgkmcnt(7)
    ds_read_b64_tr_b16 a[46:47], v10 offset:16064
    buffer_load_dwordx4 v15, s[12:15], s72 offen offset:1024 lds
    v_mfma_f32_16x16x32_bf16 v[216:219], a[16:19], v[112:115], v[216:219]
    s_barrier
    ds_read_b64_tr_b16 a[0:1], v2 offset:0
    v_mfma_f32_16x16x32_bf16 v[216:219], a[20:23], v[120:123], v[216:219]
    ds_read_b64_tr_b16 a[2:3], v2 offset:37440
    v_add_f32 v35, v35, v47
    v_mfma_f32_16x16x32_bf16 v[220:223], a[16:19], v[116:119], v[220:223]
    s_add_u32 m0, s67, 14336
    ds_read_b64_tr_b16 a[4:5], v6 offset:9344
    v_add_f32 v32, v32, v48
    v_mfma_f32_16x16x32_bf16 v[220:223], a[20:23], v[124:127], v[220:223]
    s_add_u32 s72, s73, 1768448
    ds_read_b64_tr_b16 a[6:7], v6 offset:46784
    buffer_load_dwordx4 v14, s[12:15], s72 offen lds
    v_mfma_f32_16x16x32_bf16 v[224:227], a[24:27], v[112:115], v[224:227]
    ds_read_b64_tr_b16 a[8:9], v3 offset:0
    v_add_f32 v33, v33, v49
    v_mfma_f32_16x16x32_bf16 v[224:227], a[28:31], v[120:123], v[224:227]
    ds_read_b64_tr_b16 a[10:11], v3 offset:37440
    v_add_f32 v34, v34, v50
    v_mfma_f32_16x16x32_bf16 v[228:231], a[24:27], v[116:119], v[228:231]
    ds_read_b64_tr_b16 a[12:13], v7 offset:9344
    v_mfma_f32_16x16x32_bf16 v[228:231], a[28:31], v[124:127], v[228:231]
    s_waitcnt lgkmcnt(7)
    ds_read_b64_tr_b16 a[14:15], v7 offset:46784
    buffer_load_dwordx4 v15, s[12:15], s72 offen offset:1024 lds
    v_mfma_f32_16x16x32_bf16 v[232:235], a[32:35], v[112:115], v[232:235]
    ds_read_b64_tr_b16 a[16:17], v4 offset:0
    v_add_f32 v35, v35, v51
    v_mfma_f32_16x16x32_bf16 v[232:235], a[36:39], v[120:123], v[232:235]
    s_add_u32 m0, s67, 16384
    ds_read_b64_tr_b16 a[18:19], v4 offset:37440
    v_add_f32 v32, v32, v52
    v_mfma_f32_16x16x32_bf16 v[236:239], a[32:35], v[116:119], v[236:239]
    s_add_u32 s72, s73, 1768576
    ds_read_b64_tr_b16 a[20:21], v8 offset:9344
    buffer_load_dwordx4 v14, s[12:15], s72 offen lds
    v_mfma_f32_16x16x32_bf16 v[236:239], a[36:39], v[124:127], v[236:239]
    ds_read_b64_tr_b16 a[22:23], v8 offset:46784
    v_add_f32 v33, v33, v53
    v_mfma_f32_16x16x32_bf16 v[240:243], a[40:43], v[112:115], v[240:243]
    ds_read_b64_tr_b16 a[24:25], v5 offset:0
    v_add_f32 v34, v34, v54
    v_mfma_f32_16x16x32_bf16 v[240:243], a[44:47], v[120:123], v[240:243]
    ds_read_b64_tr_b16 a[26:27], v5 offset:37440
    v_mfma_f32_16x16x32_bf16 v[244:247], a[40:43], v[116:119], v[244:247]
    ds_read_b64_tr_b16 a[28:29], v9 offset:9344
    buffer_load_dwordx4 v15, s[12:15], s72 offen offset:1024 lds
    v_mfma_f32_16x16x32_bf16 v[244:247], a[44:47], v[124:127], v[244:247]
    s_waitcnt lgkmcnt(7)
    ds_read_b64_tr_b16 a[30:31], v9 offset:46784
    v_add_f32 v35, v35, v55
    v_mfma_f32_16x16x32_bf16 v[176:179], a[0:3], v[128:131], v[176:179]
    ds_read_b64_tr_b16 a[32:33], v2 offset:2048
    v_add_f32 v32, v32, v56
    v_mfma_f32_16x16x32_bf16 v[176:179], a[4:7], v[136:139], v[176:179]
    ds_read_b64_tr_b16 a[34:35], v2 offset:39488
    v_add_f32 v33, v33, v57
    v_mfma_f32_16x16x32_bf16 v[180:183], a[0:3], v[132:135], v[180:183]
    ds_read_b64_tr_b16 a[36:37], v6 offset:11392
    v_add_f32 v34, v34, v58
    v_mfma_f32_16x16x32_bf16 v[180:183], a[4:7], v[140:143], v[180:183]
    ds_read_b64_tr_b16 a[38:39], v6 offset:48832
    v_add_f32 v35, v35, v59
    v_mfma_f32_16x16x32_bf16 v[184:187], a[8:11], v[128:131], v[184:187]
    ds_read_b64_tr_b16 a[40:41], v3 offset:2048
    s_waitcnt vmcnt(20)
    v_add_f32 v32, v32, v60
    v_mfma_f32_16x16x32_bf16 v[184:187], a[12:15], v[136:139], v[184:187]
    ds_read_b64_tr_b16 a[42:43], v3 offset:39488
    v_add_f32 v33, v33, v61
    v_add_f32 v34, v34, v62
    v_mfma_f32_16x16x32_bf16 v[188:191], a[8:11], v[132:135], v[188:191]
    ds_read_b64_tr_b16 a[44:45], v7 offset:11392
    v_add_f32 v35, v35, v63
    v_mfma_f32_16x16x32_bf16 v[188:191], a[12:15], v[140:143], v[188:191]
    s_waitcnt lgkmcnt(7)
    ds_read_b64_tr_b16 a[46:47], v7 offset:48832
    s_waitcnt vmcnt(18)
    v_add_f32 v32, v32, v64
    v_mfma_f32_16x16x32_bf16 v[192:195], a[16:19], v[128:131], v[192:195]
    ds_read_b64_tr_b16 a[0:1], v4 offset:2048
    v_add_f32 v33, v33, v65
    v_mfma_f32_16x16x32_bf16 v[192:195], a[20:23], v[136:139], v[192:195]
    ds_read_b64_tr_b16 a[2:3], v4 offset:39488
    v_add_f32 v34, v34, v66
    v_mfma_f32_16x16x32_bf16 v[196:199], a[16:19], v[132:135], v[196:199]
    ds_read_b64_tr_b16 a[4:5], v8 offset:11392
    v_add_f32 v35, v35, v67
    v_mfma_f32_16x16x32_bf16 v[196:199], a[20:23], v[140:143], v[196:199]
    ds_read_b64_tr_b16 a[6:7], v8 offset:48832
    s_waitcnt vmcnt(16)
    v_add_f32 v32, v32, v68
    v_add_f32 v33, v33, v69
    v_mfma_f32_16x16x32_bf16 v[200:203], a[24:27], v[128:131], v[200:203]
    ds_read_b64_tr_b16 a[8:9], v5 offset:2048
    v_add_f32 v34, v34, v70
    v_mfma_f32_16x16x32_bf16 v[200:203], a[28:31], v[136:139], v[200:203]
    ds_read_b64_tr_b16 a[10:11], v5 offset:39488
    v_add_f32 v35, v35, v71
    v_mfma_f32_16x16x32_bf16 v[204:207], a[24:27], v[132:135], v[204:207]
    ds_read_b64_tr_b16 a[12:13], v9 offset:11392
    s_waitcnt vmcnt(13)
    v_add_f32 v32, v32, v72
    v_mfma_f32_16x16x32_bf16 v[204:207], a[28:31], v[140:143], v[204:207]
    s_waitcnt lgkmcnt(7)
    ds_read_b64_tr_b16 a[14:15], v9 offset:48832
    v_add_f32 v33, v33, v73
    v_mfma_f32_16x16x32_bf16 v[208:211], a[32:35], v[128:131], v[208:211]
    ds_read_b64_tr_b16 a[16:17], v2 offset:4096
    v_add_f32 v34, v34, v74
    v_mfma_f32_16x16x32_bf16 v[208:211], a[36:39], v[136:139], v[208:211]
    ds_read_b64_tr_b16 a[18:19], v2 offset:41536
    v_add_f32 v35, v35, v75
    s_waitcnt vmcnt(11)
    v_add_f32 v32, v32, v76
    v_mfma_f32_16x16x32_bf16 v[212:215], a[32:35], v[132:135], v[212:215]
    ds_read_b64_tr_b16 a[20:21], v6 offset:13440
    v_add_f32 v33, v33, v77
    v_mfma_f32_16x16x32_bf16 v[212:215], a[36:39], v[140:143], v[212:215]
    s_waitcnt vmcnt(10)
    ds_read_b64_tr_b16 a[22:23], v6 offset:50880
    v_add_f32 v34, v34, v78
    v_mfma_f32_16x16x32_bf16 v[216:219], a[40:43], v[128:131], v[216:219]
    s_barrier
    ds_read_b64_tr_b16 a[24:25], v2 offset:6144
    v_mfma_f32_16x16x32_bf16 v[216:219], a[44:47], v[136:139], v[216:219]
    ds_read_b64_tr_b16 a[26:27], v2 offset:43584
    v_add_f32 v35, v35, v79
    v_mfma_f32_16x16x32_bf16 v[220:223], a[40:43], v[132:135], v[220:223]
    ds_read_b64_tr_b16 a[28:29], v6 offset:15488
    s_waitcnt vmcnt(9)
    v_add_f32 v32, v32, v80
    v_mfma_f32_16x16x32_bf16 v[220:223], a[44:47], v[140:143], v[220:223]
    s_waitcnt lgkmcnt(7)
    ds_read_b64_tr_b16 a[30:31], v6 offset:52928
    v_add_f32 v33, v33, v81
    v_mfma_f32_16x16x32_bf16 v[224:227], a[0:3], v[128:131], v[224:227]
    ds_read_b64_tr_b16 a[32:33], v3 offset:6144
    v_add_f32 v34, v34, v82
    v_add_f32 v35, v35, v83
    v_mfma_f32_16x16x32_bf16 v[224:227], a[4:7], v[136:139], v[224:227]
    ds_read_b64_tr_b16 a[34:35], v3 offset:43584
    s_waitcnt vmcnt(8)
    v_add_f32 v32, v32, v84
    v_mfma_f32_16x16x32_bf16 v[228:231], a[0:3], v[132:135], v[228:231]
    ds_read_b64_tr_b16 a[36:37], v7 offset:15488
    v_add_f32 v33, v33, v85
    v_mfma_f32_16x16x32_bf16 v[228:231], a[4:7], v[140:143], v[228:231]
    ds_read_b64_tr_b16 a[38:39], v7 offset:52928
    v_add_f32 v34, v34, v86
    v_mfma_f32_16x16x32_bf16 v[232:235], a[8:11], v[128:131], v[232:235]
    ds_read_b64_tr_b16 a[40:41], v4 offset:6144
    v_add_f32 v35, v35, v87
    v_mfma_f32_16x16x32_bf16 v[232:235], a[12:15], v[136:139], v[232:235]
    ds_read_b64_tr_b16 a[42:43], v4 offset:43584
    s_waitcnt vmcnt(7)
    v_add_f32 v32, v32, v88
    v_mfma_f32_16x16x32_bf16 v[236:239], a[8:11], v[132:135], v[236:239]
    ds_read_b64_tr_b16 a[44:45], v8 offset:15488
    v_add_f32 v33, v33, v89
    v_add_f32 v34, v34, v90
    v_mfma_f32_16x16x32_bf16 v[236:239], a[12:15], v[140:143], v[236:239]
    s_waitcnt lgkmcnt(7)
    ds_read_b64_tr_b16 a[46:47], v8 offset:52928
    v_add_f32 v35, v35, v91
    v_mfma_f32_16x16x32_bf16 v[240:243], a[16:19], v[128:131], v[240:243]
    ds_read_b64_tr_b16 a[0:1], v5 offset:6144
    s_waitcnt vmcnt(6)
    v_add_f32 v32, v32, v92
    v_mfma_f32_16x16x32_bf16 v[240:243], a[20:23], v[136:139], v[240:243]
    ds_read_b64_tr_b16 a[2:3], v5 offset:43584
    v_add_f32 v33, v33, v93
    v_mfma_f32_16x16x32_bf16 v[244:247], a[16:19], v[132:135], v[244:247]
    ds_read_b64_tr_b16 a[4:5], v9 offset:15488
    v_add_f32 v34, v34, v94
    v_mfma_f32_16x16x32_bf16 v[244:247], a[20:23], v[140:143], v[244:247]
    ds_read_b64_tr_b16 a[6:7], v9 offset:52928
    v_add_f32 v35, v35, v95
    v_add_f32 v248, v32, v33
    v_add_f32 v249, v34, v35
    v_cmp_u_f32 vcc, v248, v249
    s_nop 0
    s_cmp_lg_u64 vcc, 0
    s_cbranch_scc1 L_slow_43
L_back_44:
    s_mov_b32 exec_hi, 0
    v_mul_f32 v32, s27, v32
    v_mul_f32 v33, s27, v33
    v_mul_f32 v34, s27, v34
    v_mul_f32 v35, s27, v35
    s_mov_b64 exec, -1
    v_cmp_eq_u32 vcc, v23, v27
    s_nop 1
    v_cndmask_b32 v32, 0, v32, vcc
    v_cmp_eq_u32 vcc, v24, v27
    s_nop 1
    v_cndmask_b32 v33, 0, v33, vcc
    v_cmp_eq_u32 vcc, v25, v27
    s_nop 1
    v_cndmask_b32 v34, 0, v34, vcc
    v_cmp_eq_u32 vcc, v26, v27
    s_nop 1
    v_cndmask_b32 v35, 0, v35, vcc
    v_cvt_pk_bf16_f32 v32, v32, v33
    v_cvt_pk_bf16_f32 v33, v34, v35
    buffer_store_dwordx2 v[32:33], v16, s[20:23], s83 offen sc1
    v_mfma_f32_16x16x32_bf16 v[176:179], a[24:27], v[144:147], v[176:179]
    s_mul_i32 s68, s62, 6144
    ds_read_b64_tr_b16 a[8:9], v2 offset:8192
    v_mfma_f32_16x16x32_bf16 v[176:179], a[28:31], v[152:155], v[176:179]
    s_max_u32 s71, s68, 1024
    ds_read_b64_tr_b16 a[10:11], v2 offset:45632
    v_mfma_f32_16x16x32_bf16 v[180:183], a[24:27], v[148:151], v[180:183]
    s_add_u32 s68, s68, s74
    ds_read_b64_tr_b16 a[12:13], v6 offset:17536
    v_mfma_f32_16x16x32_bf16 v[180:183], a[28:31], v[156:159], v[180:183]
    s_waitcnt lgkmcnt(7)
    ds_read_b64_tr_b16 a[14:15], v6 offset:54976
    v_mfma_f32_16x16x32_bf16 v[184:187], a[32:35], v[144:147], v[184:187]
    s_add_u32 s71, s71, s74
    ds_read_b64_tr_b16 a[16:17], v3 offset:8192
    v_mfma_f32_16x16x32_bf16 v[184:187], a[36:39], v[152:155], v[184:187]
    s_sub_u32 s68, s68, 1024
    ds_read_b64_tr_b16 a[18:19], v3 offset:45632
    v_mfma_f32_16x16x32_bf16 v[188:191], a[32:35], v[148:151], v[188:191]
    s_sub_u32 s71, s71, 1024
    ds_read_b64_tr_b16 a[20:21], v7 offset:17536
    v_mfma_f32_16x16x32_bf16 v[188:191], a[36:39], v[156:159], v[188:191]
    s_add_u32 s69, s68, 3072
    ds_read_b64_tr_b16 a[22:23], v7 offset:54976
    v_mfma_f32_16x16x32_bf16 v[192:195], a[40:43], v[144:147], v[192:195]
    s_add_u32 s70, s74, 23552
    ds_read_b64_tr_b16 a[24:25], v4 offset:8192
    v_add_u32 v23, s67, v18
    v_mfma_f32_16x16x32_bf16 v[192:195], a[44:47], v[152:155], v[192:195]
    ds_read_b64_tr_b16 a[26:27], v4 offset:45632
    v_add_u32 v24, 74880, v18
    v_mfma_f32_16x16x32_bf16 v[196:199], a[40:43], v[148:151], v[196:199]
    s_add_u32 s84, s91, 4096
    ds_read_b64_tr_b16 a[28:29], v8 offset:17536
    v_mfma_f32_16x16x32_bf16 v[196:199], a[44:47], v[156:159], v[196:199]
    s_waitcnt lgkmcnt(7)
    ds_read_b64_tr_b16 a[30:31], v8 offset:54976
    v_mfma_f32_16x16x32_bf16 v[200:203], a[0:3], v[144:147], v[200:203]
    s_add_u32 s85, s91, 8192
    ds_read_b64_tr_b16 a[32:33], v5 offset:8192
    v_mov_b32 v50, 0
    v_mfma_f32_16x16x32_bf16 v[200:203], a[4:7], v[152:155], v[200:203]
    ds_read_b64_tr_b16 a[34:35], v5 offset:45632
    v_mov_b32 v51, 0
    v_mfma_f32_16x16x32_bf16 v[204:207], a[0:3], v[148:151], v[204:207]
    ds_read_b64_tr_b16 a[36:37], v9 offset:17536
    v_mov_b32 v54, 0
    v_mfma_f32_16x16x32_bf16 v[204:207], a[4:7], v[156:159], v[204:207]
    ds_read_b64_tr_b16 a[38:39], v9 offset:54976
    v_mov_b32 v55, 0
    v_mfma_f32_16x16x32_bf16 v[208:211], a[8:11], v[144:147], v[208:211]
    ds_read_b64_tr_b16 a[40:41], v2 offset:10240
    v_mov_b32 v72, 0
    v_mfma_f32_16x16x32_bf16 v[208:211], a[12:15], v[152:155], v[208:211]
    ds_read_b64_tr_b16 a[42:43], v2 offset:47680
    v_mov_b32 v73, 0
    v_mfma_f32_16x16x32_bf16 v[212:215], a[8:11], v[148:151], v[212:215]
    ds_read_b64_tr_b16 a[44:45], v6 offset:19584
    v_mov_b32 v76, 0
    v_mfma_f32_16x16x32_bf16 v[212:215], a[12:15], v[156:159], v[212:215]
    s_waitcnt vmcnt(1) lgkmcnt(7)
    ds_read_b64_tr_b16 a[46:47], v6 offset:57024
    v_mov_b32 v77, 0
    v_mfma_f32_16x16x32_bf16 v[216:219], a[16:19], v[144:147], v[216:219]
    s_barrier
    ds_read_b64_tr_b16 a[0:1], v2 offset:12288
    v_mfma_f32_16x16x32_bf16 v[216:219], a[20:23], v[152:155], v[216:219]
    ds_read_b64_tr_b16 a[2:3], v2 offset:49728
    v_mov_b32 v34, 0
    v_mfma_f32_16x16x32_bf16 v[220:223], a[16:19], v[148:151], v[220:223]
    ds_read_b64_tr_b16 a[4:5], v6 offset:21632
    v_mov_b32 v35, 0
    v_mfma_f32_16x16x32_bf16 v[220:223], a[20:23], v[156:159], v[220:223]
    ds_read_b64_tr_b16 a[6:7], v6 offset:59072
    v_mov_b32 v38, 0
    v_mfma_f32_16x16x32_bf16 v[224:227], a[24:27], v[144:147], v[224:227]
    ds_read_b64_tr_b16 a[8:9], v3 offset:12288
    v_mov_b32 v39, 0
    v_mfma_f32_16x16x32_bf16 v[224:227], a[28:31], v[152:155], v[224:227]
    ds_read_b64_tr_b16 a[10:11], v3 offset:49728
    v_mov_b32 v42, 0
    v_mfma_f32_16x16x32_bf16 v[228:231], a[24:27], v[148:151], v[228:231]
    ds_read_b64_tr_b16 a[12:13], v7 offset:21632
    v_mov_b32 v43, 0
    v_mfma_f32_16x16x32_bf16 v[228:231], a[28:31], v[156:159], v[228:231]
    s_waitcnt lgkmcnt(7)
    ds_read_b64_tr_b16 a[14:15], v7 offset:59072
    v_mov_b32 v46, 0
    v_mfma_f32_16x16x32_bf16 v[232:235], a[32:35], v[144:147], v[232:235]
    ds_read_b64_tr_b16 a[16:17], v4 offset:12288
    v_mov_b32 v47, 0
    v_mfma_f32_16x16x32_bf16 v[232:235], a[36:39], v[152:155], v[232:235]
    ds_read_b64_tr_b16 a[18:19], v4 offset:49728
    v_mov_b32 v130, 0
    v_mfma_f32_16x16x32_bf16 v[236:239], a[32:35], v[148:151], v[236:239]
    ds_read_b64_tr_b16 a[20:21], v8 offset:21632
    v_mov_b32 v131, 0
    v_mfma_f32_16x16x32_bf16 v[236:239], a[36:39], v[156:159], v[236:239]
    ds_read_b64_tr_b16 a[22:23], v8 offset:59072
    v_mov_b32 v134, 0
    v_mfma_f32_16x16x32_bf16 v[240:243], a[40:43], v[144:147], v[240:243]
    ds_read_b64_tr_b16 a[24:25], v5 offset:12288
    v_mov_b32 v135, 0
    v_mfma_f32_16x16x32_bf16 v[240:243], a[44:47], v[152:155], v[240:243]
    ds_read_b64_tr_b16 a[26:27], v5 offset:49728
    v_mov_b32 v252, 0x358637bd
    v_mfma_f32_16x16x32_bf16 v[244:247], a[40:43], v[148:151], v[244:247]
    ds_read_b64_tr_b16 a[28:29], v9 offset:21632
    v_mov_b32 v253, 0x358637bd
    v_mfma_f32_16x16x32_bf16 v[244:247], a[44:47], v[156:159], v[244:247]
    s_waitcnt lgkmcnt(7)
    ds_read_b64_tr_b16 a[30:31], v9 offset:59072
    v_mov_b32 v254, 0x358637bd
    v_mov_b32 v255, 0x358637bd
    v_mfma_f32_16x16x32_bf16 v[176:179], a[0:3], v[160:163], v[176:179]
    ds_read_b64_tr_b16 a[32:33], v2 offset:14336
    v_mfma_f32_16x16x32_bf16 v[176:179], a[4:7], v[168:171], v[176:179]
    ds_read_b64_tr_b16 a[34:35], v2 offset:51776
    v_mfma_f32_16x16x32_bf16 v[180:183], a[0:3], v[164:167], v[180:183]
    ds_read_b64_tr_b16 a[36:37], v6 offset:23680
    v_mfma_f32_16x16x32_bf16 v[180:183], a[4:7], v[172:175], v[180:183]
    ds_read_b64_tr_b16 a[38:39], v6 offset:61120
    v_mfma_f32_16x16x32_bf16 v[184:187], a[8:11], v[160:163], v[184:187]
    ds_read_b64_tr_b16 a[40:41], v3 offset:14336
    v_mfma_f32_16x16x32_bf16 v[184:187], a[12:15], v[168:171], v[184:187]
    ds_read_b64_tr_b16 a[42:43], v3 offset:51776
    v_mfma_f32_16x16x32_bf16 v[188:191], a[8:11], v[164:167], v[188:191]
    ds_read_b64_tr_b16 a[44:45], v7 offset:23680
    v_mfma_f32_16x16x32_bf16 v[188:191], a[12:15], v[172:175], v[188:191]
    s_waitcnt lgkmcnt(7)
    ds_read_b64_tr_b16 a[46:47], v7 offset:61120
    v_mfma_f32_16x16x32_bf16 v[192:195], a[16:19], v[160:163], v[192:195]
    ds_read_b64_tr_b16 a[0:1], v4 offset:14336
    v_mfma_f32_16x16x32_bf16 v[192:195], a[20:23], v[168:171], v[192:195]
    ds_read_b64_tr_b16 a[2:3], v4 offset:51776
    v_mfma_f32_16x16x32_bf16 v[196:199], a[16:19], v[164:167], v[196:199]
    ds_read_b64_tr_b16 a[4:5], v8 offset:23680
    v_mfma_f32_16x16x32_bf16 v[196:199], a[20:23], v[172:175], v[196:199]
    ds_read_b64_tr_b16 a[6:7], v8 offset:61120
    v_mfma_f32_16x16x32_bf16 v[200:203], a[24:27], v[160:163], v[200:203]
    ds_read_b64_tr_b16 a[8:9], v5 offset:14336
    v_mfma_f32_16x16x32_bf16 v[200:203], a[28:31], v[168:171], v[200:203]
    ds_read_b64_tr_b16 a[10:11], v5 offset:51776
    v_mfma_f32_16x16x32_bf16 v[204:207], a[24:27], v[164:167], v[204:207]
    ds_read_b64_tr_b16 a[12:13], v9 offset:23680
    v_mfma_f32_16x16x32_bf16 v[204:207], a[28:31], v[172:175], v[204:207]
    s_waitcnt lgkmcnt(7)
    ds_read_b64_tr_b16 a[14:15], v9 offset:61120
    v_mfma_f32_16x16x32_bf16 v[208:211], a[32:35], v[160:163], v[208:211]
L_pad_a2_1:
    s_cbranch_execz L_walk_ret
    ds_read_b64_tr_b16 a[16:17], v2 offset:16384
    v_mfma_f32_16x16x32_bf16 v[208:211], a[36:39], v[168:171], v[208:211]
    ds_read_b64_tr_b16 a[18:19], v2 offset:53824
    v_mfma_f32_16x16x32_bf16 v[212:215], a[32:35], v[164:167], v[212:215]
    ds_read_b64_tr_b16 a[20:21], v6 offset:25728
    v_mfma_f32_16x16x32_bf16 v[212:215], a[36:39], v[172:175], v[212:215]
    ds_read_b64_tr_b16 a[22:23], v6 offset:63168
    v_mfma_f32_16x16x32_bf16 v[216:219], a[40:43], v[160:163], v[216:219]
    v_mfma_f32_16x16x32_bf16 v[216:219], a[44:47], v[168:171], v[216:219]
    v_mfma_f32_16x16x32_bf16 v[220:223], a[40:43], v[164:167], v[220:223]
    v_mfma_f32_16x16x32_bf16 v[220:223], a[44:47], v[172:175], v[220:223]
    s_waitcnt lgkmcnt(4)
    v_mfma_f32_16x16x32_bf16 v[224:227], a[0:3], v[160:163], v[224:227]
    v_mfma_f32_16x16x32_bf16 v[224:227], a[4:7], v[168:171], v[224:227]
    v_mfma_f32_16x16x32_bf16 v[228:231], a[0:3], v[164:167], v[228:231]
    v_mfma_f32_16x16x32_bf16 v[228:231], a[4:7], v[172:175], v[228:231]
    v_mfma_f32_16x16x32_bf16 v[232:235], a[8:11], v[160:163], v[232:235]
    v_mfma_f32_16x16x32_bf16 v[232:235], a[12:15], v[168:171], v[232:235]
    v_mfma_f32_16x16x32_bf16 v[236:239], a[8:11], v[164:167], v[236:239]
    v_mfma_f32_16x16x32_bf16 v[236:239], a[12:15], v[172:175], v[236:239]
    s_waitcnt lgkmcnt(0)
    v_mfma_f32_16x16x32_bf16 v[240:243], a[16:19], v[160:163], v[240:243]
    v_mfma_f32_16x16x32_bf16 v[240:243], a[20:23], v[168:171], v[240:243]
    v_mfma_f32_16x16x32_bf16 v[244:247], a[16:19], v[164:167], v[244:247]
    v_mfma_f32_16x16x32_bf16 v[244:247], a[20:23], v[172:175], v[244:247]
    v_exp_f32 v248, v176 clamp
    buffer_load_dwordx2 v[48:49], v19, s[20:23], s71 offen offset:0 sc1
    v_exp_f32 v249, v177 clamp
    v_exp_f32 v250, v178 clamp
    buffer_load_dwordx2 v[52:53], v19, s[20:23], s71 offen offset:512 sc1
    v_exp_f32 v251, v179 clamp
    v_max_f32 v176, 0x35c1a2a0, v176
    v_max_f32 v177, 0x35c1a2a0, v177
    buffer_load_dwordx2 v[56:57], v19, s[20:23], s68 offen offset:1024 sc1
    v_max_f32 v178, 0x35c1a2a0, v178
    v_max_f32 v179, 0x35c1a2a0, v179
    buffer_load_dwordx2 v[60:61], v19, s[20:23], s68 offen offset:1536 sc1
    v_fma_f32 v176, v176, s27, v248
    v_fma_f32 v177, v177, s27, v249
    buffer_load_dwordx2 v[58:59], v19, s[20:23], s69 offen offset:0 sc1
    v_fma_f32 v178, v178, s27, v250
    v_fma_f32 v179, v179, s27, v251
    buffer_load_dwordx2 v[62:63], v19, s[20:23], s69 offen offset:512 sc1
    v_cvt_pk_bf16_f32 v96, v176, v177
    v_cvt_pk_bf16_f32 v97, v178, v179
    v_exp_f32 v248, v180 clamp
    buffer_load_dwordx2 v[64:65], v19, s[20:23], s68 offen offset:2048 sc1
    v_exp_f32 v249, v181 clamp
    v_exp_f32 v250, v182 clamp
    buffer_load_dwordx2 v[68:69], v19, s[20:23], s68 offen offset:2560 sc1
    v_exp_f32 v251, v183 clamp
    v_max_f32 v180, 0x35c1a2a0, v180
    buffer_load_dwordx2 v[66:67], v19, s[20:23], s69 offen offset:1024 sc1
    v_max_f32 v181, 0x35c1a2a0, v181
    v_max_f32 v182, 0x35c1a2a0, v182
    buffer_load_dwordx2 v[70:71], v19, s[20:23], s69 offen offset:1536 sc1
    v_max_f32 v183, 0x35c1a2a0, v183
    v_fma_f32 v180, v180, s27, v248
    v_fma_f32 v181, v181, s27, v249
    buffer_load_dwordx2 v[74:75], v19, s[20:23], s69 offen offset:2048 sc1
    v_fma_f32 v182, v182, s27, v250
    v_fma_f32 v183, v183, s27, v251
    buffer_load_dwordx2 v[78:79], v19, s[20:23], s69 offen offset:2560 sc1
    v_cvt_pk_bf16_f32 v100, v180, v181
    v_cvt_pk_bf16_f32 v101, v182, v183
    buffer_load_dwordx2 v[32:33], v19, s[20:23], s70 offen offset:0 sc1
    v_exp_f32 v248, v184 clamp
    v_exp_f32 v249, v185 clamp
    buffer_load_dwordx2 v[36:37], v19, s[20:23], s70 offen offset:512 sc1
    v_exp_f32 v250, v186 clamp
    v_exp_f32 v251, v187 clamp
    v_max_f32 v184, 0x35c1a2a0, v184
    buffer_load_dwordx2 v[40:41], v19, s[20:23], s70 offen offset:1024 sc1
    v_max_f32 v185, 0x35c1a2a0, v185
    v_max_f32 v186, 0x35c1a2a0, v186
    buffer_load_dwordx2 v[44:45], v19, s[20:23], s70 offen offset:1536 sc1
    v_max_f32 v187, 0x35c1a2a0, v187
    v_fma_f32 v184, v184, s27, v248
    v_fma_f32 v185, v185, s27, v249
    v_fma_f32 v186, v186, s27, v250
    v_fma_f32 v187, v187, s27, v251
    v_cvt_pk_bf16_f32 v98, v184, v185
    v_cvt_pk_bf16_f32 v99, v186, v187
    v_exp_f32 v248, v188 clamp
    v_exp_f32 v249, v189 clamp
    v_exp_f32 v250, v190 clamp
    v_exp_f32 v251, v191 clamp
    v_max_f32 v188, 0x35c1a2a0, v188
    v_max_f32 v189, 0x35c1a2a0, v189
    v_max_f32 v190, 0x35c1a2a0, v190
    v_max_f32 v191, 0x35c1a2a0, v191
    v_fma_f32 v188, v188, s27, v248
    v_fma_f32 v189, v189, s27, v249
    v_fma_f32 v190, v190, s27, v250
    v_fma_f32 v191, v191, s27, v251
    v_cvt_pk_bf16_f32 v102, v188, v189
    v_cvt_pk_bf16_f32 v103, v190, v191
    v_exp_f32 v248, v192 clamp
    v_exp_f32 v249, v193 clamp
    v_exp_f32 v250, v194 clamp
    v_exp_f32 v251, v195 clamp
    v_max_f32 v192, 0x35c1a2a0, v192
    v_max_f32 v193, 0x35c1a2a0, v193
    v_max_f32 v194, 0x35c1a2a0, v194
    v_max_f32 v195, 0x35c1a2a0, v195
    v_fma_f32 v192, v192, s27, v248
    v_fma_f32 v193, v193, s27, v249
    v_fma_f32 v194, v194, s27, v250
    v_fma_f32 v195, v195, s27, v251
    v_cvt_pk_bf16_f32 v104, v192, v193
    v_cvt_pk_bf16_f32 v105, v194, v195
    v_exp_f32 v248, v196 clamp
    v_exp_f32 v249, v197 clamp
    v_exp_f32 v250, v198 clamp
    v_exp_f32 v251, v199 clamp
    v_max_f32 v196, 0x35c1a2a0, v196
    v_max_f32 v197, 0x35c1a2a0, v197
    v_max_f32 v198, 0x35c1a2a0, v198
    v_max_f32 v199, 0x35c1a2a0, v199
    v_fma_f32 v196, v196, s27, v248
    v_fma_f32 v197, v197, s27, v249
    v_fma_f32 v198, v198, s27, v250
    v_fma_f32 v199, v199, s27, v251
    v_cvt_pk_bf16_f32 v108, v196, v197
    v_cvt_pk_bf16_f32 v109, v198, v199
    v_exp_f32 v248, v200 clamp
    v_exp_f32 v249, v201 clamp
    v_exp_f32 v250, v202 clamp
    v_exp_f32 v251, v203 clamp
    v_max_f32 v200, 0x35c1a2a0, v200
    v_max_f32 v201, 0x35c1a2a0, v201
    v_max_f32 v202, 0x35c1a2a0, v202
    v_max_f32 v203, 0x35c1a2a0, v203
    v_fma_f32 v200, v200, s27, v248
    v_fma_f32 v201, v201, s27, v249
    v_fma_f32 v202, v202, s27, v250
    v_fma_f32 v203, v203, s27, v251
    v_cvt_pk_bf16_f32 v106, v200, v201
    v_cvt_pk_bf16_f32 v107, v202, v203
    v_exp_f32 v248, v204 clamp
    v_exp_f32 v249, v205 clamp
    v_exp_f32 v250, v206 clamp
    v_exp_f32 v251, v207 clamp
    v_max_f32 v204, 0x35c1a2a0, v204
    v_max_f32 v205, 0x35c1a2a0, v205
    v_max_f32 v206, 0x35c1a2a0, v206
    v_max_f32 v207, 0x35c1a2a0, v207
    v_fma_f32 v204, v204, s27, v248
    v_fma_f32 v205, v205, s27, v249
    v_fma_f32 v206, v206, s27, v250
    v_fma_f32 v207, v207, s27, v251
    v_cvt_pk_bf16_f32 v110, v204, v205
    v_cvt_pk_bf16_f32 v111, v206, v207
    s_waitcnt vmcnt(15)
    v_max_u32 v25, v48, v49
    s_waitcnt vmcnt(14)
    v_max3_u32 v25, v25, v52, v53
    s_waitcnt vmcnt(13)
    v_max3_u32 v25, v25, v56, v57
    s_waitcnt vmcnt(12)
    v_max3_u32 v25, v25, v60, v61
    s_waitcnt vmcnt(11)
    v_max3_u32 v25, v25, v58, v59
    s_waitcnt vmcnt(10)
    v_max3_u32 v25, v25, v62, v63
    s_waitcnt vmcnt(9)
    v_max3_u32 v25, v25, v64, v65
    s_waitcnt vmcnt(8)
    v_max3_u32 v25, v25, v68, v69
    s_waitcnt vmcnt(7)
    v_max3_u32 v25, v25, v66, v67
    s_waitcnt vmcnt(6)
    v_max3_u32 v25, v25, v70, v71
    s_waitcnt vmcnt(5)
    v_max3_u32 v25, v25, v74, v75
    s_waitcnt vmcnt(4)
    v_max3_u32 v25, v25, v78, v79
    s_waitcnt vmcnt(3)
    v_max3_u32 v25, v25, v32, v33
    s_waitcnt vmcnt(2)
    v_max3_u32 v25, v25, v36, v37
    s_waitcnt vmcnt(1)
    v_max3_u32 v25, v25, v40, v41
    s_waitcnt vmcnt(0)
    v_max3_u32 v25, v25, v44, v45
    v_cmp_eq_u32 vcc, -1, v25
    s_nop 0
    s_cmp_lg_u64 vcc, 0
    s_cbranch_scc1 L_slow_46
L_back_47:
    v_exp_f32 v248, v208 clamp
    v_exp_f32 v249, v209 clamp
    ds_write_b128 v23, v[48:51] offset:18432
    v_exp_f32 v250, v210 clamp
    v_exp_f32 v251, v211 clamp
    v_max_f32 v208, 0x35c1a2a0, v208
    ds_write_b128 v23, v[52:55] offset:19456
    v_max_f32 v209, 0x35c1a2a0, v209
    v_max_f32 v210, 0x35c1a2a0, v210
    v_max_f32 v211, 0x35c1a2a0, v211
    v_fma_f32 v208, v208, s27, v248
    ds_write_b128 v23, v[56:59] offset:20480
    v_fma_f32 v209, v209, s27, v249
    v_fma_f32 v210, v210, s27, v250
    v_fma_f32 v211, v211, s27, v251
    ds_write_b128 v23, v[60:63] offset:21504
    v_cvt_pk_bf16_f32 v112, v208, v209
    v_cvt_pk_bf16_f32 v113, v210, v211
    v_exp_f32 v248, v212 clamp
    v_exp_f32 v249, v213 clamp
    ds_write_b128 v23, v[64:67] offset:22528
    v_exp_f32 v250, v214 clamp
    v_exp_f32 v251, v215 clamp
    v_max_f32 v212, 0x35c1a2a0, v212
    ds_write_b128 v23, v[68:71] offset:23552
    v_max_f32 v213, 0x35c1a2a0, v213
    v_max_f32 v214, 0x35c1a2a0, v214
    v_max_f32 v215, 0x35c1a2a0, v215
    v_fma_f32 v212, v212, s27, v248
    ds_write_b128 v23, v[72:75] offset:24576
    v_fma_f32 v213, v213, s27, v249
    v_fma_f32 v214, v214, s27, v250
    v_fma_f32 v215, v215, s27, v251
    ds_write_b128 v23, v[76:79] offset:25600
    v_cvt_pk_bf16_f32 v116, v212, v213
    v_cvt_pk_bf16_f32 v117, v214, v215
    s_waitcnt lgkmcnt(0)
    s_barrier
    ds_read_b128 a[80:83], v18 offset:20480
    v_exp_f32 v248, v216 clamp
    ds_read_b128 a[84:87], v18 offset:21504
    v_exp_f32 v249, v217 clamp
    ds_read_b128 a[88:91], v18 offset:22528
    v_exp_f32 v250, v218 clamp
    ds_read_b128 a[92:95], v18 offset:23552
    v_exp_f32 v251, v219 clamp
    ds_read_b128 a[96:99], v18 offset:24576
    v_max_f32 v216, 0x35c1a2a0, v216
    ds_read_b128 a[100:103], v18 offset:25600
    v_max_f32 v217, 0x35c1a2a0, v217
    ds_read_b128 a[104:107], v18 offset:55872
    v_max_f32 v218, 0x35c1a2a0, v218
    ds_read_b128 a[108:111], v18 offset:56896
    v_max_f32 v219, 0x35c1a2a0, v219
    ds_read_b128 a[112:115], v18 offset:57920
    v_fma_f32 v216, v216, s27, v248
    ds_read_b128 a[116:119], v18 offset:58944
    v_fma_f32 v217, v217, s27, v249
    ds_read_b128 a[120:123], v18 offset:59968
    v_fma_f32 v218, v218, s27, v250
    ds_read_b128 a[124:127], v18 offset:60992
    v_fma_f32 v219, v219, s27, v251
    ds_read_b128 a[128:131], v18 offset:62016
    v_cvt_pk_bf16_f32 v114, v216, v217
    ds_read_b128 a[132:135], v18 offset:63040
    v_cvt_pk_bf16_f32 v115, v218, v219
    ds_read_b128 a[136:139], v24 offset:18432
    ds_read_b128 a[140:143], v24 offset:19456
    v_exp_f32 v248, v220 clamp
    ds_read_b128 a[144:147], v24 offset:20480
    v_exp_f32 v249, v221 clamp
    ds_read_b128 a[148:151], v24 offset:21504
    v_exp_f32 v250, v222 clamp
    ds_read_b128 a[152:155], v24 offset:22528
    v_exp_f32 v251, v223 clamp
    ds_read_b128 a[156:159], v24 offset:23552
    v_max_f32 v220, 0x35c1a2a0, v220
    ds_read_b128 a[160:163], v24 offset:24576
    v_max_f32 v221, 0x35c1a2a0, v221
    ds_read_b128 a[164:167], v24 offset:25600
    v_max_f32 v222, 0x35c1a2a0, v222
    ds_read_b128 a[168:171], v24 offset:55872
    v_max_f32 v223, 0x35c1a2a0, v223
    ds_read_b128 a[172:175], v24 offset:56896
    v_fma_f32 v220, v220, s27, v248
    ds_read_b128 a[176:179], v24 offset:57920
    v_fma_f32 v221, v221, s27, v249
    ds_read_b128 a[180:183], v24 offset:58944
    v_fma_f32 v222, v222, s27, v250
    ds_read_b128 a[184:187], v24 offset:59968
    v_fma_f32 v223, v223, s27, v251
    ds_read_b128 a[188:191], v24 offset:60992
    v_cvt_pk_bf16_f32 v118, v220, v221
    ds_read_b128 a[192:195], v24 offset:62016
    v_cvt_pk_bf16_f32 v119, v222, v223
    ds_read_b128 a[196:199], v24 offset:63040
    v_exp_f32 v248, v224 clamp
    s_waitcnt lgkmcnt(15)
    v_mfma_f32_16x16x32_bf16 v[48:51], a[84:87], v[96:99], v[252:255]
    v_exp_f32 v249, v225 clamp
    v_exp_f32 v250, v226 clamp
    v_exp_f32 v251, v227 clamp
    v_mfma_f32_16x16x32_bf16 v[176:179], a[80:83], v[96:99], 0
    v_max_f32 v224, 0x35c1a2a0, v224
    v_max_f32 v225, 0x35c1a2a0, v225
    v_mfma_f32_16x16x32_bf16 v[52:55], a[84:87], v[100:103], v[252:255]
    v_max_f32 v226, 0x35c1a2a0, v226
    v_max_f32 v227, 0x35c1a2a0, v227
    v_mfma_f32_16x16x32_bf16 v[180:183], a[80:83], v[100:103], 0
    v_fma_f32 v224, v224, s27, v248
    v_fma_f32 v225, v225, s27, v249
    v_fma_f32 v226, v226, s27, v250
    v_mfma_f32_16x16x32_bf16 v[56:59], a[92:95], v[96:99], v[252:255]
    v_fma_f32 v227, v227, s27, v251
    v_cvt_pk_bf16_f32 v120, v224, v225
    v_mfma_f32_16x16x32_bf16 v[56:59], a[108:111], v[104:107], v[56:59]
    v_cvt_pk_bf16_f32 v121, v226, v227
    v_exp_f32 v248, v228 clamp
    v_mfma_f32_16x16x32_bf16 v[184:187], a[88:91], v[96:99], 0
    v_exp_f32 v249, v229 clamp
    v_exp_f32 v250, v230 clamp
    v_exp_f32 v251, v231 clamp
    v_mfma_f32_16x16x32_bf16 v[184:187], a[104:107], v[104:107], v[184:187]
    v_max_f32 v228, 0x35c1a2a0, v228
    v_max_f32 v229, 0x35c1a2a0, v229
    v_mfma_f32_16x16x32_bf16 v[60:63], a[92:95], v[100:103], v[252:255]
    v_max_f32 v230, 0x35c1a2a0, v230
    v_max_f32 v231, 0x35c1a2a0, v231
    v_mfma_f32_16x16x32_bf16 v[60:63], a[108:111], v[108:111], v[60:63]
    v_fma_f32 v228, v228, s27, v248
    v_fma_f32 v229, v229, s27, v249
    v_fma_f32 v230, v230, s27, v250
    v_mfma_f32_16x16x32_bf16 v[188:191], a[88:91], v[100:103], 0
    v_fma_f32 v231, v231, s27, v251
    v_cvt_pk_bf16_f32 v124, v228, v229
    v_mfma_f32_16x16x32_bf16 v[188:191], a[104:107], v[108:111], v[188:191]
    v_cvt_pk_bf16_f32 v125, v230, v231
    v_exp_f32 v248, v232 clamp
    v_mfma_f32_16x16x32_bf16 v[64:67], a[100:103], v[96:99], v[252:255]
    v_exp_f32 v249, v233 clamp
    v_exp_f32 v250, v234 clamp
    v_mfma_f32_16x16x32_bf16 v[64:67], a[116:119], v[104:107], v[64:67]
    v_exp_f32 v251, v235 clamp
    v_mfma_f32_16x16x32_bf16 v[192:195], a[96:99], v[96:99], 0
    v_max_f32 v232, 0x35c1a2a0, v232
    v_max_f32 v233, 0x35c1a2a0, v233
    v_mfma_f32_16x16x32_bf16 v[192:195], a[112:115], v[104:107], v[192:195]
    v_max_f32 v234, 0x35c1a2a0, v234
    v_max_f32 v235, 0x35c1a2a0, v235
    v_mfma_f32_16x16x32_bf16 v[68:71], a[100:103], v[100:103], v[252:255]
    v_fma_f32 v232, v232, s27, v248
    v_fma_f32 v233, v233, s27, v249
    v_mfma_f32_16x16x32_bf16 v[68:71], a[116:119], v[108:111], v[68:71]
    v_fma_f32 v234, v234, s27, v250
    v_mfma_f32_16x16x32_bf16 v[196:199], a[96:99], v[100:103], 0
    v_fma_f32 v235, v235, s27, v251
    v_cvt_pk_bf16_f32 v122, v232, v233
    v_mfma_f32_16x16x32_bf16 v[196:199], a[112:115], v[108:111], v[196:199]
    v_cvt_pk_bf16_f32 v123, v234, v235
    v_exp_f32 v248, v236 clamp
    v_mfma_f32_16x16x32_bf16 v[72:75], a[124:127], v[104:107], v[252:255]
    v_exp_f32 v249, v237 clamp
    v_exp_f32 v250, v238 clamp
    s_waitcnt lgkmcnt(14)
    v_mfma_f32_16x16x32_bf16 v[72:75], a[140:143], v[112:115], v[72:75]
    v_exp_f32 v251, v239 clamp
    v_mfma_f32_16x16x32_bf16 v[200:203], a[120:123], v[104:107], 0
    v_max_f32 v236, 0x35c1a2a0, v236
    v_max_f32 v237, 0x35c1a2a0, v237
    v_mfma_f32_16x16x32_bf16 v[200:203], a[136:139], v[112:115], v[200:203]
    v_max_f32 v238, 0x35c1a2a0, v238
    v_max_f32 v239, 0x35c1a2a0, v239
    v_mfma_f32_16x16x32_bf16 v[76:79], a[124:127], v[108:111], v[252:255]
    v_fma_f32 v236, v236, s27, v248
    v_fma_f32 v237, v237, s27, v249
    v_mfma_f32_16x16x32_bf16 v[76:79], a[140:143], v[116:119], v[76:79]
    v_fma_f32 v238, v238, s27, v250
    v_mfma_f32_16x16x32_bf16 v[204:207], a[120:123], v[108:111], 0
    v_fma_f32 v239, v239, s27, v251
    v_cvt_pk_bf16_f32 v126, v236, v237
    v_mfma_f32_16x16x32_bf16 v[204:207], a[136:139], v[116:119], v[204:207]
    v_cvt_pk_bf16_f32 v127, v238, v239
    v_exp_f32 v248, v240 clamp
    v_mfma_f32_16x16x32_bf16 v[80:83], a[132:135], v[104:107], v[252:255]
    v_exp_f32 v249, v241 clamp
    v_exp_f32 v250, v242 clamp
    s_waitcnt lgkmcnt(12)
    v_mfma_f32_16x16x32_bf16 v[80:83], a[148:151], v[112:115], v[80:83]
    v_exp_f32 v251, v243 clamp
    v_mfma_f32_16x16x32_bf16 v[208:211], a[128:131], v[104:107], 0
    v_max_f32 v240, 0x35c1a2a0, v240
    v_max_f32 v241, 0x35c1a2a0, v241
    v_mfma_f32_16x16x32_bf16 v[208:211], a[144:147], v[112:115], v[208:211]
    v_max_f32 v242, 0x35c1a2a0, v242
    v_max_f32 v243, 0x35c1a2a0, v243
    v_mfma_f32_16x16x32_bf16 v[84:87], a[132:135], v[108:111], v[252:255]
    v_fma_f32 v240, v240, s27, v248
    v_fma_f32 v241, v241, s27, v249
    v_mfma_f32_16x16x32_bf16 v[84:87], a[148:151], v[116:119], v[84:87]
    v_fma_f32 v242, v242, s27, v250
    v_mfma_f32_16x16x32_bf16 v[212:215], a[128:131], v[108:111], 0
    v_fma_f32 v243, v243, s27, v251
    v_cvt_pk_bf16_f32 v128, v240, v241
    v_mfma_f32_16x16x32_bf16 v[212:215], a[144:147], v[116:119], v[212:215]
    v_cvt_pk_bf16_f32 v129, v242, v243
    v_exp_f32 v248, v244 clamp
    s_waitcnt lgkmcnt(10)
    v_mfma_f32_16x16x32_bf16 v[88:91], a[156:159], v[112:115], v[252:255]
    v_exp_f32 v249, v245 clamp
    v_exp_f32 v250, v246 clamp
    s_waitcnt lgkmcnt(6)
    v_mfma_f32_16x16x32_bf16 v[88:91], a[172:175], v[120:123], v[88:91]
    v_exp_f32 v251, v247 clamp
    v_mfma_f32_16x16x32_bf16 v[216:219], a[152:155], v[112:115], 0
    v_max_f32 v244, 0x35c1a2a0, v244
    v_max_f32 v245, 0x35c1a2a0, v245
    v_mfma_f32_16x16x32_bf16 v[216:219], a[168:171], v[120:123], v[216:219]
    v_max_f32 v246, 0x35c1a2a0, v246
    v_max_f32 v247, 0x35c1a2a0, v247
    v_mfma_f32_16x16x32_bf16 v[92:95], a[156:159], v[116:119], v[252:255]
    v_fma_f32 v244, v244, s27, v248
    v_fma_f32 v245, v245, s27, v249
    v_mfma_f32_16x16x32_bf16 v[92:95], a[172:175], v[124:127], v[92:95]
    v_fma_f32 v246, v246, s27, v250
    v_mfma_f32_16x16x32_bf16 v[220:223], a[152:155], v[116:119], 0
    v_fma_f32 v247, v247, s27, v251
    v_cvt_pk_bf16_f32 v132, v244, v245
    v_mfma_f32_16x16x32_bf16 v[220:223], a[168:171], v[124:127], v[220:223]
    v_cvt_pk_bf16_f32 v133, v246, v247
    v_rcp_f32 v48, v48
    v_rcp_f32 v49, v49
    v_rcp_f32 v50, v50
    v_rcp_f32 v51, v51
    v_mul_f32 v176, v176, v48
    v_mul_f32 v177, v177, v49
    v_mul_f32 v178, v178, v50
    v_mul_f32 v179, v179, v51
    v_cvt_pk_bf16_f32 v136, v176, v177
    v_cvt_pk_bf16_f32 v137, v178, v179
    v_rcp_f32 v52, v52
    v_rcp_f32 v53, v53
    v_rcp_f32 v54, v54
    v_rcp_f32 v55, v55
    v_mul_f32 v180, v180, v52
    v_mul_f32 v181, v181, v53
    v_mul_f32 v182, v182, v54
    v_mul_f32 v183, v183, v55
    v_cvt_pk_bf16_f32 v156, v180, v181
    v_cvt_pk_bf16_f32 v157, v182, v183
    v_rcp_f32 v56, v56
    v_mfma_f32_16x16x32_bf16 v[48:51], a[164:167], v[112:115], v[252:255]
    v_rcp_f32 v57, v57
    v_rcp_f32 v58, v58
    v_rcp_f32 v59, v59
    s_waitcnt lgkmcnt(4)
    v_mfma_f32_16x16x32_bf16 v[48:51], a[180:183], v[120:123], v[48:51]
    v_mul_f32 v184, v184, v56
    v_mul_f32 v185, v185, v57
    v_mfma_f32_16x16x32_bf16 v[224:227], a[160:163], v[112:115], 0
    v_mul_f32 v186, v186, v58
    v_mul_f32 v187, v187, v59
    v_cvt_pk_bf16_f32 v138, v184, v185
    v_mfma_f32_16x16x32_bf16 v[224:227], a[176:179], v[120:123], v[224:227]
    v_cvt_pk_bf16_f32 v139, v186, v187
    v_rcp_f32 v60, v60
    v_mfma_f32_16x16x32_bf16 v[52:55], a[164:167], v[116:119], v[252:255]
    v_rcp_f32 v61, v61
    v_rcp_f32 v62, v62
    v_rcp_f32 v63, v63
    v_mfma_f32_16x16x32_bf16 v[52:55], a[180:183], v[124:127], v[52:55]
    v_mul_f32 v188, v188, v60
    v_mul_f32 v189, v189, v61
    v_mfma_f32_16x16x32_bf16 v[228:231], a[160:163], v[116:119], 0
    v_mul_f32 v190, v190, v62
    v_mul_f32 v191, v191, v63
    v_cvt_pk_bf16_f32 v158, v188, v189
    v_mfma_f32_16x16x32_bf16 v[228:231], a[176:179], v[124:127], v[228:231]
    v_cvt_pk_bf16_f32 v159, v190, v191
    s_bitcmp1_b32 s63, 0
    s_cbranch_scc1 L_odd_49
    buffer_store_dwordx4 v[136:139], v18, s[20:23], s91 offen offset:0 sc1
    buffer_store_dwordx4 v[156:159], v18, s[20:23], s91 offen offset:1024 sc1
    s_branch L_join_50
L_odd_49:
    buffer_store_dwordx2 v[136:137], v19, s[20:23], s91 offen offset:512 sc1
    buffer_store_dwordx2 v[156:157], v19, s[20:23], s91 offen offset:1536 sc1
L_join_50:
    v_rcp_f32 v64, v64
    s_waitcnt lgkmcnt(2)
    v_mfma_f32_16x16x32_bf16 v[56:59], a[188:191], v[120:123], v[252:255]
    v_rcp_f32 v65, v65
    v_rcp_f32 v66, v66
    v_rcp_f32 v67, v67
    v_mfma_f32_16x16x32_bf16 v[56:59], v[36:39], v[128:131], v[56:59]
    v_mul_f32 v192, v192, v64
    v_mul_f32 v193, v193, v65
    v_mfma_f32_16x16x32_bf16 v[232:235], a[184:187], v[120:123], 0
    v_mul_f32 v194, v194, v66
    v_mul_f32 v195, v195, v67
    v_cvt_pk_bf16_f32 v140, v192, v193
    v_mfma_f32_16x16x32_bf16 v[232:235], v[32:35], v[128:131], v[232:235]
    v_cvt_pk_bf16_f32 v141, v194, v195
    v_rcp_f32 v68, v68
    v_mfma_f32_16x16x32_bf16 v[60:63], a[188:191], v[124:127], v[252:255]
    v_rcp_f32 v69, v69
    v_rcp_f32 v70, v70
    v_rcp_f32 v71, v71
    v_mfma_f32_16x16x32_bf16 v[60:63], v[36:39], v[132:135], v[60:63]
    v_mul_f32 v196, v196, v68
    v_mul_f32 v197, v197, v69
    v_mfma_f32_16x16x32_bf16 v[236:239], a[184:187], v[124:127], 0
    v_mul_f32 v198, v198, v70
    v_mul_f32 v199, v199, v71
    v_cvt_pk_bf16_f32 v160, v196, v197
    v_mfma_f32_16x16x32_bf16 v[236:239], v[32:35], v[132:135], v[236:239]
    v_cvt_pk_bf16_f32 v161, v198, v199
    v_rcp_f32 v72, v72
    s_waitcnt lgkmcnt(0)
    v_mfma_f32_16x16x32_bf16 v[64:67], a[196:199], v[120:123], v[252:255]
    v_rcp_f32 v73, v73
    v_rcp_f32 v74, v74
    v_rcp_f32 v75, v75
    v_mfma_f32_16x16x32_bf16 v[64:67], v[44:47], v[128:131], v[64:67]
    v_mul_f32 v200, v200, v72
    v_mul_f32 v201, v201, v73
    v_mfma_f32_16x16x32_bf16 v[240:243], a[192:195], v[120:123], 0
    v_mul_f32 v202, v202, v74
    v_mul_f32 v203, v203, v75
    v_cvt_pk_bf16_f32 v142, v200, v201
    v_mfma_f32_16x16x32_bf16 v[240:243], v[40:43], v[128:131], v[240:243]
    v_cvt_pk_bf16_f32 v143, v202, v203
    v_rcp_f32 v76, v76
    v_mfma_f32_16x16x32_bf16 v[68:71], a[196:199], v[124:127], v[252:255]
    v_rcp_f32 v77, v77
    v_rcp_f32 v78, v78
    v_rcp_f32 v79, v79
    v_mfma_f32_16x16x32_bf16 v[68:71], v[44:47], v[132:135], v[68:71]
    v_mul_f32 v204, v204, v76
    v_mul_f32 v205, v205, v77
    v_mfma_f32_16x16x32_bf16 v[244:247], a[192:195], v[124:127], 0
    v_mul_f32 v206, v206, v78
    v_mul_f32 v207, v207, v79
    v_cvt_pk_bf16_f32 v162, v204, v205
    v_mfma_f32_16x16x32_bf16 v[244:247], v[40:43], v[132:135], v[244:247]
    v_cvt_pk_bf16_f32 v163, v206, v207
    s_bitcmp1_b32 s63, 0
    s_cbranch_scc1 L_odd_51
    buffer_store_dwordx4 v[140:143], v18, s[20:23], s91 offen offset:2048 sc1
    buffer_store_dwordx4 v[160:163], v18, s[20:23], s91 offen offset:3072 sc1
    s_branch L_join_52
L_odd_51:
    buffer_store_dwordx4 v[138:141], v18, s[20:23], s91 offen offset:2048 sc1
    buffer_store_dwordx4 v[158:161], v18, s[20:23], s91 offen offset:3072 sc1
L_join_52:
    v_rcp_f32 v80, v80
    v_rcp_f32 v81, v81
    v_rcp_f32 v82, v82
    v_rcp_f32 v83, v83
    v_mul_f32 v208, v208, v80
    v_mul_f32 v209, v209, v81
    v_mul_f32 v210, v210, v82
    v_mul_f32 v211, v211, v83
    v_cvt_pk_bf16_f32 v144, v208, v209
    v_cvt_pk_bf16_f32 v145, v210, v211
    v_rcp_f32 v84, v84
    v_rcp_f32 v85, v85
    v_rcp_f32 v86, v86
    v_rcp_f32 v87, v87
    v_mul_f32 v212, v212, v84
    v_mul_f32 v213, v213, v85
    v_mul_f32 v214, v214, v86
    v_mul_f32 v215, v215, v87
    v_cvt_pk_bf16_f32 v164, v212, v213
    v_cvt_pk_bf16_f32 v165, v214, v215
    v_rcp_f32 v88, v88
    v_rcp_f32 v89, v89
    v_rcp_f32 v90, v90
    v_rcp_f32 v91, v91
    v_mul_f32 v216, v216, v88
    v_mul_f32 v217, v217, v89
    v_mul_f32 v218, v218, v90
    v_mul_f32 v219, v219, v91
    v_cvt_pk_bf16_f32 v146, v216, v217
    v_cvt_pk_bf16_f32 v147, v218, v219
    v_rcp_f32 v92, v92
    v_rcp_f32 v93, v93
    v_rcp_f32 v94, v94
    v_rcp_f32 v95, v95
    v_mul_f32 v220, v220, v92
    v_mul_f32 v221, v221, v93
    v_mul_f32 v222, v222, v94
    v_mul_f32 v223, v223, v95
    v_cvt_pk_bf16_f32 v166, v220, v221
    v_cvt_pk_bf16_f32 v167, v222, v223
L_pad_a3_1:
    s_cbranch_execz L_walk_ret
    s_bitcmp1_b32 s63, 0
    s_cbranch_scc1 L_odd_53
    buffer_store_dwordx4 v[144:147], v18, s[20:23], s84 offen offset:0 sc1
    buffer_store_dwordx4 v[164:167], v18, s[20:23], s84 offen offset:1024 sc1
    s_branch L_join_54
L_odd_53:
    buffer_store_dwordx4 v[142:145], v18, s[20:23], s84 offen offset:0 sc1
    buffer_store_dwordx4 v[162:165], v18, s[20:23], s84 offen offset:1024 sc1
L_join_54:
    v_rcp_f32 v48, v48
    v_rcp_f32 v49, v49
    v_rcp_f32 v50, v50
    v_rcp_f32 v51, v51
    v_mul_f32 v224, v224, v48
    v_mul_f32 v225, v225, v49
    v_mul_f32 v226, v226, v50
    v_mul_f32 v227, v227, v51
    v_cvt_pk_bf16_f32 v148, v224, v225
    v_cvt_pk_bf16_f32 v149, v226, v227
    v_rcp_f32 v52, v52
    v_rcp_f32 v53, v53
    v_rcp_f32 v54, v54
    v_rcp_f32 v55, v55
    v_mul_f32 v228, v228, v52
    v_mul_f32 v229, v229, v53
    v_mul_f32 v230, v230, v54
    v_mul_f32 v231, v231, v55
    v_cvt_pk_bf16_f32 v168, v228, v229
    v_cvt_pk_bf16_f32 v169, v230, v231
    v_rcp_f32 v56, v56
    v_rcp_f32 v57, v57
    v_rcp_f32 v58, v58
    v_rcp_f32 v59, v59
    v_mul_f32 v232, v232, v56
    v_mul_f32 v233, v233, v57
    v_mul_f32 v234, v234, v58
    v_mul_f32 v235, v235, v59
    v_cvt_pk_bf16_f32 v150, v232, v233
    v_cvt_pk_bf16_f32 v151, v234, v235
    v_rcp_f32 v60, v60
    v_rcp_f32 v61, v61
    v_rcp_f32 v62, v62
    v_rcp_f32 v63, v63
    v_mul_f32 v236, v236, v60
    v_mul_f32 v237, v237, v61
    v_mul_f32 v238, v238, v62
    v_mul_f32 v239, v239, v63
    v_cvt_pk_bf16_f32 v170, v236, v237
    v_cvt_pk_bf16_f32 v171, v238, v239
    s_bitcmp1_b32 s63, 0
    s_cbranch_scc1 L_odd_55
    buffer_store_dwordx4 v[148:151], v18, s[20:23], s84 offen offset:2048 sc1
    buffer_store_dwordx4 v[168:171], v18, s[20:23], s84 offen offset:3072 sc1
    s_branch L_join_56
L_odd_55:
    buffer_store_dwordx4 v[146:149], v18, s[20:23], s84 offen offset:2048 sc1
    buffer_store_dwordx4 v[166:169], v18, s[20:23], s84 offen offset:3072 sc1
L_join_56:
    v_rcp_f32 v64, v64
    v_rcp_f32 v65, v65
    v_rcp_f32 v66, v66
    v_rcp_f32 v67, v67
    v_mul_f32 v240, v240, v64
    v_mul_f32 v241, v241, v65
    v_mul_f32 v242, v242, v66
    v_mul_f32 v243, v243, v67
    v_cvt_pk_bf16_f32 v152, v240, v241
    v_cvt_pk_bf16_f32 v153, v242, v243
    v_rcp_f32 v68, v68
    v_rcp_f32 v69, v69
    v_rcp_f32 v70, v70
    v_rcp_f32 v71, v71
    v_mul_f32 v244, v244, v68
    v_mul_f32 v245, v245, v69
    v_mul_f32 v246, v246, v70
    v_mul_f32 v247, v247, v71
    v_cvt_pk_bf16_f32 v172, v244, v245
    v_cvt_pk_bf16_f32 v173, v246, v247
    s_bitcmp1_b32 s63, 0
    s_cbranch_scc1 L_odd_57
    buffer_store_dwordx2 v[152:153], v19, s[20:23], s85 offen offset:0 sc1
    buffer_store_dwordx2 v[172:173], v19, s[20:23], s85 offen offset:1024 sc1
    s_branch L_join_58
L_odd_57:
    buffer_store_dwordx4 v[150:153], v18, s[20:23], s85 offen offset:0 sc1
    buffer_store_dwordx4 v[170:173], v18, s[20:23], s85 offen offset:1024 sc1
L_join_58:
    s_waitcnt vmcnt(0)
    s_add_u32 s71, s66, 1
    v_mov_b32 v22, s71
    buffer_store_dword v22, off, s[20:23], s90 sc1
    s_endpgm
L_slow_40:
    s_mov_b32 s80, 40000
L_spin_42:
    buffer_load_dword v21, v20, s[36:39], 0 offen sc1
    s_waitcnt vmcnt(0)
    v_cmp_le_u32 vcc, 16, v21
    s_nop 1
    s_cmp_eq_u64 vcc, exec
    s_cbranch_scc1 L_back_41
    s_sub_u32 s80, s80, 1
    s_cmp_lg_u32 s80, 0
    s_cbranch_scc1 L_spin_42
    s_branch L_back_41
L_slow_43:
    s_mov_b32 s80, 40000
L_spin_45:
    s_add_u32 s68, s84, 0
    buffer_load_dwordx4 v[32:35], v17, s[20:23], s68 offen sc1
    s_add_u32 s68, s84, 40960
    buffer_load_dwordx4 v[36:39], v17, s[20:23], s68 offen sc1
    s_add_u32 s68, s84, 81920
    buffer_load_dwordx4 v[40:43], v17, s[20:23], s68 offen sc1
    s_add_u32 s68, s84, 122880
    buffer_load_dwordx4 v[44:47], v17, s[20:23], s68 offen sc1
    s_add_u32 s68, s84, 163840
    buffer_load_dwordx4 v[48:51], v17, s[20:23], s68 offen sc1
    s_add_u32 s68, s84, 204800
    buffer_load_dwordx4 v[52:55], v17, s[20:23], s68 offen sc1
    s_add_u32 s68, s84, 245760
    buffer_load_dwordx4 v[56:59], v17, s[20:23], s68 offen sc1
    s_add_u32 s68, s84, 286720
    buffer_load_dwordx4 v[60:63], v17, s[20:23], s68 offen sc1
    s_add_u32 s68, s84, 327680
    buffer_load_dwordx4 v[64:67], v17, s[20:23], s68 offen sc1
    s_add_u32 s68, s84, 368640
    buffer_load_dwordx4 v[68:71], v17, s[20:23], s68 offen sc1
    s_add_u32 s68, s84, 409600
    buffer_load_dwordx4 v[72:75], v17, s[20:23], s68 offen sc1
    s_add_u32 s68, s84, 450560
    buffer_load_dwordx4 v[76:79], v17, s[20:23], s68 offen sc1
    s_add_u32 s68, s84, 491520
    buffer_load_dwordx4 v[80:83], v17, s[20:23], s68 offen sc1
    s_add_u32 s68, s84, 532480
    buffer_load_dwordx4 v[84:87], v17, s[20:23], s68 offen sc1
    s_add_u32 s68, s84, 573440
    buffer_load_dwordx4 v[88:91], v17, s[20:23], s68 offen sc1
    s_add_u32 s68, s84, 614400
    buffer_load_dwordx4 v[92:95], v17, s[20:23], s68 offen sc1
    s_waitcnt vmcnt(0)
    v_add_f32 v32, v32, v36
    v_add_f32 v33, v33, v37
    v_add_f32 v34, v34, v38
    v_add_f32 v35, v35, v39
    v_add_f32 v32, v32, v40
    v_add_f32 v33, v33, v41
    v_add_f32 v34, v34, v42
    v_add_f32 v35, v35, v43
    v_add_f32 v32, v32, v44
    v_add_f32 v33, v33, v45
    v_add_f32 v34, v34, v46
    v_add_f32 v35, v35, v47
    v_add_f32 v32, v32, v48
    v_add_f32 v33, v33, v49
    v_add_f32 v34, v34, v50
    v_add_f32 v35, v35, v51
    v_add_f32 v32, v32, v52
    v_add_f32 v33, v33, v53
    v_add_f32 v34, v34, v54
    v_add_f32 v35, v35, v55
    v_add_f32 v32, v32, v56
    v_add_f32 v33, v33, v57
    v_add_f32 v34, v34, v58
    v_add_f32 v35, v35, v59
    v_add_f32 v32, v32, v60
    v_add_f32 v33, v33, v61
    v_add_f32 v34, v34, v62
    v_add_f32 v35, v35, v63
    v_add_f32 v32, v32, v64
    v_add_f32 v33, v33, v65
    v_add_f32 v34, v34, v66
    v_add_f32 v35, v35, v67
    v_add_f32 v32, v32, v68
    v_add_f32 v33, v33, v69
    v_add_f32 v34, v34, v70
    v_add_f32 v35, v35, v71
    v_add_f32 v32, v32, v72
    v_add_f32 v33, v33, v73
    v_add_f32 v34, v34, v74
    v_add_f32 v35, v35, v75
    v_add_f32 v32, v32, v76
    v_add_f32 v33, v33, v77
    v_add_f32 v34, v34, v78
    v_add_f32 v35, v35, v79
    v_add_f32 v32, v32, v80
    v_add_f32 v33, v33, v81
    v_add_f32 v34, v34, v82
    v_add_f32 v35, v35, v83
    v_add_f32 v32, v32, v84
    v_add_f32 v33, v33, v85
    v_add_f32 v34, v34, v86
    v_add_f32 v35, v35, v87
    v_add_f32 v32, v32, v88
    v_add_f32 v33, v33, v89
    v_add_f32 v34, v34, v90
    v_add_f32 v35, v35, v91
    v_add_f32 v32, v32, v92
    v_add_f32 v33, v33, v93
    v_add_f32 v34, v34, v94
    v_add_f32 v35, v35, v95
    s_nop 1
    v_add_f32 v248, v32, v33
    v_add_f32 v249, v34, v35
    v_cmp_u_f32 vcc, v248, v249
    s_nop 1
    s_cmp_lg_u64 vcc, 0
    s_cbranch_scc0 L_back_44
    s_sub_u32 s80, s80, 1
    s_cmp_lg_u32 s80, 0
    s_cbranch_scc1 L_spin_45
    s_branch L_back_44
L_slow_46:
    s_mov_b32 s80, 40000
L_spin_48:
    buffer_load_dwordx2 v[48:49], v19, s[20:23], s71 offen offset:0 sc1
    buffer_load_dwordx2 v[52:53], v19, s[20:23], s71 offen offset:512 sc1
    buffer_load_dwordx2 v[56:57], v19, s[20:23], s68 offen offset:1024 sc1
    buffer_load_dwordx2 v[60:61], v19, s[20:23], s68 offen offset:1536 sc1
    buffer_load_dwordx2 v[58:59], v19, s[20:23], s69 offen offset:0 sc1
    buffer_load_dwordx2 v[62:63], v19, s[20:23], s69 offen offset:512 sc1
    buffer_load_dwordx2 v[64:65], v19, s[20:23], s68 offen offset:2048 sc1
    buffer_load_dwordx2 v[68:69], v19, s[20:23], s68 offen offset:2560 sc1
    buffer_load_dwordx2 v[66:67], v19, s[20:23], s69 offen offset:1024 sc1
    buffer_load_dwordx2 v[70:71], v19, s[20:23], s69 offen offset:1536 sc1
    buffer_load_dwordx2 v[74:75], v19, s[20:23], s69 offen offset:2048 sc1
    buffer_load_dwordx2 v[78:79], v19, s[20:23], s69 offen offset:2560 sc1
    buffer_load_dwordx2 v[32:33], v19, s[20:23], s70 offen offset:0 sc1
    buffer_load_dwordx2 v[36:37], v19, s[20:23], s70 offen offset:512 sc1
    buffer_load_dwordx2 v[40:41], v19, s[20:23], s70 offen offset:1024 sc1
    buffer_load_dwordx2 v[44:45], v19, s[20:23], s70 offen offset:1536 sc1
    s_waitcnt vmcnt(0)
    s_nop 1
    v_max_u32 v25, v48, v49
    v_max3_u32 v25, v25, v52, v53
    v_max3_u32 v25, v25, v56, v57
    v_max3_u32 v25, v25, v60, v61
    v_max3_u32 v25, v25, v58, v59
    v_max3_u32 v25, v25, v62, v63
    v_max3_u32 v25, v25, v64, v65
    v_max3_u32 v25, v25, v68, v69
    v_max3_u32 v25, v25, v66, v67
    v_max3_u32 v25, v25, v70, v71
    v_max3_u32 v25, v25, v74, v75
    v_max3_u32 v25, v25, v78, v79
    v_max3_u32 v25, v25, v32, v33
    v_max3_u32 v25, v25, v36, v37
    v_max3_u32 v25, v25, v40, v41
    v_max3_u32 v25, v25, v44, v45
    v_cmp_eq_u32 vcc, -1, v25
    s_nop 1
    s_cmp_lg_u64 vcc, 0
    s_cbranch_scc0 L_back_47
    s_sub_u32 s80, s80, 1
    s_cmp_lg_u32 s80, 0
    s_cbranch_scc1 L_spin_48
    s_branch L_back_47
L_exit:
    s_endpgm

.section .rodata,"a"
.p2align 6
.amdhsa_kernel parallel_sum__linear_attn_block__dense_activation_squared_relu__prompt_kernel
  .amdhsa_next_free_vgpr 512
  .amdhsa_next_free_sgpr 102
  .amdhsa_accum_offset 256
  .amdhsa_group_segment_fixed_size 0
  .amdhsa_kernarg_size 88
  .amdhsa_user_sgpr_count 2
  .amdhsa_user_sgpr_kernarg_segment_ptr 1
  .amdhsa_system_sgpr_workgroup_id_x 1
  .amdhsa_float_denorm_mode_32 3
.end_amdhsa_kernel
```
